```python
import torch

def _softmax(x, axis=-1):
    return torch.softmax(x, dim=axis)
def _gelu(x):
    return torch.nn.functional.gelu(x, approximate="tanh")
def _silu(x):
    return torch.nn.functional.silu(x)
def _sigmoid(x):
    return torch.sigmoid(x)
def _layernorm(x, axis=-1, eps=1e-5):
    m = x.mean(dim=axis, keepdim=True)
    v = x.var(dim=axis, keepdim=True, unbiased=False)
    return (x - m) / torch.sqrt(v + eps)
def _scatter_add(tgt, idx, src, axis=0):
    return tgt.clone().index_add_(axis, idx, src)
def _segment_sum(src, seg, n):
    out = torch.zeros((n,) + src.shape[1:], dtype=src.dtype)
    return out.index_add_(0, seg, src)
def _pad(x, pw):
    flat = tuple(v for pair in reversed(pw) for v in pair)
    return torch.nn.functional.pad(x, flat)

kernel_name = 'parallel_sum__compressed_kv_cla__dense_activation_gelu__prompt'

def setup_inputs():

    _w = (lambda a: (lambda t: t.to(torch.bfloat16) if t.is_floating_point() else t)(torch.as_tensor(a)))
    def _A_setup():
        B, H, Sq, Sk, D, M = 1, 32, 2048, 2048, 128, 1024
        Dc = 4 * D
        return {
            "x": _w((lambda *s: torch.randn(*s, dtype=torch.bfloat16) * 0.05)(B, Sq, M)),
            "c_kv": _w((lambda *s: torch.randn(*s, dtype=torch.bfloat16) * 0.4)(B, Sk, Dc)),
            "w_q": _w((lambda *s: torch.randn(*s, dtype=torch.bfloat16) * 3.2)(M, H, D) * (M ** -0.5)),
            "w_uk": _w((lambda *s: torch.randn(*s, dtype=torch.bfloat16) * 3.2)(Dc, H, D) * (Dc ** -0.5)),
            "w_uv": _w((lambda *s: torch.randn(*s, dtype=torch.bfloat16) * 0.4)(Dc, H, D) * (Dc ** -0.5)),
            "w_o": _w((lambda *s: torch.randn(*s, dtype=torch.bfloat16) * 0.4)(H, D, M) * ((H * D) ** -0.5)),
        }
    _A_in = _A_setup()

    def _B_setup():
        B, S, D, F = 1, 2048, 1024, 3584
        return {
            "x": _w((lambda *s: torch.randn(*s, dtype=torch.bfloat16) * 0.05)(B, S, D)),
            "w1": _w((lambda *s: torch.randn(*s, dtype=torch.bfloat16) * 0.4)(D, F) * (D ** -0.5)),
            "b1": _w((lambda *s: torch.randn(*s, dtype=torch.bfloat16) * 12.8)(F) * 0.01),
            "w2": _w((lambda *s: torch.randn(*s, dtype=torch.bfloat16) * 0.2)(F, D) * (F ** -0.5)),
            "b2": _w((lambda *s: torch.randn(*s, dtype=torch.bfloat16) * 1.6)(D) * 0.01),
        }
    _B_in = _B_setup()

    return {
        "A_x": _A_in["x"],
        "A_c_kv": _A_in["c_kv"],
        "A_w_q": _A_in["w_q"],
        "A_w_uk": _A_in["w_uk"],
        "A_w_uv": _A_in["w_uv"],
        "A_w_o": _A_in["w_o"],
        "B_x": _B_in["x"],
        "B_w1": _B_in["w1"],
        "B_b1": _B_in["b1"],
        "B_w2": _B_in["w2"],
        "B_b2": _B_in["b2"],
    }

def reference(A_x, A_c_kv, A_w_q, A_w_uk, A_w_uv, A_w_o, B_x, B_w1, B_b1, B_w2, B_b2):
    def _A_ref(x, c_kv, w_q, w_uk, w_uv, w_o):
        B, Sq, M = x.shape[0], x.shape[1], x.shape[2]
        Sk = c_kv.shape[1]
        H, D = w_q.shape[1], w_q.shape[2]
        q = torch.einsum("bqm,mhd->bhqd", x, w_q)
        k = torch.einsum("bkc,chd->bhkd", c_kv, w_uk)
        v = torch.einsum("bkc,chd->bhkd", c_kv, w_uv)
        scores = torch.einsum("bhqd,bhkd->bhqk", q, k) * (D ** -0.5)
        off = Sk - Sq
        qi = torch.arange(Sq)[:, None]
        kj = torch.arange(Sk)[None, :]
        cmask = kj <= (qi + off)
        scores = torch.where(cmask[None, None], scores, -1e9)
        p = _softmax(scores, axis=-1)
        ctx = torch.einsum("bhqk,bhkd->bhqd", p, v)
        return torch.einsum("bhqd,hdm->bqm", ctx, w_o)

    def _B_ref(x, w1, b1, w2, b2):
        h = torch.einsum("bsd,df->bsf", x, w1) + b1
        h = _gelu(h)
        return torch.einsum("bsf,fd->bsd", h, w2) + b2

    x = A_x
    xn = _layernorm(x, axis=-1)
    return x + _A_ref(xn, A_c_kv, A_w_q, A_w_uk, A_w_uv, A_w_o) + _B_ref(xn, B_w1, B_b1, B_w2, B_b2)
```

```asm
; @launch kernel=mega_kernel grid=(256,1,1) block=(512,1,1) lds=163840
.amdgcn_target "amdgcn-amd-amdhsa--gfx950"
.text
.globl mega_kernel
.p2align 8
.type mega_kernel,@function
mega_kernel:
    s_cmp_ge_u32 s2, 256
    s_cbranch_scc1 L_ao_end
    s_mov_b32 s93, s2
L_pj_task:
    s_load_dwordx4 s[40:43], s[0:1], 0
    s_load_dwordx4 s[44:47], s[0:1], 24
    s_load_dwordx2 s[48:49], s[0:1], 104
    s_load_dwordx2 s[50:51], s[0:1], 16
    s_load_dwordx4 s[52:55], s[0:1], 56
    s_load_dwordx2 s[56:57], s[0:1], 40
    s_load_dwordx2 s[58:59], s[0:1], 72
    s_load_dwordx2 s[60:61], s[0:1], 96
    s_and_b32 s35, s2, 7
    s_bfe_u32 s101, s2, 0x20003
    s_lshl2_add_u32 s35, s35, s101
    s_lshr_b32 s62, s2, 5
    s_and_b32 s63, s35, 15
    s_lshr_b32 s96, s35, 4
    s_movk_i32 s29, 1024
    s_movk_i32 s30, 8192
    s_movk_i32 s33, 128
    s_mov_b32 s26, 524288
    s_mov_b32 s16, 0
    s_mov_b32 s17, 0
    v_lshrrev_b32 v16, 6, v0
    v_and_b32 v20, 63, v0
    v_readfirstlane_b32 s19, v16
    v_lshlrev_b32 v1, 4, v20
    s_nop 1
    s_lshr_b32 s27, s19, 2
    s_and_b32 s28, s19, 3
    s_and_b32 s3, s19, 3
    s_lshl_b32 s3, s3, 1
    s_mul_i32 s31, s3, 4096
    s_add_u32 s20, s31, 0
    s_mul_i32 s31, s3, 2048
    s_add_u32 s23, s31, 65536
    s_mul_i32 s31, s3, 4096
    s_add_u32 s21, s31, 32768
    s_mul_i32 s31, s3, 2048
    s_add_u32 s24, s31, 98304
    v_bfe_u32 v18, v1, 6, 2
    v_lshrrev_b32 v17, 8, v1
    v_lshl_add_u32 v17, v17, 3, v18
    v_and_b32 v16, 3, v17
    v_lshlrev_b32 v16, 2, v16
    v_bfe_u32 v19, v17, 3, 1
    v_lshl_or_b32 v16, v19, 1, v16
    v_lshlrev_b32 v17, 9, v17
    v_bfe_u32 v18, v1, 4, 1
    v_lshl_add_u32 v17, v18, 3, v17
    v_bfe_u32 v18, v1, 5, 1
    s_lshl_b32 s31, s28, 3
    s_add_u32 s31, s31, 0
    v_add_u32 v19, s31, v18
    v_xor_b32 v19, v19, v16
    v_lshl_add_u32 v19, v19, 4, v17
    v_add_u32 v12, 65536, v19
    s_lshl_b32 s31, s28, 3
    s_add_u32 s31, s31, 2
    v_add_u32 v19, s31, v18
    v_xor_b32 v19, v19, v16
    v_lshl_add_u32 v19, v19, 4, v17
    v_add_u32 v13, 65536, v19
    s_lshl_b32 s31, s28, 3
    s_add_u32 s31, s31, 4
    v_add_u32 v19, s31, v18
    v_xor_b32 v19, v19, v16
    v_lshl_add_u32 v19, v19, 4, v17
    v_add_u32 v14, 65536, v19
    s_lshl_b32 s31, s28, 3
    s_add_u32 s31, s31, 6
    v_add_u32 v19, s31, v18
    v_xor_b32 v19, v19, v16
    v_lshl_add_u32 v19, v19, 4, v17
    v_add_u32 v15, 65536, v19
    s_mul_i32 s31, s3, 32
    v_lshrrev_b32 v16, 3, v20
    v_add_u32 v16, s31, v16
    v_and_b32 v17, 7, v20
    v_add_u32 v18, 0, v16
    v_bfe_u32 v19, v18, 1, 3
    v_xor_b32 v19, v19, v17
    v_mul_lo_u32 v18, v18, s29
    v_lshl_add_u32 v18, v19, 4, v18
    v_subrev_u32 v2, 0, v18
    v_add_u32 v18, 8, v16
    v_bfe_u32 v19, v18, 1, 3
    v_xor_b32 v19, v19, v17
    v_mul_lo_u32 v18, v18, s29
    v_lshl_add_u32 v18, v19, 4, v18
    v_subrev_u32 v3, 1024, v18
    v_add_u32 v18, 16, v16
    v_bfe_u32 v19, v18, 1, 3
    v_xor_b32 v19, v19, v17
    v_mul_lo_u32 v18, v18, s29
    v_lshl_add_u32 v18, v19, 4, v18
    v_subrev_u32 v4, 2048, v18
    v_add_u32 v18, 24, v16
    v_bfe_u32 v19, v18, 1, 3
    v_xor_b32 v19, v19, v17
    v_mul_lo_u32 v18, v18, s29
    v_lshl_add_u32 v18, v19, 4, v18
    v_subrev_u32 v5, 3072, v18
    s_lshl_b32 s31, s3, 2
    s_lshl_b32 s18, s29, 5
    s_add_u32 s18, s18, s16
    s_lshl_b32 s22, s30, 5
    s_add_u32 s22, s22, s17
    v_lshrrev_b32 v16, 5, v20
    v_add_u32 v16, s31, v16
    v_and_b32 v17, 31, v20
    v_add_u32 v18, 0, v16
    v_and_b32 v19, 3, v18
    v_lshlrev_b32 v19, 2, v19
    v_bfe_u32 v21, v18, 3, 1
    v_lshl_or_b32 v19, v21, 1, v19
    v_xor_b32 v19, v19, v17
    v_mul_lo_u32 v18, v18, s30
    v_lshl_add_u32 v18, v19, 4, v18
    v_subrev_u32 v6, 0, v18
    v_add_u32 v18, 2, v16
    v_and_b32 v19, 3, v18
    v_lshlrev_b32 v19, 2, v19
    v_bfe_u32 v21, v18, 3, 1
    v_lshl_or_b32 v19, v21, 1, v19
    v_xor_b32 v19, v19, v17
    v_mul_lo_u32 v18, v18, s30
    v_lshl_add_u32 v18, v19, 4, v18
    v_subrev_u32 v7, 1024, v18
    v_add_u32 v18, 4, v16
    v_and_b32 v19, 3, v18
    v_lshlrev_b32 v19, 2, v19
    v_bfe_u32 v21, v18, 3, 1
    v_lshl_or_b32 v19, v21, 1, v19
    v_xor_b32 v19, v19, v17
    v_mul_lo_u32 v18, v18, s30
    v_lshl_add_u32 v18, v19, 4, v18
    v_subrev_u32 v8, 2048, v18
    v_add_u32 v18, 6, v16
    v_and_b32 v19, 3, v18
    v_lshlrev_b32 v19, 2, v19
    v_bfe_u32 v21, v18, 3, 1
    v_lshl_or_b32 v19, v21, 1, v19
    v_xor_b32 v19, v19, v17
    v_mul_lo_u32 v18, v18, s30
    v_lshl_add_u32 v18, v19, 4, v18
    v_subrev_u32 v9, 3072, v18
    s_mul_i32 s31, s27, 16384
    v_and_b32 v16, 15, v20
    v_bfe_u32 v17, v20, 1, 3
    v_lshrrev_b32 v18, 4, v20
    v_xor_b32 v17, v17, v18
    v_lshlrev_b32 v16, 7, v16
    v_add_u32 v16, s31, v16
    v_xor_b32 v18, 0, v17
    v_lshl_add_u32 v10, v18, 4, v16
    v_xor_b32 v18, 4, v17
    v_lshl_add_u32 v11, v18, 4, v16
    s_waitcnt lgkmcnt(0)
    s_lshl_b32 s35, s62, 18
    s_sub_u32 s101, 2097152, s35
    s_add_u32 s4, s42, s35
    s_addc_u32 s5, s43, 0
    s_mov_b32 s6, s101
    s_mov_b32 s7, 0x00020000
    s_cmp_eq_u32 s96, 0
    s_cselect_b32 s78, s44, s46
    s_cselect_b32 s79, s45, s47
    s_lshl_b32 s35, s63, 9
    s_sub_u32 s101, 4194304, s35
    s_add_u32 s8, s78, s35
    s_addc_u32 s9, s79, 0
    s_mov_b32 s10, s101
    s_mov_b32 s11, 0x00020000
    s_add_u32 s36, s40, 0
    s_addc_u32 s37, s41, 0
    s_mov_b32 s38, 4194304
    s_mov_b32 s39, 0x00020000
    s_lshl3_add_u32 s34, s2, s19
    s_and_b32 s35, s19, 3
    s_lshl2_add_u32 s35, s2, s35
    s_lshl_b32 s35, s35, 12
    v_lshlrev_b32 v21, 2, v1
    v_add_u32 v21, s35, v21
    v_mov_b32 v23, 0
    s_cmp_ge_u32 s19, 4
    s_cbranch_scc1 L_pj_startP
    s_mov_b32 m0, s23
    s_nop 0
    buffer_load_dwordx4 v6, s[8:11], s17 offen offset:0 lds
    buffer_load_dwordx4 v7, s[8:11], s17 offen offset:1024 lds
    buffer_load_dwordx4 v8, s[8:11], s17 offen offset:2048 lds
    buffer_load_dwordx4 v9, s[8:11], s17 offen offset:3072 lds
    s_add_u32 s17, s17, s26
    s_add_u32 m0, s23, 16384
    s_nop 0
    buffer_load_dwordx4 v6, s[8:11], s22 offen offset:0 lds
    buffer_load_dwordx4 v7, s[8:11], s22 offen offset:1024 lds
    buffer_load_dwordx4 v8, s[8:11], s22 offen offset:2048 lds
    buffer_load_dwordx4 v9, s[8:11], s22 offen offset:3072 lds
    s_add_u32 s22, s22, s26
    s_mov_b32 m0, s20
    s_nop 0
    buffer_load_dwordx4 v2, s[4:7], s16 offen offset:0 lds
    buffer_load_dwordx4 v3, s[4:7], s16 offen offset:1024 lds
    buffer_load_dwordx4 v4, s[4:7], s16 offen offset:2048 lds
    buffer_load_dwordx4 v5, s[4:7], s16 offen offset:3072 lds
    s_add_u32 s16, s16, s33
    s_add_u32 m0, s20, 4096
    s_nop 0
    buffer_load_dwordx4 v2, s[4:7], s18 offen offset:0 lds
    buffer_load_dwordx4 v3, s[4:7], s18 offen offset:1024 lds
    buffer_load_dwordx4 v4, s[4:7], s18 offen offset:2048 lds
    buffer_load_dwordx4 v5, s[4:7], s18 offen offset:3072 lds
    s_add_u32 s18, s18, s33
    s_mov_b32 m0, s24
    s_nop 0
    buffer_load_dwordx4 v6, s[8:11], s17 offen offset:0 lds
    buffer_load_dwordx4 v7, s[8:11], s17 offen offset:1024 lds
    buffer_load_dwordx4 v8, s[8:11], s17 offen offset:2048 lds
    buffer_load_dwordx4 v9, s[8:11], s17 offen offset:3072 lds
    s_add_u32 s17, s17, s26
    s_add_u32 m0, s24, 16384
    s_nop 0
    buffer_load_dwordx4 v6, s[8:11], s22 offen offset:0 lds
    buffer_load_dwordx4 v7, s[8:11], s22 offen offset:1024 lds
    buffer_load_dwordx4 v8, s[8:11], s22 offen offset:2048 lds
    buffer_load_dwordx4 v9, s[8:11], s22 offen offset:3072 lds
    s_add_u32 s22, s22, s26
    s_mov_b32 m0, s21
    s_nop 0
    buffer_load_dwordx4 v2, s[4:7], s16 offen offset:0 lds
    buffer_load_dwordx4 v3, s[4:7], s16 offen offset:1024 lds
    buffer_load_dwordx4 v4, s[4:7], s16 offen offset:2048 lds
    buffer_load_dwordx4 v5, s[4:7], s16 offen offset:3072 lds
    s_add_u32 s16, s16, s33
    s_add_u32 m0, s21, 4096
    s_nop 0
    buffer_load_dwordx4 v2, s[4:7], s18 offen offset:0 lds
    buffer_load_dwordx4 v3, s[4:7], s18 offen offset:1024 lds
    buffer_load_dwordx4 v4, s[4:7], s18 offen offset:2048 lds
    buffer_load_dwordx4 v5, s[4:7], s18 offen offset:3072 lds
    s_add_u32 s18, s18, s33
    s_lshl_b32 s35, s34, 11
    v_lshlrev_b32 v16, 1, v1
    buffer_load_dwordx4 v[248:251], v16, s[36:39], s35 offen
    buffer_load_dwordx4 v[252:255], v16, s[36:39], s35 offen offset:16
    s_branch L_pj_start2
L_pj_startP:
    v_mov_b32 v241, 0
    v_mov_b32 v243, 0
    s_cmp_lg_u32 s19, 7
    s_cbranch_scc1 L_non1_1
    s_memrealtime vcc
    s_add_u32 s84, s60, 0
    s_addc_u32 s85, s61, 0
    s_mov_b32 s86, 256
    s_mov_b32 s87, 0x00020000
    s_waitcnt lgkmcnt(0)
    v_mov_b32 v240, vcc_lo
    v_or_b32 v240, 1, v240
    v_mov_b32 v242, v240
    s_mov_b64 exec, 1
    buffer_atomic_cmpswap v[240:241], v243, s[84:87], 0 offen sc0 sc1
    s_mov_b64 exec, -1
L_non1_1:
    s_lshl_b32 s35, s34, 11
    v_lshlrev_b32 v16, 1, v1
    buffer_load_dwordx4 v[248:251], v16, s[36:39], s35 offen
    buffer_load_dwordx4 v[252:255], v16, s[36:39], s35 offen offset:16
    s_and_b32 s35, s19, 3
    s_lshl2_add_u32 s35, s2, s35
    s_lshl_b32 s35, s35, 10
    v_bfe_u32 v23, v1, 4, 3
    v_lshl_add_u32 v23, v23, 7, s35
    s_add_u32 s84, s44, 0
    s_addc_u32 s85, s45, 0
    s_mov_b32 s86, 4194304
    s_mov_b32 s87, 0x00020000
    s_mov_b32 s92, 1048576
    buffer_load_dword v22, v23, s[84:87], s92 offen
    s_add_u32 s84, s46, 0
    s_addc_u32 s85, s47, 0
    s_mov_b32 s86, 4194304
    s_mov_b32 s87, 0x00020000
    s_mov_b32 s92, 1048576
    buffer_load_dword v22, v23, s[84:87], s92 offen
    s_add_u32 s84, s42, 0
    s_addc_u32 s85, s43, 0
    s_mov_b32 s86, 2097152
    s_mov_b32 s87, 0x00020000
    s_mov_b32 s92, 0
    buffer_load_dword v22, v21, s[84:87], s92 offen
L_pj_start2:
    s_add_u32 s80, s48, 0
    s_addc_u32 s81, s49, 0
    s_mov_b32 s82, 4194304
    s_mov_b32 s83, 0x00020000
    s_add_u32 s88, s48, 87031808
    s_addc_u32 s89, s49, 0
    s_mov_b32 s90, 65536
    s_mov_b32 s91, 0x00020000
    s_and_b32 s35, s2, 7
    s_bfe_u32 s101, s2, 0x20003
    s_lshl2_add_u32 s97, s35, s101
    s_lshr_b32 s98, s2, 5
    s_cmp_lt_u32 s97, 28
    s_cselect_b32 s99, 1, 0
    s_movk_i32 s77, 8192
    s_movk_i32 s74, 4096
    s_mov_b32 s75, 524288
    s_mov_b32 s76, 458752
    s_mov_b32 s72, 0
    s_mov_b32 s25, 65536
    s_mov_b32 s73, 0
    s_mov_b32 s94, 0
    s_sub_u32 s35, 15, s98
    s_sub_u32 s101, s98, 1
    s_cmp_lt_u32 s3, 4
    s_cselect_b32 s35, s35, s101
    s_lshl2_add_u32 s35, s35, s3
    s_lshl_b32 s35, s35, 16
    v_add_u32 v72, s35, v1
    s_lshl_b32 s35, s27, 14
    v_lshrrev_b32 v16, 8, v1
    v_and_b32 v77, 0xf0, v1
    v_lshl_add_u32 v77, v16, 9, v77
    v_add_u32 v77, s35, v77
    s_add_u32 s64, s48, 0
    s_addc_u32 s65, s49, 0
    s_mov_b32 s66, 4194304
    s_mov_b32 s67, 0x00020000
    s_lshl_b32 s35, s97, 8
    s_sub_u32 s101, 8388608, s35
    s_add_u32 s68, s50, s35
    s_addc_u32 s69, s51, 0
    s_mov_b32 s70, s101
    s_mov_b32 s71, 0x00020000
    s_lshr_b32 s35, s28, 1
    s_lshl1_add_u32 s35, s63, s35
    s_lshl_b32 s100, s35, 19
    s_lshl_b32 s35, s62, 3
    s_lshl2_add_u32 s35, s27, s35
    s_lshl_b32 s35, s35, 13
    s_add_u32 s100, s100, s35
    s_and_b32 s35, s28, 1
    s_lshl_b32 s35, s35, 12
    s_add_u32 s100, s100, s35
    s_lshl_b32 s35, s96, 24
    s_add_u32 s35, s35, 20971520
    s_add_u32 s12, s48, s35
    s_addc_u32 s13, s49, 0
    s_mov_b32 s14, 16777216
    s_mov_b32 s15, 0x00020000
    s_cmp_ge_u32 s19, 4
    s_cbranch_scc1 L_pj_roleP
    s_mul_i32 s35, s97, s99
    s_lshl_b32 s35, s35, 8
    s_sub_u32 s101, 7340032, s35
    s_add_u32 s84, s52, s35
    s_addc_u32 s85, s53, 0
    s_mov_b32 s86, s101
    s_mov_b32 s87, 0x00020000
    s_movk_i32 s78, 7168
    s_lshl_b32 s31, s3, 3
    v_lshrrev_b32 v16, 8, v1
    v_add_u32 v16, s31, v16
    v_bfe_u32 v17, v1, 4, 4
    v_add_u32 v18, 0, v16
    v_and_b32 v19, 3, v18
    v_lshlrev_b32 v19, 2, v19
    v_bfe_u32 v73, v18, 3, 1
    v_lshl_or_b32 v19, v73, 1, v19
    v_xor_b32 v19, v19, v17
    v_mul_lo_u32 v18, v18, s77
    v_lshl_add_u32 v18, v19, 4, v18
    v_subrev_u32 v73, 0, v18
    v_add_u32 v18, 4, v16
    v_and_b32 v19, 3, v18
    v_lshlrev_b32 v19, 2, v19
    v_bfe_u32 v74, v18, 3, 1
    v_lshl_or_b32 v19, v74, 1, v19
    v_xor_b32 v19, v19, v17
    v_mul_lo_u32 v18, v18, s77
    v_lshl_add_u32 v18, v19, 4, v18
    v_subrev_u32 v74, 1024, v18
    v_add_u32 v18, 8, v16
    v_and_b32 v19, 3, v18
    v_lshlrev_b32 v19, 2, v19
    v_bfe_u32 v75, v18, 3, 1
    v_lshl_or_b32 v19, v75, 1, v19
    v_xor_b32 v19, v19, v17
    v_mul_lo_u32 v18, v18, s77
    v_lshl_add_u32 v18, v19, 4, v18
    v_subrev_u32 v75, 2048, v18
    v_add_u32 v18, 12, v16
    v_and_b32 v19, 3, v18
    v_lshlrev_b32 v19, 2, v19
    v_bfe_u32 v76, v18, 3, 1
    v_lshl_or_b32 v19, v76, 1, v19
    v_xor_b32 v19, v19, v17
    v_mul_lo_u32 v18, v18, s77
    v_lshl_add_u32 v18, v19, 4, v18
    v_subrev_u32 v76, 3072, v18
    v_add_u32 v18, 0, v16
    v_and_b32 v19, 3, v18
    v_lshlrev_b32 v19, 2, v19
    v_bfe_u32 v20, v18, 3, 1
    v_lshl_or_b32 v19, v20, 1, v19
    v_xor_b32 v19, v19, v17
    v_mul_lo_u32 v18, v18, s78
    v_lshl_add_u32 v18, v19, 4, v18
    v_subrev_u32 v20, 0, v18
    v_add_u32 v18, 4, v16
    v_and_b32 v19, 3, v18
    v_lshlrev_b32 v19, 2, v19
    v_bfe_u32 v21, v18, 3, 1
    v_lshl_or_b32 v19, v21, 1, v19
    v_xor_b32 v19, v19, v17
    v_mul_lo_u32 v18, v18, s78
    v_lshl_add_u32 v18, v19, 4, v18
    v_subrev_u32 v21, 1024, v18
    v_add_u32 v18, 8, v16
    v_and_b32 v19, 3, v18
    v_lshlrev_b32 v19, 2, v19
    v_bfe_u32 v22, v18, 3, 1
    v_lshl_or_b32 v19, v22, 1, v19
    v_xor_b32 v19, v19, v17
    v_mul_lo_u32 v18, v18, s78
    v_lshl_add_u32 v18, v19, 4, v18
    v_subrev_u32 v22, 2048, v18
    v_add_u32 v18, 12, v16
    v_and_b32 v19, 3, v18
    v_lshlrev_b32 v19, 2, v19
    v_bfe_u32 v23, v18, 3, 1
    v_lshl_or_b32 v19, v23, 1, v19
    v_xor_b32 v19, v19, v17
    v_mul_lo_u32 v18, v18, s78
    v_lshl_add_u32 v18, v19, 4, v18
    v_subrev_u32 v23, 3072, v18
    s_waitcnt vmcnt(18)
    s_barrier
    s_cmp_eq_u32 s96, 0
    s_cbranch_scc0 L_pj_VD
    ds_read_b64_tr_b16 v[40:41], v12 offset:0
    ds_read_b64_tr_b16 v[42:43], v12 offset:2048
    ds_read_b128 v[24:27], v10 offset:0
    ds_read_b128 v[28:31], v10 offset:2048
    ds_read_b128 v[32:35], v10 offset:4096
    ds_read_b128 v[36:39], v10 offset:6144
    ds_read_b64_tr_b16 v[44:45], v13 offset:0
    ds_read_b64_tr_b16 v[46:47], v13 offset:2048
    ds_read_b64_tr_b16 v[64:65], v14 offset:0
    ds_read_b64_tr_b16 v[66:67], v14 offset:2048
    ds_read_b64_tr_b16 v[68:69], v15 offset:0
    ds_read_b64_tr_b16 v[70:71], v15 offset:2048
    s_waitcnt lgkmcnt(9)
    v_mfma_f32_16x16x32_bf16 v[80:83], v[40:43], v[24:27], 0
    ds_read_b128 v[48:51], v10 offset:8192
    s_waitcnt vmcnt(0)
    v_lshlrev_b32 v208, 16, v248
    s_waitcnt lgkmcnt(9)
    v_mfma_f32_16x16x32_bf16 v[84:87], v[40:43], v[28:31], 0
    ds_read_b128 v[52:55], v10 offset:10240
    v_and_b32 v209, 0xffff0000, v248
    v_lshlrev_b32 v210, 16, v249
    s_waitcnt lgkmcnt(9)
    v_mfma_f32_16x16x32_bf16 v[112:115], v[40:43], v[32:35], 0
    ds_read_b128 v[56:59], v10 offset:12288
    v_and_b32 v211, 0xffff0000, v249
    v_lshlrev_b32 v212, 16, v250
    s_waitcnt lgkmcnt(9)
    v_mfma_f32_16x16x32_bf16 v[116:119], v[40:43], v[36:39], 0
    ds_read_b128 v[60:63], v10 offset:14336
    v_and_b32 v213, 0xffff0000, v250
    v_lshlrev_b32 v214, 16, v251
    s_waitcnt lgkmcnt(8)
    v_mfma_f32_16x16x32_bf16 v[88:91], v[44:47], v[24:27], 0
    v_and_b32 v215, 0xffff0000, v251
    v_lshlrev_b32 v216, 16, v252
    v_mfma_f32_16x16x32_bf16 v[92:95], v[44:47], v[28:31], 0
    v_and_b32 v217, 0xffff0000, v252
    v_mfma_f32_16x16x32_bf16 v[120:123], v[44:47], v[32:35], 0
    v_lshlrev_b32 v218, 16, v253
    v_and_b32 v219, 0xffff0000, v253
    v_mfma_f32_16x16x32_bf16 v[124:127], v[44:47], v[36:39], 0
    v_lshlrev_b32 v220, 16, v254
    v_and_b32 v221, 0xffff0000, v254
    s_waitcnt lgkmcnt(6)
    v_mfma_f32_16x16x32_bf16 v[96:99], v[64:67], v[24:27], 0
    v_lshlrev_b32 v222, 16, v255
    v_and_b32 v223, 0xffff0000, v255
    v_mfma_f32_16x16x32_bf16 v[100:103], v[64:67], v[28:31], 0
    v_add_f32 v224, v208, v209
    v_add_f32 v226, v210, v211
    v_mfma_f32_16x16x32_bf16 v[128:131], v[64:67], v[32:35], 0
    v_add_f32 v224, v224, v212
    v_mfma_f32_16x16x32_bf16 v[132:135], v[64:67], v[36:39], 0
    v_add_f32 v226, v226, v213
    v_add_f32 v224, v224, v214
    s_waitcnt lgkmcnt(4)
    v_mfma_f32_16x16x32_bf16 v[104:107], v[68:71], v[24:27], 0
    v_add_f32 v226, v226, v215
    v_add_f32 v224, v224, v216
    v_mfma_f32_16x16x32_bf16 v[108:111], v[68:71], v[28:31], 0
    v_add_f32 v226, v226, v217
    v_add_f32 v224, v224, v218
    v_mfma_f32_16x16x32_bf16 v[136:139], v[68:71], v[32:35], 0
    v_add_f32 v226, v226, v219
    v_add_f32 v224, v224, v220
    v_mfma_f32_16x16x32_bf16 v[140:143], v[68:71], v[36:39], 0
    v_add_f32 v226, v226, v221
    s_waitcnt lgkmcnt(3)
    v_mfma_f32_16x16x32_bf16 v[144:147], v[40:43], v[48:51], 0
    ds_read_b128 v[24:27], v11 offset:0
    v_add_f32 v224, v224, v222
    v_add_f32 v226, v226, v223
    s_waitcnt lgkmcnt(3)
    v_mfma_f32_16x16x32_bf16 v[148:151], v[40:43], v[52:55], 0
    ds_read_b128 v[28:31], v11 offset:2048
    v_add_f32 v224, v224, v226
    s_nop 1
    s_waitcnt lgkmcnt(3)
    v_mfma_f32_16x16x32_bf16 v[176:179], v[40:43], v[56:59], 0
    ds_read_b128 v[32:35], v11 offset:4096
    v_add_f32_dpp v224, v224, v224 quad_perm:[1,0,3,2] row_mask:0xf bank_mask:0xf
    s_nop 1
    s_waitcnt lgkmcnt(3)
    v_mfma_f32_16x16x32_bf16 v[180:183], v[40:43], v[60:63], 0
    ds_read_b128 v[36:39], v11 offset:6144
    ds_read_b64_tr_b16 v[40:41], v12 offset:16384
    ds_read_b64_tr_b16 v[42:43], v12 offset:18432
    v_add_f32_dpp v224, v224, v224 quad_perm:[2,3,0,1] row_mask:0xf bank_mask:0xf
    s_nop 1
    v_mfma_f32_16x16x32_bf16 v[152:155], v[44:47], v[48:51], 0
    v_add_f32_dpp v224, v224, v224 row_half_mirror row_mask:0xf bank_mask:0xf
    s_nop 1
    v_mfma_f32_16x16x32_bf16 v[156:159], v[44:47], v[52:55], 0
    v_add_f32_dpp v224, v224, v224 row_mirror row_mask:0xf bank_mask:0xf
    v_mfma_f32_16x16x32_bf16 v[184:187], v[44:47], v[56:59], 0
    v_mov_b32 v226, v224
    s_nop 1
    v_mfma_f32_16x16x32_bf16 v[188:191], v[44:47], v[60:63], 0
    ds_read_b64_tr_b16 v[44:45], v13 offset:16384
    ds_read_b64_tr_b16 v[46:47], v13 offset:18432
    v_permlane16_swap_b32 v226, v224
    v_add_f32 v224, v224, v226
    v_mfma_f32_16x16x32_bf16 v[160:163], v[64:67], v[48:51], 0
    v_mov_b32 v226, v224
    s_nop 1
    v_mfma_f32_16x16x32_bf16 v[164:167], v[64:67], v[52:55], 0
    v_permlane32_swap_b32 v226, v224
    v_add_f32 v224, v224, v226
    v_mfma_f32_16x16x32_bf16 v[192:195], v[64:67], v[56:59], 0
    v_mul_f32 v224, 0x3a800000, v224
    v_mfma_f32_16x16x32_bf16 v[196:199], v[64:67], v[60:63], 0
    ds_read_b64_tr_b16 v[64:65], v14 offset:16384
    ds_read_b64_tr_b16 v[66:67], v14 offset:18432
    v_sub_f32 v227, v208, v224
    v_mul_f32 v225, v227, v227
    v_mfma_f32_16x16x32_bf16 v[168:171], v[68:71], v[48:51], 0
    v_sub_f32 v227, v209, v224
    v_fmac_f32 v225, v227, v227
    v_mfma_f32_16x16x32_bf16 v[172:175], v[68:71], v[52:55], 0
    v_sub_f32 v227, v210, v224
    v_fmac_f32 v225, v227, v227
    v_mfma_f32_16x16x32_bf16 v[200:203], v[68:71], v[56:59], 0
    v_sub_f32 v227, v211, v224
    v_fmac_f32 v225, v227, v227
    v_mfma_f32_16x16x32_bf16 v[204:207], v[68:71], v[60:63], 0
    ds_read_b64_tr_b16 v[68:69], v15 offset:16384
    ds_read_b64_tr_b16 v[70:71], v15 offset:18432
    v_sub_f32 v227, v212, v224
    s_waitcnt lgkmcnt(6)
    v_mfma_f32_16x16x32_bf16 v[80:83], v[40:43], v[24:27], v[80:83]
    ds_read_b128 v[48:51], v11 offset:8192
    v_fmac_f32 v225, v227, v227
    v_sub_f32 v227, v213, v224
    v_mfma_f32_16x16x32_bf16 v[84:87], v[40:43], v[28:31], v[84:87]
    ds_read_b128 v[52:55], v11 offset:10240
    v_fmac_f32 v225, v227, v227
    v_sub_f32 v227, v214, v224
    v_mfma_f32_16x16x32_bf16 v[112:115], v[40:43], v[32:35], v[112:115]
    ds_read_b128 v[56:59], v11 offset:12288
    v_fmac_f32 v225, v227, v227
    v_sub_f32 v227, v215, v224
    v_mfma_f32_16x16x32_bf16 v[116:119], v[40:43], v[36:39], v[116:119]
    ds_read_b128 v[60:63], v11 offset:14336
    v_fmac_f32 v225, v227, v227
    v_sub_f32 v227, v216, v224
    s_waitcnt lgkmcnt(8)
    v_mfma_f32_16x16x32_bf16 v[88:91], v[44:47], v[24:27], v[88:91]
    v_fmac_f32 v225, v227, v227
    v_sub_f32 v227, v217, v224
    v_mfma_f32_16x16x32_bf16 v[92:95], v[44:47], v[28:31], v[92:95]
    v_fmac_f32 v225, v227, v227
    v_mfma_f32_16x16x32_bf16 v[120:123], v[44:47], v[32:35], v[120:123]
    v_sub_f32 v227, v218, v224
    v_fmac_f32 v225, v227, v227
    v_mfma_f32_16x16x32_bf16 v[124:127], v[44:47], v[36:39], v[124:127]
    v_sub_f32 v227, v219, v224
    v_fmac_f32 v225, v227, v227
    s_waitcnt lgkmcnt(6)
    v_mfma_f32_16x16x32_bf16 v[96:99], v[64:67], v[24:27], v[96:99]
    v_sub_f32 v227, v220, v224
    v_fmac_f32 v225, v227, v227
    v_mfma_f32_16x16x32_bf16 v[100:103], v[64:67], v[28:31], v[100:103]
    v_sub_f32 v227, v221, v224
    v_fmac_f32 v225, v227, v227
    v_mfma_f32_16x16x32_bf16 v[128:131], v[64:67], v[32:35], v[128:131]
    v_sub_f32 v227, v222, v224
    v_mfma_f32_16x16x32_bf16 v[132:135], v[64:67], v[36:39], v[132:135]
    v_fmac_f32 v225, v227, v227
    v_sub_f32 v227, v223, v224
    s_waitcnt lgkmcnt(4)
    v_mfma_f32_16x16x32_bf16 v[104:107], v[68:71], v[24:27], v[104:107]
    v_fmac_f32 v225, v227, v227
    s_nop 1
    v_mfma_f32_16x16x32_bf16 v[108:111], v[68:71], v[28:31], v[108:111]
    v_add_f32_dpp v225, v225, v225 quad_perm:[1,0,3,2] row_mask:0xf bank_mask:0xf
    s_nop 1
    v_mfma_f32_16x16x32_bf16 v[136:139], v[68:71], v[32:35], v[136:139]
    v_add_f32_dpp v225, v225, v225 quad_perm:[2,3,0,1] row_mask:0xf bank_mask:0xf
    s_nop 1
    v_mfma_f32_16x16x32_bf16 v[140:143], v[68:71], v[36:39], v[140:143]
    v_add_f32_dpp v225, v225, v225 row_half_mirror row_mask:0xf bank_mask:0xf
    s_waitcnt lgkmcnt(0)
    s_barrier
    v_mfma_f32_16x16x32_bf16 v[144:147], v[40:43], v[48:51], v[144:147]
    ds_read_b128 v[24:27], v10 offset:32768
    s_mov_b32 m0, s23
    s_nop 0
    buffer_load_dwordx4 v6, s[8:11], s17 offen offset:0 lds
    v_mfma_f32_16x16x32_bf16 v[148:151], v[40:43], v[52:55], v[148:151]
    ds_read_b128 v[28:31], v10 offset:34816
    v_mfma_f32_16x16x32_bf16 v[176:179], v[40:43], v[56:59], v[176:179]
    ds_read_b128 v[32:35], v10 offset:36864
    buffer_load_dwordx4 v7, s[8:11], s17 offen offset:1024 lds
    v_mfma_f32_16x16x32_bf16 v[180:183], v[40:43], v[60:63], v[180:183]
    ds_read_b128 v[36:39], v10 offset:38912
    ds_read_b64_tr_b16 v[40:41], v12 offset:32768
    ds_read_b64_tr_b16 v[42:43], v12 offset:34816
    v_mfma_f32_16x16x32_bf16 v[152:155], v[44:47], v[48:51], v[152:155]
    buffer_load_dwordx4 v8, s[8:11], s17 offen offset:2048 lds
    v_mfma_f32_16x16x32_bf16 v[156:159], v[44:47], v[52:55], v[156:159]
    v_mfma_f32_16x16x32_bf16 v[184:187], v[44:47], v[56:59], v[184:187]
    buffer_load_dwordx4 v9, s[8:11], s17 offen offset:3072 lds
    s_add_u32 s17, s17, s26
    v_mfma_f32_16x16x32_bf16 v[188:191], v[44:47], v[60:63], v[188:191]
    ds_read_b64_tr_b16 v[44:45], v13 offset:32768
    ds_read_b64_tr_b16 v[46:47], v13 offset:34816
    v_mfma_f32_16x16x32_bf16 v[160:163], v[64:67], v[48:51], v[160:163]
    s_add_u32 m0, s23, 16384
    s_nop 0
    buffer_load_dwordx4 v6, s[8:11], s22 offen offset:0 lds
    v_mfma_f32_16x16x32_bf16 v[164:167], v[64:67], v[52:55], v[164:167]
    v_mfma_f32_16x16x32_bf16 v[192:195], v[64:67], v[56:59], v[192:195]
    buffer_load_dwordx4 v7, s[8:11], s22 offen offset:1024 lds
    v_mfma_f32_16x16x32_bf16 v[196:199], v[64:67], v[60:63], v[196:199]
    ds_read_b64_tr_b16 v[64:65], v14 offset:32768
    ds_read_b64_tr_b16 v[66:67], v14 offset:34816
    v_mfma_f32_16x16x32_bf16 v[168:171], v[68:71], v[48:51], v[168:171]
    buffer_load_dwordx4 v8, s[8:11], s22 offen offset:2048 lds
    v_mfma_f32_16x16x32_bf16 v[172:175], v[68:71], v[52:55], v[172:175]
    v_mfma_f32_16x16x32_bf16 v[200:203], v[68:71], v[56:59], v[200:203]
    buffer_load_dwordx4 v9, s[8:11], s22 offen offset:3072 lds
    s_add_u32 s22, s22, s26
    v_mfma_f32_16x16x32_bf16 v[204:207], v[68:71], v[60:63], v[204:207]
    ds_read_b64_tr_b16 v[68:69], v15 offset:32768
    ds_read_b64_tr_b16 v[70:71], v15 offset:34816
    s_waitcnt lgkmcnt(6)
    v_mfma_f32_16x16x32_bf16 v[80:83], v[40:43], v[24:27], v[80:83]
    ds_read_b128 v[48:51], v10 offset:40960
    s_mov_b32 m0, s20
    s_nop 0
    buffer_load_dwordx4 v2, s[4:7], s16 offen offset:0 lds
    buffer_load_dwordx4 v3, s[4:7], s16 offen offset:1024 lds
    buffer_load_dwordx4 v4, s[4:7], s16 offen offset:2048 lds
    v_mfma_f32_16x16x32_bf16 v[84:87], v[40:43], v[28:31], v[84:87]
    ds_read_b128 v[52:55], v10 offset:43008
    buffer_load_dwordx4 v5, s[4:7], s16 offen offset:3072 lds
    s_add_u32 s16, s16, s33
    s_add_u32 m0, s20, 4096
    s_nop 0
    buffer_load_dwordx4 v2, s[4:7], s18 offen offset:0 lds
    v_mfma_f32_16x16x32_bf16 v[112:115], v[40:43], v[32:35], v[112:115]
    ds_read_b128 v[56:59], v10 offset:45056
    buffer_load_dwordx4 v3, s[4:7], s18 offen offset:1024 lds
    buffer_load_dwordx4 v4, s[4:7], s18 offen offset:2048 lds
    v_mfma_f32_16x16x32_bf16 v[116:119], v[40:43], v[36:39], v[116:119]
    ds_read_b128 v[60:63], v10 offset:47104
    buffer_load_dwordx4 v5, s[4:7], s18 offen offset:3072 lds
    s_add_u32 s18, s18, s33
    s_nop 1
    v_add_f32_dpp v225, v225, v225 row_mirror row_mask:0xf bank_mask:0xf
    s_waitcnt lgkmcnt(8)
    v_mfma_f32_16x16x32_bf16 v[88:91], v[44:47], v[24:27], v[88:91]
    v_mov_b32 v226, v225
    s_nop 1
    v_mfma_f32_16x16x32_bf16 v[92:95], v[44:47], v[28:31], v[92:95]
    v_permlane16_swap_b32 v226, v225
    v_add_f32 v225, v225, v226
    v_mfma_f32_16x16x32_bf16 v[120:123], v[44:47], v[32:35], v[120:123]
    v_mov_b32 v226, v225
    s_nop 1
    v_permlane32_swap_b32 v226, v225
    v_mfma_f32_16x16x32_bf16 v[124:127], v[44:47], v[36:39], v[124:127]
    v_add_f32 v225, v225, v226
    v_mul_f32 v225, 0x3a800000, v225
    s_waitcnt lgkmcnt(6)
    v_mfma_f32_16x16x32_bf16 v[96:99], v[64:67], v[24:27], v[96:99]
    v_cvt_pk_bf16_f32 v224, v224, v224
    v_lshlrev_b32 v224, 16, v224
    v_mfma_f32_16x16x32_bf16 v[100:103], v[64:67], v[28:31], v[100:103]
    v_cvt_pk_bf16_f32 v225, v225, v225
    v_lshlrev_b32 v225, 16, v225
    v_add_f32 v225, 0x3727c5ac, v225
    v_mfma_f32_16x16x32_bf16 v[128:131], v[64:67], v[32:35], v[128:131]
    v_cvt_pk_bf16_f32 v225, v225, v225
    v_lshlrev_b32 v225, 16, v225
    v_mfma_f32_16x16x32_bf16 v[132:135], v[64:67], v[36:39], v[132:135]
    v_sqrt_f32 v225, v225
    s_nop 0
    s_waitcnt lgkmcnt(4)
    v_mfma_f32_16x16x32_bf16 v[104:107], v[68:71], v[24:27], v[104:107]
    v_cvt_pk_bf16_f32 v225, v225, v225
    v_lshlrev_b32 v225, 16, v225
    v_rcp_f32 v225, v225
    v_mfma_f32_16x16x32_bf16 v[108:111], v[68:71], v[28:31], v[108:111]
    v_sub_f32 v208, v208, v224
    v_sub_f32 v209, v209, v224
    v_mfma_f32_16x16x32_bf16 v[136:139], v[68:71], v[32:35], v[136:139]
    v_sub_f32 v210, v210, v224
    v_sub_f32 v211, v211, v224
    v_mfma_f32_16x16x32_bf16 v[140:143], v[68:71], v[36:39], v[140:143]
    v_sub_f32 v212, v212, v224
    v_sub_f32 v213, v213, v224
    s_waitcnt lgkmcnt(3)
    v_mfma_f32_16x16x32_bf16 v[144:147], v[40:43], v[48:51], v[144:147]
    ds_read_b128 v[24:27], v11 offset:32768
    v_sub_f32 v214, v214, v224
    v_sub_f32 v215, v215, v224
    s_waitcnt lgkmcnt(3)
    v_mfma_f32_16x16x32_bf16 v[148:151], v[40:43], v[52:55], v[148:151]
    ds_read_b128 v[28:31], v11 offset:34816
    v_sub_f32 v216, v216, v224
    v_sub_f32 v217, v217, v224
    s_waitcnt lgkmcnt(3)
    v_mfma_f32_16x16x32_bf16 v[176:179], v[40:43], v[56:59], v[176:179]
    ds_read_b128 v[32:35], v11 offset:36864
    v_sub_f32 v218, v218, v224
    v_sub_f32 v219, v219, v224
    s_waitcnt lgkmcnt(3)
    v_mfma_f32_16x16x32_bf16 v[180:183], v[40:43], v[60:63], v[180:183]
    ds_read_b128 v[36:39], v11 offset:38912
    ds_read_b64_tr_b16 v[40:41], v12 offset:49152
    ds_read_b64_tr_b16 v[42:43], v12 offset:51200
    v_sub_f32 v220, v220, v224
    v_sub_f32 v221, v221, v224
    v_mfma_f32_16x16x32_bf16 v[152:155], v[44:47], v[48:51], v[152:155]
    v_sub_f32 v222, v222, v224
    v_sub_f32 v223, v223, v224
    v_mfma_f32_16x16x32_bf16 v[156:159], v[44:47], v[52:55], v[156:159]
    v_cvt_pk_bf16_f32 v248, v208, v209
    v_mfma_f32_16x16x32_bf16 v[184:187], v[44:47], v[56:59], v[184:187]
    v_cvt_pk_bf16_f32 v249, v210, v211
    v_cvt_pk_bf16_f32 v250, v212, v213
    v_mfma_f32_16x16x32_bf16 v[188:191], v[44:47], v[60:63], v[188:191]
    ds_read_b64_tr_b16 v[44:45], v13 offset:49152
    ds_read_b64_tr_b16 v[46:47], v13 offset:51200
    v_cvt_pk_bf16_f32 v251, v214, v215
    v_cvt_pk_bf16_f32 v252, v216, v217
    v_mfma_f32_16x16x32_bf16 v[160:163], v[64:67], v[48:51], v[160:163]
    v_cvt_pk_bf16_f32 v253, v218, v219
    v_cvt_pk_bf16_f32 v254, v220, v221
    v_mfma_f32_16x16x32_bf16 v[164:167], v[64:67], v[52:55], v[164:167]
    v_cvt_pk_bf16_f32 v255, v222, v223
    v_lshlrev_b32 v208, 16, v248
    v_mfma_f32_16x16x32_bf16 v[192:195], v[64:67], v[56:59], v[192:195]
    v_and_b32 v209, 0xffff0000, v248
    v_mfma_f32_16x16x32_bf16 v[196:199], v[64:67], v[60:63], v[196:199]
    ds_read_b64_tr_b16 v[64:65], v14 offset:49152
    ds_read_b64_tr_b16 v[66:67], v14 offset:51200
    v_lshlrev_b32 v210, 16, v249
    v_and_b32 v211, 0xffff0000, v249
    v_mfma_f32_16x16x32_bf16 v[168:171], v[68:71], v[48:51], v[168:171]
    v_lshlrev_b32 v212, 16, v250
    v_and_b32 v213, 0xffff0000, v250
    v_mfma_f32_16x16x32_bf16 v[172:175], v[68:71], v[52:55], v[172:175]
    v_lshlrev_b32 v214, 16, v251
    v_and_b32 v215, 0xffff0000, v251
    v_mfma_f32_16x16x32_bf16 v[200:203], v[68:71], v[56:59], v[200:203]
    v_lshlrev_b32 v216, 16, v252
    v_and_b32 v217, 0xffff0000, v252
    v_mfma_f32_16x16x32_bf16 v[204:207], v[68:71], v[60:63], v[204:207]
    ds_read_b64_tr_b16 v[68:69], v15 offset:49152
    ds_read_b64_tr_b16 v[70:71], v15 offset:51200
    v_lshlrev_b32 v218, 16, v253
    s_waitcnt lgkmcnt(6)
    v_mfma_f32_16x16x32_bf16 v[80:83], v[40:43], v[24:27], v[80:83]
    ds_read_b128 v[48:51], v11 offset:40960
    v_and_b32 v219, 0xffff0000, v253
    v_lshlrev_b32 v220, 16, v254
    v_mfma_f32_16x16x32_bf16 v[84:87], v[40:43], v[28:31], v[84:87]
    ds_read_b128 v[52:55], v11 offset:43008
    v_and_b32 v221, 0xffff0000, v254
    v_lshlrev_b32 v222, 16, v255
    v_mfma_f32_16x16x32_bf16 v[112:115], v[40:43], v[32:35], v[112:115]
    ds_read_b128 v[56:59], v11 offset:45056
    v_and_b32 v223, 0xffff0000, v255
    v_mul_f32 v208, v208, v225
    v_mfma_f32_16x16x32_bf16 v[116:119], v[40:43], v[36:39], v[116:119]
    ds_read_b128 v[60:63], v11 offset:47104
    v_mul_f32 v209, v209, v225
    v_mul_f32 v210, v210, v225
    s_waitcnt lgkmcnt(8)
    v_mfma_f32_16x16x32_bf16 v[88:91], v[44:47], v[24:27], v[88:91]
    v_mul_f32 v211, v211, v225
    v_mul_f32 v212, v212, v225
    v_mfma_f32_16x16x32_bf16 v[92:95], v[44:47], v[28:31], v[92:95]
    v_mul_f32 v213, v213, v225
    v_mul_f32 v214, v214, v225
    v_mfma_f32_16x16x32_bf16 v[120:123], v[44:47], v[32:35], v[120:123]
    v_mul_f32 v215, v215, v225
    v_mul_f32 v216, v216, v225
    v_mfma_f32_16x16x32_bf16 v[124:127], v[44:47], v[36:39], v[124:127]
    v_mul_f32 v217, v217, v225
    s_waitcnt lgkmcnt(6)
    v_mfma_f32_16x16x32_bf16 v[96:99], v[64:67], v[24:27], v[96:99]
    v_mul_f32 v218, v218, v225
    v_mul_f32 v219, v219, v225
    v_mfma_f32_16x16x32_bf16 v[100:103], v[64:67], v[28:31], v[100:103]
    v_mul_f32 v220, v220, v225
    v_mul_f32 v221, v221, v225
    v_mfma_f32_16x16x32_bf16 v[128:131], v[64:67], v[32:35], v[128:131]
    v_mul_f32 v222, v222, v225
    v_mul_f32 v223, v223, v225
    v_mfma_f32_16x16x32_bf16 v[132:135], v[64:67], v[36:39], v[132:135]
    v_cvt_pk_bf16_f32 v248, v208, v209
    v_cvt_pk_bf16_f32 v249, v210, v211
    s_waitcnt lgkmcnt(4)
    v_mfma_f32_16x16x32_bf16 v[104:107], v[68:71], v[24:27], v[104:107]
    v_cvt_pk_bf16_f32 v250, v212, v213
    v_cvt_pk_bf16_f32 v251, v214, v215
    v_mfma_f32_16x16x32_bf16 v[108:111], v[68:71], v[28:31], v[108:111]
    v_cvt_pk_bf16_f32 v252, v216, v217
    v_cvt_pk_bf16_f32 v253, v218, v219
    v_mfma_f32_16x16x32_bf16 v[136:139], v[68:71], v[32:35], v[136:139]
    v_cvt_pk_bf16_f32 v254, v220, v221
    v_cvt_pk_bf16_f32 v255, v222, v223
    v_mfma_f32_16x16x32_bf16 v[140:143], v[68:71], v[36:39], v[140:143]
    s_lshl_b32 s35, s19, 4
    s_add_u32 s35, s35, 131072
    v_lshl_add_u32 v228, v1, 4, s35
    ds_write_b128 v228, v[248:251]
    ds_write_b128 v228, v[252:255] offset:128
    s_waitcnt lgkmcnt(0) vmcnt(0)
    s_barrier
    v_mfma_f32_16x16x32_bf16 v[144:147], v[40:43], v[48:51], v[144:147]
    ds_read_b128 v[24:27], v10 offset:0
    s_mov_b32 m0, s24
    s_nop 0
    buffer_load_dwordx4 v6, s[8:11], s17 offen offset:0 lds
    v_mfma_f32_16x16x32_bf16 v[148:151], v[40:43], v[52:55], v[148:151]
    ds_read_b128 v[28:31], v10 offset:2048
    v_mfma_f32_16x16x32_bf16 v[176:179], v[40:43], v[56:59], v[176:179]
    ds_read_b128 v[32:35], v10 offset:4096
    buffer_load_dwordx4 v7, s[8:11], s17 offen offset:1024 lds
    v_mfma_f32_16x16x32_bf16 v[180:183], v[40:43], v[60:63], v[180:183]
    ds_read_b128 v[36:39], v10 offset:6144
    ds_read_b64_tr_b16 v[40:41], v12 offset:0
    ds_read_b64_tr_b16 v[42:43], v12 offset:2048
    v_mfma_f32_16x16x32_bf16 v[152:155], v[44:47], v[48:51], v[152:155]
    buffer_load_dwordx4 v8, s[8:11], s17 offen offset:2048 lds
    v_mfma_f32_16x16x32_bf16 v[156:159], v[44:47], v[52:55], v[156:159]
    v_mfma_f32_16x16x32_bf16 v[184:187], v[44:47], v[56:59], v[184:187]
    buffer_load_dwordx4 v9, s[8:11], s17 offen offset:3072 lds
    s_add_u32 s17, s17, s26
    v_mfma_f32_16x16x32_bf16 v[188:191], v[44:47], v[60:63], v[188:191]
    ds_read_b64_tr_b16 v[44:45], v13 offset:0
    ds_read_b64_tr_b16 v[46:47], v13 offset:2048
    v_mfma_f32_16x16x32_bf16 v[160:163], v[64:67], v[48:51], v[160:163]
    s_add_u32 m0, s24, 16384
    s_nop 0
    buffer_load_dwordx4 v6, s[8:11], s22 offen offset:0 lds
    v_mfma_f32_16x16x32_bf16 v[164:167], v[64:67], v[52:55], v[164:167]
    v_mfma_f32_16x16x32_bf16 v[192:195], v[64:67], v[56:59], v[192:195]
    buffer_load_dwordx4 v7, s[8:11], s22 offen offset:1024 lds
    v_mfma_f32_16x16x32_bf16 v[196:199], v[64:67], v[60:63], v[196:199]
    ds_read_b64_tr_b16 v[64:65], v14 offset:0
    ds_read_b64_tr_b16 v[66:67], v14 offset:2048
    v_mfma_f32_16x16x32_bf16 v[168:171], v[68:71], v[48:51], v[168:171]
    buffer_load_dwordx4 v8, s[8:11], s22 offen offset:2048 lds
    v_mfma_f32_16x16x32_bf16 v[172:175], v[68:71], v[52:55], v[172:175]
    v_mfma_f32_16x16x32_bf16 v[200:203], v[68:71], v[56:59], v[200:203]
    buffer_load_dwordx4 v9, s[8:11], s22 offen offset:3072 lds
    s_add_u32 s22, s22, s26
    v_mfma_f32_16x16x32_bf16 v[204:207], v[68:71], v[60:63], v[204:207]
    ds_read_b64_tr_b16 v[68:69], v15 offset:0
    ds_read_b64_tr_b16 v[70:71], v15 offset:2048
    s_waitcnt lgkmcnt(6)
    v_mfma_f32_16x16x32_bf16 v[80:83], v[40:43], v[24:27], v[80:83]
    ds_read_b128 v[48:51], v10 offset:8192
    s_mov_b32 m0, s21
    s_nop 0
    buffer_load_dwordx4 v2, s[4:7], s16 offen offset:0 lds
    v_mfma_f32_16x16x32_bf16 v[84:87], v[40:43], v[28:31], v[84:87]
    ds_read_b128 v[52:55], v10 offset:10240
    v_mfma_f32_16x16x32_bf16 v[112:115], v[40:43], v[32:35], v[112:115]
    ds_read_b128 v[56:59], v10 offset:12288
    buffer_load_dwordx4 v3, s[4:7], s16 offen offset:1024 lds
    v_mfma_f32_16x16x32_bf16 v[116:119], v[40:43], v[36:39], v[116:119]
    ds_read_b128 v[60:63], v10 offset:14336
    s_waitcnt lgkmcnt(8)
    v_mfma_f32_16x16x32_bf16 v[88:91], v[44:47], v[24:27], v[88:91]
    buffer_load_dwordx4 v4, s[4:7], s16 offen offset:2048 lds
    v_mfma_f32_16x16x32_bf16 v[92:95], v[44:47], v[28:31], v[92:95]
    v_mfma_f32_16x16x32_bf16 v[120:123], v[44:47], v[32:35], v[120:123]
    buffer_load_dwordx4 v5, s[4:7], s16 offen offset:3072 lds
    s_add_u32 s16, s16, s33
    v_mfma_f32_16x16x32_bf16 v[124:127], v[44:47], v[36:39], v[124:127]
    s_waitcnt lgkmcnt(6)
    v_mfma_f32_16x16x32_bf16 v[96:99], v[64:67], v[24:27], v[96:99]
    s_add_u32 m0, s21, 4096
    s_nop 0
    buffer_load_dwordx4 v2, s[4:7], s18 offen offset:0 lds
    v_mfma_f32_16x16x32_bf16 v[100:103], v[64:67], v[28:31], v[100:103]
    v_mfma_f32_16x16x32_bf16 v[128:131], v[64:67], v[32:35], v[128:131]
    buffer_load_dwordx4 v3, s[4:7], s18 offen offset:1024 lds
    v_mfma_f32_16x16x32_bf16 v[132:135], v[64:67], v[36:39], v[132:135]
    s_waitcnt lgkmcnt(4)
    v_mfma_f32_16x16x32_bf16 v[104:107], v[68:71], v[24:27], v[104:107]
    buffer_load_dwordx4 v4, s[4:7], s18 offen offset:2048 lds
    v_mfma_f32_16x16x32_bf16 v[108:111], v[68:71], v[28:31], v[108:111]
    v_mfma_f32_16x16x32_bf16 v[136:139], v[68:71], v[32:35], v[136:139]
    buffer_load_dwordx4 v5, s[4:7], s18 offen offset:3072 lds
    s_add_u32 s18, s18, s33
    v_mfma_f32_16x16x32_bf16 v[140:143], v[68:71], v[36:39], v[140:143]
    s_waitcnt lgkmcnt(3)
    v_mfma_f32_16x16x32_bf16 v[144:147], v[40:43], v[48:51], v[144:147]
    ds_read_b128 v[24:27], v11 offset:0
    s_waitcnt lgkmcnt(3)
    v_mfma_f32_16x16x32_bf16 v[148:151], v[40:43], v[52:55], v[148:151]
    ds_read_b128 v[28:31], v11 offset:2048
    s_waitcnt lgkmcnt(3)
    v_mfma_f32_16x16x32_bf16 v[176:179], v[40:43], v[56:59], v[176:179]
    ds_read_b128 v[32:35], v11 offset:4096
    s_waitcnt lgkmcnt(3)
    v_mfma_f32_16x16x32_bf16 v[180:183], v[40:43], v[60:63], v[180:183]
    ds_read_b128 v[36:39], v11 offset:6144
    ds_read_b64_tr_b16 v[40:41], v12 offset:16384
    ds_read_b64_tr_b16 v[42:43], v12 offset:18432
    v_mfma_f32_16x16x32_bf16 v[152:155], v[44:47], v[48:51], v[152:155]
    v_mfma_f32_16x16x32_bf16 v[156:159], v[44:47], v[52:55], v[156:159]
    v_mfma_f32_16x16x32_bf16 v[184:187], v[44:47], v[56:59], v[184:187]
    v_mfma_f32_16x16x32_bf16 v[188:191], v[44:47], v[60:63], v[188:191]
    ds_read_b64_tr_b16 v[44:45], v13 offset:16384
    ds_read_b64_tr_b16 v[46:47], v13 offset:18432
    v_mfma_f32_16x16x32_bf16 v[160:163], v[64:67], v[48:51], v[160:163]
    v_mfma_f32_16x16x32_bf16 v[164:167], v[64:67], v[52:55], v[164:167]
    v_mfma_f32_16x16x32_bf16 v[192:195], v[64:67], v[56:59], v[192:195]
    v_mfma_f32_16x16x32_bf16 v[196:199], v[64:67], v[60:63], v[196:199]
    ds_read_b64_tr_b16 v[64:65], v14 offset:16384
    ds_read_b64_tr_b16 v[66:67], v14 offset:18432
    v_mfma_f32_16x16x32_bf16 v[168:171], v[68:71], v[48:51], v[168:171]
    v_mfma_f32_16x16x32_bf16 v[172:175], v[68:71], v[52:55], v[172:175]
    v_mfma_f32_16x16x32_bf16 v[200:203], v[68:71], v[56:59], v[200:203]
    v_mfma_f32_16x16x32_bf16 v[204:207], v[68:71], v[60:63], v[204:207]
    ds_read_b64_tr_b16 v[68:69], v15 offset:16384
    ds_read_b64_tr_b16 v[70:71], v15 offset:18432
    s_waitcnt lgkmcnt(6)
    v_mfma_f32_16x16x32_bf16 v[80:83], v[40:43], v[24:27], v[80:83]
    ds_read_b128 v[48:51], v11 offset:8192
    v_mfma_f32_16x16x32_bf16 v[84:87], v[40:43], v[28:31], v[84:87]
    ds_read_b128 v[52:55], v11 offset:10240
    v_mfma_f32_16x16x32_bf16 v[112:115], v[40:43], v[32:35], v[112:115]
    ds_read_b128 v[56:59], v11 offset:12288
    v_mfma_f32_16x16x32_bf16 v[116:119], v[40:43], v[36:39], v[116:119]
    ds_read_b128 v[60:63], v11 offset:14336
    s_waitcnt lgkmcnt(8)
    v_mfma_f32_16x16x32_bf16 v[88:91], v[44:47], v[24:27], v[88:91]
    v_mfma_f32_16x16x32_bf16 v[92:95], v[44:47], v[28:31], v[92:95]
    v_mfma_f32_16x16x32_bf16 v[120:123], v[44:47], v[32:35], v[120:123]
    v_mfma_f32_16x16x32_bf16 v[124:127], v[44:47], v[36:39], v[124:127]
    s_waitcnt lgkmcnt(6)
    v_mfma_f32_16x16x32_bf16 v[96:99], v[64:67], v[24:27], v[96:99]
    v_mfma_f32_16x16x32_bf16 v[100:103], v[64:67], v[28:31], v[100:103]
    v_mfma_f32_16x16x32_bf16 v[128:131], v[64:67], v[32:35], v[128:131]
    v_mfma_f32_16x16x32_bf16 v[132:135], v[64:67], v[36:39], v[132:135]
    s_waitcnt lgkmcnt(4)
    v_mfma_f32_16x16x32_bf16 v[104:107], v[68:71], v[24:27], v[104:107]
    v_mfma_f32_16x16x32_bf16 v[108:111], v[68:71], v[28:31], v[108:111]
    v_mfma_f32_16x16x32_bf16 v[136:139], v[68:71], v[32:35], v[136:139]
    v_mfma_f32_16x16x32_bf16 v[140:143], v[68:71], v[36:39], v[140:143]
    s_waitcnt lgkmcnt(0) vmcnt(0)
    s_barrier
    v_mfma_f32_16x16x32_bf16 v[144:147], v[40:43], v[48:51], v[144:147]
    ds_read_b128 v[24:27], v10 offset:32768
    s_mov_b32 m0, s23
    s_nop 0
    buffer_load_dwordx4 v6, s[8:11], s17 offen offset:0 lds
    v_mfma_f32_16x16x32_bf16 v[148:151], v[40:43], v[52:55], v[148:151]
    ds_read_b128 v[28:31], v10 offset:34816
    v_mfma_f32_16x16x32_bf16 v[176:179], v[40:43], v[56:59], v[176:179]
    ds_read_b128 v[32:35], v10 offset:36864
    buffer_load_dwordx4 v7, s[8:11], s17 offen offset:1024 lds
    v_mfma_f32_16x16x32_bf16 v[180:183], v[40:43], v[60:63], v[180:183]
    ds_read_b128 v[36:39], v10 offset:38912
    ds_read_b64_tr_b16 v[40:41], v12 offset:32768
    ds_read_b64_tr_b16 v[42:43], v12 offset:34816
    v_mfma_f32_16x16x32_bf16 v[152:155], v[44:47], v[48:51], v[152:155]
    buffer_load_dwordx4 v8, s[8:11], s17 offen offset:2048 lds
    v_mfma_f32_16x16x32_bf16 v[156:159], v[44:47], v[52:55], v[156:159]
    v_mfma_f32_16x16x32_bf16 v[184:187], v[44:47], v[56:59], v[184:187]
    buffer_load_dwordx4 v9, s[8:11], s17 offen offset:3072 lds
    s_add_u32 s17, s17, s26
    v_mfma_f32_16x16x32_bf16 v[188:191], v[44:47], v[60:63], v[188:191]
    ds_read_b64_tr_b16 v[44:45], v13 offset:32768
    ds_read_b64_tr_b16 v[46:47], v13 offset:34816
    v_mfma_f32_16x16x32_bf16 v[160:163], v[64:67], v[48:51], v[160:163]
    s_add_u32 m0, s23, 16384
    s_nop 0
    buffer_load_dwordx4 v6, s[8:11], s22 offen offset:0 lds
    v_mfma_f32_16x16x32_bf16 v[164:167], v[64:67], v[52:55], v[164:167]
    v_mfma_f32_16x16x32_bf16 v[192:195], v[64:67], v[56:59], v[192:195]
    buffer_load_dwordx4 v7, s[8:11], s22 offen offset:1024 lds
    v_mfma_f32_16x16x32_bf16 v[196:199], v[64:67], v[60:63], v[196:199]
    ds_read_b64_tr_b16 v[64:65], v14 offset:32768
    ds_read_b64_tr_b16 v[66:67], v14 offset:34816
    v_mfma_f32_16x16x32_bf16 v[168:171], v[68:71], v[48:51], v[168:171]
    buffer_load_dwordx4 v8, s[8:11], s22 offen offset:2048 lds
    v_mfma_f32_16x16x32_bf16 v[172:175], v[68:71], v[52:55], v[172:175]
    v_mfma_f32_16x16x32_bf16 v[200:203], v[68:71], v[56:59], v[200:203]
    buffer_load_dwordx4 v9, s[8:11], s22 offen offset:3072 lds
    s_add_u32 s22, s22, s26
    v_mfma_f32_16x16x32_bf16 v[204:207], v[68:71], v[60:63], v[204:207]
    ds_read_b64_tr_b16 v[68:69], v15 offset:32768
    ds_read_b64_tr_b16 v[70:71], v15 offset:34816
    s_waitcnt lgkmcnt(6)
    v_mfma_f32_16x16x32_bf16 v[80:83], v[40:43], v[24:27], v[80:83]
    ds_read_b128 v[48:51], v10 offset:40960
    s_mov_b32 m0, s20
    s_nop 0
    buffer_load_dwordx4 v2, s[4:7], s16 offen offset:0 lds
    v_mfma_f32_16x16x32_bf16 v[84:87], v[40:43], v[28:31], v[84:87]
    ds_read_b128 v[52:55], v10 offset:43008
    buffer_load_dwordx4 v3, s[4:7], s16 offen offset:1024 lds
    v_mfma_f32_16x16x32_bf16 v[112:115], v[40:43], v[32:35], v[112:115]
    ds_read_b128 v[56:59], v10 offset:45056
    v_mfma_f32_16x16x32_bf16 v[116:119], v[40:43], v[36:39], v[116:119]
    ds_read_b128 v[60:63], v10 offset:47104
    buffer_load_dwordx4 v4, s[4:7], s16 offen offset:2048 lds
    s_waitcnt lgkmcnt(8)
    v_mfma_f32_16x16x32_bf16 v[88:91], v[44:47], v[24:27], v[88:91]
    v_mfma_f32_16x16x32_bf16 v[92:95], v[44:47], v[28:31], v[92:95]
    buffer_load_dwordx4 v5, s[4:7], s16 offen offset:3072 lds
    s_add_u32 s16, s16, s33
    v_mfma_f32_16x16x32_bf16 v[120:123], v[44:47], v[32:35], v[120:123]
    v_mfma_f32_16x16x32_bf16 v[124:127], v[44:47], v[36:39], v[124:127]
    s_add_u32 m0, s20, 4096
    s_nop 0
    buffer_load_dwordx4 v2, s[4:7], s18 offen offset:0 lds
    s_waitcnt lgkmcnt(6)
    v_mfma_f32_16x16x32_bf16 v[96:99], v[64:67], v[24:27], v[96:99]
    buffer_load_dwordx4 v3, s[4:7], s18 offen offset:1024 lds
    v_mfma_f32_16x16x32_bf16 v[100:103], v[64:67], v[28:31], v[100:103]
    v_mfma_f32_16x16x32_bf16 v[128:131], v[64:67], v[32:35], v[128:131]
    buffer_load_dwordx4 v4, s[4:7], s18 offen offset:2048 lds
    v_mfma_f32_16x16x32_bf16 v[132:135], v[64:67], v[36:39], v[132:135]
    s_waitcnt lgkmcnt(4)
    v_mfma_f32_16x16x32_bf16 v[104:107], v[68:71], v[24:27], v[104:107]
    buffer_load_dwordx4 v5, s[4:7], s18 offen offset:3072 lds
    s_add_u32 s18, s18, s33
    v_mfma_f32_16x16x32_bf16 v[108:111], v[68:71], v[28:31], v[108:111]
    v_mfma_f32_16x16x32_bf16 v[136:139], v[68:71], v[32:35], v[136:139]
    v_mov_b32 v241, 147456
    ds_read_b32 v240, v241
    v_mfma_f32_16x16x32_bf16 v[140:143], v[68:71], v[36:39], v[140:143]
    s_waitcnt lgkmcnt(4)
    v_mfma_f32_16x16x32_bf16 v[144:147], v[40:43], v[48:51], v[144:147]
    ds_read_b128 v[24:27], v11 offset:32768
    s_waitcnt lgkmcnt(1)
    v_readfirstlane_b32 s95, v240
    v_mfma_f32_16x16x32_bf16 v[148:151], v[40:43], v[52:55], v[148:151]
    ds_read_b128 v[28:31], v11 offset:34816
    v_mfma_f32_16x16x32_bf16 v[176:179], v[40:43], v[56:59], v[176:179]
    ds_read_b128 v[32:35], v11 offset:36864
    v_mfma_f32_16x16x32_bf16 v[180:183], v[40:43], v[60:63], v[180:183]
    ds_read_b128 v[36:39], v11 offset:38912
    ds_read_b64_tr_b16 v[40:41], v12 offset:49152
    ds_read_b64_tr_b16 v[42:43], v12 offset:51200
    v_mfma_f32_16x16x32_bf16 v[152:155], v[44:47], v[48:51], v[152:155]
    v_mfma_f32_16x16x32_bf16 v[156:159], v[44:47], v[52:55], v[156:159]
    v_mfma_f32_16x16x32_bf16 v[184:187], v[44:47], v[56:59], v[184:187]
    v_mfma_f32_16x16x32_bf16 v[188:191], v[44:47], v[60:63], v[188:191]
    ds_read_b64_tr_b16 v[44:45], v13 offset:49152
    ds_read_b64_tr_b16 v[46:47], v13 offset:51200
    v_mfma_f32_16x16x32_bf16 v[160:163], v[64:67], v[48:51], v[160:163]
    v_mfma_f32_16x16x32_bf16 v[164:167], v[64:67], v[52:55], v[164:167]
    v_mfma_f32_16x16x32_bf16 v[192:195], v[64:67], v[56:59], v[192:195]
    v_mfma_f32_16x16x32_bf16 v[196:199], v[64:67], v[60:63], v[196:199]
    ds_read_b64_tr_b16 v[64:65], v14 offset:49152
    ds_read_b64_tr_b16 v[66:67], v14 offset:51200
    v_mfma_f32_16x16x32_bf16 v[168:171], v[68:71], v[48:51], v[168:171]
    v_mfma_f32_16x16x32_bf16 v[172:175], v[68:71], v[52:55], v[172:175]
    v_mfma_f32_16x16x32_bf16 v[200:203], v[68:71], v[56:59], v[200:203]
    v_mfma_f32_16x16x32_bf16 v[204:207], v[68:71], v[60:63], v[204:207]
    ds_read_b64_tr_b16 v[68:69], v15 offset:49152
    ds_read_b64_tr_b16 v[70:71], v15 offset:51200
    s_waitcnt lgkmcnt(6)
    v_mfma_f32_16x16x32_bf16 v[80:83], v[40:43], v[24:27], v[80:83]
    ds_read_b128 v[48:51], v11 offset:40960
    v_mfma_f32_16x16x32_bf16 v[84:87], v[40:43], v[28:31], v[84:87]
    ds_read_b128 v[52:55], v11 offset:43008
    v_mfma_f32_16x16x32_bf16 v[112:115], v[40:43], v[32:35], v[112:115]
    ds_read_b128 v[56:59], v11 offset:45056
    v_mfma_f32_16x16x32_bf16 v[116:119], v[40:43], v[36:39], v[116:119]
    ds_read_b128 v[60:63], v11 offset:47104
    s_waitcnt lgkmcnt(8)
    v_mfma_f32_16x16x32_bf16 v[88:91], v[44:47], v[24:27], v[88:91]
    v_mfma_f32_16x16x32_bf16 v[92:95], v[44:47], v[28:31], v[92:95]
    v_mfma_f32_16x16x32_bf16 v[120:123], v[44:47], v[32:35], v[120:123]
    v_mfma_f32_16x16x32_bf16 v[124:127], v[44:47], v[36:39], v[124:127]
    s_waitcnt lgkmcnt(6)
    v_mfma_f32_16x16x32_bf16 v[96:99], v[64:67], v[24:27], v[96:99]
    v_mfma_f32_16x16x32_bf16 v[100:103], v[64:67], v[28:31], v[100:103]
    v_mfma_f32_16x16x32_bf16 v[128:131], v[64:67], v[32:35], v[128:131]
    v_mfma_f32_16x16x32_bf16 v[132:135], v[64:67], v[36:39], v[132:135]
    s_waitcnt lgkmcnt(4)
    v_mfma_f32_16x16x32_bf16 v[104:107], v[68:71], v[24:27], v[104:107]
    v_mfma_f32_16x16x32_bf16 v[108:111], v[68:71], v[28:31], v[108:111]
    v_mfma_f32_16x16x32_bf16 v[136:139], v[68:71], v[32:35], v[136:139]
    v_mfma_f32_16x16x32_bf16 v[140:143], v[68:71], v[36:39], v[140:143]
    s_waitcnt lgkmcnt(0) vmcnt(0)
    s_barrier
    v_mfma_f32_16x16x32_bf16 v[144:147], v[40:43], v[48:51], v[144:147]
    ds_read_b128 v[24:27], v10 offset:0
    s_mov_b32 m0, s24
    s_nop 0
    buffer_load_dwordx4 v6, s[8:11], s17 offen offset:0 lds
    v_mfma_f32_16x16x32_bf16 v[148:151], v[40:43], v[52:55], v[148:151]
    ds_read_b128 v[28:31], v10 offset:2048
    v_mfma_f32_16x16x32_bf16 v[176:179], v[40:43], v[56:59], v[176:179]
    ds_read_b128 v[32:35], v10 offset:4096
    buffer_load_dwordx4 v7, s[8:11], s17 offen offset:1024 lds
    v_mfma_f32_16x16x32_bf16 v[180:183], v[40:43], v[60:63], v[180:183]
    ds_read_b128 v[36:39], v10 offset:6144
    ds_read_b64_tr_b16 v[40:41], v12 offset:0
    ds_read_b64_tr_b16 v[42:43], v12 offset:2048
    v_mfma_f32_16x16x32_bf16 v[152:155], v[44:47], v[48:51], v[152:155]
    buffer_load_dwordx4 v8, s[8:11], s17 offen offset:2048 lds
    v_mfma_f32_16x16x32_bf16 v[156:159], v[44:47], v[52:55], v[156:159]
    v_mfma_f32_16x16x32_bf16 v[184:187], v[44:47], v[56:59], v[184:187]
    buffer_load_dwordx4 v9, s[8:11], s17 offen offset:3072 lds
    s_add_u32 s17, s17, s26
    v_mfma_f32_16x16x32_bf16 v[188:191], v[44:47], v[60:63], v[188:191]
    ds_read_b64_tr_b16 v[44:45], v13 offset:0
    ds_read_b64_tr_b16 v[46:47], v13 offset:2048
    v_mfma_f32_16x16x32_bf16 v[160:163], v[64:67], v[48:51], v[160:163]
    s_add_u32 m0, s24, 16384
    s_nop 0
    buffer_load_dwordx4 v6, s[8:11], s22 offen offset:0 lds
    v_mfma_f32_16x16x32_bf16 v[164:167], v[64:67], v[52:55], v[164:167]
    v_mfma_f32_16x16x32_bf16 v[192:195], v[64:67], v[56:59], v[192:195]
    buffer_load_dwordx4 v7, s[8:11], s22 offen offset:1024 lds
    v_mfma_f32_16x16x32_bf16 v[196:199], v[64:67], v[60:63], v[196:199]
    ds_read_b64_tr_b16 v[64:65], v14 offset:0
    ds_read_b64_tr_b16 v[66:67], v14 offset:2048
    v_mfma_f32_16x16x32_bf16 v[168:171], v[68:71], v[48:51], v[168:171]
    buffer_load_dwordx4 v8, s[8:11], s22 offen offset:2048 lds
    v_mfma_f32_16x16x32_bf16 v[172:175], v[68:71], v[52:55], v[172:175]
    v_mfma_f32_16x16x32_bf16 v[200:203], v[68:71], v[56:59], v[200:203]
    buffer_load_dwordx4 v9, s[8:11], s22 offen offset:3072 lds
    s_add_u32 s22, s22, s26
    v_mfma_f32_16x16x32_bf16 v[204:207], v[68:71], v[60:63], v[204:207]
    ds_read_b64_tr_b16 v[68:69], v15 offset:0
    ds_read_b64_tr_b16 v[70:71], v15 offset:2048
    s_waitcnt lgkmcnt(6)
    v_mfma_f32_16x16x32_bf16 v[80:83], v[40:43], v[24:27], v[80:83]
    ds_read_b128 v[48:51], v10 offset:8192
    s_mov_b32 m0, s21
    s_nop 0
    buffer_load_dwordx4 v2, s[4:7], s16 offen offset:0 lds
    v_mfma_f32_16x16x32_bf16 v[84:87], v[40:43], v[28:31], v[84:87]
    ds_read_b128 v[52:55], v10 offset:10240
    v_mfma_f32_16x16x32_bf16 v[112:115], v[40:43], v[32:35], v[112:115]
    ds_read_b128 v[56:59], v10 offset:12288
    buffer_load_dwordx4 v3, s[4:7], s16 offen offset:1024 lds
    v_mfma_f32_16x16x32_bf16 v[116:119], v[40:43], v[36:39], v[116:119]
    ds_read_b128 v[60:63], v10 offset:14336
    s_waitcnt lgkmcnt(8)
    v_mfma_f32_16x16x32_bf16 v[88:91], v[44:47], v[24:27], v[88:91]
    buffer_load_dwordx4 v4, s[4:7], s16 offen offset:2048 lds
    v_mfma_f32_16x16x32_bf16 v[92:95], v[44:47], v[28:31], v[92:95]
    v_mfma_f32_16x16x32_bf16 v[120:123], v[44:47], v[32:35], v[120:123]
    buffer_load_dwordx4 v5, s[4:7], s16 offen offset:3072 lds
    s_add_u32 s16, s16, s33
    v_mfma_f32_16x16x32_bf16 v[124:127], v[44:47], v[36:39], v[124:127]
    s_waitcnt lgkmcnt(6)
    v_mfma_f32_16x16x32_bf16 v[96:99], v[64:67], v[24:27], v[96:99]
    s_add_u32 m0, s21, 4096
    s_nop 0
    buffer_load_dwordx4 v2, s[4:7], s18 offen offset:0 lds
    v_mfma_f32_16x16x32_bf16 v[100:103], v[64:67], v[28:31], v[100:103]
    v_mfma_f32_16x16x32_bf16 v[128:131], v[64:67], v[32:35], v[128:131]
    buffer_load_dwordx4 v3, s[4:7], s18 offen offset:1024 lds
    v_mfma_f32_16x16x32_bf16 v[132:135], v[64:67], v[36:39], v[132:135]
    s_waitcnt lgkmcnt(4)
    v_mfma_f32_16x16x32_bf16 v[104:107], v[68:71], v[24:27], v[104:107]
    buffer_load_dwordx4 v4, s[4:7], s18 offen offset:2048 lds
    v_mfma_f32_16x16x32_bf16 v[108:111], v[68:71], v[28:31], v[108:111]
    v_mfma_f32_16x16x32_bf16 v[136:139], v[68:71], v[32:35], v[136:139]
    buffer_load_dwordx4 v5, s[4:7], s18 offen offset:3072 lds
    s_add_u32 s18, s18, s33
    v_mfma_f32_16x16x32_bf16 v[140:143], v[68:71], v[36:39], v[140:143]
    s_waitcnt lgkmcnt(3)
    v_mfma_f32_16x16x32_bf16 v[144:147], v[40:43], v[48:51], v[144:147]
    ds_read_b128 v[24:27], v11 offset:0
    s_waitcnt lgkmcnt(3)
    v_mfma_f32_16x16x32_bf16 v[148:151], v[40:43], v[52:55], v[148:151]
    ds_read_b128 v[28:31], v11 offset:2048
    s_waitcnt lgkmcnt(3)
    v_mfma_f32_16x16x32_bf16 v[176:179], v[40:43], v[56:59], v[176:179]
    ds_read_b128 v[32:35], v11 offset:4096
    s_waitcnt lgkmcnt(3)
    v_mfma_f32_16x16x32_bf16 v[180:183], v[40:43], v[60:63], v[180:183]
    ds_read_b128 v[36:39], v11 offset:6144
    ds_read_b64_tr_b16 v[40:41], v12 offset:16384
    ds_read_b64_tr_b16 v[42:43], v12 offset:18432
    v_mfma_f32_16x16x32_bf16 v[152:155], v[44:47], v[48:51], v[152:155]
    v_mfma_f32_16x16x32_bf16 v[156:159], v[44:47], v[52:55], v[156:159]
    v_mfma_f32_16x16x32_bf16 v[184:187], v[44:47], v[56:59], v[184:187]
    v_mfma_f32_16x16x32_bf16 v[188:191], v[44:47], v[60:63], v[188:191]
    ds_read_b64_tr_b16 v[44:45], v13 offset:16384
    ds_read_b64_tr_b16 v[46:47], v13 offset:18432
    v_mfma_f32_16x16x32_bf16 v[160:163], v[64:67], v[48:51], v[160:163]
    v_mfma_f32_16x16x32_bf16 v[164:167], v[64:67], v[52:55], v[164:167]
    v_mfma_f32_16x16x32_bf16 v[192:195], v[64:67], v[56:59], v[192:195]
    v_mfma_f32_16x16x32_bf16 v[196:199], v[64:67], v[60:63], v[196:199]
    ds_read_b64_tr_b16 v[64:65], v14 offset:16384
    ds_read_b64_tr_b16 v[66:67], v14 offset:18432
    v_mfma_f32_16x16x32_bf16 v[168:171], v[68:71], v[48:51], v[168:171]
    v_mfma_f32_16x16x32_bf16 v[172:175], v[68:71], v[52:55], v[172:175]
    v_mfma_f32_16x16x32_bf16 v[200:203], v[68:71], v[56:59], v[200:203]
    v_mfma_f32_16x16x32_bf16 v[204:207], v[68:71], v[60:63], v[204:207]
    ds_read_b64_tr_b16 v[68:69], v15 offset:16384
    ds_read_b64_tr_b16 v[70:71], v15 offset:18432
    s_waitcnt lgkmcnt(6)
    v_mfma_f32_16x16x32_bf16 v[80:83], v[40:43], v[24:27], v[80:83]
    ds_read_b128 v[48:51], v11 offset:8192
    v_mfma_f32_16x16x32_bf16 v[84:87], v[40:43], v[28:31], v[84:87]
    ds_read_b128 v[52:55], v11 offset:10240
    v_mfma_f32_16x16x32_bf16 v[112:115], v[40:43], v[32:35], v[112:115]
    ds_read_b128 v[56:59], v11 offset:12288
    v_mfma_f32_16x16x32_bf16 v[116:119], v[40:43], v[36:39], v[116:119]
    ds_read_b128 v[60:63], v11 offset:14336
    s_waitcnt lgkmcnt(8)
    v_mfma_f32_16x16x32_bf16 v[88:91], v[44:47], v[24:27], v[88:91]
    v_mfma_f32_16x16x32_bf16 v[92:95], v[44:47], v[28:31], v[92:95]
    v_mfma_f32_16x16x32_bf16 v[120:123], v[44:47], v[32:35], v[120:123]
    v_mfma_f32_16x16x32_bf16 v[124:127], v[44:47], v[36:39], v[124:127]
    s_waitcnt lgkmcnt(6)
    v_mfma_f32_16x16x32_bf16 v[96:99], v[64:67], v[24:27], v[96:99]
    v_mfma_f32_16x16x32_bf16 v[100:103], v[64:67], v[28:31], v[100:103]
    v_mfma_f32_16x16x32_bf16 v[128:131], v[64:67], v[32:35], v[128:131]
    v_mfma_f32_16x16x32_bf16 v[132:135], v[64:67], v[36:39], v[132:135]
    s_waitcnt lgkmcnt(4)
    v_mfma_f32_16x16x32_bf16 v[104:107], v[68:71], v[24:27], v[104:107]
    v_mfma_f32_16x16x32_bf16 v[108:111], v[68:71], v[28:31], v[108:111]
    v_mfma_f32_16x16x32_bf16 v[136:139], v[68:71], v[32:35], v[136:139]
    v_mfma_f32_16x16x32_bf16 v[140:143], v[68:71], v[36:39], v[140:143]
    s_waitcnt lgkmcnt(0) vmcnt(0)
    s_barrier
    v_mfma_f32_16x16x32_bf16 v[144:147], v[40:43], v[48:51], v[144:147]
    ds_read_b128 v[24:27], v10 offset:32768
    s_mov_b32 m0, s23
    s_nop 0
    buffer_load_dwordx4 v6, s[8:11], s17 offen offset:0 lds
    v_mfma_f32_16x16x32_bf16 v[148:151], v[40:43], v[52:55], v[148:151]
    ds_read_b128 v[28:31], v10 offset:34816
    v_mfma_f32_16x16x32_bf16 v[176:179], v[40:43], v[56:59], v[176:179]
    ds_read_b128 v[32:35], v10 offset:36864
    buffer_load_dwordx4 v7, s[8:11], s17 offen offset:1024 lds
    v_mfma_f32_16x16x32_bf16 v[180:183], v[40:43], v[60:63], v[180:183]
    ds_read_b128 v[36:39], v10 offset:38912
    ds_read_b64_tr_b16 v[40:41], v12 offset:32768
    ds_read_b64_tr_b16 v[42:43], v12 offset:34816
    v_mfma_f32_16x16x32_bf16 v[152:155], v[44:47], v[48:51], v[152:155]
    buffer_load_dwordx4 v8, s[8:11], s17 offen offset:2048 lds
    v_mfma_f32_16x16x32_bf16 v[156:159], v[44:47], v[52:55], v[156:159]
    v_mfma_f32_16x16x32_bf16 v[184:187], v[44:47], v[56:59], v[184:187]
    buffer_load_dwordx4 v9, s[8:11], s17 offen offset:3072 lds
    s_add_u32 s17, s17, s26
    v_mfma_f32_16x16x32_bf16 v[188:191], v[44:47], v[60:63], v[188:191]
    ds_read_b64_tr_b16 v[44:45], v13 offset:32768
    ds_read_b64_tr_b16 v[46:47], v13 offset:34816
    v_mfma_f32_16x16x32_bf16 v[160:163], v[64:67], v[48:51], v[160:163]
    s_add_u32 m0, s23, 16384
    s_nop 0
    buffer_load_dwordx4 v6, s[8:11], s22 offen offset:0 lds
    v_mfma_f32_16x16x32_bf16 v[164:167], v[64:67], v[52:55], v[164:167]
    v_mfma_f32_16x16x32_bf16 v[192:195], v[64:67], v[56:59], v[192:195]
    buffer_load_dwordx4 v7, s[8:11], s22 offen offset:1024 lds
    v_mfma_f32_16x16x32_bf16 v[196:199], v[64:67], v[60:63], v[196:199]
    ds_read_b64_tr_b16 v[64:65], v14 offset:32768
    ds_read_b64_tr_b16 v[66:67], v14 offset:34816
    v_mfma_f32_16x16x32_bf16 v[168:171], v[68:71], v[48:51], v[168:171]
    buffer_load_dwordx4 v8, s[8:11], s22 offen offset:2048 lds
    v_mfma_f32_16x16x32_bf16 v[172:175], v[68:71], v[52:55], v[172:175]
    v_mfma_f32_16x16x32_bf16 v[200:203], v[68:71], v[56:59], v[200:203]
    buffer_load_dwordx4 v9, s[8:11], s22 offen offset:3072 lds
    s_add_u32 s22, s22, s26
    v_mfma_f32_16x16x32_bf16 v[204:207], v[68:71], v[60:63], v[204:207]
    ds_read_b64_tr_b16 v[68:69], v15 offset:32768
    ds_read_b64_tr_b16 v[70:71], v15 offset:34816
    s_waitcnt lgkmcnt(6)
    v_mfma_f32_16x16x32_bf16 v[80:83], v[40:43], v[24:27], v[80:83]
    ds_read_b128 v[48:51], v10 offset:40960
    s_mov_b32 m0, s20
    s_nop 0
    buffer_load_dwordx4 v2, s[4:7], s16 offen offset:0 lds
    v_mfma_f32_16x16x32_bf16 v[84:87], v[40:43], v[28:31], v[84:87]
    ds_read_b128 v[52:55], v10 offset:43008
    v_mfma_f32_16x16x32_bf16 v[112:115], v[40:43], v[32:35], v[112:115]
    ds_read_b128 v[56:59], v10 offset:45056
    buffer_load_dwordx4 v3, s[4:7], s16 offen offset:1024 lds
    v_mfma_f32_16x16x32_bf16 v[116:119], v[40:43], v[36:39], v[116:119]
    ds_read_b128 v[60:63], v10 offset:47104
    s_waitcnt lgkmcnt(8)
    v_mfma_f32_16x16x32_bf16 v[88:91], v[44:47], v[24:27], v[88:91]
    buffer_load_dwordx4 v4, s[4:7], s16 offen offset:2048 lds
    v_mfma_f32_16x16x32_bf16 v[92:95], v[44:47], v[28:31], v[92:95]
    v_mfma_f32_16x16x32_bf16 v[120:123], v[44:47], v[32:35], v[120:123]
    buffer_load_dwordx4 v5, s[4:7], s16 offen offset:3072 lds
    s_add_u32 s16, s16, s33
    v_mfma_f32_16x16x32_bf16 v[124:127], v[44:47], v[36:39], v[124:127]
    s_waitcnt lgkmcnt(6)
    v_mfma_f32_16x16x32_bf16 v[96:99], v[64:67], v[24:27], v[96:99]
    s_add_u32 m0, s20, 4096
    s_nop 0
    buffer_load_dwordx4 v2, s[4:7], s18 offen offset:0 lds
    v_mfma_f32_16x16x32_bf16 v[100:103], v[64:67], v[28:31], v[100:103]
    v_mfma_f32_16x16x32_bf16 v[128:131], v[64:67], v[32:35], v[128:131]
    buffer_load_dwordx4 v3, s[4:7], s18 offen offset:1024 lds
    v_mfma_f32_16x16x32_bf16 v[132:135], v[64:67], v[36:39], v[132:135]
    s_waitcnt lgkmcnt(4)
    v_mfma_f32_16x16x32_bf16 v[104:107], v[68:71], v[24:27], v[104:107]
    buffer_load_dwordx4 v4, s[4:7], s18 offen offset:2048 lds
    v_mfma_f32_16x16x32_bf16 v[108:111], v[68:71], v[28:31], v[108:111]
    v_mfma_f32_16x16x32_bf16 v[136:139], v[68:71], v[32:35], v[136:139]
    buffer_load_dwordx4 v5, s[4:7], s18 offen offset:3072 lds
    s_add_u32 s18, s18, s33
    v_mfma_f32_16x16x32_bf16 v[140:143], v[68:71], v[36:39], v[140:143]
    s_waitcnt lgkmcnt(3)
    v_mfma_f32_16x16x32_bf16 v[144:147], v[40:43], v[48:51], v[144:147]
    ds_read_b128 v[24:27], v11 offset:32768
    s_waitcnt lgkmcnt(3)
    v_mfma_f32_16x16x32_bf16 v[148:151], v[40:43], v[52:55], v[148:151]
    ds_read_b128 v[28:31], v11 offset:34816
    s_waitcnt lgkmcnt(3)
    v_mfma_f32_16x16x32_bf16 v[176:179], v[40:43], v[56:59], v[176:179]
    ds_read_b128 v[32:35], v11 offset:36864
    s_waitcnt lgkmcnt(3)
    v_mfma_f32_16x16x32_bf16 v[180:183], v[40:43], v[60:63], v[180:183]
    ds_read_b128 v[36:39], v11 offset:38912
    ds_read_b64_tr_b16 v[40:41], v12 offset:49152
    ds_read_b64_tr_b16 v[42:43], v12 offset:51200
    v_mfma_f32_16x16x32_bf16 v[152:155], v[44:47], v[48:51], v[152:155]
    v_mfma_f32_16x16x32_bf16 v[156:159], v[44:47], v[52:55], v[156:159]
    v_mfma_f32_16x16x32_bf16 v[184:187], v[44:47], v[56:59], v[184:187]
    v_mfma_f32_16x16x32_bf16 v[188:191], v[44:47], v[60:63], v[188:191]
    ds_read_b64_tr_b16 v[44:45], v13 offset:49152
    ds_read_b64_tr_b16 v[46:47], v13 offset:51200
    v_mfma_f32_16x16x32_bf16 v[160:163], v[64:67], v[48:51], v[160:163]
    v_mfma_f32_16x16x32_bf16 v[164:167], v[64:67], v[52:55], v[164:167]
    v_mfma_f32_16x16x32_bf16 v[192:195], v[64:67], v[56:59], v[192:195]
    v_mfma_f32_16x16x32_bf16 v[196:199], v[64:67], v[60:63], v[196:199]
    ds_read_b64_tr_b16 v[64:65], v14 offset:49152
    ds_read_b64_tr_b16 v[66:67], v14 offset:51200
    v_mfma_f32_16x16x32_bf16 v[168:171], v[68:71], v[48:51], v[168:171]
    v_mfma_f32_16x16x32_bf16 v[172:175], v[68:71], v[52:55], v[172:175]
    v_mfma_f32_16x16x32_bf16 v[200:203], v[68:71], v[56:59], v[200:203]
    v_mfma_f32_16x16x32_bf16 v[204:207], v[68:71], v[60:63], v[204:207]
    ds_read_b64_tr_b16 v[68:69], v15 offset:49152
    ds_read_b64_tr_b16 v[70:71], v15 offset:51200
    s_waitcnt lgkmcnt(6)
    v_mfma_f32_16x16x32_bf16 v[80:83], v[40:43], v[24:27], v[80:83]
    ds_read_b128 v[48:51], v11 offset:40960
    buffer_load_dwordx4 v[248:251], v1, s[88:91], 0 offen offset:1024 sc1
    v_mfma_f32_16x16x32_bf16 v[84:87], v[40:43], v[28:31], v[84:87]
    ds_read_b128 v[52:55], v11 offset:43008
    v_mfma_f32_16x16x32_bf16 v[112:115], v[40:43], v[32:35], v[112:115]
    ds_read_b128 v[56:59], v11 offset:45056
    v_mfma_f32_16x16x32_bf16 v[116:119], v[40:43], v[36:39], v[116:119]
    ds_read_b128 v[60:63], v11 offset:47104
    s_waitcnt lgkmcnt(8)
    v_mfma_f32_16x16x32_bf16 v[88:91], v[44:47], v[24:27], v[88:91]
    v_mfma_f32_16x16x32_bf16 v[92:95], v[44:47], v[28:31], v[92:95]
    v_mfma_f32_16x16x32_bf16 v[120:123], v[44:47], v[32:35], v[120:123]
    v_mfma_f32_16x16x32_bf16 v[124:127], v[44:47], v[36:39], v[124:127]
    s_waitcnt lgkmcnt(6)
    v_mfma_f32_16x16x32_bf16 v[96:99], v[64:67], v[24:27], v[96:99]
    v_mfma_f32_16x16x32_bf16 v[100:103], v[64:67], v[28:31], v[100:103]
    v_mfma_f32_16x16x32_bf16 v[128:131], v[64:67], v[32:35], v[128:131]
    v_mfma_f32_16x16x32_bf16 v[132:135], v[64:67], v[36:39], v[132:135]
    s_waitcnt lgkmcnt(4)
    v_mfma_f32_16x16x32_bf16 v[104:107], v[68:71], v[24:27], v[104:107]
    v_mfma_f32_16x16x32_bf16 v[108:111], v[68:71], v[28:31], v[108:111]
    v_mfma_f32_16x16x32_bf16 v[136:139], v[68:71], v[32:35], v[136:139]
    v_mfma_f32_16x16x32_bf16 v[140:143], v[68:71], v[36:39], v[140:143]
    s_waitcnt lgkmcnt(0) vmcnt(1)
    s_barrier
    v_mfma_f32_16x16x32_bf16 v[144:147], v[40:43], v[48:51], v[144:147]
    ds_read_b128 v[24:27], v10 offset:0
    s_mov_b32 m0, s24
    s_nop 0
    buffer_load_dwordx4 v6, s[8:11], s17 offen offset:0 lds
    v_mfma_f32_16x16x32_bf16 v[148:151], v[40:43], v[52:55], v[148:151]
    ds_read_b128 v[28:31], v10 offset:2048
    v_mfma_f32_16x16x32_bf16 v[176:179], v[40:43], v[56:59], v[176:179]
    ds_read_b128 v[32:35], v10 offset:4096
    buffer_load_dwordx4 v7, s[8:11], s17 offen offset:1024 lds
    v_mfma_f32_16x16x32_bf16 v[180:183], v[40:43], v[60:63], v[180:183]
    ds_read_b128 v[36:39], v10 offset:6144
    ds_read_b64_tr_b16 v[40:41], v12 offset:0
    ds_read_b64_tr_b16 v[42:43], v12 offset:2048
    v_mfma_f32_16x16x32_bf16 v[152:155], v[44:47], v[48:51], v[152:155]
    buffer_load_dwordx4 v8, s[8:11], s17 offen offset:2048 lds
    v_mfma_f32_16x16x32_bf16 v[156:159], v[44:47], v[52:55], v[156:159]
    v_mfma_f32_16x16x32_bf16 v[184:187], v[44:47], v[56:59], v[184:187]
    buffer_load_dwordx4 v9, s[8:11], s17 offen offset:3072 lds
    s_add_u32 s17, s17, s26
    v_mfma_f32_16x16x32_bf16 v[188:191], v[44:47], v[60:63], v[188:191]
    ds_read_b64_tr_b16 v[44:45], v13 offset:0
    ds_read_b64_tr_b16 v[46:47], v13 offset:2048
    v_mfma_f32_16x16x32_bf16 v[160:163], v[64:67], v[48:51], v[160:163]
    s_add_u32 m0, s24, 16384
    s_nop 0
    buffer_load_dwordx4 v6, s[8:11], s22 offen offset:0 lds
    v_mfma_f32_16x16x32_bf16 v[164:167], v[64:67], v[52:55], v[164:167]
    v_mfma_f32_16x16x32_bf16 v[192:195], v[64:67], v[56:59], v[192:195]
    buffer_load_dwordx4 v7, s[8:11], s22 offen offset:1024 lds
    v_mfma_f32_16x16x32_bf16 v[196:199], v[64:67], v[60:63], v[196:199]
    ds_read_b64_tr_b16 v[64:65], v14 offset:0
    ds_read_b64_tr_b16 v[66:67], v14 offset:2048
    v_mfma_f32_16x16x32_bf16 v[168:171], v[68:71], v[48:51], v[168:171]
    buffer_load_dwordx4 v8, s[8:11], s22 offen offset:2048 lds
    v_mfma_f32_16x16x32_bf16 v[172:175], v[68:71], v[52:55], v[172:175]
    v_mfma_f32_16x16x32_bf16 v[200:203], v[68:71], v[56:59], v[200:203]
    buffer_load_dwordx4 v9, s[8:11], s22 offen offset:3072 lds
    s_add_u32 s22, s22, s26
    v_mfma_f32_16x16x32_bf16 v[204:207], v[68:71], v[60:63], v[204:207]
    ds_read_b64_tr_b16 v[68:69], v15 offset:0
    ds_read_b64_tr_b16 v[70:71], v15 offset:2048
    s_waitcnt lgkmcnt(6)
    v_mfma_f32_16x16x32_bf16 v[80:83], v[40:43], v[24:27], v[80:83]
    ds_read_b128 v[48:51], v10 offset:8192
    s_mov_b32 m0, s21
    s_nop 0
    buffer_load_dwordx4 v2, s[4:7], s16 offen offset:0 lds
    v_mfma_f32_16x16x32_bf16 v[84:87], v[40:43], v[28:31], v[84:87]
    ds_read_b128 v[52:55], v10 offset:10240
    v_mfma_f32_16x16x32_bf16 v[112:115], v[40:43], v[32:35], v[112:115]
    ds_read_b128 v[56:59], v10 offset:12288
    buffer_load_dwordx4 v3, s[4:7], s16 offen offset:1024 lds
    v_mfma_f32_16x16x32_bf16 v[116:119], v[40:43], v[36:39], v[116:119]
    ds_read_b128 v[60:63], v10 offset:14336
    s_waitcnt lgkmcnt(8)
    v_mfma_f32_16x16x32_bf16 v[88:91], v[44:47], v[24:27], v[88:91]
    buffer_load_dwordx4 v4, s[4:7], s16 offen offset:2048 lds
    v_mfma_f32_16x16x32_bf16 v[92:95], v[44:47], v[28:31], v[92:95]
    v_mfma_f32_16x16x32_bf16 v[120:123], v[44:47], v[32:35], v[120:123]
    buffer_load_dwordx4 v5, s[4:7], s16 offen offset:3072 lds
    s_add_u32 s16, s16, s33
    v_mfma_f32_16x16x32_bf16 v[124:127], v[44:47], v[36:39], v[124:127]
    s_waitcnt lgkmcnt(6)
    v_mfma_f32_16x16x32_bf16 v[96:99], v[64:67], v[24:27], v[96:99]
    s_add_u32 m0, s21, 4096
    s_nop 0
    buffer_load_dwordx4 v2, s[4:7], s18 offen offset:0 lds
    v_mfma_f32_16x16x32_bf16 v[100:103], v[64:67], v[28:31], v[100:103]
    v_mfma_f32_16x16x32_bf16 v[128:131], v[64:67], v[32:35], v[128:131]
    buffer_load_dwordx4 v3, s[4:7], s18 offen offset:1024 lds
    v_mfma_f32_16x16x32_bf16 v[132:135], v[64:67], v[36:39], v[132:135]
    s_waitcnt lgkmcnt(4)
    v_mfma_f32_16x16x32_bf16 v[104:107], v[68:71], v[24:27], v[104:107]
    buffer_load_dwordx4 v4, s[4:7], s18 offen offset:2048 lds
    v_mfma_f32_16x16x32_bf16 v[108:111], v[68:71], v[28:31], v[108:111]
    v_mfma_f32_16x16x32_bf16 v[136:139], v[68:71], v[32:35], v[136:139]
    buffer_load_dwordx4 v5, s[4:7], s18 offen offset:3072 lds
    s_add_u32 s18, s18, s33
    v_mfma_f32_16x16x32_bf16 v[140:143], v[68:71], v[36:39], v[140:143]
    s_waitcnt lgkmcnt(3)
    v_mfma_f32_16x16x32_bf16 v[144:147], v[40:43], v[48:51], v[144:147]
    ds_read_b128 v[24:27], v11 offset:0
    s_waitcnt lgkmcnt(3)
    v_mfma_f32_16x16x32_bf16 v[148:151], v[40:43], v[52:55], v[148:151]
    ds_read_b128 v[28:31], v11 offset:2048
    s_waitcnt lgkmcnt(3)
    v_mfma_f32_16x16x32_bf16 v[176:179], v[40:43], v[56:59], v[176:179]
    ds_read_b128 v[32:35], v11 offset:4096
    s_waitcnt lgkmcnt(3)
    v_mfma_f32_16x16x32_bf16 v[180:183], v[40:43], v[60:63], v[180:183]
    ds_read_b128 v[36:39], v11 offset:6144
    ds_read_b64_tr_b16 v[40:41], v12 offset:16384
    ds_read_b64_tr_b16 v[42:43], v12 offset:18432
    v_mfma_f32_16x16x32_bf16 v[152:155], v[44:47], v[48:51], v[152:155]
    v_mfma_f32_16x16x32_bf16 v[156:159], v[44:47], v[52:55], v[156:159]
    v_mfma_f32_16x16x32_bf16 v[184:187], v[44:47], v[56:59], v[184:187]
    v_mfma_f32_16x16x32_bf16 v[188:191], v[44:47], v[60:63], v[188:191]
    ds_read_b64_tr_b16 v[44:45], v13 offset:16384
    ds_read_b64_tr_b16 v[46:47], v13 offset:18432
    v_mfma_f32_16x16x32_bf16 v[160:163], v[64:67], v[48:51], v[160:163]
    v_mfma_f32_16x16x32_bf16 v[164:167], v[64:67], v[52:55], v[164:167]
    v_mfma_f32_16x16x32_bf16 v[192:195], v[64:67], v[56:59], v[192:195]
    v_mfma_f32_16x16x32_bf16 v[196:199], v[64:67], v[60:63], v[196:199]
    ds_read_b64_tr_b16 v[64:65], v14 offset:16384
    ds_read_b64_tr_b16 v[66:67], v14 offset:18432
    v_mfma_f32_16x16x32_bf16 v[168:171], v[68:71], v[48:51], v[168:171]
    v_mfma_f32_16x16x32_bf16 v[172:175], v[68:71], v[52:55], v[172:175]
    v_mfma_f32_16x16x32_bf16 v[200:203], v[68:71], v[56:59], v[200:203]
    v_mfma_f32_16x16x32_bf16 v[204:207], v[68:71], v[60:63], v[204:207]
    ds_read_b64_tr_b16 v[68:69], v15 offset:16384
    ds_read_b64_tr_b16 v[70:71], v15 offset:18432
    s_waitcnt lgkmcnt(6)
    v_mfma_f32_16x16x32_bf16 v[80:83], v[40:43], v[24:27], v[80:83]
    ds_read_b128 v[48:51], v11 offset:8192
    v_mfma_f32_16x16x32_bf16 v[84:87], v[40:43], v[28:31], v[84:87]
    ds_read_b128 v[52:55], v11 offset:10240
    v_mfma_f32_16x16x32_bf16 v[112:115], v[40:43], v[32:35], v[112:115]
    ds_read_b128 v[56:59], v11 offset:12288
    v_mfma_f32_16x16x32_bf16 v[116:119], v[40:43], v[36:39], v[116:119]
    ds_read_b128 v[60:63], v11 offset:14336
    s_waitcnt lgkmcnt(8)
    v_mfma_f32_16x16x32_bf16 v[88:91], v[44:47], v[24:27], v[88:91]
    v_mfma_f32_16x16x32_bf16 v[92:95], v[44:47], v[28:31], v[92:95]
    v_mfma_f32_16x16x32_bf16 v[120:123], v[44:47], v[32:35], v[120:123]
    v_mfma_f32_16x16x32_bf16 v[124:127], v[44:47], v[36:39], v[124:127]
    s_waitcnt lgkmcnt(6)
    v_mfma_f32_16x16x32_bf16 v[96:99], v[64:67], v[24:27], v[96:99]
    v_mfma_f32_16x16x32_bf16 v[100:103], v[64:67], v[28:31], v[100:103]
    v_mfma_f32_16x16x32_bf16 v[128:131], v[64:67], v[32:35], v[128:131]
    v_mfma_f32_16x16x32_bf16 v[132:135], v[64:67], v[36:39], v[132:135]
    s_waitcnt lgkmcnt(4)
    v_mfma_f32_16x16x32_bf16 v[104:107], v[68:71], v[24:27], v[104:107]
    v_mfma_f32_16x16x32_bf16 v[108:111], v[68:71], v[28:31], v[108:111]
    v_mfma_f32_16x16x32_bf16 v[136:139], v[68:71], v[32:35], v[136:139]
    v_mfma_f32_16x16x32_bf16 v[140:143], v[68:71], v[36:39], v[140:143]
    s_waitcnt lgkmcnt(0) vmcnt(0)
    s_barrier
    v_xor_b32 v248, s95, v248
    v_xor_b32 v249, s95, v249
    v_xor_b32 v250, s95, v250
    v_xor_b32 v251, s95, v251
    v_or3_b32 v252, v248, v249, v250
    v_or_b32 v252, v252, v251
    v_cmp_ne_u32 vcc, 0, v252
    s_cbranch_vccnz L_pollslow_2
L_pollback_3:
    v_mfma_f32_16x16x32_bf16 v[144:147], v[40:43], v[48:51], v[144:147]
    ds_read_b128 v[24:27], v10 offset:32768
    s_mov_b32 m0, s23
    s_nop 0
    buffer_load_dwordx4 v73, s[68:71], s73 offen offset:0 lds
    v_mfma_f32_16x16x32_bf16 v[148:151], v[40:43], v[52:55], v[148:151]
    ds_read_b128 v[28:31], v10 offset:34816
    v_mfma_f32_16x16x32_bf16 v[176:179], v[40:43], v[56:59], v[176:179]
    ds_read_b128 v[32:35], v10 offset:36864
    buffer_load_dwordx4 v74, s[68:71], s73 offen offset:1024 lds
    v_mfma_f32_16x16x32_bf16 v[180:183], v[40:43], v[60:63], v[180:183]
    ds_read_b128 v[36:39], v10 offset:38912
    ds_read_b64_tr_b16 v[40:41], v12 offset:32768
    ds_read_b64_tr_b16 v[42:43], v12 offset:34816
    v_mfma_f32_16x16x32_bf16 v[152:155], v[44:47], v[48:51], v[152:155]
    buffer_load_dwordx4 v75, s[68:71], s73 offen offset:2048 lds
    v_mfma_f32_16x16x32_bf16 v[156:159], v[44:47], v[52:55], v[156:159]
    v_mfma_f32_16x16x32_bf16 v[184:187], v[44:47], v[56:59], v[184:187]
    buffer_load_dwordx4 v76, s[68:71], s73 offen offset:3072 lds
    s_add_u32 s73, s73, s75
    v_mfma_f32_16x16x32_bf16 v[188:191], v[44:47], v[60:63], v[188:191]
    ds_read_b64_tr_b16 v[44:45], v13 offset:32768
    ds_read_b64_tr_b16 v[46:47], v13 offset:34816
    v_mfma_f32_16x16x32_bf16 v[160:163], v[64:67], v[48:51], v[160:163]
    s_add_u32 m0, s23, 16384
    s_nop 0
    buffer_load_dwordx4 v20, s[84:87], s94 offen offset:0 lds
    v_mfma_f32_16x16x32_bf16 v[164:167], v[64:67], v[52:55], v[164:167]
    v_mfma_f32_16x16x32_bf16 v[192:195], v[64:67], v[56:59], v[192:195]
    buffer_load_dwordx4 v21, s[84:87], s94 offen offset:1024 lds
    v_mfma_f32_16x16x32_bf16 v[196:199], v[64:67], v[60:63], v[196:199]
    ds_read_b64_tr_b16 v[64:65], v14 offset:32768
    ds_read_b64_tr_b16 v[66:67], v14 offset:34816
    v_mfma_f32_16x16x32_bf16 v[168:171], v[68:71], v[48:51], v[168:171]
    buffer_load_dwordx4 v22, s[84:87], s94 offen offset:2048 lds
    v_mfma_f32_16x16x32_bf16 v[172:175], v[68:71], v[52:55], v[172:175]
    v_mfma_f32_16x16x32_bf16 v[200:203], v[68:71], v[56:59], v[200:203]
    buffer_load_dwordx4 v23, s[84:87], s94 offen offset:3072 lds
    s_add_u32 s94, s94, s76
    v_mfma_f32_16x16x32_bf16 v[204:207], v[68:71], v[60:63], v[204:207]
    ds_read_b64_tr_b16 v[68:69], v15 offset:32768
    ds_read_b64_tr_b16 v[70:71], v15 offset:34816
    s_waitcnt lgkmcnt(6)
    v_mfma_f32_16x16x32_bf16 v[80:83], v[40:43], v[24:27], v[80:83]
    ds_read_b128 v[48:51], v10 offset:40960
    s_mov_b32 m0, s20
    s_nop 0
    buffer_load_dwordx4 v72, s[64:67], s72 offen offset:0 lds
    v_mfma_f32_16x16x32_bf16 v[84:87], v[40:43], v[28:31], v[84:87]
    ds_read_b128 v[52:55], v10 offset:43008
    v_mfma_f32_16x16x32_bf16 v[112:115], v[40:43], v[32:35], v[112:115]
    ds_read_b128 v[56:59], v10 offset:45056
    buffer_load_dwordx4 v72, s[64:67], s72 offen offset:1024 lds
    v_mfma_f32_16x16x32_bf16 v[116:119], v[40:43], v[36:39], v[116:119]
    ds_read_b128 v[60:63], v10 offset:47104
    s_waitcnt lgkmcnt(8)
    v_mfma_f32_16x16x32_bf16 v[88:91], v[44:47], v[24:27], v[88:91]
    buffer_load_dwordx4 v72, s[64:67], s72 offen offset:2048 lds
    v_mfma_f32_16x16x32_bf16 v[92:95], v[44:47], v[28:31], v[92:95]
    v_mfma_f32_16x16x32_bf16 v[120:123], v[44:47], v[32:35], v[120:123]
    buffer_load_dwordx4 v72, s[64:67], s72 offen offset:3072 lds
    s_add_u32 s72, s72, s74
    v_mfma_f32_16x16x32_bf16 v[124:127], v[44:47], v[36:39], v[124:127]
    s_waitcnt lgkmcnt(6)
    v_mfma_f32_16x16x32_bf16 v[96:99], v[64:67], v[24:27], v[96:99]
    s_add_u32 m0, s20, 4096
    s_nop 0
    buffer_load_dwordx4 v72, s[64:67], s25 offen offset:0 lds
    v_mfma_f32_16x16x32_bf16 v[100:103], v[64:67], v[28:31], v[100:103]
    v_mfma_f32_16x16x32_bf16 v[128:131], v[64:67], v[32:35], v[128:131]
    buffer_load_dwordx4 v72, s[64:67], s25 offen offset:1024 lds
    v_mfma_f32_16x16x32_bf16 v[132:135], v[64:67], v[36:39], v[132:135]
    s_waitcnt lgkmcnt(4)
    v_mfma_f32_16x16x32_bf16 v[104:107], v[68:71], v[24:27], v[104:107]
    buffer_load_dwordx4 v72, s[64:67], s25 offen offset:2048 lds
    v_mfma_f32_16x16x32_bf16 v[108:111], v[68:71], v[28:31], v[108:111]
    v_mfma_f32_16x16x32_bf16 v[136:139], v[68:71], v[32:35], v[136:139]
    buffer_load_dwordx4 v72, s[64:67], s25 offen offset:3072 lds
    s_add_u32 s25, s25, s74
    v_mfma_f32_16x16x32_bf16 v[140:143], v[68:71], v[36:39], v[140:143]
    s_waitcnt lgkmcnt(3)
    v_mfma_f32_16x16x32_bf16 v[144:147], v[40:43], v[48:51], v[144:147]
    ds_read_b128 v[24:27], v11 offset:32768
    s_waitcnt lgkmcnt(3)
    v_mfma_f32_16x16x32_bf16 v[148:151], v[40:43], v[52:55], v[148:151]
    ds_read_b128 v[28:31], v11 offset:34816
    s_waitcnt lgkmcnt(3)
    v_mfma_f32_16x16x32_bf16 v[176:179], v[40:43], v[56:59], v[176:179]
    ds_read_b128 v[32:35], v11 offset:36864
    s_waitcnt lgkmcnt(3)
    v_mfma_f32_16x16x32_bf16 v[180:183], v[40:43], v[60:63], v[180:183]
    ds_read_b128 v[36:39], v11 offset:38912
    ds_read_b64_tr_b16 v[40:41], v12 offset:49152
    ds_read_b64_tr_b16 v[42:43], v12 offset:51200
    v_mfma_f32_16x16x32_bf16 v[152:155], v[44:47], v[48:51], v[152:155]
    v_mfma_f32_16x16x32_bf16 v[156:159], v[44:47], v[52:55], v[156:159]
    v_mfma_f32_16x16x32_bf16 v[184:187], v[44:47], v[56:59], v[184:187]
    v_mfma_f32_16x16x32_bf16 v[188:191], v[44:47], v[60:63], v[188:191]
    ds_read_b64_tr_b16 v[44:45], v13 offset:49152
    ds_read_b64_tr_b16 v[46:47], v13 offset:51200
    v_mfma_f32_16x16x32_bf16 v[160:163], v[64:67], v[48:51], v[160:163]
    v_mfma_f32_16x16x32_bf16 v[164:167], v[64:67], v[52:55], v[164:167]
    v_mfma_f32_16x16x32_bf16 v[192:195], v[64:67], v[56:59], v[192:195]
    v_mfma_f32_16x16x32_bf16 v[196:199], v[64:67], v[60:63], v[196:199]
    ds_read_b64_tr_b16 v[64:65], v14 offset:49152
    ds_read_b64_tr_b16 v[66:67], v14 offset:51200
    v_mfma_f32_16x16x32_bf16 v[168:171], v[68:71], v[48:51], v[168:171]
    v_mfma_f32_16x16x32_bf16 v[172:175], v[68:71], v[52:55], v[172:175]
    v_mfma_f32_16x16x32_bf16 v[200:203], v[68:71], v[56:59], v[200:203]
    v_mfma_f32_16x16x32_bf16 v[204:207], v[68:71], v[60:63], v[204:207]
    ds_read_b64_tr_b16 v[68:69], v15 offset:49152
    ds_read_b64_tr_b16 v[70:71], v15 offset:51200
    s_waitcnt lgkmcnt(6)
    v_mfma_f32_16x16x32_bf16 v[80:83], v[40:43], v[24:27], v[80:83]
    ds_read_b128 v[48:51], v11 offset:40960
    v_mfma_f32_16x16x32_bf16 v[84:87], v[40:43], v[28:31], v[84:87]
    ds_read_b128 v[52:55], v11 offset:43008
    v_mfma_f32_16x16x32_bf16 v[112:115], v[40:43], v[32:35], v[112:115]
    ds_read_b128 v[56:59], v11 offset:45056
    v_mfma_f32_16x16x32_bf16 v[116:119], v[40:43], v[36:39], v[116:119]
    ds_read_b128 v[60:63], v11 offset:47104
    s_waitcnt lgkmcnt(8)
    v_mfma_f32_16x16x32_bf16 v[88:91], v[44:47], v[24:27], v[88:91]
    v_mfma_f32_16x16x32_bf16 v[92:95], v[44:47], v[28:31], v[92:95]
    v_mfma_f32_16x16x32_bf16 v[120:123], v[44:47], v[32:35], v[120:123]
    v_mfma_f32_16x16x32_bf16 v[124:127], v[44:47], v[36:39], v[124:127]
    s_waitcnt lgkmcnt(6)
    v_mfma_f32_16x16x32_bf16 v[96:99], v[64:67], v[24:27], v[96:99]
    v_mfma_f32_16x16x32_bf16 v[100:103], v[64:67], v[28:31], v[100:103]
    v_mfma_f32_16x16x32_bf16 v[128:131], v[64:67], v[32:35], v[128:131]
    v_mfma_f32_16x16x32_bf16 v[132:135], v[64:67], v[36:39], v[132:135]
    s_waitcnt lgkmcnt(4)
    v_mfma_f32_16x16x32_bf16 v[104:107], v[68:71], v[24:27], v[104:107]
    v_mfma_f32_16x16x32_bf16 v[108:111], v[68:71], v[28:31], v[108:111]
    v_mfma_f32_16x16x32_bf16 v[136:139], v[68:71], v[32:35], v[136:139]
    v_mfma_f32_16x16x32_bf16 v[140:143], v[68:71], v[36:39], v[140:143]
    s_waitcnt lgkmcnt(0) vmcnt(0)
    s_barrier
    v_bfe_u32 v18, v1, 6, 2
    v_lshrrev_b32 v17, 8, v1
    v_lshl_add_u32 v17, v17, 3, v18
    v_and_b32 v16, 3, v17
    v_lshlrev_b32 v16, 2, v16
    v_bfe_u32 v19, v17, 3, 1
    v_lshl_or_b32 v16, v19, 1, v16
    v_lshlrev_b32 v17, 8, v17
    v_bfe_u32 v18, v1, 4, 1
    v_lshl_add_u32 v17, v18, 3, v17
    v_bfe_u32 v18, v1, 5, 1
    s_lshl_b32 s31, s28, 2
    s_add_u32 s31, s31, 0
    v_add_u32 v19, s31, v18
    v_xor_b32 v19, v19, v16
    v_lshl_add_u32 v19, v19, 4, v17
    v_add_u32 v14, 65536, v19
    s_lshl_b32 s31, s28, 2
    s_add_u32 s31, s31, 2
    v_add_u32 v19, s31, v18
    v_xor_b32 v19, v19, v16
    v_lshl_add_u32 v19, v19, 4, v17
    v_add_u32 v15, 65536, v19
    v_mfma_f32_16x16x32_bf16 v[144:147], v[40:43], v[48:51], v[144:147]
    ds_read_b128 v[24:27], v77 offset:0
    s_mov_b32 m0, s24
    s_nop 0
    buffer_load_dwordx4 v73, s[68:71], s73 offen offset:0 lds
    v_mfma_f32_16x16x32_bf16 v[148:151], v[40:43], v[52:55], v[148:151]
    ds_read_b128 v[28:31], v77 offset:256
    v_mfma_f32_16x16x32_bf16 v[176:179], v[40:43], v[56:59], v[176:179]
    ds_read_b128 v[32:35], v77 offset:4096
    buffer_load_dwordx4 v74, s[68:71], s73 offen offset:1024 lds
    v_mfma_f32_16x16x32_bf16 v[180:183], v[40:43], v[60:63], v[180:183]
    ds_read_b128 v[36:39], v77 offset:4352
    ds_read_b64_tr_b16 v[40:41], v14 offset:0
    ds_read_b64_tr_b16 v[42:43], v14 offset:1024
    v_mfma_f32_16x16x32_bf16 v[152:155], v[44:47], v[48:51], v[152:155]
    buffer_load_dwordx4 v75, s[68:71], s73 offen offset:2048 lds
    v_mfma_f32_16x16x32_bf16 v[156:159], v[44:47], v[52:55], v[156:159]
    v_mfma_f32_16x16x32_bf16 v[184:187], v[44:47], v[56:59], v[184:187]
    buffer_load_dwordx4 v76, s[68:71], s73 offen offset:3072 lds
    s_add_u32 s73, s73, s75
    v_mfma_f32_16x16x32_bf16 v[188:191], v[44:47], v[60:63], v[188:191]
    ds_read_b64_tr_b16 v[44:45], v15 offset:0
    ds_read_b64_tr_b16 v[46:47], v15 offset:1024
    v_mfma_f32_16x16x32_bf16 v[160:163], v[64:67], v[48:51], v[160:163]
    s_add_u32 m0, s24, 16384
    s_nop 0
    buffer_load_dwordx4 v20, s[84:87], s94 offen offset:0 lds
    v_mfma_f32_16x16x32_bf16 v[164:167], v[64:67], v[52:55], v[164:167]
    v_mfma_f32_16x16x32_bf16 v[192:195], v[64:67], v[56:59], v[192:195]
    buffer_load_dwordx4 v21, s[84:87], s94 offen offset:1024 lds
    v_mfma_f32_16x16x32_bf16 v[196:199], v[64:67], v[60:63], v[196:199]
    ds_read_b64_tr_b16 v[64:65], v14 offset:16384
    ds_read_b64_tr_b16 v[66:67], v14 offset:17408
    v_mfma_f32_16x16x32_bf16 v[168:171], v[68:71], v[48:51], v[168:171]
    buffer_load_dwordx4 v22, s[84:87], s94 offen offset:2048 lds
    v_mfma_f32_16x16x32_bf16 v[172:175], v[68:71], v[52:55], v[172:175]
    v_mfma_f32_16x16x32_bf16 v[200:203], v[68:71], v[56:59], v[200:203]
    buffer_load_dwordx4 v23, s[84:87], s94 offen offset:3072 lds
    s_add_u32 s94, s94, s76
    v_mfma_f32_16x16x32_bf16 v[204:207], v[68:71], v[60:63], v[204:207]
    ds_read_b64_tr_b16 v[68:69], v15 offset:16384
    ds_read_b64_tr_b16 v[70:71], v15 offset:17408
    s_branch L_pj_TD
L_pj_VD:
    ds_read_b64_tr_b16 v[40:41], v12 offset:0
    ds_read_b64_tr_b16 v[42:43], v12 offset:2048
    ds_read_b128 v[24:27], v10 offset:0
    ds_read_b128 v[28:31], v10 offset:2048
    ds_read_b128 v[32:35], v10 offset:4096
    ds_read_b128 v[36:39], v10 offset:6144
    ds_read_b64_tr_b16 v[44:45], v13 offset:0
    ds_read_b64_tr_b16 v[46:47], v13 offset:2048
    ds_read_b64_tr_b16 v[64:65], v14 offset:0
    ds_read_b64_tr_b16 v[66:67], v14 offset:2048
    ds_read_b64_tr_b16 v[68:69], v15 offset:0
    ds_read_b64_tr_b16 v[70:71], v15 offset:2048
    s_waitcnt lgkmcnt(9)
    v_mfma_f32_16x16x32_bf16 v[80:83], v[24:27], v[40:43], 0
    ds_read_b128 v[48:51], v10 offset:8192
    s_waitcnt vmcnt(0)
    v_lshlrev_b32 v208, 16, v248
    s_waitcnt lgkmcnt(9)
    v_mfma_f32_16x16x32_bf16 v[88:91], v[28:31], v[40:43], 0
    ds_read_b128 v[52:55], v10 offset:10240
    v_and_b32 v209, 0xffff0000, v248
    v_lshlrev_b32 v210, 16, v249
    s_waitcnt lgkmcnt(9)
    v_mfma_f32_16x16x32_bf16 v[112:115], v[32:35], v[40:43], 0
    ds_read_b128 v[56:59], v10 offset:12288
    v_and_b32 v211, 0xffff0000, v249
    v_lshlrev_b32 v212, 16, v250
    s_waitcnt lgkmcnt(9)
    v_mfma_f32_16x16x32_bf16 v[120:123], v[36:39], v[40:43], 0
    ds_read_b128 v[60:63], v10 offset:14336
    v_and_b32 v213, 0xffff0000, v250
    v_lshlrev_b32 v214, 16, v251
    s_waitcnt lgkmcnt(8)
    v_mfma_f32_16x16x32_bf16 v[84:87], v[24:27], v[44:47], 0
    v_and_b32 v215, 0xffff0000, v251
    v_lshlrev_b32 v216, 16, v252
    v_mfma_f32_16x16x32_bf16 v[92:95], v[28:31], v[44:47], 0
    v_and_b32 v217, 0xffff0000, v252
    v_mfma_f32_16x16x32_bf16 v[116:119], v[32:35], v[44:47], 0
    v_lshlrev_b32 v218, 16, v253
    v_and_b32 v219, 0xffff0000, v253
    v_mfma_f32_16x16x32_bf16 v[124:127], v[36:39], v[44:47], 0
    v_lshlrev_b32 v220, 16, v254
    v_and_b32 v221, 0xffff0000, v254
    s_waitcnt lgkmcnt(6)
    v_mfma_f32_16x16x32_bf16 v[96:99], v[24:27], v[64:67], 0
    v_lshlrev_b32 v222, 16, v255
    v_and_b32 v223, 0xffff0000, v255
    v_mfma_f32_16x16x32_bf16 v[104:107], v[28:31], v[64:67], 0
    v_add_f32 v224, v208, v209
    v_add_f32 v226, v210, v211
    v_mfma_f32_16x16x32_bf16 v[128:131], v[32:35], v[64:67], 0
    v_add_f32 v224, v224, v212
    v_mfma_f32_16x16x32_bf16 v[136:139], v[36:39], v[64:67], 0
    v_add_f32 v226, v226, v213
    v_add_f32 v224, v224, v214
    s_waitcnt lgkmcnt(4)
    v_mfma_f32_16x16x32_bf16 v[100:103], v[24:27], v[68:71], 0
    v_add_f32 v226, v226, v215
    v_add_f32 v224, v224, v216
    v_mfma_f32_16x16x32_bf16 v[108:111], v[28:31], v[68:71], 0
    v_add_f32 v226, v226, v217
    v_add_f32 v224, v224, v218
    v_mfma_f32_16x16x32_bf16 v[132:135], v[32:35], v[68:71], 0
    v_add_f32 v226, v226, v219
    v_add_f32 v224, v224, v220
    v_mfma_f32_16x16x32_bf16 v[140:143], v[36:39], v[68:71], 0
    v_add_f32 v226, v226, v221
    s_waitcnt lgkmcnt(3)
    v_mfma_f32_16x16x32_bf16 v[144:147], v[48:51], v[40:43], 0
    ds_read_b128 v[24:27], v11 offset:0
    v_add_f32 v224, v224, v222
    v_add_f32 v226, v226, v223
    s_waitcnt lgkmcnt(3)
    v_mfma_f32_16x16x32_bf16 v[152:155], v[52:55], v[40:43], 0
    ds_read_b128 v[28:31], v11 offset:2048
    v_add_f32 v224, v224, v226
    s_nop 1
    s_waitcnt lgkmcnt(3)
    v_mfma_f32_16x16x32_bf16 v[176:179], v[56:59], v[40:43], 0
    ds_read_b128 v[32:35], v11 offset:4096
    v_add_f32_dpp v224, v224, v224 quad_perm:[1,0,3,2] row_mask:0xf bank_mask:0xf
    s_nop 1
    s_waitcnt lgkmcnt(3)
    v_mfma_f32_16x16x32_bf16 v[184:187], v[60:63], v[40:43], 0
    ds_read_b128 v[36:39], v11 offset:6144
    ds_read_b64_tr_b16 v[40:41], v12 offset:16384
    ds_read_b64_tr_b16 v[42:43], v12 offset:18432
    v_add_f32_dpp v224, v224, v224 quad_perm:[2,3,0,1] row_mask:0xf bank_mask:0xf
    s_nop 1
    v_mfma_f32_16x16x32_bf16 v[148:151], v[48:51], v[44:47], 0
    v_add_f32_dpp v224, v224, v224 row_half_mirror row_mask:0xf bank_mask:0xf
    s_nop 1
    v_mfma_f32_16x16x32_bf16 v[156:159], v[52:55], v[44:47], 0
    v_add_f32_dpp v224, v224, v224 row_mirror row_mask:0xf bank_mask:0xf
    v_mfma_f32_16x16x32_bf16 v[180:183], v[56:59], v[44:47], 0
    v_mov_b32 v226, v224
    s_nop 1
    v_mfma_f32_16x16x32_bf16 v[188:191], v[60:63], v[44:47], 0
    ds_read_b64_tr_b16 v[44:45], v13 offset:16384
    ds_read_b64_tr_b16 v[46:47], v13 offset:18432
    v_permlane16_swap_b32 v226, v224
    v_add_f32 v224, v224, v226
    v_mfma_f32_16x16x32_bf16 v[160:163], v[48:51], v[64:67], 0
    v_mov_b32 v226, v224
    s_nop 1
    v_mfma_f32_16x16x32_bf16 v[168:171], v[52:55], v[64:67], 0
    v_permlane32_swap_b32 v226, v224
    v_add_f32 v224, v224, v226
    v_mfma_f32_16x16x32_bf16 v[192:195], v[56:59], v[64:67], 0
    v_mul_f32 v224, 0x3a800000, v224
    v_mfma_f32_16x16x32_bf16 v[200:203], v[60:63], v[64:67], 0
    ds_read_b64_tr_b16 v[64:65], v14 offset:16384
    ds_read_b64_tr_b16 v[66:67], v14 offset:18432
    v_sub_f32 v227, v208, v224
    v_mul_f32 v225, v227, v227
    v_mfma_f32_16x16x32_bf16 v[164:167], v[48:51], v[68:71], 0
    v_sub_f32 v227, v209, v224
    v_fmac_f32 v225, v227, v227
    v_mfma_f32_16x16x32_bf16 v[172:175], v[52:55], v[68:71], 0
    v_sub_f32 v227, v210, v224
    v_fmac_f32 v225, v227, v227
    v_mfma_f32_16x16x32_bf16 v[196:199], v[56:59], v[68:71], 0
    v_sub_f32 v227, v211, v224
    v_fmac_f32 v225, v227, v227
    v_mfma_f32_16x16x32_bf16 v[204:207], v[60:63], v[68:71], 0
    ds_read_b64_tr_b16 v[68:69], v15 offset:16384
    ds_read_b64_tr_b16 v[70:71], v15 offset:18432
    v_sub_f32 v227, v212, v224
    s_waitcnt lgkmcnt(6)
    v_mfma_f32_16x16x32_bf16 v[80:83], v[24:27], v[40:43], v[80:83]
    ds_read_b128 v[48:51], v11 offset:8192
    v_fmac_f32 v225, v227, v227
    v_sub_f32 v227, v213, v224
    v_mfma_f32_16x16x32_bf16 v[88:91], v[28:31], v[40:43], v[88:91]
    ds_read_b128 v[52:55], v11 offset:10240
    v_fmac_f32 v225, v227, v227
    v_sub_f32 v227, v214, v224
    v_mfma_f32_16x16x32_bf16 v[112:115], v[32:35], v[40:43], v[112:115]
    ds_read_b128 v[56:59], v11 offset:12288
    v_fmac_f32 v225, v227, v227
    v_sub_f32 v227, v215, v224
    v_mfma_f32_16x16x32_bf16 v[120:123], v[36:39], v[40:43], v[120:123]
    ds_read_b128 v[60:63], v11 offset:14336
    v_fmac_f32 v225, v227, v227
    v_sub_f32 v227, v216, v224
    s_waitcnt lgkmcnt(8)
    v_mfma_f32_16x16x32_bf16 v[84:87], v[24:27], v[44:47], v[84:87]
    v_fmac_f32 v225, v227, v227
    v_sub_f32 v227, v217, v224
    v_mfma_f32_16x16x32_bf16 v[92:95], v[28:31], v[44:47], v[92:95]
    v_fmac_f32 v225, v227, v227
    v_mfma_f32_16x16x32_bf16 v[116:119], v[32:35], v[44:47], v[116:119]
    v_sub_f32 v227, v218, v224
    v_fmac_f32 v225, v227, v227
    v_mfma_f32_16x16x32_bf16 v[124:127], v[36:39], v[44:47], v[124:127]
    v_sub_f32 v227, v219, v224
    v_fmac_f32 v225, v227, v227
    s_waitcnt lgkmcnt(6)
    v_mfma_f32_16x16x32_bf16 v[96:99], v[24:27], v[64:67], v[96:99]
    v_sub_f32 v227, v220, v224
    v_fmac_f32 v225, v227, v227
    v_mfma_f32_16x16x32_bf16 v[104:107], v[28:31], v[64:67], v[104:107]
    v_sub_f32 v227, v221, v224
    v_fmac_f32 v225, v227, v227
    v_mfma_f32_16x16x32_bf16 v[128:131], v[32:35], v[64:67], v[128:131]
    v_sub_f32 v227, v222, v224
    v_mfma_f32_16x16x32_bf16 v[136:139], v[36:39], v[64:67], v[136:139]
    v_fmac_f32 v225, v227, v227
    v_sub_f32 v227, v223, v224
    s_waitcnt lgkmcnt(4)
    v_mfma_f32_16x16x32_bf16 v[100:103], v[24:27], v[68:71], v[100:103]
    v_fmac_f32 v225, v227, v227
    s_nop 1
    v_mfma_f32_16x16x32_bf16 v[108:111], v[28:31], v[68:71], v[108:111]
    v_add_f32_dpp v225, v225, v225 quad_perm:[1,0,3,2] row_mask:0xf bank_mask:0xf
    s_nop 1
    v_mfma_f32_16x16x32_bf16 v[132:135], v[32:35], v[68:71], v[132:135]
    v_add_f32_dpp v225, v225, v225 quad_perm:[2,3,0,1] row_mask:0xf bank_mask:0xf
    s_nop 1
    v_mfma_f32_16x16x32_bf16 v[140:143], v[36:39], v[68:71], v[140:143]
    v_add_f32_dpp v225, v225, v225 row_half_mirror row_mask:0xf bank_mask:0xf
    s_waitcnt lgkmcnt(0)
    s_barrier
    v_mfma_f32_16x16x32_bf16 v[144:147], v[48:51], v[40:43], v[144:147]
    ds_read_b128 v[24:27], v10 offset:32768
    s_mov_b32 m0, s23
    s_nop 0
    buffer_load_dwordx4 v6, s[8:11], s17 offen offset:0 lds
    v_mfma_f32_16x16x32_bf16 v[152:155], v[52:55], v[40:43], v[152:155]
    ds_read_b128 v[28:31], v10 offset:34816
    v_mfma_f32_16x16x32_bf16 v[176:179], v[56:59], v[40:43], v[176:179]
    ds_read_b128 v[32:35], v10 offset:36864
    buffer_load_dwordx4 v7, s[8:11], s17 offen offset:1024 lds
    v_mfma_f32_16x16x32_bf16 v[184:187], v[60:63], v[40:43], v[184:187]
    ds_read_b128 v[36:39], v10 offset:38912
    ds_read_b64_tr_b16 v[40:41], v12 offset:32768
    ds_read_b64_tr_b16 v[42:43], v12 offset:34816
    v_mfma_f32_16x16x32_bf16 v[148:151], v[48:51], v[44:47], v[148:151]
    buffer_load_dwordx4 v8, s[8:11], s17 offen offset:2048 lds
    v_mfma_f32_16x16x32_bf16 v[156:159], v[52:55], v[44:47], v[156:159]
    v_mfma_f32_16x16x32_bf16 v[180:183], v[56:59], v[44:47], v[180:183]
    buffer_load_dwordx4 v9, s[8:11], s17 offen offset:3072 lds
    s_add_u32 s17, s17, s26
    v_mfma_f32_16x16x32_bf16 v[188:191], v[60:63], v[44:47], v[188:191]
    ds_read_b64_tr_b16 v[44:45], v13 offset:32768
    ds_read_b64_tr_b16 v[46:47], v13 offset:34816
    v_mfma_f32_16x16x32_bf16 v[160:163], v[48:51], v[64:67], v[160:163]
    s_add_u32 m0, s23, 16384
    s_nop 0
    buffer_load_dwordx4 v6, s[8:11], s22 offen offset:0 lds
    v_mfma_f32_16x16x32_bf16 v[168:171], v[52:55], v[64:67], v[168:171]
    v_mfma_f32_16x16x32_bf16 v[192:195], v[56:59], v[64:67], v[192:195]
    buffer_load_dwordx4 v7, s[8:11], s22 offen offset:1024 lds
    v_mfma_f32_16x16x32_bf16 v[200:203], v[60:63], v[64:67], v[200:203]
    ds_read_b64_tr_b16 v[64:65], v14 offset:32768
    ds_read_b64_tr_b16 v[66:67], v14 offset:34816
    v_mfma_f32_16x16x32_bf16 v[164:167], v[48:51], v[68:71], v[164:167]
    buffer_load_dwordx4 v8, s[8:11], s22 offen offset:2048 lds
    v_mfma_f32_16x16x32_bf16 v[172:175], v[52:55], v[68:71], v[172:175]
    v_mfma_f32_16x16x32_bf16 v[196:199], v[56:59], v[68:71], v[196:199]
    buffer_load_dwordx4 v9, s[8:11], s22 offen offset:3072 lds
    s_add_u32 s22, s22, s26
    v_mfma_f32_16x16x32_bf16 v[204:207], v[60:63], v[68:71], v[204:207]
    ds_read_b64_tr_b16 v[68:69], v15 offset:32768
    ds_read_b64_tr_b16 v[70:71], v15 offset:34816
    s_waitcnt lgkmcnt(6)
    v_mfma_f32_16x16x32_bf16 v[80:83], v[24:27], v[40:43], v[80:83]
    ds_read_b128 v[48:51], v10 offset:40960
    s_mov_b32 m0, s20
    s_nop 0
    buffer_load_dwordx4 v2, s[4:7], s16 offen offset:0 lds
    buffer_load_dwordx4 v3, s[4:7], s16 offen offset:1024 lds
    buffer_load_dwordx4 v4, s[4:7], s16 offen offset:2048 lds
    v_mfma_f32_16x16x32_bf16 v[88:91], v[28:31], v[40:43], v[88:91]
    ds_read_b128 v[52:55], v10 offset:43008
    buffer_load_dwordx4 v5, s[4:7], s16 offen offset:3072 lds
    s_add_u32 s16, s16, s33
    s_add_u32 m0, s20, 4096
    s_nop 0
    buffer_load_dwordx4 v2, s[4:7], s18 offen offset:0 lds
    v_mfma_f32_16x16x32_bf16 v[112:115], v[32:35], v[40:43], v[112:115]
    ds_read_b128 v[56:59], v10 offset:45056
    buffer_load_dwordx4 v3, s[4:7], s18 offen offset:1024 lds
    buffer_load_dwordx4 v4, s[4:7], s18 offen offset:2048 lds
    v_mfma_f32_16x16x32_bf16 v[120:123], v[36:39], v[40:43], v[120:123]
    ds_read_b128 v[60:63], v10 offset:47104
    buffer_load_dwordx4 v5, s[4:7], s18 offen offset:3072 lds
    s_add_u32 s18, s18, s33
    s_nop 1
    v_add_f32_dpp v225, v225, v225 row_mirror row_mask:0xf bank_mask:0xf
    s_waitcnt lgkmcnt(8)
    v_mfma_f32_16x16x32_bf16 v[84:87], v[24:27], v[44:47], v[84:87]
    v_mov_b32 v226, v225
    s_nop 1
    v_mfma_f32_16x16x32_bf16 v[92:95], v[28:31], v[44:47], v[92:95]
    v_permlane16_swap_b32 v226, v225
    v_add_f32 v225, v225, v226
    v_mfma_f32_16x16x32_bf16 v[116:119], v[32:35], v[44:47], v[116:119]
    v_mov_b32 v226, v225
    s_nop 1
    v_permlane32_swap_b32 v226, v225
    v_mfma_f32_16x16x32_bf16 v[124:127], v[36:39], v[44:47], v[124:127]
    v_add_f32 v225, v225, v226
    v_mul_f32 v225, 0x3a800000, v225
    s_waitcnt lgkmcnt(6)
    v_mfma_f32_16x16x32_bf16 v[96:99], v[24:27], v[64:67], v[96:99]
    v_cvt_pk_bf16_f32 v224, v224, v224
    v_lshlrev_b32 v224, 16, v224
    v_mfma_f32_16x16x32_bf16 v[104:107], v[28:31], v[64:67], v[104:107]
    v_cvt_pk_bf16_f32 v225, v225, v225
    v_lshlrev_b32 v225, 16, v225
    v_add_f32 v225, 0x3727c5ac, v225
    v_mfma_f32_16x16x32_bf16 v[128:131], v[32:35], v[64:67], v[128:131]
    v_cvt_pk_bf16_f32 v225, v225, v225
    v_lshlrev_b32 v225, 16, v225
    v_mfma_f32_16x16x32_bf16 v[136:139], v[36:39], v[64:67], v[136:139]
    v_sqrt_f32 v225, v225
    s_nop 0
    s_waitcnt lgkmcnt(4)
    v_mfma_f32_16x16x32_bf16 v[100:103], v[24:27], v[68:71], v[100:103]
    v_cvt_pk_bf16_f32 v225, v225, v225
    v_lshlrev_b32 v225, 16, v225
    v_rcp_f32 v225, v225
    v_mfma_f32_16x16x32_bf16 v[108:111], v[28:31], v[68:71], v[108:111]
    v_sub_f32 v208, v208, v224
    v_sub_f32 v209, v209, v224
    v_mfma_f32_16x16x32_bf16 v[132:135], v[32:35], v[68:71], v[132:135]
    v_sub_f32 v210, v210, v224
    v_sub_f32 v211, v211, v224
    v_mfma_f32_16x16x32_bf16 v[140:143], v[36:39], v[68:71], v[140:143]
    v_sub_f32 v212, v212, v224
    v_sub_f32 v213, v213, v224
    s_waitcnt lgkmcnt(3)
    v_mfma_f32_16x16x32_bf16 v[144:147], v[48:51], v[40:43], v[144:147]
    ds_read_b128 v[24:27], v11 offset:32768
    v_sub_f32 v214, v214, v224
    v_sub_f32 v215, v215, v224
    s_waitcnt lgkmcnt(3)
    v_mfma_f32_16x16x32_bf16 v[152:155], v[52:55], v[40:43], v[152:155]
    ds_read_b128 v[28:31], v11 offset:34816
    v_sub_f32 v216, v216, v224
    v_sub_f32 v217, v217, v224
    s_waitcnt lgkmcnt(3)
    v_mfma_f32_16x16x32_bf16 v[176:179], v[56:59], v[40:43], v[176:179]
    ds_read_b128 v[32:35], v11 offset:36864
    v_sub_f32 v218, v218, v224
    v_sub_f32 v219, v219, v224
    s_waitcnt lgkmcnt(3)
    v_mfma_f32_16x16x32_bf16 v[184:187], v[60:63], v[40:43], v[184:187]
    ds_read_b128 v[36:39], v11 offset:38912
    ds_read_b64_tr_b16 v[40:41], v12 offset:49152
    ds_read_b64_tr_b16 v[42:43], v12 offset:51200
    v_sub_f32 v220, v220, v224
    v_sub_f32 v221, v221, v224
    v_mfma_f32_16x16x32_bf16 v[148:151], v[48:51], v[44:47], v[148:151]
    v_sub_f32 v222, v222, v224
    v_sub_f32 v223, v223, v224
    v_mfma_f32_16x16x32_bf16 v[156:159], v[52:55], v[44:47], v[156:159]
    v_cvt_pk_bf16_f32 v248, v208, v209
    v_mfma_f32_16x16x32_bf16 v[180:183], v[56:59], v[44:47], v[180:183]
    v_cvt_pk_bf16_f32 v249, v210, v211
    v_cvt_pk_bf16_f32 v250, v212, v213
    v_mfma_f32_16x16x32_bf16 v[188:191], v[60:63], v[44:47], v[188:191]
    ds_read_b64_tr_b16 v[44:45], v13 offset:49152
    ds_read_b64_tr_b16 v[46:47], v13 offset:51200
    v_cvt_pk_bf16_f32 v251, v214, v215
    v_cvt_pk_bf16_f32 v252, v216, v217
    v_mfma_f32_16x16x32_bf16 v[160:163], v[48:51], v[64:67], v[160:163]
    v_cvt_pk_bf16_f32 v253, v218, v219
    v_cvt_pk_bf16_f32 v254, v220, v221
    v_mfma_f32_16x16x32_bf16 v[168:171], v[52:55], v[64:67], v[168:171]
    v_cvt_pk_bf16_f32 v255, v222, v223
    v_lshlrev_b32 v208, 16, v248
    v_mfma_f32_16x16x32_bf16 v[192:195], v[56:59], v[64:67], v[192:195]
    v_and_b32 v209, 0xffff0000, v248
    v_mfma_f32_16x16x32_bf16 v[200:203], v[60:63], v[64:67], v[200:203]
    ds_read_b64_tr_b16 v[64:65], v14 offset:49152
    ds_read_b64_tr_b16 v[66:67], v14 offset:51200
    v_lshlrev_b32 v210, 16, v249
    v_and_b32 v211, 0xffff0000, v249
    v_mfma_f32_16x16x32_bf16 v[164:167], v[48:51], v[68:71], v[164:167]
    v_lshlrev_b32 v212, 16, v250
    v_and_b32 v213, 0xffff0000, v250
    v_mfma_f32_16x16x32_bf16 v[172:175], v[52:55], v[68:71], v[172:175]
    v_lshlrev_b32 v214, 16, v251
    v_and_b32 v215, 0xffff0000, v251
    v_mfma_f32_16x16x32_bf16 v[196:199], v[56:59], v[68:71], v[196:199]
    v_lshlrev_b32 v216, 16, v252
    v_and_b32 v217, 0xffff0000, v252
    v_mfma_f32_16x16x32_bf16 v[204:207], v[60:63], v[68:71], v[204:207]
    ds_read_b64_tr_b16 v[68:69], v15 offset:49152
    ds_read_b64_tr_b16 v[70:71], v15 offset:51200
    v_lshlrev_b32 v218, 16, v253
    s_waitcnt lgkmcnt(6)
    v_mfma_f32_16x16x32_bf16 v[80:83], v[24:27], v[40:43], v[80:83]
    ds_read_b128 v[48:51], v11 offset:40960
    v_and_b32 v219, 0xffff0000, v253
    v_lshlrev_b32 v220, 16, v254
    v_mfma_f32_16x16x32_bf16 v[88:91], v[28:31], v[40:43], v[88:91]
    ds_read_b128 v[52:55], v11 offset:43008
    v_and_b32 v221, 0xffff0000, v254
    v_lshlrev_b32 v222, 16, v255
    v_mfma_f32_16x16x32_bf16 v[112:115], v[32:35], v[40:43], v[112:115]
    ds_read_b128 v[56:59], v11 offset:45056
    v_and_b32 v223, 0xffff0000, v255
    v_mul_f32 v208, v208, v225
    v_mfma_f32_16x16x32_bf16 v[120:123], v[36:39], v[40:43], v[120:123]
    ds_read_b128 v[60:63], v11 offset:47104
    v_mul_f32 v209, v209, v225
    v_mul_f32 v210, v210, v225
    s_waitcnt lgkmcnt(8)
    v_mfma_f32_16x16x32_bf16 v[84:87], v[24:27], v[44:47], v[84:87]
    v_mul_f32 v211, v211, v225
    v_mul_f32 v212, v212, v225
    v_mfma_f32_16x16x32_bf16 v[92:95], v[28:31], v[44:47], v[92:95]
    v_mul_f32 v213, v213, v225
    v_mul_f32 v214, v214, v225
    v_mfma_f32_16x16x32_bf16 v[116:119], v[32:35], v[44:47], v[116:119]
    v_mul_f32 v215, v215, v225
    v_mul_f32 v216, v216, v225
    v_mfma_f32_16x16x32_bf16 v[124:127], v[36:39], v[44:47], v[124:127]
    v_mul_f32 v217, v217, v225
    s_waitcnt lgkmcnt(6)
    v_mfma_f32_16x16x32_bf16 v[96:99], v[24:27], v[64:67], v[96:99]
    v_mul_f32 v218, v218, v225
    v_mul_f32 v219, v219, v225
    v_mfma_f32_16x16x32_bf16 v[104:107], v[28:31], v[64:67], v[104:107]
    v_mul_f32 v220, v220, v225
    v_mul_f32 v221, v221, v225
    v_mfma_f32_16x16x32_bf16 v[128:131], v[32:35], v[64:67], v[128:131]
    v_mul_f32 v222, v222, v225
    v_mul_f32 v223, v223, v225
    v_mfma_f32_16x16x32_bf16 v[136:139], v[36:39], v[64:67], v[136:139]
    v_cvt_pk_bf16_f32 v248, v208, v209
    v_cvt_pk_bf16_f32 v249, v210, v211
    s_waitcnt lgkmcnt(4)
    v_mfma_f32_16x16x32_bf16 v[100:103], v[24:27], v[68:71], v[100:103]
    v_cvt_pk_bf16_f32 v250, v212, v213
    v_cvt_pk_bf16_f32 v251, v214, v215
    v_mfma_f32_16x16x32_bf16 v[108:111], v[28:31], v[68:71], v[108:111]
    v_cvt_pk_bf16_f32 v252, v216, v217
    v_cvt_pk_bf16_f32 v253, v218, v219
    v_mfma_f32_16x16x32_bf16 v[132:135], v[32:35], v[68:71], v[132:135]
    v_cvt_pk_bf16_f32 v254, v220, v221
    v_cvt_pk_bf16_f32 v255, v222, v223
    v_mfma_f32_16x16x32_bf16 v[140:143], v[36:39], v[68:71], v[140:143]
    s_lshl_b32 s35, s19, 4
    s_add_u32 s35, s35, 131072
    v_lshl_add_u32 v228, v1, 4, s35
    ds_write_b128 v228, v[248:251]
    ds_write_b128 v228, v[252:255] offset:128
    s_waitcnt lgkmcnt(0) vmcnt(0)
    s_barrier
    v_mfma_f32_16x16x32_bf16 v[144:147], v[48:51], v[40:43], v[144:147]
    ds_read_b128 v[24:27], v10 offset:0
    s_mov_b32 m0, s24
    s_nop 0
    buffer_load_dwordx4 v6, s[8:11], s17 offen offset:0 lds
    v_mfma_f32_16x16x32_bf16 v[152:155], v[52:55], v[40:43], v[152:155]
    ds_read_b128 v[28:31], v10 offset:2048
    v_mfma_f32_16x16x32_bf16 v[176:179], v[56:59], v[40:43], v[176:179]
    ds_read_b128 v[32:35], v10 offset:4096
    buffer_load_dwordx4 v7, s[8:11], s17 offen offset:1024 lds
    v_mfma_f32_16x16x32_bf16 v[184:187], v[60:63], v[40:43], v[184:187]
    ds_read_b128 v[36:39], v10 offset:6144
    ds_read_b64_tr_b16 v[40:41], v12 offset:0
    ds_read_b64_tr_b16 v[42:43], v12 offset:2048
    v_mfma_f32_16x16x32_bf16 v[148:151], v[48:51], v[44:47], v[148:151]
    buffer_load_dwordx4 v8, s[8:11], s17 offen offset:2048 lds
    v_mfma_f32_16x16x32_bf16 v[156:159], v[52:55], v[44:47], v[156:159]
    v_mfma_f32_16x16x32_bf16 v[180:183], v[56:59], v[44:47], v[180:183]
    buffer_load_dwordx4 v9, s[8:11], s17 offen offset:3072 lds
    s_add_u32 s17, s17, s26
    v_mfma_f32_16x16x32_bf16 v[188:191], v[60:63], v[44:47], v[188:191]
    ds_read_b64_tr_b16 v[44:45], v13 offset:0
    ds_read_b64_tr_b16 v[46:47], v13 offset:2048
    v_mfma_f32_16x16x32_bf16 v[160:163], v[48:51], v[64:67], v[160:163]
    s_add_u32 m0, s24, 16384
    s_nop 0
    buffer_load_dwordx4 v6, s[8:11], s22 offen offset:0 lds
    v_mfma_f32_16x16x32_bf16 v[168:171], v[52:55], v[64:67], v[168:171]
    v_mfma_f32_16x16x32_bf16 v[192:195], v[56:59], v[64:67], v[192:195]
    buffer_load_dwordx4 v7, s[8:11], s22 offen offset:1024 lds
    v_mfma_f32_16x16x32_bf16 v[200:203], v[60:63], v[64:67], v[200:203]
    ds_read_b64_tr_b16 v[64:65], v14 offset:0
    ds_read_b64_tr_b16 v[66:67], v14 offset:2048
    v_mfma_f32_16x16x32_bf16 v[164:167], v[48:51], v[68:71], v[164:167]
    buffer_load_dwordx4 v8, s[8:11], s22 offen offset:2048 lds
    v_mfma_f32_16x16x32_bf16 v[172:175], v[52:55], v[68:71], v[172:175]
    v_mfma_f32_16x16x32_bf16 v[196:199], v[56:59], v[68:71], v[196:199]
    buffer_load_dwordx4 v9, s[8:11], s22 offen offset:3072 lds
    s_add_u32 s22, s22, s26
    v_mfma_f32_16x16x32_bf16 v[204:207], v[60:63], v[68:71], v[204:207]
    ds_read_b64_tr_b16 v[68:69], v15 offset:0
    ds_read_b64_tr_b16 v[70:71], v15 offset:2048
    s_waitcnt lgkmcnt(6)
    v_mfma_f32_16x16x32_bf16 v[80:83], v[24:27], v[40:43], v[80:83]
    ds_read_b128 v[48:51], v10 offset:8192
    s_mov_b32 m0, s21
    s_nop 0
    buffer_load_dwordx4 v2, s[4:7], s16 offen offset:0 lds
    v_mfma_f32_16x16x32_bf16 v[88:91], v[28:31], v[40:43], v[88:91]
    ds_read_b128 v[52:55], v10 offset:10240
    v_mfma_f32_16x16x32_bf16 v[112:115], v[32:35], v[40:43], v[112:115]
    ds_read_b128 v[56:59], v10 offset:12288
    buffer_load_dwordx4 v3, s[4:7], s16 offen offset:1024 lds
    v_mfma_f32_16x16x32_bf16 v[120:123], v[36:39], v[40:43], v[120:123]
    ds_read_b128 v[60:63], v10 offset:14336
    s_waitcnt lgkmcnt(8)
    v_mfma_f32_16x16x32_bf16 v[84:87], v[24:27], v[44:47], v[84:87]
    buffer_load_dwordx4 v4, s[4:7], s16 offen offset:2048 lds
    v_mfma_f32_16x16x32_bf16 v[92:95], v[28:31], v[44:47], v[92:95]
    v_mfma_f32_16x16x32_bf16 v[116:119], v[32:35], v[44:47], v[116:119]
    buffer_load_dwordx4 v5, s[4:7], s16 offen offset:3072 lds
    s_add_u32 s16, s16, s33
    v_mfma_f32_16x16x32_bf16 v[124:127], v[36:39], v[44:47], v[124:127]
    s_waitcnt lgkmcnt(6)
    v_mfma_f32_16x16x32_bf16 v[96:99], v[24:27], v[64:67], v[96:99]
    s_add_u32 m0, s21, 4096
    s_nop 0
    buffer_load_dwordx4 v2, s[4:7], s18 offen offset:0 lds
    v_mfma_f32_16x16x32_bf16 v[104:107], v[28:31], v[64:67], v[104:107]
    v_mfma_f32_16x16x32_bf16 v[128:131], v[32:35], v[64:67], v[128:131]
    buffer_load_dwordx4 v3, s[4:7], s18 offen offset:1024 lds
    v_mfma_f32_16x16x32_bf16 v[136:139], v[36:39], v[64:67], v[136:139]
    s_waitcnt lgkmcnt(4)
    v_mfma_f32_16x16x32_bf16 v[100:103], v[24:27], v[68:71], v[100:103]
    buffer_load_dwordx4 v4, s[4:7], s18 offen offset:2048 lds
    v_mfma_f32_16x16x32_bf16 v[108:111], v[28:31], v[68:71], v[108:111]
    v_mfma_f32_16x16x32_bf16 v[132:135], v[32:35], v[68:71], v[132:135]
    buffer_load_dwordx4 v5, s[4:7], s18 offen offset:3072 lds
    s_add_u32 s18, s18, s33
    v_mfma_f32_16x16x32_bf16 v[140:143], v[36:39], v[68:71], v[140:143]
    s_waitcnt lgkmcnt(3)
    v_mfma_f32_16x16x32_bf16 v[144:147], v[48:51], v[40:43], v[144:147]
    ds_read_b128 v[24:27], v11 offset:0
    s_waitcnt lgkmcnt(3)
    v_mfma_f32_16x16x32_bf16 v[152:155], v[52:55], v[40:43], v[152:155]
    ds_read_b128 v[28:31], v11 offset:2048
    s_waitcnt lgkmcnt(3)
    v_mfma_f32_16x16x32_bf16 v[176:179], v[56:59], v[40:43], v[176:179]
    ds_read_b128 v[32:35], v11 offset:4096
    s_waitcnt lgkmcnt(3)
    v_mfma_f32_16x16x32_bf16 v[184:187], v[60:63], v[40:43], v[184:187]
    ds_read_b128 v[36:39], v11 offset:6144
    ds_read_b64_tr_b16 v[40:41], v12 offset:16384
    ds_read_b64_tr_b16 v[42:43], v12 offset:18432
    v_mfma_f32_16x16x32_bf16 v[148:151], v[48:51], v[44:47], v[148:151]
    v_mfma_f32_16x16x32_bf16 v[156:159], v[52:55], v[44:47], v[156:159]
    v_mfma_f32_16x16x32_bf16 v[180:183], v[56:59], v[44:47], v[180:183]
    v_mfma_f32_16x16x32_bf16 v[188:191], v[60:63], v[44:47], v[188:191]
    ds_read_b64_tr_b16 v[44:45], v13 offset:16384
    ds_read_b64_tr_b16 v[46:47], v13 offset:18432
    v_mfma_f32_16x16x32_bf16 v[160:163], v[48:51], v[64:67], v[160:163]
    v_mfma_f32_16x16x32_bf16 v[168:171], v[52:55], v[64:67], v[168:171]
    v_mfma_f32_16x16x32_bf16 v[192:195], v[56:59], v[64:67], v[192:195]
    v_mfma_f32_16x16x32_bf16 v[200:203], v[60:63], v[64:67], v[200:203]
    ds_read_b64_tr_b16 v[64:65], v14 offset:16384
    ds_read_b64_tr_b16 v[66:67], v14 offset:18432
    v_mfma_f32_16x16x32_bf16 v[164:167], v[48:51], v[68:71], v[164:167]
    v_mfma_f32_16x16x32_bf16 v[172:175], v[52:55], v[68:71], v[172:175]
    v_mfma_f32_16x16x32_bf16 v[196:199], v[56:59], v[68:71], v[196:199]
    v_mfma_f32_16x16x32_bf16 v[204:207], v[60:63], v[68:71], v[204:207]
    ds_read_b64_tr_b16 v[68:69], v15 offset:16384
    ds_read_b64_tr_b16 v[70:71], v15 offset:18432
    s_waitcnt lgkmcnt(6)
    v_mfma_f32_16x16x32_bf16 v[80:83], v[24:27], v[40:43], v[80:83]
    ds_read_b128 v[48:51], v11 offset:8192
    v_mfma_f32_16x16x32_bf16 v[88:91], v[28:31], v[40:43], v[88:91]
    ds_read_b128 v[52:55], v11 offset:10240
    v_mfma_f32_16x16x32_bf16 v[112:115], v[32:35], v[40:43], v[112:115]
    ds_read_b128 v[56:59], v11 offset:12288
    v_mfma_f32_16x16x32_bf16 v[120:123], v[36:39], v[40:43], v[120:123]
    ds_read_b128 v[60:63], v11 offset:14336
    s_waitcnt lgkmcnt(8)
    v_mfma_f32_16x16x32_bf16 v[84:87], v[24:27], v[44:47], v[84:87]
    v_mfma_f32_16x16x32_bf16 v[92:95], v[28:31], v[44:47], v[92:95]
    v_mfma_f32_16x16x32_bf16 v[116:119], v[32:35], v[44:47], v[116:119]
    v_mfma_f32_16x16x32_bf16 v[124:127], v[36:39], v[44:47], v[124:127]
    s_waitcnt lgkmcnt(6)
    v_mfma_f32_16x16x32_bf16 v[96:99], v[24:27], v[64:67], v[96:99]
    v_mfma_f32_16x16x32_bf16 v[104:107], v[28:31], v[64:67], v[104:107]
    v_mfma_f32_16x16x32_bf16 v[128:131], v[32:35], v[64:67], v[128:131]
    v_mfma_f32_16x16x32_bf16 v[136:139], v[36:39], v[64:67], v[136:139]
    s_waitcnt lgkmcnt(4)
    v_mfma_f32_16x16x32_bf16 v[100:103], v[24:27], v[68:71], v[100:103]
    v_mfma_f32_16x16x32_bf16 v[108:111], v[28:31], v[68:71], v[108:111]
    v_mfma_f32_16x16x32_bf16 v[132:135], v[32:35], v[68:71], v[132:135]
    v_mfma_f32_16x16x32_bf16 v[140:143], v[36:39], v[68:71], v[140:143]
    s_waitcnt lgkmcnt(0) vmcnt(0)
    s_barrier
    v_mfma_f32_16x16x32_bf16 v[144:147], v[48:51], v[40:43], v[144:147]
    ds_read_b128 v[24:27], v10 offset:32768
    s_mov_b32 m0, s23
    s_nop 0
    buffer_load_dwordx4 v6, s[8:11], s17 offen offset:0 lds
    v_mfma_f32_16x16x32_bf16 v[152:155], v[52:55], v[40:43], v[152:155]
    ds_read_b128 v[28:31], v10 offset:34816
    v_mfma_f32_16x16x32_bf16 v[176:179], v[56:59], v[40:43], v[176:179]
    ds_read_b128 v[32:35], v10 offset:36864
    buffer_load_dwordx4 v7, s[8:11], s17 offen offset:1024 lds
    v_mfma_f32_16x16x32_bf16 v[184:187], v[60:63], v[40:43], v[184:187]
    ds_read_b128 v[36:39], v10 offset:38912
    ds_read_b64_tr_b16 v[40:41], v12 offset:32768
    ds_read_b64_tr_b16 v[42:43], v12 offset:34816
    v_mfma_f32_16x16x32_bf16 v[148:151], v[48:51], v[44:47], v[148:151]
    buffer_load_dwordx4 v8, s[8:11], s17 offen offset:2048 lds
    v_mfma_f32_16x16x32_bf16 v[156:159], v[52:55], v[44:47], v[156:159]
    v_mfma_f32_16x16x32_bf16 v[180:183], v[56:59], v[44:47], v[180:183]
    buffer_load_dwordx4 v9, s[8:11], s17 offen offset:3072 lds
    s_add_u32 s17, s17, s26
    v_mfma_f32_16x16x32_bf16 v[188:191], v[60:63], v[44:47], v[188:191]
    ds_read_b64_tr_b16 v[44:45], v13 offset:32768
    ds_read_b64_tr_b16 v[46:47], v13 offset:34816
    v_mfma_f32_16x16x32_bf16 v[160:163], v[48:51], v[64:67], v[160:163]
    s_add_u32 m0, s23, 16384
    s_nop 0
    buffer_load_dwordx4 v6, s[8:11], s22 offen offset:0 lds
    v_mfma_f32_16x16x32_bf16 v[168:171], v[52:55], v[64:67], v[168:171]
    v_mfma_f32_16x16x32_bf16 v[192:195], v[56:59], v[64:67], v[192:195]
    buffer_load_dwordx4 v7, s[8:11], s22 offen offset:1024 lds
    v_mfma_f32_16x16x32_bf16 v[200:203], v[60:63], v[64:67], v[200:203]
    ds_read_b64_tr_b16 v[64:65], v14 offset:32768
    ds_read_b64_tr_b16 v[66:67], v14 offset:34816
    v_mfma_f32_16x16x32_bf16 v[164:167], v[48:51], v[68:71], v[164:167]
    buffer_load_dwordx4 v8, s[8:11], s22 offen offset:2048 lds
    v_mfma_f32_16x16x32_bf16 v[172:175], v[52:55], v[68:71], v[172:175]
    v_mfma_f32_16x16x32_bf16 v[196:199], v[56:59], v[68:71], v[196:199]
    buffer_load_dwordx4 v9, s[8:11], s22 offen offset:3072 lds
    s_add_u32 s22, s22, s26
    v_mfma_f32_16x16x32_bf16 v[204:207], v[60:63], v[68:71], v[204:207]
    ds_read_b64_tr_b16 v[68:69], v15 offset:32768
    ds_read_b64_tr_b16 v[70:71], v15 offset:34816
    s_waitcnt lgkmcnt(6)
    v_mfma_f32_16x16x32_bf16 v[80:83], v[24:27], v[40:43], v[80:83]
    ds_read_b128 v[48:51], v10 offset:40960
    s_mov_b32 m0, s20
    s_nop 0
    buffer_load_dwordx4 v2, s[4:7], s16 offen offset:0 lds
    v_mfma_f32_16x16x32_bf16 v[88:91], v[28:31], v[40:43], v[88:91]
    ds_read_b128 v[52:55], v10 offset:43008
    buffer_load_dwordx4 v3, s[4:7], s16 offen offset:1024 lds
    v_mfma_f32_16x16x32_bf16 v[112:115], v[32:35], v[40:43], v[112:115]
    ds_read_b128 v[56:59], v10 offset:45056
    v_mfma_f32_16x16x32_bf16 v[120:123], v[36:39], v[40:43], v[120:123]
    ds_read_b128 v[60:63], v10 offset:47104
    buffer_load_dwordx4 v4, s[4:7], s16 offen offset:2048 lds
    s_waitcnt lgkmcnt(8)
    v_mfma_f32_16x16x32_bf16 v[84:87], v[24:27], v[44:47], v[84:87]
    v_mfma_f32_16x16x32_bf16 v[92:95], v[28:31], v[44:47], v[92:95]
    buffer_load_dwordx4 v5, s[4:7], s16 offen offset:3072 lds
    s_add_u32 s16, s16, s33
    v_mfma_f32_16x16x32_bf16 v[116:119], v[32:35], v[44:47], v[116:119]
    v_mfma_f32_16x16x32_bf16 v[124:127], v[36:39], v[44:47], v[124:127]
    s_add_u32 m0, s20, 4096
    s_nop 0
    buffer_load_dwordx4 v2, s[4:7], s18 offen offset:0 lds
    s_waitcnt lgkmcnt(6)
    v_mfma_f32_16x16x32_bf16 v[96:99], v[24:27], v[64:67], v[96:99]
    buffer_load_dwordx4 v3, s[4:7], s18 offen offset:1024 lds
    v_mfma_f32_16x16x32_bf16 v[104:107], v[28:31], v[64:67], v[104:107]
    v_mfma_f32_16x16x32_bf16 v[128:131], v[32:35], v[64:67], v[128:131]
    buffer_load_dwordx4 v4, s[4:7], s18 offen offset:2048 lds
    v_mfma_f32_16x16x32_bf16 v[136:139], v[36:39], v[64:67], v[136:139]
    s_waitcnt lgkmcnt(4)
    v_mfma_f32_16x16x32_bf16 v[100:103], v[24:27], v[68:71], v[100:103]
    buffer_load_dwordx4 v5, s[4:7], s18 offen offset:3072 lds
    s_add_u32 s18, s18, s33
    v_mfma_f32_16x16x32_bf16 v[108:111], v[28:31], v[68:71], v[108:111]
    v_mfma_f32_16x16x32_bf16 v[132:135], v[32:35], v[68:71], v[132:135]
    v_mov_b32 v241, 147456
    ds_read_b32 v240, v241
    v_mfma_f32_16x16x32_bf16 v[140:143], v[36:39], v[68:71], v[140:143]
    s_waitcnt lgkmcnt(4)
    v_mfma_f32_16x16x32_bf16 v[144:147], v[48:51], v[40:43], v[144:147]
    ds_read_b128 v[24:27], v11 offset:32768
    s_waitcnt lgkmcnt(1)
    v_readfirstlane_b32 s95, v240
    v_mfma_f32_16x16x32_bf16 v[152:155], v[52:55], v[40:43], v[152:155]
    ds_read_b128 v[28:31], v11 offset:34816
    v_mfma_f32_16x16x32_bf16 v[176:179], v[56:59], v[40:43], v[176:179]
    ds_read_b128 v[32:35], v11 offset:36864
    v_mfma_f32_16x16x32_bf16 v[184:187], v[60:63], v[40:43], v[184:187]
    ds_read_b128 v[36:39], v11 offset:38912
    ds_read_b64_tr_b16 v[40:41], v12 offset:49152
    ds_read_b64_tr_b16 v[42:43], v12 offset:51200
    v_mfma_f32_16x16x32_bf16 v[148:151], v[48:51], v[44:47], v[148:151]
    v_mfma_f32_16x16x32_bf16 v[156:159], v[52:55], v[44:47], v[156:159]
    v_mfma_f32_16x16x32_bf16 v[180:183], v[56:59], v[44:47], v[180:183]
    v_mfma_f32_16x16x32_bf16 v[188:191], v[60:63], v[44:47], v[188:191]
    ds_read_b64_tr_b16 v[44:45], v13 offset:49152
    ds_read_b64_tr_b16 v[46:47], v13 offset:51200
    v_mfma_f32_16x16x32_bf16 v[160:163], v[48:51], v[64:67], v[160:163]
    v_mfma_f32_16x16x32_bf16 v[168:171], v[52:55], v[64:67], v[168:171]
    v_mfma_f32_16x16x32_bf16 v[192:195], v[56:59], v[64:67], v[192:195]
    v_mfma_f32_16x16x32_bf16 v[200:203], v[60:63], v[64:67], v[200:203]
    ds_read_b64_tr_b16 v[64:65], v14 offset:49152
    ds_read_b64_tr_b16 v[66:67], v14 offset:51200
    v_mfma_f32_16x16x32_bf16 v[164:167], v[48:51], v[68:71], v[164:167]
    v_mfma_f32_16x16x32_bf16 v[172:175], v[52:55], v[68:71], v[172:175]
    v_mfma_f32_16x16x32_bf16 v[196:199], v[56:59], v[68:71], v[196:199]
    v_mfma_f32_16x16x32_bf16 v[204:207], v[60:63], v[68:71], v[204:207]
    ds_read_b64_tr_b16 v[68:69], v15 offset:49152
    ds_read_b64_tr_b16 v[70:71], v15 offset:51200
    s_waitcnt lgkmcnt(6)
    v_mfma_f32_16x16x32_bf16 v[80:83], v[24:27], v[40:43], v[80:83]
    ds_read_b128 v[48:51], v11 offset:40960
    v_mfma_f32_16x16x32_bf16 v[88:91], v[28:31], v[40:43], v[88:91]
    ds_read_b128 v[52:55], v11 offset:43008
    v_mfma_f32_16x16x32_bf16 v[112:115], v[32:35], v[40:43], v[112:115]
    ds_read_b128 v[56:59], v11 offset:45056
    v_mfma_f32_16x16x32_bf16 v[120:123], v[36:39], v[40:43], v[120:123]
    ds_read_b128 v[60:63], v11 offset:47104
    s_waitcnt lgkmcnt(8)
    v_mfma_f32_16x16x32_bf16 v[84:87], v[24:27], v[44:47], v[84:87]
    v_mfma_f32_16x16x32_bf16 v[92:95], v[28:31], v[44:47], v[92:95]
    v_mfma_f32_16x16x32_bf16 v[116:119], v[32:35], v[44:47], v[116:119]
    v_mfma_f32_16x16x32_bf16 v[124:127], v[36:39], v[44:47], v[124:127]
    s_waitcnt lgkmcnt(6)
    v_mfma_f32_16x16x32_bf16 v[96:99], v[24:27], v[64:67], v[96:99]
    v_mfma_f32_16x16x32_bf16 v[104:107], v[28:31], v[64:67], v[104:107]
    v_mfma_f32_16x16x32_bf16 v[128:131], v[32:35], v[64:67], v[128:131]
    v_mfma_f32_16x16x32_bf16 v[136:139], v[36:39], v[64:67], v[136:139]
    s_waitcnt lgkmcnt(4)
    v_mfma_f32_16x16x32_bf16 v[100:103], v[24:27], v[68:71], v[100:103]
    v_mfma_f32_16x16x32_bf16 v[108:111], v[28:31], v[68:71], v[108:111]
    v_mfma_f32_16x16x32_bf16 v[132:135], v[32:35], v[68:71], v[132:135]
    v_mfma_f32_16x16x32_bf16 v[140:143], v[36:39], v[68:71], v[140:143]
    s_waitcnt lgkmcnt(0) vmcnt(0)
    s_barrier
    v_mfma_f32_16x16x32_bf16 v[144:147], v[48:51], v[40:43], v[144:147]
    ds_read_b128 v[24:27], v10 offset:0
    s_mov_b32 m0, s24
    s_nop 0
    buffer_load_dwordx4 v6, s[8:11], s17 offen offset:0 lds
    v_mfma_f32_16x16x32_bf16 v[152:155], v[52:55], v[40:43], v[152:155]
    ds_read_b128 v[28:31], v10 offset:2048
    v_mfma_f32_16x16x32_bf16 v[176:179], v[56:59], v[40:43], v[176:179]
    ds_read_b128 v[32:35], v10 offset:4096
    buffer_load_dwordx4 v7, s[8:11], s17 offen offset:1024 lds
    v_mfma_f32_16x16x32_bf16 v[184:187], v[60:63], v[40:43], v[184:187]
    ds_read_b128 v[36:39], v10 offset:6144
    ds_read_b64_tr_b16 v[40:41], v12 offset:0
    ds_read_b64_tr_b16 v[42:43], v12 offset:2048
    v_mfma_f32_16x16x32_bf16 v[148:151], v[48:51], v[44:47], v[148:151]
    buffer_load_dwordx4 v8, s[8:11], s17 offen offset:2048 lds
    v_mfma_f32_16x16x32_bf16 v[156:159], v[52:55], v[44:47], v[156:159]
    v_mfma_f32_16x16x32_bf16 v[180:183], v[56:59], v[44:47], v[180:183]
    buffer_load_dwordx4 v9, s[8:11], s17 offen offset:3072 lds
    s_add_u32 s17, s17, s26
    v_mfma_f32_16x16x32_bf16 v[188:191], v[60:63], v[44:47], v[188:191]
    ds_read_b64_tr_b16 v[44:45], v13 offset:0
    ds_read_b64_tr_b16 v[46:47], v13 offset:2048
    v_mfma_f32_16x16x32_bf16 v[160:163], v[48:51], v[64:67], v[160:163]
    s_add_u32 m0, s24, 16384
    s_nop 0
    buffer_load_dwordx4 v6, s[8:11], s22 offen offset:0 lds
    v_mfma_f32_16x16x32_bf16 v[168:171], v[52:55], v[64:67], v[168:171]
    v_mfma_f32_16x16x32_bf16 v[192:195], v[56:59], v[64:67], v[192:195]
    buffer_load_dwordx4 v7, s[8:11], s22 offen offset:1024 lds
    v_mfma_f32_16x16x32_bf16 v[200:203], v[60:63], v[64:67], v[200:203]
    ds_read_b64_tr_b16 v[64:65], v14 offset:0
    ds_read_b64_tr_b16 v[66:67], v14 offset:2048
    v_mfma_f32_16x16x32_bf16 v[164:167], v[48:51], v[68:71], v[164:167]
    buffer_load_dwordx4 v8, s[8:11], s22 offen offset:2048 lds
    v_mfma_f32_16x16x32_bf16 v[172:175], v[52:55], v[68:71], v[172:175]
    v_mfma_f32_16x16x32_bf16 v[196:199], v[56:59], v[68:71], v[196:199]
    buffer_load_dwordx4 v9, s[8:11], s22 offen offset:3072 lds
    s_add_u32 s22, s22, s26
    v_mfma_f32_16x16x32_bf16 v[204:207], v[60:63], v[68:71], v[204:207]
    ds_read_b64_tr_b16 v[68:69], v15 offset:0
    ds_read_b64_tr_b16 v[70:71], v15 offset:2048
    s_waitcnt lgkmcnt(6)
    v_mfma_f32_16x16x32_bf16 v[80:83], v[24:27], v[40:43], v[80:83]
    ds_read_b128 v[48:51], v10 offset:8192
    s_mov_b32 m0, s21
    s_nop 0
    buffer_load_dwordx4 v2, s[4:7], s16 offen offset:0 lds
    v_mfma_f32_16x16x32_bf16 v[88:91], v[28:31], v[40:43], v[88:91]
    ds_read_b128 v[52:55], v10 offset:10240
    v_mfma_f32_16x16x32_bf16 v[112:115], v[32:35], v[40:43], v[112:115]
    ds_read_b128 v[56:59], v10 offset:12288
    buffer_load_dwordx4 v3, s[4:7], s16 offen offset:1024 lds
    v_mfma_f32_16x16x32_bf16 v[120:123], v[36:39], v[40:43], v[120:123]
    ds_read_b128 v[60:63], v10 offset:14336
    s_waitcnt lgkmcnt(8)
    v_mfma_f32_16x16x32_bf16 v[84:87], v[24:27], v[44:47], v[84:87]
    buffer_load_dwordx4 v4, s[4:7], s16 offen offset:2048 lds
    v_mfma_f32_16x16x32_bf16 v[92:95], v[28:31], v[44:47], v[92:95]
    v_mfma_f32_16x16x32_bf16 v[116:119], v[32:35], v[44:47], v[116:119]
    buffer_load_dwordx4 v5, s[4:7], s16 offen offset:3072 lds
    s_add_u32 s16, s16, s33
    v_mfma_f32_16x16x32_bf16 v[124:127], v[36:39], v[44:47], v[124:127]
    s_waitcnt lgkmcnt(6)
    v_mfma_f32_16x16x32_bf16 v[96:99], v[24:27], v[64:67], v[96:99]
    s_add_u32 m0, s21, 4096
    s_nop 0
    buffer_load_dwordx4 v2, s[4:7], s18 offen offset:0 lds
    v_mfma_f32_16x16x32_bf16 v[104:107], v[28:31], v[64:67], v[104:107]
    v_mfma_f32_16x16x32_bf16 v[128:131], v[32:35], v[64:67], v[128:131]
    buffer_load_dwordx4 v3, s[4:7], s18 offen offset:1024 lds
    v_mfma_f32_16x16x32_bf16 v[136:139], v[36:39], v[64:67], v[136:139]
    s_waitcnt lgkmcnt(4)
    v_mfma_f32_16x16x32_bf16 v[100:103], v[24:27], v[68:71], v[100:103]
    buffer_load_dwordx4 v4, s[4:7], s18 offen offset:2048 lds
    v_mfma_f32_16x16x32_bf16 v[108:111], v[28:31], v[68:71], v[108:111]
    v_mfma_f32_16x16x32_bf16 v[132:135], v[32:35], v[68:71], v[132:135]
    buffer_load_dwordx4 v5, s[4:7], s18 offen offset:3072 lds
    s_add_u32 s18, s18, s33
    v_mfma_f32_16x16x32_bf16 v[140:143], v[36:39], v[68:71], v[140:143]
    s_waitcnt lgkmcnt(3)
    v_mfma_f32_16x16x32_bf16 v[144:147], v[48:51], v[40:43], v[144:147]
    ds_read_b128 v[24:27], v11 offset:0
    s_waitcnt lgkmcnt(3)
    v_mfma_f32_16x16x32_bf16 v[152:155], v[52:55], v[40:43], v[152:155]
    ds_read_b128 v[28:31], v11 offset:2048
    s_waitcnt lgkmcnt(3)
    v_mfma_f32_16x16x32_bf16 v[176:179], v[56:59], v[40:43], v[176:179]
    ds_read_b128 v[32:35], v11 offset:4096
    s_waitcnt lgkmcnt(3)
    v_mfma_f32_16x16x32_bf16 v[184:187], v[60:63], v[40:43], v[184:187]
    ds_read_b128 v[36:39], v11 offset:6144
    ds_read_b64_tr_b16 v[40:41], v12 offset:16384
    ds_read_b64_tr_b16 v[42:43], v12 offset:18432
    v_mfma_f32_16x16x32_bf16 v[148:151], v[48:51], v[44:47], v[148:151]
    v_mfma_f32_16x16x32_bf16 v[156:159], v[52:55], v[44:47], v[156:159]
    v_mfma_f32_16x16x32_bf16 v[180:183], v[56:59], v[44:47], v[180:183]
    v_mfma_f32_16x16x32_bf16 v[188:191], v[60:63], v[44:47], v[188:191]
    ds_read_b64_tr_b16 v[44:45], v13 offset:16384
    ds_read_b64_tr_b16 v[46:47], v13 offset:18432
    v_mfma_f32_16x16x32_bf16 v[160:163], v[48:51], v[64:67], v[160:163]
    v_mfma_f32_16x16x32_bf16 v[168:171], v[52:55], v[64:67], v[168:171]
    v_mfma_f32_16x16x32_bf16 v[192:195], v[56:59], v[64:67], v[192:195]
    v_mfma_f32_16x16x32_bf16 v[200:203], v[60:63], v[64:67], v[200:203]
    ds_read_b64_tr_b16 v[64:65], v14 offset:16384
    ds_read_b64_tr_b16 v[66:67], v14 offset:18432
    v_mfma_f32_16x16x32_bf16 v[164:167], v[48:51], v[68:71], v[164:167]
    v_mfma_f32_16x16x32_bf16 v[172:175], v[52:55], v[68:71], v[172:175]
    v_mfma_f32_16x16x32_bf16 v[196:199], v[56:59], v[68:71], v[196:199]
    v_mfma_f32_16x16x32_bf16 v[204:207], v[60:63], v[68:71], v[204:207]
    ds_read_b64_tr_b16 v[68:69], v15 offset:16384
    ds_read_b64_tr_b16 v[70:71], v15 offset:18432
    s_waitcnt lgkmcnt(6)
    v_mfma_f32_16x16x32_bf16 v[80:83], v[24:27], v[40:43], v[80:83]
    ds_read_b128 v[48:51], v11 offset:8192
    v_mfma_f32_16x16x32_bf16 v[88:91], v[28:31], v[40:43], v[88:91]
    ds_read_b128 v[52:55], v11 offset:10240
    v_mfma_f32_16x16x32_bf16 v[112:115], v[32:35], v[40:43], v[112:115]
    ds_read_b128 v[56:59], v11 offset:12288
    v_mfma_f32_16x16x32_bf16 v[120:123], v[36:39], v[40:43], v[120:123]
    ds_read_b128 v[60:63], v11 offset:14336
    s_waitcnt lgkmcnt(8)
    v_mfma_f32_16x16x32_bf16 v[84:87], v[24:27], v[44:47], v[84:87]
    v_mfma_f32_16x16x32_bf16 v[92:95], v[28:31], v[44:47], v[92:95]
    v_mfma_f32_16x16x32_bf16 v[116:119], v[32:35], v[44:47], v[116:119]
    v_mfma_f32_16x16x32_bf16 v[124:127], v[36:39], v[44:47], v[124:127]
    s_waitcnt lgkmcnt(6)
    v_mfma_f32_16x16x32_bf16 v[96:99], v[24:27], v[64:67], v[96:99]
    v_mfma_f32_16x16x32_bf16 v[104:107], v[28:31], v[64:67], v[104:107]
    v_mfma_f32_16x16x32_bf16 v[128:131], v[32:35], v[64:67], v[128:131]
    v_mfma_f32_16x16x32_bf16 v[136:139], v[36:39], v[64:67], v[136:139]
    s_waitcnt lgkmcnt(4)
    v_mfma_f32_16x16x32_bf16 v[100:103], v[24:27], v[68:71], v[100:103]
    v_mfma_f32_16x16x32_bf16 v[108:111], v[28:31], v[68:71], v[108:111]
    v_mfma_f32_16x16x32_bf16 v[132:135], v[32:35], v[68:71], v[132:135]
    v_mfma_f32_16x16x32_bf16 v[140:143], v[36:39], v[68:71], v[140:143]
    s_waitcnt lgkmcnt(0) vmcnt(0)
    s_barrier
    v_mfma_f32_16x16x32_bf16 v[144:147], v[48:51], v[40:43], v[144:147]
    ds_read_b128 v[24:27], v10 offset:32768
    s_mov_b32 m0, s23
    s_nop 0
    buffer_load_dwordx4 v6, s[8:11], s17 offen offset:0 lds
    v_mfma_f32_16x16x32_bf16 v[152:155], v[52:55], v[40:43], v[152:155]
    ds_read_b128 v[28:31], v10 offset:34816
    v_mfma_f32_16x16x32_bf16 v[176:179], v[56:59], v[40:43], v[176:179]
    ds_read_b128 v[32:35], v10 offset:36864
    buffer_load_dwordx4 v7, s[8:11], s17 offen offset:1024 lds
    v_mfma_f32_16x16x32_bf16 v[184:187], v[60:63], v[40:43], v[184:187]
    ds_read_b128 v[36:39], v10 offset:38912
    ds_read_b64_tr_b16 v[40:41], v12 offset:32768
    ds_read_b64_tr_b16 v[42:43], v12 offset:34816
    v_mfma_f32_16x16x32_bf16 v[148:151], v[48:51], v[44:47], v[148:151]
    buffer_load_dwordx4 v8, s[8:11], s17 offen offset:2048 lds
    v_mfma_f32_16x16x32_bf16 v[156:159], v[52:55], v[44:47], v[156:159]
    v_mfma_f32_16x16x32_bf16 v[180:183], v[56:59], v[44:47], v[180:183]
    buffer_load_dwordx4 v9, s[8:11], s17 offen offset:3072 lds
    s_add_u32 s17, s17, s26
    v_mfma_f32_16x16x32_bf16 v[188:191], v[60:63], v[44:47], v[188:191]
    ds_read_b64_tr_b16 v[44:45], v13 offset:32768
    ds_read_b64_tr_b16 v[46:47], v13 offset:34816
    v_mfma_f32_16x16x32_bf16 v[160:163], v[48:51], v[64:67], v[160:163]
    s_add_u32 m0, s23, 16384
    s_nop 0
    buffer_load_dwordx4 v6, s[8:11], s22 offen offset:0 lds
    v_mfma_f32_16x16x32_bf16 v[168:171], v[52:55], v[64:67], v[168:171]
    v_mfma_f32_16x16x32_bf16 v[192:195], v[56:59], v[64:67], v[192:195]
    buffer_load_dwordx4 v7, s[8:11], s22 offen offset:1024 lds
    v_mfma_f32_16x16x32_bf16 v[200:203], v[60:63], v[64:67], v[200:203]
    ds_read_b64_tr_b16 v[64:65], v14 offset:32768
    ds_read_b64_tr_b16 v[66:67], v14 offset:34816
    v_mfma_f32_16x16x32_bf16 v[164:167], v[48:51], v[68:71], v[164:167]
    buffer_load_dwordx4 v8, s[8:11], s22 offen offset:2048 lds
    v_mfma_f32_16x16x32_bf16 v[172:175], v[52:55], v[68:71], v[172:175]
    v_mfma_f32_16x16x32_bf16 v[196:199], v[56:59], v[68:71], v[196:199]
    buffer_load_dwordx4 v9, s[8:11], s22 offen offset:3072 lds
    s_add_u32 s22, s22, s26
    v_mfma_f32_16x16x32_bf16 v[204:207], v[60:63], v[68:71], v[204:207]
    ds_read_b64_tr_b16 v[68:69], v15 offset:32768
    ds_read_b64_tr_b16 v[70:71], v15 offset:34816
    s_waitcnt lgkmcnt(6)
    v_mfma_f32_16x16x32_bf16 v[80:83], v[24:27], v[40:43], v[80:83]
    ds_read_b128 v[48:51], v10 offset:40960
    s_mov_b32 m0, s20
    s_nop 0
    buffer_load_dwordx4 v2, s[4:7], s16 offen offset:0 lds
    v_mfma_f32_16x16x32_bf16 v[88:91], v[28:31], v[40:43], v[88:91]
    ds_read_b128 v[52:55], v10 offset:43008
    v_mfma_f32_16x16x32_bf16 v[112:115], v[32:35], v[40:43], v[112:115]
    ds_read_b128 v[56:59], v10 offset:45056
    buffer_load_dwordx4 v3, s[4:7], s16 offen offset:1024 lds
    v_mfma_f32_16x16x32_bf16 v[120:123], v[36:39], v[40:43], v[120:123]
    ds_read_b128 v[60:63], v10 offset:47104
    s_waitcnt lgkmcnt(8)
    v_mfma_f32_16x16x32_bf16 v[84:87], v[24:27], v[44:47], v[84:87]
    buffer_load_dwordx4 v4, s[4:7], s16 offen offset:2048 lds
    v_mfma_f32_16x16x32_bf16 v[92:95], v[28:31], v[44:47], v[92:95]
    v_mfma_f32_16x16x32_bf16 v[116:119], v[32:35], v[44:47], v[116:119]
    buffer_load_dwordx4 v5, s[4:7], s16 offen offset:3072 lds
    s_add_u32 s16, s16, s33
    v_mfma_f32_16x16x32_bf16 v[124:127], v[36:39], v[44:47], v[124:127]
    s_waitcnt lgkmcnt(6)
    v_mfma_f32_16x16x32_bf16 v[96:99], v[24:27], v[64:67], v[96:99]
    s_add_u32 m0, s20, 4096
    s_nop 0
    buffer_load_dwordx4 v2, s[4:7], s18 offen offset:0 lds
    v_mfma_f32_16x16x32_bf16 v[104:107], v[28:31], v[64:67], v[104:107]
    v_mfma_f32_16x16x32_bf16 v[128:131], v[32:35], v[64:67], v[128:131]
    buffer_load_dwordx4 v3, s[4:7], s18 offen offset:1024 lds
    v_mfma_f32_16x16x32_bf16 v[136:139], v[36:39], v[64:67], v[136:139]
    s_waitcnt lgkmcnt(4)
    v_mfma_f32_16x16x32_bf16 v[100:103], v[24:27], v[68:71], v[100:103]
    buffer_load_dwordx4 v4, s[4:7], s18 offen offset:2048 lds
    v_mfma_f32_16x16x32_bf16 v[108:111], v[28:31], v[68:71], v[108:111]
    v_mfma_f32_16x16x32_bf16 v[132:135], v[32:35], v[68:71], v[132:135]
    buffer_load_dwordx4 v5, s[4:7], s18 offen offset:3072 lds
    s_add_u32 s18, s18, s33
    v_mfma_f32_16x16x32_bf16 v[140:143], v[36:39], v[68:71], v[140:143]
    s_waitcnt lgkmcnt(3)
    v_mfma_f32_16x16x32_bf16 v[144:147], v[48:51], v[40:43], v[144:147]
    ds_read_b128 v[24:27], v11 offset:32768
    s_waitcnt lgkmcnt(3)
    v_mfma_f32_16x16x32_bf16 v[152:155], v[52:55], v[40:43], v[152:155]
    ds_read_b128 v[28:31], v11 offset:34816
    s_waitcnt lgkmcnt(3)
    v_mfma_f32_16x16x32_bf16 v[176:179], v[56:59], v[40:43], v[176:179]
    ds_read_b128 v[32:35], v11 offset:36864
    s_waitcnt lgkmcnt(3)
    v_mfma_f32_16x16x32_bf16 v[184:187], v[60:63], v[40:43], v[184:187]
    ds_read_b128 v[36:39], v11 offset:38912
    ds_read_b64_tr_b16 v[40:41], v12 offset:49152
    ds_read_b64_tr_b16 v[42:43], v12 offset:51200
    v_mfma_f32_16x16x32_bf16 v[148:151], v[48:51], v[44:47], v[148:151]
    v_mfma_f32_16x16x32_bf16 v[156:159], v[52:55], v[44:47], v[156:159]
    v_mfma_f32_16x16x32_bf16 v[180:183], v[56:59], v[44:47], v[180:183]
    v_mfma_f32_16x16x32_bf16 v[188:191], v[60:63], v[44:47], v[188:191]
    ds_read_b64_tr_b16 v[44:45], v13 offset:49152
    ds_read_b64_tr_b16 v[46:47], v13 offset:51200
    v_mfma_f32_16x16x32_bf16 v[160:163], v[48:51], v[64:67], v[160:163]
    v_mfma_f32_16x16x32_bf16 v[168:171], v[52:55], v[64:67], v[168:171]
    v_mfma_f32_16x16x32_bf16 v[192:195], v[56:59], v[64:67], v[192:195]
    v_mfma_f32_16x16x32_bf16 v[200:203], v[60:63], v[64:67], v[200:203]
    ds_read_b64_tr_b16 v[64:65], v14 offset:49152
    ds_read_b64_tr_b16 v[66:67], v14 offset:51200
    v_mfma_f32_16x16x32_bf16 v[164:167], v[48:51], v[68:71], v[164:167]
    v_mfma_f32_16x16x32_bf16 v[172:175], v[52:55], v[68:71], v[172:175]
    v_mfma_f32_16x16x32_bf16 v[196:199], v[56:59], v[68:71], v[196:199]
    v_mfma_f32_16x16x32_bf16 v[204:207], v[60:63], v[68:71], v[204:207]
    ds_read_b64_tr_b16 v[68:69], v15 offset:49152
    ds_read_b64_tr_b16 v[70:71], v15 offset:51200
    s_waitcnt lgkmcnt(6)
    v_mfma_f32_16x16x32_bf16 v[80:83], v[24:27], v[40:43], v[80:83]
    ds_read_b128 v[48:51], v11 offset:40960
    buffer_load_dwordx4 v[248:251], v1, s[88:91], 0 offen offset:1024 sc1
    v_mfma_f32_16x16x32_bf16 v[88:91], v[28:31], v[40:43], v[88:91]
    ds_read_b128 v[52:55], v11 offset:43008
    v_mfma_f32_16x16x32_bf16 v[112:115], v[32:35], v[40:43], v[112:115]
    ds_read_b128 v[56:59], v11 offset:45056
    v_mfma_f32_16x16x32_bf16 v[120:123], v[36:39], v[40:43], v[120:123]
    ds_read_b128 v[60:63], v11 offset:47104
    s_waitcnt lgkmcnt(8)
    v_mfma_f32_16x16x32_bf16 v[84:87], v[24:27], v[44:47], v[84:87]
    v_mfma_f32_16x16x32_bf16 v[92:95], v[28:31], v[44:47], v[92:95]
    v_mfma_f32_16x16x32_bf16 v[116:119], v[32:35], v[44:47], v[116:119]
    v_mfma_f32_16x16x32_bf16 v[124:127], v[36:39], v[44:47], v[124:127]
    s_waitcnt lgkmcnt(6)
    v_mfma_f32_16x16x32_bf16 v[96:99], v[24:27], v[64:67], v[96:99]
    v_mfma_f32_16x16x32_bf16 v[104:107], v[28:31], v[64:67], v[104:107]
    v_mfma_f32_16x16x32_bf16 v[128:131], v[32:35], v[64:67], v[128:131]
    v_mfma_f32_16x16x32_bf16 v[136:139], v[36:39], v[64:67], v[136:139]
    s_waitcnt lgkmcnt(4)
    v_mfma_f32_16x16x32_bf16 v[100:103], v[24:27], v[68:71], v[100:103]
    v_mfma_f32_16x16x32_bf16 v[108:111], v[28:31], v[68:71], v[108:111]
    v_mfma_f32_16x16x32_bf16 v[132:135], v[32:35], v[68:71], v[132:135]
    v_mfma_f32_16x16x32_bf16 v[140:143], v[36:39], v[68:71], v[140:143]
    s_waitcnt lgkmcnt(0) vmcnt(1)
    s_barrier
    v_mfma_f32_16x16x32_bf16 v[144:147], v[48:51], v[40:43], v[144:147]
    ds_read_b128 v[24:27], v10 offset:0
    s_mov_b32 m0, s24
    s_nop 0
    buffer_load_dwordx4 v6, s[8:11], s17 offen offset:0 lds
    v_mfma_f32_16x16x32_bf16 v[152:155], v[52:55], v[40:43], v[152:155]
    ds_read_b128 v[28:31], v10 offset:2048
    v_mfma_f32_16x16x32_bf16 v[176:179], v[56:59], v[40:43], v[176:179]
    ds_read_b128 v[32:35], v10 offset:4096
    buffer_load_dwordx4 v7, s[8:11], s17 offen offset:1024 lds
    v_mfma_f32_16x16x32_bf16 v[184:187], v[60:63], v[40:43], v[184:187]
    ds_read_b128 v[36:39], v10 offset:6144
    ds_read_b64_tr_b16 v[40:41], v12 offset:0
    ds_read_b64_tr_b16 v[42:43], v12 offset:2048
    v_mfma_f32_16x16x32_bf16 v[148:151], v[48:51], v[44:47], v[148:151]
    buffer_load_dwordx4 v8, s[8:11], s17 offen offset:2048 lds
    v_mfma_f32_16x16x32_bf16 v[156:159], v[52:55], v[44:47], v[156:159]
    v_mfma_f32_16x16x32_bf16 v[180:183], v[56:59], v[44:47], v[180:183]
    buffer_load_dwordx4 v9, s[8:11], s17 offen offset:3072 lds
    s_add_u32 s17, s17, s26
    v_mfma_f32_16x16x32_bf16 v[188:191], v[60:63], v[44:47], v[188:191]
    ds_read_b64_tr_b16 v[44:45], v13 offset:0
    ds_read_b64_tr_b16 v[46:47], v13 offset:2048
    v_mfma_f32_16x16x32_bf16 v[160:163], v[48:51], v[64:67], v[160:163]
    s_add_u32 m0, s24, 16384
    s_nop 0
    buffer_load_dwordx4 v6, s[8:11], s22 offen offset:0 lds
    v_mfma_f32_16x16x32_bf16 v[168:171], v[52:55], v[64:67], v[168:171]
    v_mfma_f32_16x16x32_bf16 v[192:195], v[56:59], v[64:67], v[192:195]
    buffer_load_dwordx4 v7, s[8:11], s22 offen offset:1024 lds
    v_mfma_f32_16x16x32_bf16 v[200:203], v[60:63], v[64:67], v[200:203]
    ds_read_b64_tr_b16 v[64:65], v14 offset:0
    ds_read_b64_tr_b16 v[66:67], v14 offset:2048
    v_mfma_f32_16x16x32_bf16 v[164:167], v[48:51], v[68:71], v[164:167]
    buffer_load_dwordx4 v8, s[8:11], s22 offen offset:2048 lds
    v_mfma_f32_16x16x32_bf16 v[172:175], v[52:55], v[68:71], v[172:175]
    v_mfma_f32_16x16x32_bf16 v[196:199], v[56:59], v[68:71], v[196:199]
    buffer_load_dwordx4 v9, s[8:11], s22 offen offset:3072 lds
    s_add_u32 s22, s22, s26
    v_mfma_f32_16x16x32_bf16 v[204:207], v[60:63], v[68:71], v[204:207]
    ds_read_b64_tr_b16 v[68:69], v15 offset:0
    ds_read_b64_tr_b16 v[70:71], v15 offset:2048
    s_waitcnt lgkmcnt(6)
    v_mfma_f32_16x16x32_bf16 v[80:83], v[24:27], v[40:43], v[80:83]
    ds_read_b128 v[48:51], v10 offset:8192
    s_mov_b32 m0, s21
    s_nop 0
    buffer_load_dwordx4 v2, s[4:7], s16 offen offset:0 lds
    v_mfma_f32_16x16x32_bf16 v[88:91], v[28:31], v[40:43], v[88:91]
    ds_read_b128 v[52:55], v10 offset:10240
    v_mfma_f32_16x16x32_bf16 v[112:115], v[32:35], v[40:43], v[112:115]
    ds_read_b128 v[56:59], v10 offset:12288
    buffer_load_dwordx4 v3, s[4:7], s16 offen offset:1024 lds
    v_mfma_f32_16x16x32_bf16 v[120:123], v[36:39], v[40:43], v[120:123]
    ds_read_b128 v[60:63], v10 offset:14336
    s_waitcnt lgkmcnt(8)
    v_mfma_f32_16x16x32_bf16 v[84:87], v[24:27], v[44:47], v[84:87]
    buffer_load_dwordx4 v4, s[4:7], s16 offen offset:2048 lds
    v_mfma_f32_16x16x32_bf16 v[92:95], v[28:31], v[44:47], v[92:95]
    v_mfma_f32_16x16x32_bf16 v[116:119], v[32:35], v[44:47], v[116:119]
    buffer_load_dwordx4 v5, s[4:7], s16 offen offset:3072 lds
    s_add_u32 s16, s16, s33
    v_mfma_f32_16x16x32_bf16 v[124:127], v[36:39], v[44:47], v[124:127]
    s_waitcnt lgkmcnt(6)
    v_mfma_f32_16x16x32_bf16 v[96:99], v[24:27], v[64:67], v[96:99]
    s_add_u32 m0, s21, 4096
    s_nop 0
    buffer_load_dwordx4 v2, s[4:7], s18 offen offset:0 lds
    v_mfma_f32_16x16x32_bf16 v[104:107], v[28:31], v[64:67], v[104:107]
    v_mfma_f32_16x16x32_bf16 v[128:131], v[32:35], v[64:67], v[128:131]
    buffer_load_dwordx4 v3, s[4:7], s18 offen offset:1024 lds
    v_mfma_f32_16x16x32_bf16 v[136:139], v[36:39], v[64:67], v[136:139]
    s_waitcnt lgkmcnt(4)
    v_mfma_f32_16x16x32_bf16 v[100:103], v[24:27], v[68:71], v[100:103]
    buffer_load_dwordx4 v4, s[4:7], s18 offen offset:2048 lds
    v_mfma_f32_16x16x32_bf16 v[108:111], v[28:31], v[68:71], v[108:111]
    v_mfma_f32_16x16x32_bf16 v[132:135], v[32:35], v[68:71], v[132:135]
    buffer_load_dwordx4 v5, s[4:7], s18 offen offset:3072 lds
    s_add_u32 s18, s18, s33
    v_mfma_f32_16x16x32_bf16 v[140:143], v[36:39], v[68:71], v[140:143]
    s_waitcnt lgkmcnt(3)
    v_mfma_f32_16x16x32_bf16 v[144:147], v[48:51], v[40:43], v[144:147]
    ds_read_b128 v[24:27], v11 offset:0
    s_waitcnt lgkmcnt(3)
    v_mfma_f32_16x16x32_bf16 v[152:155], v[52:55], v[40:43], v[152:155]
    ds_read_b128 v[28:31], v11 offset:2048
    s_waitcnt lgkmcnt(3)
    v_mfma_f32_16x16x32_bf16 v[176:179], v[56:59], v[40:43], v[176:179]
    ds_read_b128 v[32:35], v11 offset:4096
    s_waitcnt lgkmcnt(3)
    v_mfma_f32_16x16x32_bf16 v[184:187], v[60:63], v[40:43], v[184:187]
    ds_read_b128 v[36:39], v11 offset:6144
    ds_read_b64_tr_b16 v[40:41], v12 offset:16384
    ds_read_b64_tr_b16 v[42:43], v12 offset:18432
    v_mfma_f32_16x16x32_bf16 v[148:151], v[48:51], v[44:47], v[148:151]
    v_mfma_f32_16x16x32_bf16 v[156:159], v[52:55], v[44:47], v[156:159]
    v_mfma_f32_16x16x32_bf16 v[180:183], v[56:59], v[44:47], v[180:183]
    v_mfma_f32_16x16x32_bf16 v[188:191], v[60:63], v[44:47], v[188:191]
    ds_read_b64_tr_b16 v[44:45], v13 offset:16384
    ds_read_b64_tr_b16 v[46:47], v13 offset:18432
    v_mfma_f32_16x16x32_bf16 v[160:163], v[48:51], v[64:67], v[160:163]
    v_mfma_f32_16x16x32_bf16 v[168:171], v[52:55], v[64:67], v[168:171]
    v_mfma_f32_16x16x32_bf16 v[192:195], v[56:59], v[64:67], v[192:195]
    v_mfma_f32_16x16x32_bf16 v[200:203], v[60:63], v[64:67], v[200:203]
    ds_read_b64_tr_b16 v[64:65], v14 offset:16384
    ds_read_b64_tr_b16 v[66:67], v14 offset:18432
    v_mfma_f32_16x16x32_bf16 v[164:167], v[48:51], v[68:71], v[164:167]
    v_mfma_f32_16x16x32_bf16 v[172:175], v[52:55], v[68:71], v[172:175]
    v_mfma_f32_16x16x32_bf16 v[196:199], v[56:59], v[68:71], v[196:199]
    v_mfma_f32_16x16x32_bf16 v[204:207], v[60:63], v[68:71], v[204:207]
    ds_read_b64_tr_b16 v[68:69], v15 offset:16384
    ds_read_b64_tr_b16 v[70:71], v15 offset:18432
    s_waitcnt lgkmcnt(6)
    v_mfma_f32_16x16x32_bf16 v[80:83], v[24:27], v[40:43], v[80:83]
    ds_read_b128 v[48:51], v11 offset:8192
    v_mfma_f32_16x16x32_bf16 v[88:91], v[28:31], v[40:43], v[88:91]
    ds_read_b128 v[52:55], v11 offset:10240
    v_mfma_f32_16x16x32_bf16 v[112:115], v[32:35], v[40:43], v[112:115]
    ds_read_b128 v[56:59], v11 offset:12288
    v_mfma_f32_16x16x32_bf16 v[120:123], v[36:39], v[40:43], v[120:123]
    ds_read_b128 v[60:63], v11 offset:14336
    s_waitcnt lgkmcnt(8)
    v_mfma_f32_16x16x32_bf16 v[84:87], v[24:27], v[44:47], v[84:87]
    v_mfma_f32_16x16x32_bf16 v[92:95], v[28:31], v[44:47], v[92:95]
    v_mfma_f32_16x16x32_bf16 v[116:119], v[32:35], v[44:47], v[116:119]
    v_mfma_f32_16x16x32_bf16 v[124:127], v[36:39], v[44:47], v[124:127]
    s_waitcnt lgkmcnt(6)
    v_mfma_f32_16x16x32_bf16 v[96:99], v[24:27], v[64:67], v[96:99]
    v_mfma_f32_16x16x32_bf16 v[104:107], v[28:31], v[64:67], v[104:107]
    v_mfma_f32_16x16x32_bf16 v[128:131], v[32:35], v[64:67], v[128:131]
    v_mfma_f32_16x16x32_bf16 v[136:139], v[36:39], v[64:67], v[136:139]
    s_waitcnt lgkmcnt(4)
    v_mfma_f32_16x16x32_bf16 v[100:103], v[24:27], v[68:71], v[100:103]
    v_mfma_f32_16x16x32_bf16 v[108:111], v[28:31], v[68:71], v[108:111]
    v_mfma_f32_16x16x32_bf16 v[132:135], v[32:35], v[68:71], v[132:135]
    v_mfma_f32_16x16x32_bf16 v[140:143], v[36:39], v[68:71], v[140:143]
    s_waitcnt lgkmcnt(0) vmcnt(0)
    s_barrier
    v_xor_b32 v248, s95, v248
    v_xor_b32 v249, s95, v249
    v_xor_b32 v250, s95, v250
    v_xor_b32 v251, s95, v251
    v_or3_b32 v252, v248, v249, v250
    v_or_b32 v252, v252, v251
    v_cmp_ne_u32 vcc, 0, v252
    s_cbranch_vccnz L_pollslow_4
L_pollback_5:
    v_mfma_f32_16x16x32_bf16 v[144:147], v[48:51], v[40:43], v[144:147]
    ds_read_b128 v[24:27], v10 offset:32768
    s_mov_b32 m0, s23
    s_nop 0
    buffer_load_dwordx4 v73, s[68:71], s73 offen offset:0 lds
    v_mfma_f32_16x16x32_bf16 v[152:155], v[52:55], v[40:43], v[152:155]
    ds_read_b128 v[28:31], v10 offset:34816
    v_mfma_f32_16x16x32_bf16 v[176:179], v[56:59], v[40:43], v[176:179]
    ds_read_b128 v[32:35], v10 offset:36864
    buffer_load_dwordx4 v74, s[68:71], s73 offen offset:1024 lds
    v_mfma_f32_16x16x32_bf16 v[184:187], v[60:63], v[40:43], v[184:187]
    ds_read_b128 v[36:39], v10 offset:38912
    ds_read_b64_tr_b16 v[40:41], v12 offset:32768
    ds_read_b64_tr_b16 v[42:43], v12 offset:34816
    v_mfma_f32_16x16x32_bf16 v[148:151], v[48:51], v[44:47], v[148:151]
    buffer_load_dwordx4 v75, s[68:71], s73 offen offset:2048 lds
    v_mfma_f32_16x16x32_bf16 v[156:159], v[52:55], v[44:47], v[156:159]
    v_mfma_f32_16x16x32_bf16 v[180:183], v[56:59], v[44:47], v[180:183]
    buffer_load_dwordx4 v76, s[68:71], s73 offen offset:3072 lds
    s_add_u32 s73, s73, s75
    v_mfma_f32_16x16x32_bf16 v[188:191], v[60:63], v[44:47], v[188:191]
    ds_read_b64_tr_b16 v[44:45], v13 offset:32768
    ds_read_b64_tr_b16 v[46:47], v13 offset:34816
    v_mfma_f32_16x16x32_bf16 v[160:163], v[48:51], v[64:67], v[160:163]
    s_add_u32 m0, s23, 16384
    s_nop 0
    buffer_load_dwordx4 v20, s[84:87], s94 offen offset:0 lds
    v_mfma_f32_16x16x32_bf16 v[168:171], v[52:55], v[64:67], v[168:171]
    v_mfma_f32_16x16x32_bf16 v[192:195], v[56:59], v[64:67], v[192:195]
    buffer_load_dwordx4 v21, s[84:87], s94 offen offset:1024 lds
    v_mfma_f32_16x16x32_bf16 v[200:203], v[60:63], v[64:67], v[200:203]
    ds_read_b64_tr_b16 v[64:65], v14 offset:32768
    ds_read_b64_tr_b16 v[66:67], v14 offset:34816
    v_mfma_f32_16x16x32_bf16 v[164:167], v[48:51], v[68:71], v[164:167]
    buffer_load_dwordx4 v22, s[84:87], s94 offen offset:2048 lds
    v_mfma_f32_16x16x32_bf16 v[172:175], v[52:55], v[68:71], v[172:175]
    v_mfma_f32_16x16x32_bf16 v[196:199], v[56:59], v[68:71], v[196:199]
    buffer_load_dwordx4 v23, s[84:87], s94 offen offset:3072 lds
    s_add_u32 s94, s94, s76
    v_mfma_f32_16x16x32_bf16 v[204:207], v[60:63], v[68:71], v[204:207]
    ds_read_b64_tr_b16 v[68:69], v15 offset:32768
    ds_read_b64_tr_b16 v[70:71], v15 offset:34816
    s_waitcnt lgkmcnt(6)
    v_mfma_f32_16x16x32_bf16 v[80:83], v[24:27], v[40:43], v[80:83]
    ds_read_b128 v[48:51], v10 offset:40960
    s_mov_b32 m0, s20
    s_nop 0
    buffer_load_dwordx4 v72, s[64:67], s72 offen offset:0 lds
    v_mfma_f32_16x16x32_bf16 v[88:91], v[28:31], v[40:43], v[88:91]
    ds_read_b128 v[52:55], v10 offset:43008
    v_mfma_f32_16x16x32_bf16 v[112:115], v[32:35], v[40:43], v[112:115]
    ds_read_b128 v[56:59], v10 offset:45056
    buffer_load_dwordx4 v72, s[64:67], s72 offen offset:1024 lds
    v_mfma_f32_16x16x32_bf16 v[120:123], v[36:39], v[40:43], v[120:123]
    ds_read_b128 v[60:63], v10 offset:47104
    s_waitcnt lgkmcnt(8)
    v_mfma_f32_16x16x32_bf16 v[84:87], v[24:27], v[44:47], v[84:87]
    buffer_load_dwordx4 v72, s[64:67], s72 offen offset:2048 lds
    v_mfma_f32_16x16x32_bf16 v[92:95], v[28:31], v[44:47], v[92:95]
    v_mfma_f32_16x16x32_bf16 v[116:119], v[32:35], v[44:47], v[116:119]
    buffer_load_dwordx4 v72, s[64:67], s72 offen offset:3072 lds
    s_add_u32 s72, s72, s74
    v_mfma_f32_16x16x32_bf16 v[124:127], v[36:39], v[44:47], v[124:127]
    s_waitcnt lgkmcnt(6)
    v_mfma_f32_16x16x32_bf16 v[96:99], v[24:27], v[64:67], v[96:99]
    s_add_u32 m0, s20, 4096
    s_nop 0
    buffer_load_dwordx4 v72, s[64:67], s25 offen offset:0 lds
    v_mfma_f32_16x16x32_bf16 v[104:107], v[28:31], v[64:67], v[104:107]
    v_mfma_f32_16x16x32_bf16 v[128:131], v[32:35], v[64:67], v[128:131]
    buffer_load_dwordx4 v72, s[64:67], s25 offen offset:1024 lds
    v_mfma_f32_16x16x32_bf16 v[136:139], v[36:39], v[64:67], v[136:139]
    s_waitcnt lgkmcnt(4)
    v_mfma_f32_16x16x32_bf16 v[100:103], v[24:27], v[68:71], v[100:103]
    buffer_load_dwordx4 v72, s[64:67], s25 offen offset:2048 lds
    v_mfma_f32_16x16x32_bf16 v[108:111], v[28:31], v[68:71], v[108:111]
    v_mfma_f32_16x16x32_bf16 v[132:135], v[32:35], v[68:71], v[132:135]
    buffer_load_dwordx4 v72, s[64:67], s25 offen offset:3072 lds
    s_add_u32 s25, s25, s74
    v_mfma_f32_16x16x32_bf16 v[140:143], v[36:39], v[68:71], v[140:143]
    s_waitcnt lgkmcnt(3)
    v_mfma_f32_16x16x32_bf16 v[144:147], v[48:51], v[40:43], v[144:147]
    ds_read_b128 v[24:27], v11 offset:32768
    s_waitcnt lgkmcnt(3)
    v_mfma_f32_16x16x32_bf16 v[152:155], v[52:55], v[40:43], v[152:155]
    ds_read_b128 v[28:31], v11 offset:34816
    s_waitcnt lgkmcnt(3)
    v_mfma_f32_16x16x32_bf16 v[176:179], v[56:59], v[40:43], v[176:179]
    ds_read_b128 v[32:35], v11 offset:36864
    s_waitcnt lgkmcnt(3)
    v_mfma_f32_16x16x32_bf16 v[184:187], v[60:63], v[40:43], v[184:187]
    ds_read_b128 v[36:39], v11 offset:38912
    ds_read_b64_tr_b16 v[40:41], v12 offset:49152
    ds_read_b64_tr_b16 v[42:43], v12 offset:51200
    v_mfma_f32_16x16x32_bf16 v[148:151], v[48:51], v[44:47], v[148:151]
    v_mfma_f32_16x16x32_bf16 v[156:159], v[52:55], v[44:47], v[156:159]
    v_mfma_f32_16x16x32_bf16 v[180:183], v[56:59], v[44:47], v[180:183]
    v_mfma_f32_16x16x32_bf16 v[188:191], v[60:63], v[44:47], v[188:191]
    ds_read_b64_tr_b16 v[44:45], v13 offset:49152
    ds_read_b64_tr_b16 v[46:47], v13 offset:51200
    v_mfma_f32_16x16x32_bf16 v[160:163], v[48:51], v[64:67], v[160:163]
    v_mfma_f32_16x16x32_bf16 v[168:171], v[52:55], v[64:67], v[168:171]
    v_mfma_f32_16x16x32_bf16 v[192:195], v[56:59], v[64:67], v[192:195]
    v_mfma_f32_16x16x32_bf16 v[200:203], v[60:63], v[64:67], v[200:203]
    ds_read_b64_tr_b16 v[64:65], v14 offset:49152
    ds_read_b64_tr_b16 v[66:67], v14 offset:51200
    v_mfma_f32_16x16x32_bf16 v[164:167], v[48:51], v[68:71], v[164:167]
    v_mfma_f32_16x16x32_bf16 v[172:175], v[52:55], v[68:71], v[172:175]
    v_mfma_f32_16x16x32_bf16 v[196:199], v[56:59], v[68:71], v[196:199]
    v_mfma_f32_16x16x32_bf16 v[204:207], v[60:63], v[68:71], v[204:207]
    ds_read_b64_tr_b16 v[68:69], v15 offset:49152
    ds_read_b64_tr_b16 v[70:71], v15 offset:51200
    s_waitcnt lgkmcnt(6)
    v_mfma_f32_16x16x32_bf16 v[80:83], v[24:27], v[40:43], v[80:83]
    ds_read_b128 v[48:51], v11 offset:40960
    v_mfma_f32_16x16x32_bf16 v[88:91], v[28:31], v[40:43], v[88:91]
    ds_read_b128 v[52:55], v11 offset:43008
    v_mfma_f32_16x16x32_bf16 v[112:115], v[32:35], v[40:43], v[112:115]
    ds_read_b128 v[56:59], v11 offset:45056
    v_mfma_f32_16x16x32_bf16 v[120:123], v[36:39], v[40:43], v[120:123]
    ds_read_b128 v[60:63], v11 offset:47104
    s_waitcnt lgkmcnt(8)
    v_mfma_f32_16x16x32_bf16 v[84:87], v[24:27], v[44:47], v[84:87]
    v_mfma_f32_16x16x32_bf16 v[92:95], v[28:31], v[44:47], v[92:95]
    v_mfma_f32_16x16x32_bf16 v[116:119], v[32:35], v[44:47], v[116:119]
    v_mfma_f32_16x16x32_bf16 v[124:127], v[36:39], v[44:47], v[124:127]
    s_waitcnt lgkmcnt(6)
    v_mfma_f32_16x16x32_bf16 v[96:99], v[24:27], v[64:67], v[96:99]
    v_mfma_f32_16x16x32_bf16 v[104:107], v[28:31], v[64:67], v[104:107]
    v_mfma_f32_16x16x32_bf16 v[128:131], v[32:35], v[64:67], v[128:131]
    v_mfma_f32_16x16x32_bf16 v[136:139], v[36:39], v[64:67], v[136:139]
    s_waitcnt lgkmcnt(4)
    v_mfma_f32_16x16x32_bf16 v[100:103], v[24:27], v[68:71], v[100:103]
    v_mfma_f32_16x16x32_bf16 v[108:111], v[28:31], v[68:71], v[108:111]
    v_mfma_f32_16x16x32_bf16 v[132:135], v[32:35], v[68:71], v[132:135]
    v_mfma_f32_16x16x32_bf16 v[140:143], v[36:39], v[68:71], v[140:143]
    s_waitcnt lgkmcnt(0) vmcnt(0)
    s_barrier
    v_bfe_u32 v18, v1, 6, 2
    v_lshrrev_b32 v17, 8, v1
    v_lshl_add_u32 v17, v17, 3, v18
    v_and_b32 v16, 3, v17
    v_lshlrev_b32 v16, 2, v16
    v_bfe_u32 v19, v17, 3, 1
    v_lshl_or_b32 v16, v19, 1, v16
    v_lshlrev_b32 v17, 8, v17
    v_bfe_u32 v18, v1, 4, 1
    v_lshl_add_u32 v17, v18, 3, v17
    v_bfe_u32 v18, v1, 5, 1
    s_lshl_b32 s31, s28, 2
    s_add_u32 s31, s31, 0
    v_add_u32 v19, s31, v18
    v_xor_b32 v19, v19, v16
    v_lshl_add_u32 v19, v19, 4, v17
    v_add_u32 v14, 65536, v19
    s_lshl_b32 s31, s28, 2
    s_add_u32 s31, s31, 2
    v_add_u32 v19, s31, v18
    v_xor_b32 v19, v19, v16
    v_lshl_add_u32 v19, v19, 4, v17
    v_add_u32 v15, 65536, v19
    v_mfma_f32_16x16x32_bf16 v[144:147], v[48:51], v[40:43], v[144:147]
    ds_read_b128 v[24:27], v77 offset:0
    s_mov_b32 m0, s24
    s_nop 0
    buffer_load_dwordx4 v73, s[68:71], s73 offen offset:0 lds
    v_mfma_f32_16x16x32_bf16 v[152:155], v[52:55], v[40:43], v[152:155]
    ds_read_b128 v[28:31], v77 offset:256
    v_mfma_f32_16x16x32_bf16 v[176:179], v[56:59], v[40:43], v[176:179]
    ds_read_b128 v[32:35], v77 offset:4096
    buffer_load_dwordx4 v74, s[68:71], s73 offen offset:1024 lds
    v_mfma_f32_16x16x32_bf16 v[184:187], v[60:63], v[40:43], v[184:187]
    ds_read_b128 v[36:39], v77 offset:4352
    ds_read_b64_tr_b16 v[40:41], v14 offset:0
    ds_read_b64_tr_b16 v[42:43], v14 offset:1024
    v_mfma_f32_16x16x32_bf16 v[148:151], v[48:51], v[44:47], v[148:151]
    buffer_load_dwordx4 v75, s[68:71], s73 offen offset:2048 lds
    v_mfma_f32_16x16x32_bf16 v[156:159], v[52:55], v[44:47], v[156:159]
    v_mfma_f32_16x16x32_bf16 v[180:183], v[56:59], v[44:47], v[180:183]
    buffer_load_dwordx4 v76, s[68:71], s73 offen offset:3072 lds
    s_add_u32 s73, s73, s75
    v_mfma_f32_16x16x32_bf16 v[188:191], v[60:63], v[44:47], v[188:191]
    ds_read_b64_tr_b16 v[44:45], v15 offset:0
    ds_read_b64_tr_b16 v[46:47], v15 offset:1024
    v_mfma_f32_16x16x32_bf16 v[160:163], v[48:51], v[64:67], v[160:163]
    s_add_u32 m0, s24, 16384
    s_nop 0
    buffer_load_dwordx4 v20, s[84:87], s94 offen offset:0 lds
    v_mfma_f32_16x16x32_bf16 v[168:171], v[52:55], v[64:67], v[168:171]
    v_mfma_f32_16x16x32_bf16 v[192:195], v[56:59], v[64:67], v[192:195]
    buffer_load_dwordx4 v21, s[84:87], s94 offen offset:1024 lds
    v_mfma_f32_16x16x32_bf16 v[200:203], v[60:63], v[64:67], v[200:203]
    ds_read_b64_tr_b16 v[64:65], v14 offset:16384
    ds_read_b64_tr_b16 v[66:67], v14 offset:17408
    v_mfma_f32_16x16x32_bf16 v[164:167], v[48:51], v[68:71], v[164:167]
    buffer_load_dwordx4 v22, s[84:87], s94 offen offset:2048 lds
    v_mfma_f32_16x16x32_bf16 v[172:175], v[52:55], v[68:71], v[172:175]
    v_mfma_f32_16x16x32_bf16 v[196:199], v[56:59], v[68:71], v[196:199]
    buffer_load_dwordx4 v23, s[84:87], s94 offen offset:3072 lds
    s_add_u32 s94, s94, s76
    v_mfma_f32_16x16x32_bf16 v[204:207], v[60:63], v[68:71], v[204:207]
    ds_read_b64_tr_b16 v[68:69], v15 offset:16384
    ds_read_b64_tr_b16 v[70:71], v15 offset:17408
L_pj_TD:
    v_cvt_pk_bf16_f32 v208, v80, v81
    v_cvt_pk_bf16_f32 v209, v82, v83
    v_cvt_pk_bf16_f32 v210, v84, v85
    v_cvt_pk_bf16_f32 v211, v86, v87
    s_nop 1
    v_permlane16_swap_b32 v208, v210
    v_permlane16_swap_b32 v209, v211
    v_cvt_pk_bf16_f32 v212, v88, v89
    v_cvt_pk_bf16_f32 v213, v90, v91
    v_cvt_pk_bf16_f32 v214, v92, v93
    v_cvt_pk_bf16_f32 v215, v94, v95
    s_nop 1
    v_permlane16_swap_b32 v212, v214
    v_permlane16_swap_b32 v213, v215
    s_waitcnt lgkmcnt(6)
    v_mfma_f32_16x16x32_bf16 v[80:83], v[40:43], v[24:27], 0
    ds_read_b128 v[48:51], v77 offset:8192
    s_mov_b32 m0, s21
    s_nop 0
    buffer_load_dwordx4 v72, s[64:67], s72 offen offset:0 lds
    v_mfma_f32_16x16x32_bf16 v[84:87], v[40:43], v[28:31], 0
    ds_read_b128 v[52:55], v77 offset:8448
    v_cvt_pk_bf16_f32 v224, v112, v113
    v_cvt_pk_bf16_f32 v225, v114, v115
    v_cvt_pk_bf16_f32 v226, v116, v117
    v_cvt_pk_bf16_f32 v227, v118, v119
    s_nop 1
    v_permlane16_swap_b32 v224, v226
    v_permlane16_swap_b32 v225, v227
    v_cvt_pk_bf16_f32 v228, v120, v121
    v_cvt_pk_bf16_f32 v229, v122, v123
    v_cvt_pk_bf16_f32 v230, v124, v125
    v_cvt_pk_bf16_f32 v231, v126, v127
    s_nop 1
    v_permlane16_swap_b32 v228, v230
    v_permlane16_swap_b32 v229, v231
    v_mfma_f32_16x16x32_bf16 v[112:115], v[40:43], v[32:35], 0
    ds_read_b128 v[56:59], v77 offset:12288
    buffer_load_dwordx4 v72, s[64:67], s72 offen offset:1024 lds
    v_mfma_f32_16x16x32_bf16 v[116:119], v[40:43], v[36:39], 0
    ds_read_b128 v[60:63], v77 offset:12544
    s_waitcnt lgkmcnt(8)
    v_mfma_f32_16x16x32_bf16 v[88:91], v[44:47], v[24:27], 0
    buffer_load_dwordx4 v72, s[64:67], s72 offen offset:2048 lds
    v_mfma_f32_16x16x32_bf16 v[92:95], v[44:47], v[28:31], 0
    v_mfma_f32_16x16x32_bf16 v[120:123], v[44:47], v[32:35], 0
    buffer_load_dwordx4 v72, s[64:67], s72 offen offset:3072 lds
    s_add_u32 s72, s72, s74
    v_mfma_f32_16x16x32_bf16 v[124:127], v[44:47], v[36:39], 0
    v_cvt_pk_bf16_f32 v216, v96, v97
    v_cvt_pk_bf16_f32 v217, v98, v99
    v_cvt_pk_bf16_f32 v218, v100, v101
    v_cvt_pk_bf16_f32 v219, v102, v103
    s_nop 1
    v_permlane16_swap_b32 v216, v218
    v_permlane16_swap_b32 v217, v219
    v_cvt_pk_bf16_f32 v220, v104, v105
    v_cvt_pk_bf16_f32 v221, v106, v107
    v_cvt_pk_bf16_f32 v222, v108, v109
    v_cvt_pk_bf16_f32 v223, v110, v111
    s_nop 1
    v_permlane16_swap_b32 v220, v222
    v_permlane16_swap_b32 v221, v223
    s_waitcnt lgkmcnt(6)
    v_mfma_f32_16x16x32_bf16 v[96:99], v[64:67], v[24:27], 0
    s_add_u32 m0, s21, 4096
    s_nop 0
    buffer_load_dwordx4 v72, s[64:67], s25 offen offset:0 lds
    v_mfma_f32_16x16x32_bf16 v[100:103], v[64:67], v[28:31], 0
    v_cvt_pk_bf16_f32 v232, v128, v129
    v_cvt_pk_bf16_f32 v233, v130, v131
    v_cvt_pk_bf16_f32 v234, v132, v133
    v_cvt_pk_bf16_f32 v235, v134, v135
    s_nop 1
    v_permlane16_swap_b32 v232, v234
    v_permlane16_swap_b32 v233, v235
    v_cvt_pk_bf16_f32 v236, v136, v137
    v_cvt_pk_bf16_f32 v237, v138, v139
    v_cvt_pk_bf16_f32 v238, v140, v141
    v_cvt_pk_bf16_f32 v239, v142, v143
    s_nop 1
    v_permlane16_swap_b32 v236, v238
    v_permlane16_swap_b32 v237, v239
    v_mfma_f32_16x16x32_bf16 v[128:131], v[64:67], v[32:35], 0
    buffer_load_dwordx4 v72, s[64:67], s25 offen offset:1024 lds
    v_mfma_f32_16x16x32_bf16 v[132:135], v[64:67], v[36:39], 0
    s_waitcnt lgkmcnt(4)
    v_mfma_f32_16x16x32_bf16 v[104:107], v[68:71], v[24:27], 0
    buffer_load_dwordx4 v72, s[64:67], s25 offen offset:2048 lds
    v_mfma_f32_16x16x32_bf16 v[108:111], v[68:71], v[28:31], 0
    v_mfma_f32_16x16x32_bf16 v[136:139], v[68:71], v[32:35], 0
    buffer_load_dwordx4 v72, s[64:67], s25 offen offset:3072 lds
    s_add_u32 s25, s25, s74
    v_mfma_f32_16x16x32_bf16 v[140:143], v[68:71], v[36:39], 0
    v_cvt_pk_bf16_f32 v240, v144, v145
    v_cvt_pk_bf16_f32 v241, v146, v147
    v_cvt_pk_bf16_f32 v242, v148, v149
    v_cvt_pk_bf16_f32 v243, v150, v151
    s_nop 1
    v_permlane16_swap_b32 v240, v242
    v_permlane16_swap_b32 v241, v243
    v_cvt_pk_bf16_f32 v244, v152, v153
    v_cvt_pk_bf16_f32 v245, v154, v155
    v_cvt_pk_bf16_f32 v246, v156, v157
    v_cvt_pk_bf16_f32 v247, v158, v159
    s_nop 1
    v_permlane16_swap_b32 v244, v246
    v_permlane16_swap_b32 v245, v247
    s_waitcnt lgkmcnt(3)
    v_mfma_f32_16x16x32_bf16 v[144:147], v[40:43], v[48:51], 0
    ds_read_b128 v[24:27], v77 offset:2048
    s_waitcnt lgkmcnt(3)
    v_mfma_f32_16x16x32_bf16 v[148:151], v[40:43], v[52:55], 0
    ds_read_b128 v[28:31], v77 offset:2304
    v_cvt_pk_bf16_f32 v2, v176, v177
    v_cvt_pk_bf16_f32 v3, v178, v179
    v_cvt_pk_bf16_f32 v4, v180, v181
    v_cvt_pk_bf16_f32 v5, v182, v183
    s_nop 1
    v_permlane16_swap_b32 v2, v4
    v_permlane16_swap_b32 v3, v5
    v_cvt_pk_bf16_f32 v6, v184, v185
    v_cvt_pk_bf16_f32 v7, v186, v187
    v_cvt_pk_bf16_f32 v8, v188, v189
    v_cvt_pk_bf16_f32 v9, v190, v191
    s_nop 1
    v_permlane16_swap_b32 v6, v8
    v_permlane16_swap_b32 v7, v9
    s_waitcnt lgkmcnt(3)
    v_mfma_f32_16x16x32_bf16 v[176:179], v[40:43], v[56:59], 0
    ds_read_b128 v[32:35], v77 offset:6144
    s_waitcnt lgkmcnt(3)
    v_mfma_f32_16x16x32_bf16 v[180:183], v[40:43], v[60:63], 0
    ds_read_b128 v[36:39], v77 offset:6400
    ds_read_b64_tr_b16 v[40:41], v14 offset:8192
    ds_read_b64_tr_b16 v[42:43], v14 offset:9216
    v_mfma_f32_16x16x32_bf16 v[152:155], v[44:47], v[48:51], 0
    v_mfma_f32_16x16x32_bf16 v[156:159], v[44:47], v[52:55], 0
    v_mfma_f32_16x16x32_bf16 v[184:187], v[44:47], v[56:59], 0
    v_mfma_f32_16x16x32_bf16 v[188:191], v[44:47], v[60:63], 0
    ds_read_b64_tr_b16 v[44:45], v15 offset:8192
    ds_read_b64_tr_b16 v[46:47], v15 offset:9216
    v_cvt_pk_bf16_f32 v248, v160, v161
    v_cvt_pk_bf16_f32 v249, v162, v163
    v_cvt_pk_bf16_f32 v250, v164, v165
    v_cvt_pk_bf16_f32 v251, v166, v167
    s_nop 1
    v_permlane16_swap_b32 v248, v250
    v_permlane16_swap_b32 v249, v251
    v_cvt_pk_bf16_f32 v252, v168, v169
    v_cvt_pk_bf16_f32 v253, v170, v171
    v_cvt_pk_bf16_f32 v254, v172, v173
    v_cvt_pk_bf16_f32 v255, v174, v175
    s_nop 1
    v_permlane16_swap_b32 v252, v254
    v_permlane16_swap_b32 v253, v255
    v_mfma_f32_16x16x32_bf16 v[160:163], v[64:67], v[48:51], 0
    v_mfma_f32_16x16x32_bf16 v[164:167], v[64:67], v[52:55], 0
    v_cvt_pk_bf16_f32 v10, v192, v193
    v_cvt_pk_bf16_f32 v11, v194, v195
    v_cvt_pk_bf16_f32 v12, v196, v197
    v_cvt_pk_bf16_f32 v13, v198, v199
    s_nop 1
    v_permlane16_swap_b32 v10, v12
    v_permlane16_swap_b32 v11, v13
    v_cvt_pk_bf16_f32 v16, v200, v201
    v_cvt_pk_bf16_f32 v17, v202, v203
    v_cvt_pk_bf16_f32 v18, v204, v205
    v_cvt_pk_bf16_f32 v19, v206, v207
    s_nop 1
    v_permlane16_swap_b32 v16, v18
    v_permlane16_swap_b32 v17, v19
    v_mfma_f32_16x16x32_bf16 v[192:195], v[64:67], v[56:59], 0
    v_mfma_f32_16x16x32_bf16 v[196:199], v[64:67], v[60:63], 0
    ds_read_b64_tr_b16 v[64:65], v14 offset:24576
    ds_read_b64_tr_b16 v[66:67], v14 offset:25600
    v_mfma_f32_16x16x32_bf16 v[168:171], v[68:71], v[48:51], 0
    v_mfma_f32_16x16x32_bf16 v[172:175], v[68:71], v[52:55], 0
    v_mfma_f32_16x16x32_bf16 v[200:203], v[68:71], v[56:59], 0
    v_mfma_f32_16x16x32_bf16 v[204:207], v[68:71], v[60:63], 0
    ds_read_b64_tr_b16 v[68:69], v15 offset:24576
    ds_read_b64_tr_b16 v[70:71], v15 offset:25600
    s_waitcnt lgkmcnt(6)
    v_mfma_f32_16x16x32_bf16 v[80:83], v[40:43], v[24:27], v[80:83]
    ds_read_b128 v[48:51], v77 offset:10240
    buffer_store_dwordx4 v[208:211], v1, s[12:15], s100 offen offset:0 sc1
    v_mfma_f32_16x16x32_bf16 v[84:87], v[40:43], v[28:31], v[84:87]
    ds_read_b128 v[52:55], v77 offset:10496
    v_mfma_f32_16x16x32_bf16 v[112:115], v[40:43], v[32:35], v[112:115]
    ds_read_b128 v[56:59], v77 offset:14336
    v_mfma_f32_16x16x32_bf16 v[116:119], v[40:43], v[36:39], v[116:119]
    ds_read_b128 v[60:63], v77 offset:14592
    s_waitcnt lgkmcnt(8)
    v_mfma_f32_16x16x32_bf16 v[88:91], v[44:47], v[24:27], v[88:91]
    v_mfma_f32_16x16x32_bf16 v[92:95], v[44:47], v[28:31], v[92:95]
    v_mfma_f32_16x16x32_bf16 v[120:123], v[44:47], v[32:35], v[120:123]
    v_mfma_f32_16x16x32_bf16 v[124:127], v[44:47], v[36:39], v[124:127]
    s_waitcnt lgkmcnt(6)
    v_mfma_f32_16x16x32_bf16 v[96:99], v[64:67], v[24:27], v[96:99]
    v_mfma_f32_16x16x32_bf16 v[100:103], v[64:67], v[28:31], v[100:103]
    v_mfma_f32_16x16x32_bf16 v[128:131], v[64:67], v[32:35], v[128:131]
    v_mfma_f32_16x16x32_bf16 v[132:135], v[64:67], v[36:39], v[132:135]
    s_waitcnt lgkmcnt(4)
    v_mfma_f32_16x16x32_bf16 v[104:107], v[68:71], v[24:27], v[104:107]
    v_mfma_f32_16x16x32_bf16 v[108:111], v[68:71], v[28:31], v[108:111]
    v_mfma_f32_16x16x32_bf16 v[136:139], v[68:71], v[32:35], v[136:139]
    v_mfma_f32_16x16x32_bf16 v[140:143], v[68:71], v[36:39], v[140:143]
    s_waitcnt lgkmcnt(0) vmcnt(1)
    s_barrier
    v_mfma_f32_16x16x32_bf16 v[144:147], v[40:43], v[48:51], v[144:147]
    ds_read_b128 v[24:27], v77 offset:32768
    s_mov_b32 m0, s23
    s_nop 0
    buffer_load_dwordx4 v73, s[68:71], s73 offen offset:0 lds
    v_mfma_f32_16x16x32_bf16 v[148:151], v[40:43], v[52:55], v[148:151]
    ds_read_b128 v[28:31], v77 offset:33024
    v_mfma_f32_16x16x32_bf16 v[176:179], v[40:43], v[56:59], v[176:179]
    ds_read_b128 v[32:35], v77 offset:36864
    buffer_load_dwordx4 v74, s[68:71], s73 offen offset:1024 lds
    v_mfma_f32_16x16x32_bf16 v[180:183], v[40:43], v[60:63], v[180:183]
    ds_read_b128 v[36:39], v77 offset:37120
    ds_read_b64_tr_b16 v[40:41], v14 offset:32768
    ds_read_b64_tr_b16 v[42:43], v14 offset:33792
    v_mfma_f32_16x16x32_bf16 v[152:155], v[44:47], v[48:51], v[152:155]
    buffer_load_dwordx4 v75, s[68:71], s73 offen offset:2048 lds
    v_mfma_f32_16x16x32_bf16 v[156:159], v[44:47], v[52:55], v[156:159]
    v_mfma_f32_16x16x32_bf16 v[184:187], v[44:47], v[56:59], v[184:187]
    buffer_load_dwordx4 v76, s[68:71], s73 offen offset:3072 lds
    s_add_u32 s73, s73, s75
    v_mfma_f32_16x16x32_bf16 v[188:191], v[44:47], v[60:63], v[188:191]
    ds_read_b64_tr_b16 v[44:45], v15 offset:32768
    ds_read_b64_tr_b16 v[46:47], v15 offset:33792
    v_mfma_f32_16x16x32_bf16 v[160:163], v[64:67], v[48:51], v[160:163]
    s_add_u32 m0, s23, 16384
    s_nop 0
    buffer_load_dwordx4 v20, s[84:87], s94 offen offset:0 lds
    v_mfma_f32_16x16x32_bf16 v[164:167], v[64:67], v[52:55], v[164:167]
    v_mfma_f32_16x16x32_bf16 v[192:195], v[64:67], v[56:59], v[192:195]
    buffer_load_dwordx4 v21, s[84:87], s94 offen offset:1024 lds
    v_mfma_f32_16x16x32_bf16 v[196:199], v[64:67], v[60:63], v[196:199]
    ds_read_b64_tr_b16 v[64:65], v14 offset:49152
    ds_read_b64_tr_b16 v[66:67], v14 offset:50176
    v_mfma_f32_16x16x32_bf16 v[168:171], v[68:71], v[48:51], v[168:171]
    buffer_load_dwordx4 v22, s[84:87], s94 offen offset:2048 lds
    v_mfma_f32_16x16x32_bf16 v[172:175], v[68:71], v[52:55], v[172:175]
    v_mfma_f32_16x16x32_bf16 v[200:203], v[68:71], v[56:59], v[200:203]
    buffer_load_dwordx4 v23, s[84:87], s94 offen offset:3072 lds
    s_add_u32 s94, s94, s76
    v_mfma_f32_16x16x32_bf16 v[204:207], v[68:71], v[60:63], v[204:207]
    ds_read_b64_tr_b16 v[68:69], v15 offset:49152
    ds_read_b64_tr_b16 v[70:71], v15 offset:50176
    s_waitcnt lgkmcnt(6)
    v_mfma_f32_16x16x32_bf16 v[80:83], v[40:43], v[24:27], v[80:83]
    ds_read_b128 v[48:51], v77 offset:40960
    s_mov_b32 m0, s20
    s_nop 0
    buffer_load_dwordx4 v72, s[64:67], s72 offen offset:0 lds
    v_mfma_f32_16x16x32_bf16 v[84:87], v[40:43], v[28:31], v[84:87]
    ds_read_b128 v[52:55], v77 offset:41216
    buffer_load_dwordx4 v72, s[64:67], s72 offen offset:1024 lds
    v_mfma_f32_16x16x32_bf16 v[112:115], v[40:43], v[32:35], v[112:115]
    ds_read_b128 v[56:59], v77 offset:45056
    v_mfma_f32_16x16x32_bf16 v[116:119], v[40:43], v[36:39], v[116:119]
    ds_read_b128 v[60:63], v77 offset:45312
    buffer_load_dwordx4 v72, s[64:67], s72 offen offset:2048 lds
    s_waitcnt lgkmcnt(8)
    v_mfma_f32_16x16x32_bf16 v[88:91], v[44:47], v[24:27], v[88:91]
    v_mfma_f32_16x16x32_bf16 v[92:95], v[44:47], v[28:31], v[92:95]
    buffer_load_dwordx4 v72, s[64:67], s72 offen offset:3072 lds
    s_add_u32 s72, s72, s74
    v_mfma_f32_16x16x32_bf16 v[120:123], v[44:47], v[32:35], v[120:123]
    v_mfma_f32_16x16x32_bf16 v[124:127], v[44:47], v[36:39], v[124:127]
    s_add_u32 m0, s20, 4096
    s_nop 0
    buffer_load_dwordx4 v72, s[64:67], s25 offen offset:0 lds
    s_waitcnt lgkmcnt(6)
    v_mfma_f32_16x16x32_bf16 v[96:99], v[64:67], v[24:27], v[96:99]
    buffer_load_dwordx4 v72, s[64:67], s25 offen offset:1024 lds
    v_mfma_f32_16x16x32_bf16 v[100:103], v[64:67], v[28:31], v[100:103]
    v_mfma_f32_16x16x32_bf16 v[128:131], v[64:67], v[32:35], v[128:131]
    buffer_load_dwordx4 v72, s[64:67], s25 offen offset:2048 lds
    v_mfma_f32_16x16x32_bf16 v[132:135], v[64:67], v[36:39], v[132:135]
    s_waitcnt lgkmcnt(4)
    v_mfma_f32_16x16x32_bf16 v[104:107], v[68:71], v[24:27], v[104:107]
    buffer_load_dwordx4 v72, s[64:67], s25 offen offset:3072 lds
    s_add_u32 s25, s25, s74
    v_mfma_f32_16x16x32_bf16 v[108:111], v[68:71], v[28:31], v[108:111]
    v_mfma_f32_16x16x32_bf16 v[136:139], v[68:71], v[32:35], v[136:139]
    buffer_store_dwordx4 v[212:215], v1, s[12:15], s100 offen offset:1024 sc1
    v_mfma_f32_16x16x32_bf16 v[140:143], v[68:71], v[36:39], v[140:143]
    s_waitcnt lgkmcnt(3)
    v_mfma_f32_16x16x32_bf16 v[144:147], v[40:43], v[48:51], v[144:147]
    ds_read_b128 v[24:27], v77 offset:34816
    buffer_store_dwordx4 v[216:219], v1, s[12:15], s100 offen offset:2048 sc1
    s_waitcnt lgkmcnt(3)
    v_mfma_f32_16x16x32_bf16 v[148:151], v[40:43], v[52:55], v[148:151]
    ds_read_b128 v[28:31], v77 offset:35072
    s_waitcnt lgkmcnt(3)
    v_mfma_f32_16x16x32_bf16 v[176:179], v[40:43], v[56:59], v[176:179]
    ds_read_b128 v[32:35], v77 offset:38912
    s_waitcnt lgkmcnt(3)
    v_mfma_f32_16x16x32_bf16 v[180:183], v[40:43], v[60:63], v[180:183]
    ds_read_b128 v[36:39], v77 offset:39168
    ds_read_b64_tr_b16 v[40:41], v14 offset:40960
    ds_read_b64_tr_b16 v[42:43], v14 offset:41984
    v_mfma_f32_16x16x32_bf16 v[152:155], v[44:47], v[48:51], v[152:155]
    v_mfma_f32_16x16x32_bf16 v[156:159], v[44:47], v[52:55], v[156:159]
    v_mfma_f32_16x16x32_bf16 v[184:187], v[44:47], v[56:59], v[184:187]
    v_mfma_f32_16x16x32_bf16 v[188:191], v[44:47], v[60:63], v[188:191]
    ds_read_b64_tr_b16 v[44:45], v15 offset:40960
    ds_read_b64_tr_b16 v[46:47], v15 offset:41984
    v_mfma_f32_16x16x32_bf16 v[160:163], v[64:67], v[48:51], v[160:163]
    v_mfma_f32_16x16x32_bf16 v[164:167], v[64:67], v[52:55], v[164:167]
    v_mfma_f32_16x16x32_bf16 v[192:195], v[64:67], v[56:59], v[192:195]
    v_mfma_f32_16x16x32_bf16 v[196:199], v[64:67], v[60:63], v[196:199]
    ds_read_b64_tr_b16 v[64:65], v14 offset:57344
    ds_read_b64_tr_b16 v[66:67], v14 offset:58368
    v_mfma_f32_16x16x32_bf16 v[168:171], v[68:71], v[48:51], v[168:171]
    v_mfma_f32_16x16x32_bf16 v[172:175], v[68:71], v[52:55], v[172:175]
    v_mfma_f32_16x16x32_bf16 v[200:203], v[68:71], v[56:59], v[200:203]
    v_mfma_f32_16x16x32_bf16 v[204:207], v[68:71], v[60:63], v[204:207]
    ds_read_b64_tr_b16 v[68:69], v15 offset:57344
    ds_read_b64_tr_b16 v[70:71], v15 offset:58368
    s_waitcnt lgkmcnt(6)
    v_mfma_f32_16x16x32_bf16 v[80:83], v[40:43], v[24:27], v[80:83]
    ds_read_b128 v[48:51], v77 offset:43008
    v_mfma_f32_16x16x32_bf16 v[84:87], v[40:43], v[28:31], v[84:87]
    ds_read_b128 v[52:55], v77 offset:43264
    v_mfma_f32_16x16x32_bf16 v[112:115], v[40:43], v[32:35], v[112:115]
    ds_read_b128 v[56:59], v77 offset:47104
    v_mfma_f32_16x16x32_bf16 v[116:119], v[40:43], v[36:39], v[116:119]
    ds_read_b128 v[60:63], v77 offset:47360
    s_waitcnt lgkmcnt(8)
    v_mfma_f32_16x16x32_bf16 v[88:91], v[44:47], v[24:27], v[88:91]
    v_mfma_f32_16x16x32_bf16 v[92:95], v[44:47], v[28:31], v[92:95]
    v_mfma_f32_16x16x32_bf16 v[120:123], v[44:47], v[32:35], v[120:123]
    v_mfma_f32_16x16x32_bf16 v[124:127], v[44:47], v[36:39], v[124:127]
    s_waitcnt lgkmcnt(6)
    v_mfma_f32_16x16x32_bf16 v[96:99], v[64:67], v[24:27], v[96:99]
    v_mfma_f32_16x16x32_bf16 v[100:103], v[64:67], v[28:31], v[100:103]
    v_mfma_f32_16x16x32_bf16 v[128:131], v[64:67], v[32:35], v[128:131]
    v_mfma_f32_16x16x32_bf16 v[132:135], v[64:67], v[36:39], v[132:135]
    s_waitcnt lgkmcnt(4)
    v_mfma_f32_16x16x32_bf16 v[104:107], v[68:71], v[24:27], v[104:107]
    v_mfma_f32_16x16x32_bf16 v[108:111], v[68:71], v[28:31], v[108:111]
    v_mfma_f32_16x16x32_bf16 v[136:139], v[68:71], v[32:35], v[136:139]
    v_mfma_f32_16x16x32_bf16 v[140:143], v[68:71], v[36:39], v[140:143]
    s_waitcnt lgkmcnt(0) vmcnt(2)
    s_barrier
    v_mfma_f32_16x16x32_bf16 v[144:147], v[40:43], v[48:51], v[144:147]
    ds_read_b128 v[24:27], v77 offset:0
    s_mov_b32 m0, s24
    s_nop 0
    buffer_load_dwordx4 v73, s[68:71], s73 offen offset:0 lds
    v_mfma_f32_16x16x32_bf16 v[148:151], v[40:43], v[52:55], v[148:151]
    ds_read_b128 v[28:31], v77 offset:256
    v_mfma_f32_16x16x32_bf16 v[176:179], v[40:43], v[56:59], v[176:179]
    ds_read_b128 v[32:35], v77 offset:4096
    buffer_load_dwordx4 v74, s[68:71], s73 offen offset:1024 lds
    v_mfma_f32_16x16x32_bf16 v[180:183], v[40:43], v[60:63], v[180:183]
    ds_read_b128 v[36:39], v77 offset:4352
    ds_read_b64_tr_b16 v[40:41], v14 offset:0
    ds_read_b64_tr_b16 v[42:43], v14 offset:1024
    v_mfma_f32_16x16x32_bf16 v[152:155], v[44:47], v[48:51], v[152:155]
    buffer_load_dwordx4 v75, s[68:71], s73 offen offset:2048 lds
    v_mfma_f32_16x16x32_bf16 v[156:159], v[44:47], v[52:55], v[156:159]
    v_mfma_f32_16x16x32_bf16 v[184:187], v[44:47], v[56:59], v[184:187]
    buffer_load_dwordx4 v76, s[68:71], s73 offen offset:3072 lds
    s_add_u32 s73, s73, s75
    v_mfma_f32_16x16x32_bf16 v[188:191], v[44:47], v[60:63], v[188:191]
    ds_read_b64_tr_b16 v[44:45], v15 offset:0
    ds_read_b64_tr_b16 v[46:47], v15 offset:1024
    v_mfma_f32_16x16x32_bf16 v[160:163], v[64:67], v[48:51], v[160:163]
    s_add_u32 m0, s24, 16384
    s_nop 0
    buffer_load_dwordx4 v20, s[84:87], s94 offen offset:0 lds
    v_mfma_f32_16x16x32_bf16 v[164:167], v[64:67], v[52:55], v[164:167]
    v_mfma_f32_16x16x32_bf16 v[192:195], v[64:67], v[56:59], v[192:195]
    buffer_load_dwordx4 v21, s[84:87], s94 offen offset:1024 lds
    v_mfma_f32_16x16x32_bf16 v[196:199], v[64:67], v[60:63], v[196:199]
    ds_read_b64_tr_b16 v[64:65], v14 offset:16384
    ds_read_b64_tr_b16 v[66:67], v14 offset:17408
    v_mfma_f32_16x16x32_bf16 v[168:171], v[68:71], v[48:51], v[168:171]
    buffer_load_dwordx4 v22, s[84:87], s94 offen offset:2048 lds
    v_mfma_f32_16x16x32_bf16 v[172:175], v[68:71], v[52:55], v[172:175]
    v_mfma_f32_16x16x32_bf16 v[200:203], v[68:71], v[56:59], v[200:203]
    buffer_load_dwordx4 v23, s[84:87], s94 offen offset:3072 lds
    s_add_u32 s94, s94, s76
    v_mfma_f32_16x16x32_bf16 v[204:207], v[68:71], v[60:63], v[204:207]
    ds_read_b64_tr_b16 v[68:69], v15 offset:16384
    ds_read_b64_tr_b16 v[70:71], v15 offset:17408
    s_waitcnt lgkmcnt(6)
    v_mfma_f32_16x16x32_bf16 v[80:83], v[40:43], v[24:27], v[80:83]
    ds_read_b128 v[48:51], v77 offset:8192
    s_mov_b32 m0, s21
    s_nop 0
    buffer_load_dwordx4 v72, s[64:67], s72 offen offset:0 lds
    v_mfma_f32_16x16x32_bf16 v[84:87], v[40:43], v[28:31], v[84:87]
    ds_read_b128 v[52:55], v77 offset:8448
    buffer_load_dwordx4 v72, s[64:67], s72 offen offset:1024 lds
    v_mfma_f32_16x16x32_bf16 v[112:115], v[40:43], v[32:35], v[112:115]
    ds_read_b128 v[56:59], v77 offset:12288
    v_mfma_f32_16x16x32_bf16 v[116:119], v[40:43], v[36:39], v[116:119]
    ds_read_b128 v[60:63], v77 offset:12544
    buffer_load_dwordx4 v72, s[64:67], s72 offen offset:2048 lds
    s_waitcnt lgkmcnt(8)
    v_mfma_f32_16x16x32_bf16 v[88:91], v[44:47], v[24:27], v[88:91]
    v_mfma_f32_16x16x32_bf16 v[92:95], v[44:47], v[28:31], v[92:95]
    buffer_load_dwordx4 v72, s[64:67], s72 offen offset:3072 lds
    s_add_u32 s72, s72, s74
    v_mfma_f32_16x16x32_bf16 v[120:123], v[44:47], v[32:35], v[120:123]
    v_mfma_f32_16x16x32_bf16 v[124:127], v[44:47], v[36:39], v[124:127]
    s_add_u32 m0, s21, 4096
    s_nop 0
    buffer_load_dwordx4 v72, s[64:67], s25 offen offset:0 lds
    s_waitcnt lgkmcnt(6)
    v_mfma_f32_16x16x32_bf16 v[96:99], v[64:67], v[24:27], v[96:99]
    buffer_load_dwordx4 v72, s[64:67], s25 offen offset:1024 lds
    v_mfma_f32_16x16x32_bf16 v[100:103], v[64:67], v[28:31], v[100:103]
    v_mfma_f32_16x16x32_bf16 v[128:131], v[64:67], v[32:35], v[128:131]
    buffer_load_dwordx4 v72, s[64:67], s25 offen offset:2048 lds
    v_mfma_f32_16x16x32_bf16 v[132:135], v[64:67], v[36:39], v[132:135]
    s_waitcnt lgkmcnt(4)
    v_mfma_f32_16x16x32_bf16 v[104:107], v[68:71], v[24:27], v[104:107]
    buffer_load_dwordx4 v72, s[64:67], s25 offen offset:3072 lds
    s_add_u32 s25, s25, s74
    v_mfma_f32_16x16x32_bf16 v[108:111], v[68:71], v[28:31], v[108:111]
    v_mfma_f32_16x16x32_bf16 v[136:139], v[68:71], v[32:35], v[136:139]
    buffer_store_dwordx4 v[220:223], v1, s[12:15], s100 offen offset:3072 sc1
    s_add_u32 s100, s100, 8192
    v_mfma_f32_16x16x32_bf16 v[140:143], v[68:71], v[36:39], v[140:143]
    s_waitcnt lgkmcnt(3)
    v_mfma_f32_16x16x32_bf16 v[144:147], v[40:43], v[48:51], v[144:147]
    ds_read_b128 v[24:27], v77 offset:2048
    s_waitcnt lgkmcnt(3)
    v_mfma_f32_16x16x32_bf16 v[148:151], v[40:43], v[52:55], v[148:151]
    ds_read_b128 v[28:31], v77 offset:2304
    s_waitcnt lgkmcnt(3)
    v_mfma_f32_16x16x32_bf16 v[176:179], v[40:43], v[56:59], v[176:179]
    ds_read_b128 v[32:35], v77 offset:6144
    s_waitcnt lgkmcnt(3)
    v_mfma_f32_16x16x32_bf16 v[180:183], v[40:43], v[60:63], v[180:183]
    ds_read_b128 v[36:39], v77 offset:6400
    ds_read_b64_tr_b16 v[40:41], v14 offset:8192
    ds_read_b64_tr_b16 v[42:43], v14 offset:9216
    v_mfma_f32_16x16x32_bf16 v[152:155], v[44:47], v[48:51], v[152:155]
    v_mfma_f32_16x16x32_bf16 v[156:159], v[44:47], v[52:55], v[156:159]
    v_mfma_f32_16x16x32_bf16 v[184:187], v[44:47], v[56:59], v[184:187]
    v_mfma_f32_16x16x32_bf16 v[188:191], v[44:47], v[60:63], v[188:191]
    ds_read_b64_tr_b16 v[44:45], v15 offset:8192
    ds_read_b64_tr_b16 v[46:47], v15 offset:9216
    v_mfma_f32_16x16x32_bf16 v[160:163], v[64:67], v[48:51], v[160:163]
    v_mfma_f32_16x16x32_bf16 v[164:167], v[64:67], v[52:55], v[164:167]
    v_mfma_f32_16x16x32_bf16 v[192:195], v[64:67], v[56:59], v[192:195]
    v_mfma_f32_16x16x32_bf16 v[196:199], v[64:67], v[60:63], v[196:199]
    ds_read_b64_tr_b16 v[64:65], v14 offset:24576
    ds_read_b64_tr_b16 v[66:67], v14 offset:25600
    v_mfma_f32_16x16x32_bf16 v[168:171], v[68:71], v[48:51], v[168:171]
    v_mfma_f32_16x16x32_bf16 v[172:175], v[68:71], v[52:55], v[172:175]
    v_mfma_f32_16x16x32_bf16 v[200:203], v[68:71], v[56:59], v[200:203]
    v_mfma_f32_16x16x32_bf16 v[204:207], v[68:71], v[60:63], v[204:207]
    ds_read_b64_tr_b16 v[68:69], v15 offset:24576
    ds_read_b64_tr_b16 v[70:71], v15 offset:25600
    s_waitcnt lgkmcnt(6)
    v_mfma_f32_16x16x32_bf16 v[80:83], v[40:43], v[24:27], v[80:83]
    ds_read_b128 v[48:51], v77 offset:10240
    v_mfma_f32_16x16x32_bf16 v[84:87], v[40:43], v[28:31], v[84:87]
    ds_read_b128 v[52:55], v77 offset:10496
    v_mfma_f32_16x16x32_bf16 v[112:115], v[40:43], v[32:35], v[112:115]
    ds_read_b128 v[56:59], v77 offset:14336
    v_mfma_f32_16x16x32_bf16 v[116:119], v[40:43], v[36:39], v[116:119]
    ds_read_b128 v[60:63], v77 offset:14592
    s_waitcnt lgkmcnt(8)
    v_mfma_f32_16x16x32_bf16 v[88:91], v[44:47], v[24:27], v[88:91]
    v_mfma_f32_16x16x32_bf16 v[92:95], v[44:47], v[28:31], v[92:95]
    v_mfma_f32_16x16x32_bf16 v[120:123], v[44:47], v[32:35], v[120:123]
    v_mfma_f32_16x16x32_bf16 v[124:127], v[44:47], v[36:39], v[124:127]
    s_waitcnt lgkmcnt(6)
    v_mfma_f32_16x16x32_bf16 v[96:99], v[64:67], v[24:27], v[96:99]
    v_mfma_f32_16x16x32_bf16 v[100:103], v[64:67], v[28:31], v[100:103]
    v_mfma_f32_16x16x32_bf16 v[128:131], v[64:67], v[32:35], v[128:131]
    v_mfma_f32_16x16x32_bf16 v[132:135], v[64:67], v[36:39], v[132:135]
    s_waitcnt lgkmcnt(4)
    v_mfma_f32_16x16x32_bf16 v[104:107], v[68:71], v[24:27], v[104:107]
    v_mfma_f32_16x16x32_bf16 v[108:111], v[68:71], v[28:31], v[108:111]
    v_mfma_f32_16x16x32_bf16 v[136:139], v[68:71], v[32:35], v[136:139]
    v_mfma_f32_16x16x32_bf16 v[140:143], v[68:71], v[36:39], v[140:143]
    s_waitcnt lgkmcnt(0) vmcnt(1)
    s_barrier
    v_mfma_f32_16x16x32_bf16 v[144:147], v[40:43], v[48:51], v[144:147]
    ds_read_b128 v[24:27], v77 offset:32768
    s_mov_b32 m0, s23
    s_nop 0
    buffer_load_dwordx4 v73, s[68:71], s73 offen offset:0 lds
    v_mfma_f32_16x16x32_bf16 v[148:151], v[40:43], v[52:55], v[148:151]
    ds_read_b128 v[28:31], v77 offset:33024
    v_mfma_f32_16x16x32_bf16 v[176:179], v[40:43], v[56:59], v[176:179]
    ds_read_b128 v[32:35], v77 offset:36864
    buffer_load_dwordx4 v74, s[68:71], s73 offen offset:1024 lds
    v_mfma_f32_16x16x32_bf16 v[180:183], v[40:43], v[60:63], v[180:183]
    ds_read_b128 v[36:39], v77 offset:37120
    ds_read_b64_tr_b16 v[40:41], v14 offset:32768
    ds_read_b64_tr_b16 v[42:43], v14 offset:33792
    v_mfma_f32_16x16x32_bf16 v[152:155], v[44:47], v[48:51], v[152:155]
    buffer_load_dwordx4 v75, s[68:71], s73 offen offset:2048 lds
    v_mfma_f32_16x16x32_bf16 v[156:159], v[44:47], v[52:55], v[156:159]
    v_mfma_f32_16x16x32_bf16 v[184:187], v[44:47], v[56:59], v[184:187]
    buffer_load_dwordx4 v76, s[68:71], s73 offen offset:3072 lds
    s_add_u32 s73, s73, s75
    v_mfma_f32_16x16x32_bf16 v[188:191], v[44:47], v[60:63], v[188:191]
    ds_read_b64_tr_b16 v[44:45], v15 offset:32768
    ds_read_b64_tr_b16 v[46:47], v15 offset:33792
    v_mfma_f32_16x16x32_bf16 v[160:163], v[64:67], v[48:51], v[160:163]
    s_add_u32 m0, s23, 16384
    s_nop 0
    buffer_load_dwordx4 v20, s[84:87], s94 offen offset:0 lds
    v_mfma_f32_16x16x32_bf16 v[164:167], v[64:67], v[52:55], v[164:167]
    v_mfma_f32_16x16x32_bf16 v[192:195], v[64:67], v[56:59], v[192:195]
    buffer_load_dwordx4 v21, s[84:87], s94 offen offset:1024 lds
    v_mfma_f32_16x16x32_bf16 v[196:199], v[64:67], v[60:63], v[196:199]
    ds_read_b64_tr_b16 v[64:65], v14 offset:49152
    ds_read_b64_tr_b16 v[66:67], v14 offset:50176
    v_mfma_f32_16x16x32_bf16 v[168:171], v[68:71], v[48:51], v[168:171]
    buffer_load_dwordx4 v22, s[84:87], s94 offen offset:2048 lds
    v_mfma_f32_16x16x32_bf16 v[172:175], v[68:71], v[52:55], v[172:175]
    v_mfma_f32_16x16x32_bf16 v[200:203], v[68:71], v[56:59], v[200:203]
    buffer_load_dwordx4 v23, s[84:87], s94 offen offset:3072 lds
    s_add_u32 s94, s94, s76
    v_mfma_f32_16x16x32_bf16 v[204:207], v[68:71], v[60:63], v[204:207]
    ds_read_b64_tr_b16 v[68:69], v15 offset:49152
    ds_read_b64_tr_b16 v[70:71], v15 offset:50176
    s_waitcnt lgkmcnt(6)
    v_mfma_f32_16x16x32_bf16 v[80:83], v[40:43], v[24:27], v[80:83]
    ds_read_b128 v[48:51], v77 offset:40960
    s_mov_b32 m0, s20
    s_nop 0
    buffer_load_dwordx4 v72, s[64:67], s72 offen offset:0 lds
    v_mfma_f32_16x16x32_bf16 v[84:87], v[40:43], v[28:31], v[84:87]
    ds_read_b128 v[52:55], v77 offset:41216
    buffer_load_dwordx4 v72, s[64:67], s72 offen offset:1024 lds
    v_mfma_f32_16x16x32_bf16 v[112:115], v[40:43], v[32:35], v[112:115]
    ds_read_b128 v[56:59], v77 offset:45056
    v_mfma_f32_16x16x32_bf16 v[116:119], v[40:43], v[36:39], v[116:119]
    ds_read_b128 v[60:63], v77 offset:45312
    buffer_load_dwordx4 v72, s[64:67], s72 offen offset:2048 lds
    s_waitcnt lgkmcnt(8)
    v_mfma_f32_16x16x32_bf16 v[88:91], v[44:47], v[24:27], v[88:91]
    v_mfma_f32_16x16x32_bf16 v[92:95], v[44:47], v[28:31], v[92:95]
    buffer_load_dwordx4 v72, s[64:67], s72 offen offset:3072 lds
    s_add_u32 s72, s72, s74
    v_mfma_f32_16x16x32_bf16 v[120:123], v[44:47], v[32:35], v[120:123]
    v_mfma_f32_16x16x32_bf16 v[124:127], v[44:47], v[36:39], v[124:127]
    s_add_u32 m0, s20, 4096
    s_nop 0
    buffer_load_dwordx4 v72, s[64:67], s25 offen offset:0 lds
    s_waitcnt lgkmcnt(6)
    v_mfma_f32_16x16x32_bf16 v[96:99], v[64:67], v[24:27], v[96:99]
    buffer_load_dwordx4 v72, s[64:67], s25 offen offset:1024 lds
    v_mfma_f32_16x16x32_bf16 v[100:103], v[64:67], v[28:31], v[100:103]
    v_mfma_f32_16x16x32_bf16 v[128:131], v[64:67], v[32:35], v[128:131]
    buffer_load_dwordx4 v72, s[64:67], s25 offen offset:2048 lds
    v_mfma_f32_16x16x32_bf16 v[132:135], v[64:67], v[36:39], v[132:135]
    s_waitcnt lgkmcnt(4)
    v_mfma_f32_16x16x32_bf16 v[104:107], v[68:71], v[24:27], v[104:107]
    buffer_load_dwordx4 v72, s[64:67], s25 offen offset:3072 lds
    s_add_u32 s25, s25, s74
    v_mfma_f32_16x16x32_bf16 v[108:111], v[68:71], v[28:31], v[108:111]
    v_mfma_f32_16x16x32_bf16 v[136:139], v[68:71], v[32:35], v[136:139]
    buffer_store_dwordx4 v[224:227], v1, s[12:15], s100 offen offset:0 sc1
    v_mfma_f32_16x16x32_bf16 v[140:143], v[68:71], v[36:39], v[140:143]
    s_waitcnt lgkmcnt(3)
    v_mfma_f32_16x16x32_bf16 v[144:147], v[40:43], v[48:51], v[144:147]
    ds_read_b128 v[24:27], v77 offset:34816
    buffer_store_dwordx4 v[228:231], v1, s[12:15], s100 offen offset:1024 sc1
    s_waitcnt lgkmcnt(3)
    v_mfma_f32_16x16x32_bf16 v[148:151], v[40:43], v[52:55], v[148:151]
    ds_read_b128 v[28:31], v77 offset:35072
    s_waitcnt lgkmcnt(3)
    v_mfma_f32_16x16x32_bf16 v[176:179], v[40:43], v[56:59], v[176:179]
    ds_read_b128 v[32:35], v77 offset:38912
    s_waitcnt lgkmcnt(3)
    v_mfma_f32_16x16x32_bf16 v[180:183], v[40:43], v[60:63], v[180:183]
    ds_read_b128 v[36:39], v77 offset:39168
    ds_read_b64_tr_b16 v[40:41], v14 offset:40960
    ds_read_b64_tr_b16 v[42:43], v14 offset:41984
    v_mfma_f32_16x16x32_bf16 v[152:155], v[44:47], v[48:51], v[152:155]
    v_mfma_f32_16x16x32_bf16 v[156:159], v[44:47], v[52:55], v[156:159]
    v_mfma_f32_16x16x32_bf16 v[184:187], v[44:47], v[56:59], v[184:187]
    v_mfma_f32_16x16x32_bf16 v[188:191], v[44:47], v[60:63], v[188:191]
    ds_read_b64_tr_b16 v[44:45], v15 offset:40960
    ds_read_b64_tr_b16 v[46:47], v15 offset:41984
    v_mfma_f32_16x16x32_bf16 v[160:163], v[64:67], v[48:51], v[160:163]
    v_mfma_f32_16x16x32_bf16 v[164:167], v[64:67], v[52:55], v[164:167]
    v_mfma_f32_16x16x32_bf16 v[192:195], v[64:67], v[56:59], v[192:195]
    v_mfma_f32_16x16x32_bf16 v[196:199], v[64:67], v[60:63], v[196:199]
    ds_read_b64_tr_b16 v[64:65], v14 offset:57344
    ds_read_b64_tr_b16 v[66:67], v14 offset:58368
    v_mfma_f32_16x16x32_bf16 v[168:171], v[68:71], v[48:51], v[168:171]
    v_mfma_f32_16x16x32_bf16 v[172:175], v[68:71], v[52:55], v[172:175]
    v_mfma_f32_16x16x32_bf16 v[200:203], v[68:71], v[56:59], v[200:203]
    v_mfma_f32_16x16x32_bf16 v[204:207], v[68:71], v[60:63], v[204:207]
    ds_read_b64_tr_b16 v[68:69], v15 offset:57344
    ds_read_b64_tr_b16 v[70:71], v15 offset:58368
    s_waitcnt lgkmcnt(6)
    v_mfma_f32_16x16x32_bf16 v[80:83], v[40:43], v[24:27], v[80:83]
    ds_read_b128 v[48:51], v77 offset:43008
    v_mfma_f32_16x16x32_bf16 v[84:87], v[40:43], v[28:31], v[84:87]
    ds_read_b128 v[52:55], v77 offset:43264
    v_mfma_f32_16x16x32_bf16 v[112:115], v[40:43], v[32:35], v[112:115]
    ds_read_b128 v[56:59], v77 offset:47104
    v_mfma_f32_16x16x32_bf16 v[116:119], v[40:43], v[36:39], v[116:119]
    ds_read_b128 v[60:63], v77 offset:47360
    s_waitcnt lgkmcnt(8)
    v_mfma_f32_16x16x32_bf16 v[88:91], v[44:47], v[24:27], v[88:91]
    v_mfma_f32_16x16x32_bf16 v[92:95], v[44:47], v[28:31], v[92:95]
    v_mfma_f32_16x16x32_bf16 v[120:123], v[44:47], v[32:35], v[120:123]
    v_mfma_f32_16x16x32_bf16 v[124:127], v[44:47], v[36:39], v[124:127]
    s_waitcnt lgkmcnt(6)
    v_mfma_f32_16x16x32_bf16 v[96:99], v[64:67], v[24:27], v[96:99]
    v_mfma_f32_16x16x32_bf16 v[100:103], v[64:67], v[28:31], v[100:103]
    v_mfma_f32_16x16x32_bf16 v[128:131], v[64:67], v[32:35], v[128:131]
    v_mfma_f32_16x16x32_bf16 v[132:135], v[64:67], v[36:39], v[132:135]
    s_waitcnt lgkmcnt(4)
    v_mfma_f32_16x16x32_bf16 v[104:107], v[68:71], v[24:27], v[104:107]
    v_mfma_f32_16x16x32_bf16 v[108:111], v[68:71], v[28:31], v[108:111]
    v_mfma_f32_16x16x32_bf16 v[136:139], v[68:71], v[32:35], v[136:139]
    v_mfma_f32_16x16x32_bf16 v[140:143], v[68:71], v[36:39], v[140:143]
    s_waitcnt lgkmcnt(0) vmcnt(2)
    s_barrier
    v_mfma_f32_16x16x32_bf16 v[144:147], v[40:43], v[48:51], v[144:147]
    ds_read_b128 v[24:27], v77 offset:0
    s_mov_b32 m0, s24
    s_nop 0
    buffer_load_dwordx4 v73, s[68:71], s73 offen offset:0 lds
    v_mfma_f32_16x16x32_bf16 v[148:151], v[40:43], v[52:55], v[148:151]
    ds_read_b128 v[28:31], v77 offset:256
    v_mfma_f32_16x16x32_bf16 v[176:179], v[40:43], v[56:59], v[176:179]
    ds_read_b128 v[32:35], v77 offset:4096
    buffer_load_dwordx4 v74, s[68:71], s73 offen offset:1024 lds
    v_mfma_f32_16x16x32_bf16 v[180:183], v[40:43], v[60:63], v[180:183]
    ds_read_b128 v[36:39], v77 offset:4352
    ds_read_b64_tr_b16 v[40:41], v14 offset:0
    ds_read_b64_tr_b16 v[42:43], v14 offset:1024
    v_mfma_f32_16x16x32_bf16 v[152:155], v[44:47], v[48:51], v[152:155]
    buffer_load_dwordx4 v75, s[68:71], s73 offen offset:2048 lds
    v_mfma_f32_16x16x32_bf16 v[156:159], v[44:47], v[52:55], v[156:159]
    v_mfma_f32_16x16x32_bf16 v[184:187], v[44:47], v[56:59], v[184:187]
    buffer_load_dwordx4 v76, s[68:71], s73 offen offset:3072 lds
    s_add_u32 s73, s73, s75
    v_mfma_f32_16x16x32_bf16 v[188:191], v[44:47], v[60:63], v[188:191]
    ds_read_b64_tr_b16 v[44:45], v15 offset:0
    ds_read_b64_tr_b16 v[46:47], v15 offset:1024
    v_mfma_f32_16x16x32_bf16 v[160:163], v[64:67], v[48:51], v[160:163]
    s_add_u32 m0, s24, 16384
    s_nop 0
    buffer_load_dwordx4 v20, s[84:87], s94 offen offset:0 lds
    v_mfma_f32_16x16x32_bf16 v[164:167], v[64:67], v[52:55], v[164:167]
    v_mfma_f32_16x16x32_bf16 v[192:195], v[64:67], v[56:59], v[192:195]
    buffer_load_dwordx4 v21, s[84:87], s94 offen offset:1024 lds
    v_mfma_f32_16x16x32_bf16 v[196:199], v[64:67], v[60:63], v[196:199]
    ds_read_b64_tr_b16 v[64:65], v14 offset:16384
    ds_read_b64_tr_b16 v[66:67], v14 offset:17408
    v_mfma_f32_16x16x32_bf16 v[168:171], v[68:71], v[48:51], v[168:171]
    buffer_load_dwordx4 v22, s[84:87], s94 offen offset:2048 lds
    v_mfma_f32_16x16x32_bf16 v[172:175], v[68:71], v[52:55], v[172:175]
    v_mfma_f32_16x16x32_bf16 v[200:203], v[68:71], v[56:59], v[200:203]
    buffer_load_dwordx4 v23, s[84:87], s94 offen offset:3072 lds
    s_add_u32 s94, s94, s76
    v_mfma_f32_16x16x32_bf16 v[204:207], v[68:71], v[60:63], v[204:207]
    ds_read_b64_tr_b16 v[68:69], v15 offset:16384
    ds_read_b64_tr_b16 v[70:71], v15 offset:17408
    s_waitcnt lgkmcnt(6)
    v_mfma_f32_16x16x32_bf16 v[80:83], v[40:43], v[24:27], v[80:83]
    ds_read_b128 v[48:51], v77 offset:8192
    s_mov_b32 m0, s21
    s_nop 0
    buffer_load_dwordx4 v72, s[64:67], s72 offen offset:0 lds
    v_mfma_f32_16x16x32_bf16 v[84:87], v[40:43], v[28:31], v[84:87]
    ds_read_b128 v[52:55], v77 offset:8448
    buffer_load_dwordx4 v72, s[64:67], s72 offen offset:1024 lds
    v_mfma_f32_16x16x32_bf16 v[112:115], v[40:43], v[32:35], v[112:115]
    ds_read_b128 v[56:59], v77 offset:12288
    v_mfma_f32_16x16x32_bf16 v[116:119], v[40:43], v[36:39], v[116:119]
    ds_read_b128 v[60:63], v77 offset:12544
    buffer_load_dwordx4 v72, s[64:67], s72 offen offset:2048 lds
    s_waitcnt lgkmcnt(8)
    v_mfma_f32_16x16x32_bf16 v[88:91], v[44:47], v[24:27], v[88:91]
    v_mfma_f32_16x16x32_bf16 v[92:95], v[44:47], v[28:31], v[92:95]
    buffer_load_dwordx4 v72, s[64:67], s72 offen offset:3072 lds
    s_add_u32 s72, s72, s74
    v_mfma_f32_16x16x32_bf16 v[120:123], v[44:47], v[32:35], v[120:123]
    v_mfma_f32_16x16x32_bf16 v[124:127], v[44:47], v[36:39], v[124:127]
    s_add_u32 m0, s21, 4096
    s_nop 0
    buffer_load_dwordx4 v72, s[64:67], s25 offen offset:0 lds
    s_waitcnt lgkmcnt(6)
    v_mfma_f32_16x16x32_bf16 v[96:99], v[64:67], v[24:27], v[96:99]
    buffer_load_dwordx4 v72, s[64:67], s25 offen offset:1024 lds
    v_mfma_f32_16x16x32_bf16 v[100:103], v[64:67], v[28:31], v[100:103]
    v_mfma_f32_16x16x32_bf16 v[128:131], v[64:67], v[32:35], v[128:131]
    buffer_load_dwordx4 v72, s[64:67], s25 offen offset:2048 lds
    v_mfma_f32_16x16x32_bf16 v[132:135], v[64:67], v[36:39], v[132:135]
    s_waitcnt lgkmcnt(4)
    v_mfma_f32_16x16x32_bf16 v[104:107], v[68:71], v[24:27], v[104:107]
    buffer_load_dwordx4 v72, s[64:67], s25 offen offset:3072 lds
    s_add_u32 s25, s25, s74
    v_mfma_f32_16x16x32_bf16 v[108:111], v[68:71], v[28:31], v[108:111]
    v_mfma_f32_16x16x32_bf16 v[136:139], v[68:71], v[32:35], v[136:139]
    buffer_store_dwordx4 v[232:235], v1, s[12:15], s100 offen offset:2048 sc1
    v_mfma_f32_16x16x32_bf16 v[140:143], v[68:71], v[36:39], v[140:143]
    s_waitcnt lgkmcnt(3)
    v_mfma_f32_16x16x32_bf16 v[144:147], v[40:43], v[48:51], v[144:147]
    ds_read_b128 v[24:27], v77 offset:2048
    buffer_store_dwordx4 v[236:239], v1, s[12:15], s100 offen offset:3072 sc1
    s_add_u32 s100, s100, 8192
    s_waitcnt lgkmcnt(3)
    v_mfma_f32_16x16x32_bf16 v[148:151], v[40:43], v[52:55], v[148:151]
    ds_read_b128 v[28:31], v77 offset:2304
    s_waitcnt lgkmcnt(3)
    v_mfma_f32_16x16x32_bf16 v[176:179], v[40:43], v[56:59], v[176:179]
    ds_read_b128 v[32:35], v77 offset:6144
    s_waitcnt lgkmcnt(3)
    v_mfma_f32_16x16x32_bf16 v[180:183], v[40:43], v[60:63], v[180:183]
    ds_read_b128 v[36:39], v77 offset:6400
    ds_read_b64_tr_b16 v[40:41], v14 offset:8192
    ds_read_b64_tr_b16 v[42:43], v14 offset:9216
    v_mfma_f32_16x16x32_bf16 v[152:155], v[44:47], v[48:51], v[152:155]
    v_mfma_f32_16x16x32_bf16 v[156:159], v[44:47], v[52:55], v[156:159]
    v_mfma_f32_16x16x32_bf16 v[184:187], v[44:47], v[56:59], v[184:187]
    v_mfma_f32_16x16x32_bf16 v[188:191], v[44:47], v[60:63], v[188:191]
    ds_read_b64_tr_b16 v[44:45], v15 offset:8192
    ds_read_b64_tr_b16 v[46:47], v15 offset:9216
    v_mfma_f32_16x16x32_bf16 v[160:163], v[64:67], v[48:51], v[160:163]
    v_mfma_f32_16x16x32_bf16 v[164:167], v[64:67], v[52:55], v[164:167]
    v_mfma_f32_16x16x32_bf16 v[192:195], v[64:67], v[56:59], v[192:195]
    v_mfma_f32_16x16x32_bf16 v[196:199], v[64:67], v[60:63], v[196:199]
    ds_read_b64_tr_b16 v[64:65], v14 offset:24576
    ds_read_b64_tr_b16 v[66:67], v14 offset:25600
    v_mfma_f32_16x16x32_bf16 v[168:171], v[68:71], v[48:51], v[168:171]
    v_mfma_f32_16x16x32_bf16 v[172:175], v[68:71], v[52:55], v[172:175]
    v_mfma_f32_16x16x32_bf16 v[200:203], v[68:71], v[56:59], v[200:203]
    v_mfma_f32_16x16x32_bf16 v[204:207], v[68:71], v[60:63], v[204:207]
    ds_read_b64_tr_b16 v[68:69], v15 offset:24576
    ds_read_b64_tr_b16 v[70:71], v15 offset:25600
    s_waitcnt lgkmcnt(6)
    v_mfma_f32_16x16x32_bf16 v[80:83], v[40:43], v[24:27], v[80:83]
    ds_read_b128 v[48:51], v77 offset:10240
    v_mfma_f32_16x16x32_bf16 v[84:87], v[40:43], v[28:31], v[84:87]
    ds_read_b128 v[52:55], v77 offset:10496
    v_mfma_f32_16x16x32_bf16 v[112:115], v[40:43], v[32:35], v[112:115]
    ds_read_b128 v[56:59], v77 offset:14336
    v_mfma_f32_16x16x32_bf16 v[116:119], v[40:43], v[36:39], v[116:119]
    ds_read_b128 v[60:63], v77 offset:14592
    s_waitcnt lgkmcnt(8)
    v_mfma_f32_16x16x32_bf16 v[88:91], v[44:47], v[24:27], v[88:91]
    v_mfma_f32_16x16x32_bf16 v[92:95], v[44:47], v[28:31], v[92:95]
    v_mfma_f32_16x16x32_bf16 v[120:123], v[44:47], v[32:35], v[120:123]
    v_mfma_f32_16x16x32_bf16 v[124:127], v[44:47], v[36:39], v[124:127]
    s_waitcnt lgkmcnt(6)
    v_mfma_f32_16x16x32_bf16 v[96:99], v[64:67], v[24:27], v[96:99]
    v_mfma_f32_16x16x32_bf16 v[100:103], v[64:67], v[28:31], v[100:103]
    v_mfma_f32_16x16x32_bf16 v[128:131], v[64:67], v[32:35], v[128:131]
    v_mfma_f32_16x16x32_bf16 v[132:135], v[64:67], v[36:39], v[132:135]
    s_waitcnt lgkmcnt(4)
    v_mfma_f32_16x16x32_bf16 v[104:107], v[68:71], v[24:27], v[104:107]
    v_mfma_f32_16x16x32_bf16 v[108:111], v[68:71], v[28:31], v[108:111]
    v_mfma_f32_16x16x32_bf16 v[136:139], v[68:71], v[32:35], v[136:139]
    v_mfma_f32_16x16x32_bf16 v[140:143], v[68:71], v[36:39], v[140:143]
    s_waitcnt lgkmcnt(0) vmcnt(2)
    s_barrier
    v_mfma_f32_16x16x32_bf16 v[144:147], v[40:43], v[48:51], v[144:147]
    ds_read_b128 v[24:27], v77 offset:32768
    s_mov_b32 m0, s23
    s_nop 0
    buffer_load_dwordx4 v73, s[68:71], s73 offen offset:0 lds
    v_mfma_f32_16x16x32_bf16 v[148:151], v[40:43], v[52:55], v[148:151]
    ds_read_b128 v[28:31], v77 offset:33024
    v_mfma_f32_16x16x32_bf16 v[176:179], v[40:43], v[56:59], v[176:179]
    ds_read_b128 v[32:35], v77 offset:36864
    buffer_load_dwordx4 v74, s[68:71], s73 offen offset:1024 lds
    v_mfma_f32_16x16x32_bf16 v[180:183], v[40:43], v[60:63], v[180:183]
    ds_read_b128 v[36:39], v77 offset:37120
    ds_read_b64_tr_b16 v[40:41], v14 offset:32768
    ds_read_b64_tr_b16 v[42:43], v14 offset:33792
    v_mfma_f32_16x16x32_bf16 v[152:155], v[44:47], v[48:51], v[152:155]
    buffer_load_dwordx4 v75, s[68:71], s73 offen offset:2048 lds
    v_mfma_f32_16x16x32_bf16 v[156:159], v[44:47], v[52:55], v[156:159]
    v_mfma_f32_16x16x32_bf16 v[184:187], v[44:47], v[56:59], v[184:187]
    buffer_load_dwordx4 v76, s[68:71], s73 offen offset:3072 lds
    s_add_u32 s73, s73, s75
    v_mfma_f32_16x16x32_bf16 v[188:191], v[44:47], v[60:63], v[188:191]
    ds_read_b64_tr_b16 v[44:45], v15 offset:32768
    ds_read_b64_tr_b16 v[46:47], v15 offset:33792
    v_mfma_f32_16x16x32_bf16 v[160:163], v[64:67], v[48:51], v[160:163]
    s_add_u32 m0, s23, 16384
    s_nop 0
    buffer_load_dwordx4 v20, s[84:87], s94 offen offset:0 lds
    v_mfma_f32_16x16x32_bf16 v[164:167], v[64:67], v[52:55], v[164:167]
    v_mfma_f32_16x16x32_bf16 v[192:195], v[64:67], v[56:59], v[192:195]
    buffer_load_dwordx4 v21, s[84:87], s94 offen offset:1024 lds
    v_mfma_f32_16x16x32_bf16 v[196:199], v[64:67], v[60:63], v[196:199]
    ds_read_b64_tr_b16 v[64:65], v14 offset:49152
    ds_read_b64_tr_b16 v[66:67], v14 offset:50176
    v_mfma_f32_16x16x32_bf16 v[168:171], v[68:71], v[48:51], v[168:171]
    buffer_load_dwordx4 v22, s[84:87], s94 offen offset:2048 lds
    v_mfma_f32_16x16x32_bf16 v[172:175], v[68:71], v[52:55], v[172:175]
    v_mfma_f32_16x16x32_bf16 v[200:203], v[68:71], v[56:59], v[200:203]
    buffer_load_dwordx4 v23, s[84:87], s94 offen offset:3072 lds
    s_add_u32 s94, s94, s76
    v_mfma_f32_16x16x32_bf16 v[204:207], v[68:71], v[60:63], v[204:207]
    ds_read_b64_tr_b16 v[68:69], v15 offset:49152
    ds_read_b64_tr_b16 v[70:71], v15 offset:50176
    s_waitcnt lgkmcnt(6)
    v_mfma_f32_16x16x32_bf16 v[80:83], v[40:43], v[24:27], v[80:83]
    ds_read_b128 v[48:51], v77 offset:40960
    s_mov_b32 m0, s20
    s_nop 0
    buffer_load_dwordx4 v72, s[64:67], s72 offen offset:0 lds
    v_mfma_f32_16x16x32_bf16 v[84:87], v[40:43], v[28:31], v[84:87]
    ds_read_b128 v[52:55], v77 offset:41216
    buffer_load_dwordx4 v72, s[64:67], s72 offen offset:1024 lds
    v_mfma_f32_16x16x32_bf16 v[112:115], v[40:43], v[32:35], v[112:115]
    ds_read_b128 v[56:59], v77 offset:45056
    v_mfma_f32_16x16x32_bf16 v[116:119], v[40:43], v[36:39], v[116:119]
    ds_read_b128 v[60:63], v77 offset:45312
    buffer_load_dwordx4 v72, s[64:67], s72 offen offset:2048 lds
    s_waitcnt lgkmcnt(8)
    v_mfma_f32_16x16x32_bf16 v[88:91], v[44:47], v[24:27], v[88:91]
    v_mfma_f32_16x16x32_bf16 v[92:95], v[44:47], v[28:31], v[92:95]
    buffer_load_dwordx4 v72, s[64:67], s72 offen offset:3072 lds
    s_add_u32 s72, s72, s74
    v_mfma_f32_16x16x32_bf16 v[120:123], v[44:47], v[32:35], v[120:123]
    v_mfma_f32_16x16x32_bf16 v[124:127], v[44:47], v[36:39], v[124:127]
    s_add_u32 m0, s20, 4096
    s_nop 0
    buffer_load_dwordx4 v72, s[64:67], s25 offen offset:0 lds
    s_waitcnt lgkmcnt(6)
    v_mfma_f32_16x16x32_bf16 v[96:99], v[64:67], v[24:27], v[96:99]
    buffer_load_dwordx4 v72, s[64:67], s25 offen offset:1024 lds
    v_mfma_f32_16x16x32_bf16 v[100:103], v[64:67], v[28:31], v[100:103]
    v_mfma_f32_16x16x32_bf16 v[128:131], v[64:67], v[32:35], v[128:131]
    buffer_load_dwordx4 v72, s[64:67], s25 offen offset:2048 lds
    v_mfma_f32_16x16x32_bf16 v[132:135], v[64:67], v[36:39], v[132:135]
    s_waitcnt lgkmcnt(4)
    v_mfma_f32_16x16x32_bf16 v[104:107], v[68:71], v[24:27], v[104:107]
    buffer_load_dwordx4 v72, s[64:67], s25 offen offset:3072 lds
    s_add_u32 s25, s25, s74
    v_mfma_f32_16x16x32_bf16 v[108:111], v[68:71], v[28:31], v[108:111]
    v_mfma_f32_16x16x32_bf16 v[136:139], v[68:71], v[32:35], v[136:139]
    buffer_store_dwordx4 v[240:243], v1, s[12:15], s100 offen offset:0 sc1
    v_mfma_f32_16x16x32_bf16 v[140:143], v[68:71], v[36:39], v[140:143]
    s_waitcnt lgkmcnt(3)
    v_mfma_f32_16x16x32_bf16 v[144:147], v[40:43], v[48:51], v[144:147]
    ds_read_b128 v[24:27], v77 offset:34816
    s_waitcnt lgkmcnt(3)
    v_mfma_f32_16x16x32_bf16 v[148:151], v[40:43], v[52:55], v[148:151]
    ds_read_b128 v[28:31], v77 offset:35072
    s_waitcnt lgkmcnt(3)
    v_mfma_f32_16x16x32_bf16 v[176:179], v[40:43], v[56:59], v[176:179]
    ds_read_b128 v[32:35], v77 offset:38912
    s_waitcnt lgkmcnt(3)
    v_mfma_f32_16x16x32_bf16 v[180:183], v[40:43], v[60:63], v[180:183]
    ds_read_b128 v[36:39], v77 offset:39168
    ds_read_b64_tr_b16 v[40:41], v14 offset:40960
    ds_read_b64_tr_b16 v[42:43], v14 offset:41984
    v_mfma_f32_16x16x32_bf16 v[152:155], v[44:47], v[48:51], v[152:155]
    v_mfma_f32_16x16x32_bf16 v[156:159], v[44:47], v[52:55], v[156:159]
    v_mfma_f32_16x16x32_bf16 v[184:187], v[44:47], v[56:59], v[184:187]
    v_mfma_f32_16x16x32_bf16 v[188:191], v[44:47], v[60:63], v[188:191]
    ds_read_b64_tr_b16 v[44:45], v15 offset:40960
    ds_read_b64_tr_b16 v[46:47], v15 offset:41984
    v_mfma_f32_16x16x32_bf16 v[160:163], v[64:67], v[48:51], v[160:163]
    v_mfma_f32_16x16x32_bf16 v[164:167], v[64:67], v[52:55], v[164:167]
    v_mfma_f32_16x16x32_bf16 v[192:195], v[64:67], v[56:59], v[192:195]
    v_mfma_f32_16x16x32_bf16 v[196:199], v[64:67], v[60:63], v[196:199]
    ds_read_b64_tr_b16 v[64:65], v14 offset:57344
    ds_read_b64_tr_b16 v[66:67], v14 offset:58368
    v_mfma_f32_16x16x32_bf16 v[168:171], v[68:71], v[48:51], v[168:171]
    v_mfma_f32_16x16x32_bf16 v[172:175], v[68:71], v[52:55], v[172:175]
    v_mfma_f32_16x16x32_bf16 v[200:203], v[68:71], v[56:59], v[200:203]
    v_mfma_f32_16x16x32_bf16 v[204:207], v[68:71], v[60:63], v[204:207]
    ds_read_b64_tr_b16 v[68:69], v15 offset:57344
    ds_read_b64_tr_b16 v[70:71], v15 offset:58368
    s_waitcnt lgkmcnt(6)
    v_mfma_f32_16x16x32_bf16 v[80:83], v[40:43], v[24:27], v[80:83]
    ds_read_b128 v[48:51], v77 offset:43008
    v_mfma_f32_16x16x32_bf16 v[84:87], v[40:43], v[28:31], v[84:87]
    ds_read_b128 v[52:55], v77 offset:43264
    v_mfma_f32_16x16x32_bf16 v[112:115], v[40:43], v[32:35], v[112:115]
    ds_read_b128 v[56:59], v77 offset:47104
    v_mfma_f32_16x16x32_bf16 v[116:119], v[40:43], v[36:39], v[116:119]
    ds_read_b128 v[60:63], v77 offset:47360
    s_waitcnt lgkmcnt(8)
    v_mfma_f32_16x16x32_bf16 v[88:91], v[44:47], v[24:27], v[88:91]
    v_mfma_f32_16x16x32_bf16 v[92:95], v[44:47], v[28:31], v[92:95]
    v_mfma_f32_16x16x32_bf16 v[120:123], v[44:47], v[32:35], v[120:123]
    v_mfma_f32_16x16x32_bf16 v[124:127], v[44:47], v[36:39], v[124:127]
    s_waitcnt lgkmcnt(6)
    v_mfma_f32_16x16x32_bf16 v[96:99], v[64:67], v[24:27], v[96:99]
    v_mfma_f32_16x16x32_bf16 v[100:103], v[64:67], v[28:31], v[100:103]
    v_mfma_f32_16x16x32_bf16 v[128:131], v[64:67], v[32:35], v[128:131]
    v_mfma_f32_16x16x32_bf16 v[132:135], v[64:67], v[36:39], v[132:135]
    s_waitcnt lgkmcnt(4)
    v_mfma_f32_16x16x32_bf16 v[104:107], v[68:71], v[24:27], v[104:107]
    v_mfma_f32_16x16x32_bf16 v[108:111], v[68:71], v[28:31], v[108:111]
    v_mfma_f32_16x16x32_bf16 v[136:139], v[68:71], v[32:35], v[136:139]
    v_mfma_f32_16x16x32_bf16 v[140:143], v[68:71], v[36:39], v[140:143]
    s_waitcnt lgkmcnt(0) vmcnt(1)
    s_barrier
    v_mfma_f32_16x16x32_bf16 v[144:147], v[40:43], v[48:51], v[144:147]
    ds_read_b128 v[24:27], v77 offset:0
    s_mov_b32 m0, s24
    s_nop 0
    buffer_load_dwordx4 v73, s[68:71], s73 offen offset:0 lds
    v_mfma_f32_16x16x32_bf16 v[148:151], v[40:43], v[52:55], v[148:151]
    ds_read_b128 v[28:31], v77 offset:256
    v_mfma_f32_16x16x32_bf16 v[176:179], v[40:43], v[56:59], v[176:179]
    ds_read_b128 v[32:35], v77 offset:4096
    buffer_load_dwordx4 v74, s[68:71], s73 offen offset:1024 lds
    v_mfma_f32_16x16x32_bf16 v[180:183], v[40:43], v[60:63], v[180:183]
    ds_read_b128 v[36:39], v77 offset:4352
    ds_read_b64_tr_b16 v[40:41], v14 offset:0
    ds_read_b64_tr_b16 v[42:43], v14 offset:1024
    v_mfma_f32_16x16x32_bf16 v[152:155], v[44:47], v[48:51], v[152:155]
    buffer_load_dwordx4 v75, s[68:71], s73 offen offset:2048 lds
    v_mfma_f32_16x16x32_bf16 v[156:159], v[44:47], v[52:55], v[156:159]
    v_mfma_f32_16x16x32_bf16 v[184:187], v[44:47], v[56:59], v[184:187]
    buffer_load_dwordx4 v76, s[68:71], s73 offen offset:3072 lds
    s_add_u32 s73, s73, s75
    v_mfma_f32_16x16x32_bf16 v[188:191], v[44:47], v[60:63], v[188:191]
    ds_read_b64_tr_b16 v[44:45], v15 offset:0
    ds_read_b64_tr_b16 v[46:47], v15 offset:1024
    v_mfma_f32_16x16x32_bf16 v[160:163], v[64:67], v[48:51], v[160:163]
    s_add_u32 m0, s24, 16384
    s_nop 0
    buffer_load_dwordx4 v20, s[84:87], s94 offen offset:0 lds
    v_mfma_f32_16x16x32_bf16 v[164:167], v[64:67], v[52:55], v[164:167]
    v_mfma_f32_16x16x32_bf16 v[192:195], v[64:67], v[56:59], v[192:195]
    buffer_load_dwordx4 v21, s[84:87], s94 offen offset:1024 lds
    v_mfma_f32_16x16x32_bf16 v[196:199], v[64:67], v[60:63], v[196:199]
    ds_read_b64_tr_b16 v[64:65], v14 offset:16384
    ds_read_b64_tr_b16 v[66:67], v14 offset:17408
    v_mfma_f32_16x16x32_bf16 v[168:171], v[68:71], v[48:51], v[168:171]
    buffer_load_dwordx4 v22, s[84:87], s94 offen offset:2048 lds
    v_mfma_f32_16x16x32_bf16 v[172:175], v[68:71], v[52:55], v[172:175]
    v_mfma_f32_16x16x32_bf16 v[200:203], v[68:71], v[56:59], v[200:203]
    buffer_load_dwordx4 v23, s[84:87], s94 offen offset:3072 lds
    s_add_u32 s94, s94, s76
    v_mfma_f32_16x16x32_bf16 v[204:207], v[68:71], v[60:63], v[204:207]
    ds_read_b64_tr_b16 v[68:69], v15 offset:16384
    ds_read_b64_tr_b16 v[70:71], v15 offset:17408
    s_waitcnt lgkmcnt(6)
    v_mfma_f32_16x16x32_bf16 v[80:83], v[40:43], v[24:27], v[80:83]
    ds_read_b128 v[48:51], v77 offset:8192
    s_mov_b32 m0, s21
    s_nop 0
    buffer_load_dwordx4 v72, s[64:67], s72 offen offset:0 lds
    v_mfma_f32_16x16x32_bf16 v[84:87], v[40:43], v[28:31], v[84:87]
    ds_read_b128 v[52:55], v77 offset:8448
    buffer_load_dwordx4 v72, s[64:67], s72 offen offset:1024 lds
    v_mfma_f32_16x16x32_bf16 v[112:115], v[40:43], v[32:35], v[112:115]
    ds_read_b128 v[56:59], v77 offset:12288
    v_mfma_f32_16x16x32_bf16 v[116:119], v[40:43], v[36:39], v[116:119]
    ds_read_b128 v[60:63], v77 offset:12544
    buffer_load_dwordx4 v72, s[64:67], s72 offen offset:2048 lds
    s_waitcnt lgkmcnt(8)
    v_mfma_f32_16x16x32_bf16 v[88:91], v[44:47], v[24:27], v[88:91]
    v_mfma_f32_16x16x32_bf16 v[92:95], v[44:47], v[28:31], v[92:95]
    buffer_load_dwordx4 v72, s[64:67], s72 offen offset:3072 lds
    s_add_u32 s72, s72, s74
    v_mfma_f32_16x16x32_bf16 v[120:123], v[44:47], v[32:35], v[120:123]
    v_mfma_f32_16x16x32_bf16 v[124:127], v[44:47], v[36:39], v[124:127]
    s_add_u32 m0, s21, 4096
    s_nop 0
    buffer_load_dwordx4 v72, s[64:67], s25 offen offset:0 lds
    s_waitcnt lgkmcnt(6)
    v_mfma_f32_16x16x32_bf16 v[96:99], v[64:67], v[24:27], v[96:99]
    buffer_load_dwordx4 v72, s[64:67], s25 offen offset:1024 lds
    v_mfma_f32_16x16x32_bf16 v[100:103], v[64:67], v[28:31], v[100:103]
    v_mfma_f32_16x16x32_bf16 v[128:131], v[64:67], v[32:35], v[128:131]
    buffer_load_dwordx4 v72, s[64:67], s25 offen offset:2048 lds
    v_mfma_f32_16x16x32_bf16 v[132:135], v[64:67], v[36:39], v[132:135]
    s_waitcnt lgkmcnt(4)
    v_mfma_f32_16x16x32_bf16 v[104:107], v[68:71], v[24:27], v[104:107]
    buffer_load_dwordx4 v72, s[64:67], s25 offen offset:3072 lds
    s_add_u32 s25, s25, s74
    v_mfma_f32_16x16x32_bf16 v[108:111], v[68:71], v[28:31], v[108:111]
    v_mfma_f32_16x16x32_bf16 v[136:139], v[68:71], v[32:35], v[136:139]
    buffer_store_dwordx4 v[244:247], v1, s[12:15], s100 offen offset:1024 sc1
    v_mfma_f32_16x16x32_bf16 v[140:143], v[68:71], v[36:39], v[140:143]
    s_waitcnt lgkmcnt(3)
    v_mfma_f32_16x16x32_bf16 v[144:147], v[40:43], v[48:51], v[144:147]
    ds_read_b128 v[24:27], v77 offset:2048
    buffer_store_dwordx4 v[248:251], v1, s[12:15], s100 offen offset:2048 sc1
    s_waitcnt lgkmcnt(3)
    v_mfma_f32_16x16x32_bf16 v[148:151], v[40:43], v[52:55], v[148:151]
    ds_read_b128 v[28:31], v77 offset:2304
    s_waitcnt lgkmcnt(3)
    v_mfma_f32_16x16x32_bf16 v[176:179], v[40:43], v[56:59], v[176:179]
    ds_read_b128 v[32:35], v77 offset:6144
    s_waitcnt lgkmcnt(3)
    v_mfma_f32_16x16x32_bf16 v[180:183], v[40:43], v[60:63], v[180:183]
    ds_read_b128 v[36:39], v77 offset:6400
    ds_read_b64_tr_b16 v[40:41], v14 offset:8192
    ds_read_b64_tr_b16 v[42:43], v14 offset:9216
    v_mfma_f32_16x16x32_bf16 v[152:155], v[44:47], v[48:51], v[152:155]
    v_mfma_f32_16x16x32_bf16 v[156:159], v[44:47], v[52:55], v[156:159]
    v_mfma_f32_16x16x32_bf16 v[184:187], v[44:47], v[56:59], v[184:187]
    v_mfma_f32_16x16x32_bf16 v[188:191], v[44:47], v[60:63], v[188:191]
    ds_read_b64_tr_b16 v[44:45], v15 offset:8192
    ds_read_b64_tr_b16 v[46:47], v15 offset:9216
    v_mfma_f32_16x16x32_bf16 v[160:163], v[64:67], v[48:51], v[160:163]
    v_mfma_f32_16x16x32_bf16 v[164:167], v[64:67], v[52:55], v[164:167]
    v_mfma_f32_16x16x32_bf16 v[192:195], v[64:67], v[56:59], v[192:195]
    v_mfma_f32_16x16x32_bf16 v[196:199], v[64:67], v[60:63], v[196:199]
    ds_read_b64_tr_b16 v[64:65], v14 offset:24576
    ds_read_b64_tr_b16 v[66:67], v14 offset:25600
    v_mfma_f32_16x16x32_bf16 v[168:171], v[68:71], v[48:51], v[168:171]
    v_mfma_f32_16x16x32_bf16 v[172:175], v[68:71], v[52:55], v[172:175]
    v_mfma_f32_16x16x32_bf16 v[200:203], v[68:71], v[56:59], v[200:203]
    v_mfma_f32_16x16x32_bf16 v[204:207], v[68:71], v[60:63], v[204:207]
    ds_read_b64_tr_b16 v[68:69], v15 offset:24576
    ds_read_b64_tr_b16 v[70:71], v15 offset:25600
    s_waitcnt lgkmcnt(6)
    v_mfma_f32_16x16x32_bf16 v[80:83], v[40:43], v[24:27], v[80:83]
    ds_read_b128 v[48:51], v77 offset:10240
    v_mfma_f32_16x16x32_bf16 v[84:87], v[40:43], v[28:31], v[84:87]
    ds_read_b128 v[52:55], v77 offset:10496
    v_mfma_f32_16x16x32_bf16 v[112:115], v[40:43], v[32:35], v[112:115]
    ds_read_b128 v[56:59], v77 offset:14336
    v_mfma_f32_16x16x32_bf16 v[116:119], v[40:43], v[36:39], v[116:119]
    ds_read_b128 v[60:63], v77 offset:14592
    s_waitcnt lgkmcnt(8)
    v_mfma_f32_16x16x32_bf16 v[88:91], v[44:47], v[24:27], v[88:91]
    v_mfma_f32_16x16x32_bf16 v[92:95], v[44:47], v[28:31], v[92:95]
    v_mfma_f32_16x16x32_bf16 v[120:123], v[44:47], v[32:35], v[120:123]
    v_mfma_f32_16x16x32_bf16 v[124:127], v[44:47], v[36:39], v[124:127]
    s_waitcnt lgkmcnt(6)
    v_mfma_f32_16x16x32_bf16 v[96:99], v[64:67], v[24:27], v[96:99]
    v_mfma_f32_16x16x32_bf16 v[100:103], v[64:67], v[28:31], v[100:103]
    v_mfma_f32_16x16x32_bf16 v[128:131], v[64:67], v[32:35], v[128:131]
    v_mfma_f32_16x16x32_bf16 v[132:135], v[64:67], v[36:39], v[132:135]
    s_waitcnt lgkmcnt(4)
    v_mfma_f32_16x16x32_bf16 v[104:107], v[68:71], v[24:27], v[104:107]
    v_mfma_f32_16x16x32_bf16 v[108:111], v[68:71], v[28:31], v[108:111]
    v_mfma_f32_16x16x32_bf16 v[136:139], v[68:71], v[32:35], v[136:139]
    v_mfma_f32_16x16x32_bf16 v[140:143], v[68:71], v[36:39], v[140:143]
    s_waitcnt lgkmcnt(0) vmcnt(2)
    s_barrier
    v_mfma_f32_16x16x32_bf16 v[144:147], v[40:43], v[48:51], v[144:147]
    ds_read_b128 v[24:27], v77 offset:32768
    s_mov_b32 m0, s23
    s_nop 0
    buffer_load_dwordx4 v73, s[68:71], s73 offen offset:0 lds
    v_mfma_f32_16x16x32_bf16 v[148:151], v[40:43], v[52:55], v[148:151]
    ds_read_b128 v[28:31], v77 offset:33024
    v_mfma_f32_16x16x32_bf16 v[176:179], v[40:43], v[56:59], v[176:179]
    ds_read_b128 v[32:35], v77 offset:36864
    buffer_load_dwordx4 v74, s[68:71], s73 offen offset:1024 lds
    v_mfma_f32_16x16x32_bf16 v[180:183], v[40:43], v[60:63], v[180:183]
    ds_read_b128 v[36:39], v77 offset:37120
    ds_read_b64_tr_b16 v[40:41], v14 offset:32768
    ds_read_b64_tr_b16 v[42:43], v14 offset:33792
    v_mfma_f32_16x16x32_bf16 v[152:155], v[44:47], v[48:51], v[152:155]
    buffer_load_dwordx4 v75, s[68:71], s73 offen offset:2048 lds
    v_mfma_f32_16x16x32_bf16 v[156:159], v[44:47], v[52:55], v[156:159]
    v_mfma_f32_16x16x32_bf16 v[184:187], v[44:47], v[56:59], v[184:187]
    buffer_load_dwordx4 v76, s[68:71], s73 offen offset:3072 lds
    s_add_u32 s73, s73, s75
    v_mfma_f32_16x16x32_bf16 v[188:191], v[44:47], v[60:63], v[188:191]
    ds_read_b64_tr_b16 v[44:45], v15 offset:32768
    ds_read_b64_tr_b16 v[46:47], v15 offset:33792
    v_mfma_f32_16x16x32_bf16 v[160:163], v[64:67], v[48:51], v[160:163]
    s_add_u32 m0, s23, 16384
    s_nop 0
    buffer_load_dwordx4 v20, s[84:87], s94 offen offset:0 lds
    v_mfma_f32_16x16x32_bf16 v[164:167], v[64:67], v[52:55], v[164:167]
    v_mfma_f32_16x16x32_bf16 v[192:195], v[64:67], v[56:59], v[192:195]
    buffer_load_dwordx4 v21, s[84:87], s94 offen offset:1024 lds
    v_mfma_f32_16x16x32_bf16 v[196:199], v[64:67], v[60:63], v[196:199]
    ds_read_b64_tr_b16 v[64:65], v14 offset:49152
    ds_read_b64_tr_b16 v[66:67], v14 offset:50176
    v_mfma_f32_16x16x32_bf16 v[168:171], v[68:71], v[48:51], v[168:171]
    buffer_load_dwordx4 v22, s[84:87], s94 offen offset:2048 lds
    v_mfma_f32_16x16x32_bf16 v[172:175], v[68:71], v[52:55], v[172:175]
    v_mfma_f32_16x16x32_bf16 v[200:203], v[68:71], v[56:59], v[200:203]
    buffer_load_dwordx4 v23, s[84:87], s94 offen offset:3072 lds
    s_add_u32 s94, s94, s76
    v_mfma_f32_16x16x32_bf16 v[204:207], v[68:71], v[60:63], v[204:207]
    ds_read_b64_tr_b16 v[68:69], v15 offset:49152
    ds_read_b64_tr_b16 v[70:71], v15 offset:50176
    s_waitcnt lgkmcnt(6)
    v_mfma_f32_16x16x32_bf16 v[80:83], v[40:43], v[24:27], v[80:83]
    ds_read_b128 v[48:51], v77 offset:40960
    s_mov_b32 m0, s20
    s_nop 0
    buffer_load_dwordx4 v72, s[64:67], s72 offen offset:0 lds
    v_mfma_f32_16x16x32_bf16 v[84:87], v[40:43], v[28:31], v[84:87]
    ds_read_b128 v[52:55], v77 offset:41216
    buffer_load_dwordx4 v72, s[64:67], s72 offen offset:1024 lds
    v_mfma_f32_16x16x32_bf16 v[112:115], v[40:43], v[32:35], v[112:115]
    ds_read_b128 v[56:59], v77 offset:45056
    v_mfma_f32_16x16x32_bf16 v[116:119], v[40:43], v[36:39], v[116:119]
    ds_read_b128 v[60:63], v77 offset:45312
    buffer_load_dwordx4 v72, s[64:67], s72 offen offset:2048 lds
    s_waitcnt lgkmcnt(8)
    v_mfma_f32_16x16x32_bf16 v[88:91], v[44:47], v[24:27], v[88:91]
    v_mfma_f32_16x16x32_bf16 v[92:95], v[44:47], v[28:31], v[92:95]
    buffer_load_dwordx4 v72, s[64:67], s72 offen offset:3072 lds
    s_add_u32 s72, s72, s74
    v_mfma_f32_16x16x32_bf16 v[120:123], v[44:47], v[32:35], v[120:123]
    v_mfma_f32_16x16x32_bf16 v[124:127], v[44:47], v[36:39], v[124:127]
    s_add_u32 m0, s20, 4096
    s_nop 0
    buffer_load_dwordx4 v72, s[64:67], s25 offen offset:0 lds
    s_waitcnt lgkmcnt(6)
    v_mfma_f32_16x16x32_bf16 v[96:99], v[64:67], v[24:27], v[96:99]
    buffer_load_dwordx4 v72, s[64:67], s25 offen offset:1024 lds
    v_mfma_f32_16x16x32_bf16 v[100:103], v[64:67], v[28:31], v[100:103]
    v_mfma_f32_16x16x32_bf16 v[128:131], v[64:67], v[32:35], v[128:131]
    buffer_load_dwordx4 v72, s[64:67], s25 offen offset:2048 lds
    v_mfma_f32_16x16x32_bf16 v[132:135], v[64:67], v[36:39], v[132:135]
    s_waitcnt lgkmcnt(4)
    v_mfma_f32_16x16x32_bf16 v[104:107], v[68:71], v[24:27], v[104:107]
    buffer_load_dwordx4 v72, s[64:67], s25 offen offset:3072 lds
    s_add_u32 s25, s25, s74
    v_mfma_f32_16x16x32_bf16 v[108:111], v[68:71], v[28:31], v[108:111]
    v_mfma_f32_16x16x32_bf16 v[136:139], v[68:71], v[32:35], v[136:139]
    buffer_store_dwordx4 v[252:255], v1, s[12:15], s100 offen offset:3072 sc1
    s_add_u32 s100, s100, 8192
    v_mfma_f32_16x16x32_bf16 v[140:143], v[68:71], v[36:39], v[140:143]
    s_waitcnt lgkmcnt(3)
    v_mfma_f32_16x16x32_bf16 v[144:147], v[40:43], v[48:51], v[144:147]
    ds_read_b128 v[24:27], v77 offset:34816
    s_waitcnt lgkmcnt(3)
    v_mfma_f32_16x16x32_bf16 v[148:151], v[40:43], v[52:55], v[148:151]
    ds_read_b128 v[28:31], v77 offset:35072
    s_waitcnt lgkmcnt(3)
    v_mfma_f32_16x16x32_bf16 v[176:179], v[40:43], v[56:59], v[176:179]
    ds_read_b128 v[32:35], v77 offset:38912
    s_waitcnt lgkmcnt(3)
    v_mfma_f32_16x16x32_bf16 v[180:183], v[40:43], v[60:63], v[180:183]
    ds_read_b128 v[36:39], v77 offset:39168
    ds_read_b64_tr_b16 v[40:41], v14 offset:40960
    ds_read_b64_tr_b16 v[42:43], v14 offset:41984
    v_mfma_f32_16x16x32_bf16 v[152:155], v[44:47], v[48:51], v[152:155]
    v_mfma_f32_16x16x32_bf16 v[156:159], v[44:47], v[52:55], v[156:159]
    v_mfma_f32_16x16x32_bf16 v[184:187], v[44:47], v[56:59], v[184:187]
    v_mfma_f32_16x16x32_bf16 v[188:191], v[44:47], v[60:63], v[188:191]
    ds_read_b64_tr_b16 v[44:45], v15 offset:40960
    ds_read_b64_tr_b16 v[46:47], v15 offset:41984
    v_mfma_f32_16x16x32_bf16 v[160:163], v[64:67], v[48:51], v[160:163]
    v_mfma_f32_16x16x32_bf16 v[164:167], v[64:67], v[52:55], v[164:167]
    v_mfma_f32_16x16x32_bf16 v[192:195], v[64:67], v[56:59], v[192:195]
    v_mfma_f32_16x16x32_bf16 v[196:199], v[64:67], v[60:63], v[196:199]
    ds_read_b64_tr_b16 v[64:65], v14 offset:57344
    ds_read_b64_tr_b16 v[66:67], v14 offset:58368
    v_mfma_f32_16x16x32_bf16 v[168:171], v[68:71], v[48:51], v[168:171]
    v_mfma_f32_16x16x32_bf16 v[172:175], v[68:71], v[52:55], v[172:175]
    v_mfma_f32_16x16x32_bf16 v[200:203], v[68:71], v[56:59], v[200:203]
    v_mfma_f32_16x16x32_bf16 v[204:207], v[68:71], v[60:63], v[204:207]
    ds_read_b64_tr_b16 v[68:69], v15 offset:57344
    ds_read_b64_tr_b16 v[70:71], v15 offset:58368
    s_waitcnt lgkmcnt(6)
    v_mfma_f32_16x16x32_bf16 v[80:83], v[40:43], v[24:27], v[80:83]
    ds_read_b128 v[48:51], v77 offset:43008
    s_cmp_lg_u32 s19, 0
    s_cbranch_scc1 L_nops_6
    buffer_load_dwordx4 v[208:211], v1, s[88:91], 0 offen offset:2048 sc1
L_nops_6:
    v_mfma_f32_16x16x32_bf16 v[84:87], v[40:43], v[28:31], v[84:87]
    ds_read_b128 v[52:55], v77 offset:43264
    v_mfma_f32_16x16x32_bf16 v[112:115], v[40:43], v[32:35], v[112:115]
    ds_read_b128 v[56:59], v77 offset:47104
    v_mfma_f32_16x16x32_bf16 v[116:119], v[40:43], v[36:39], v[116:119]
    ds_read_b128 v[60:63], v77 offset:47360
    s_waitcnt lgkmcnt(8)
    v_mfma_f32_16x16x32_bf16 v[88:91], v[44:47], v[24:27], v[88:91]
    v_mfma_f32_16x16x32_bf16 v[92:95], v[44:47], v[28:31], v[92:95]
    v_mfma_f32_16x16x32_bf16 v[120:123], v[44:47], v[32:35], v[120:123]
    v_mfma_f32_16x16x32_bf16 v[124:127], v[44:47], v[36:39], v[124:127]
    s_waitcnt lgkmcnt(6)
    v_mfma_f32_16x16x32_bf16 v[96:99], v[64:67], v[24:27], v[96:99]
    v_mfma_f32_16x16x32_bf16 v[100:103], v[64:67], v[28:31], v[100:103]
    v_mfma_f32_16x16x32_bf16 v[128:131], v[64:67], v[32:35], v[128:131]
    v_mfma_f32_16x16x32_bf16 v[132:135], v[64:67], v[36:39], v[132:135]
    s_waitcnt lgkmcnt(4)
    v_mfma_f32_16x16x32_bf16 v[104:107], v[68:71], v[24:27], v[104:107]
    v_mfma_f32_16x16x32_bf16 v[108:111], v[68:71], v[28:31], v[108:111]
    v_mfma_f32_16x16x32_bf16 v[136:139], v[68:71], v[32:35], v[136:139]
    v_mfma_f32_16x16x32_bf16 v[140:143], v[68:71], v[36:39], v[140:143]
    s_waitcnt lgkmcnt(0) vmcnt(1)
    s_barrier
    v_mfma_f32_16x16x32_bf16 v[144:147], v[40:43], v[48:51], v[144:147]
    ds_read_b128 v[24:27], v77 offset:0
    s_mov_b32 m0, s24
    s_nop 0
    buffer_load_dwordx4 v73, s[68:71], s73 offen offset:0 lds
    v_mfma_f32_16x16x32_bf16 v[148:151], v[40:43], v[52:55], v[148:151]
    ds_read_b128 v[28:31], v77 offset:256
    v_mfma_f32_16x16x32_bf16 v[176:179], v[40:43], v[56:59], v[176:179]
    ds_read_b128 v[32:35], v77 offset:4096
    buffer_load_dwordx4 v74, s[68:71], s73 offen offset:1024 lds
    v_mfma_f32_16x16x32_bf16 v[180:183], v[40:43], v[60:63], v[180:183]
    ds_read_b128 v[36:39], v77 offset:4352
    ds_read_b64_tr_b16 v[40:41], v14 offset:0
    ds_read_b64_tr_b16 v[42:43], v14 offset:1024
    v_mfma_f32_16x16x32_bf16 v[152:155], v[44:47], v[48:51], v[152:155]
    buffer_load_dwordx4 v75, s[68:71], s73 offen offset:2048 lds
    v_mfma_f32_16x16x32_bf16 v[156:159], v[44:47], v[52:55], v[156:159]
    v_mfma_f32_16x16x32_bf16 v[184:187], v[44:47], v[56:59], v[184:187]
    buffer_load_dwordx4 v76, s[68:71], s73 offen offset:3072 lds
    s_add_u32 s73, s73, s75
    v_mfma_f32_16x16x32_bf16 v[188:191], v[44:47], v[60:63], v[188:191]
    ds_read_b64_tr_b16 v[44:45], v15 offset:0
    ds_read_b64_tr_b16 v[46:47], v15 offset:1024
    v_mfma_f32_16x16x32_bf16 v[160:163], v[64:67], v[48:51], v[160:163]
    s_add_u32 m0, s24, 16384
    s_nop 0
    buffer_load_dwordx4 v20, s[84:87], s94 offen offset:0 lds
    v_mfma_f32_16x16x32_bf16 v[164:167], v[64:67], v[52:55], v[164:167]
    v_mfma_f32_16x16x32_bf16 v[192:195], v[64:67], v[56:59], v[192:195]
    buffer_load_dwordx4 v21, s[84:87], s94 offen offset:1024 lds
    v_mfma_f32_16x16x32_bf16 v[196:199], v[64:67], v[60:63], v[196:199]
    ds_read_b64_tr_b16 v[64:65], v14 offset:16384
    ds_read_b64_tr_b16 v[66:67], v14 offset:17408
    v_mfma_f32_16x16x32_bf16 v[168:171], v[68:71], v[48:51], v[168:171]
    buffer_load_dwordx4 v22, s[84:87], s94 offen offset:2048 lds
    v_mfma_f32_16x16x32_bf16 v[172:175], v[68:71], v[52:55], v[172:175]
    v_mfma_f32_16x16x32_bf16 v[200:203], v[68:71], v[56:59], v[200:203]
    buffer_load_dwordx4 v23, s[84:87], s94 offen offset:3072 lds
    s_add_u32 s94, s94, s76
    v_mfma_f32_16x16x32_bf16 v[204:207], v[68:71], v[60:63], v[204:207]
    ds_read_b64_tr_b16 v[68:69], v15 offset:16384
    ds_read_b64_tr_b16 v[70:71], v15 offset:17408
    s_waitcnt lgkmcnt(6)
    v_mfma_f32_16x16x32_bf16 v[80:83], v[40:43], v[24:27], v[80:83]
    ds_read_b128 v[48:51], v77 offset:8192
    s_mov_b32 m0, s21
    s_nop 0
    buffer_load_dwordx4 v72, s[64:67], s72 offen offset:0 lds
    v_mfma_f32_16x16x32_bf16 v[84:87], v[40:43], v[28:31], v[84:87]
    ds_read_b128 v[52:55], v77 offset:8448
    buffer_load_dwordx4 v72, s[64:67], s72 offen offset:1024 lds
    v_mfma_f32_16x16x32_bf16 v[112:115], v[40:43], v[32:35], v[112:115]
    ds_read_b128 v[56:59], v77 offset:12288
    v_mfma_f32_16x16x32_bf16 v[116:119], v[40:43], v[36:39], v[116:119]
    ds_read_b128 v[60:63], v77 offset:12544
    buffer_load_dwordx4 v72, s[64:67], s72 offen offset:2048 lds
    s_waitcnt lgkmcnt(8)
    v_mfma_f32_16x16x32_bf16 v[88:91], v[44:47], v[24:27], v[88:91]
    v_mfma_f32_16x16x32_bf16 v[92:95], v[44:47], v[28:31], v[92:95]
    buffer_load_dwordx4 v72, s[64:67], s72 offen offset:3072 lds
    s_add_u32 s72, s72, s74
    v_mfma_f32_16x16x32_bf16 v[120:123], v[44:47], v[32:35], v[120:123]
    v_mfma_f32_16x16x32_bf16 v[124:127], v[44:47], v[36:39], v[124:127]
    s_add_u32 m0, s21, 4096
    s_nop 0
    buffer_load_dwordx4 v72, s[64:67], s25 offen offset:0 lds
    s_waitcnt lgkmcnt(6)
    v_mfma_f32_16x16x32_bf16 v[96:99], v[64:67], v[24:27], v[96:99]
    buffer_load_dwordx4 v72, s[64:67], s25 offen offset:1024 lds
    v_mfma_f32_16x16x32_bf16 v[100:103], v[64:67], v[28:31], v[100:103]
    v_mfma_f32_16x16x32_bf16 v[128:131], v[64:67], v[32:35], v[128:131]
    buffer_load_dwordx4 v72, s[64:67], s25 offen offset:2048 lds
    v_mfma_f32_16x16x32_bf16 v[132:135], v[64:67], v[36:39], v[132:135]
    s_waitcnt lgkmcnt(4)
    v_mfma_f32_16x16x32_bf16 v[104:107], v[68:71], v[24:27], v[104:107]
    buffer_load_dwordx4 v72, s[64:67], s25 offen offset:3072 lds
    s_add_u32 s25, s25, s74
    v_mfma_f32_16x16x32_bf16 v[108:111], v[68:71], v[28:31], v[108:111]
    v_mfma_f32_16x16x32_bf16 v[136:139], v[68:71], v[32:35], v[136:139]
    buffer_store_dwordx4 v[2:5], v1, s[12:15], s100 offen offset:0 sc1
    v_mfma_f32_16x16x32_bf16 v[140:143], v[68:71], v[36:39], v[140:143]
    s_waitcnt lgkmcnt(3)
    v_mfma_f32_16x16x32_bf16 v[144:147], v[40:43], v[48:51], v[144:147]
    ds_read_b128 v[24:27], v77 offset:2048
    buffer_store_dwordx4 v[6:9], v1, s[12:15], s100 offen offset:1024 sc1
    s_waitcnt lgkmcnt(3)
    v_mfma_f32_16x16x32_bf16 v[148:151], v[40:43], v[52:55], v[148:151]
    ds_read_b128 v[28:31], v77 offset:2304
    s_waitcnt lgkmcnt(3)
    v_mfma_f32_16x16x32_bf16 v[176:179], v[40:43], v[56:59], v[176:179]
    ds_read_b128 v[32:35], v77 offset:6144
    s_waitcnt lgkmcnt(3)
    v_mfma_f32_16x16x32_bf16 v[180:183], v[40:43], v[60:63], v[180:183]
    ds_read_b128 v[36:39], v77 offset:6400
    ds_read_b64_tr_b16 v[40:41], v14 offset:8192
    ds_read_b64_tr_b16 v[42:43], v14 offset:9216
    v_mfma_f32_16x16x32_bf16 v[152:155], v[44:47], v[48:51], v[152:155]
    v_mfma_f32_16x16x32_bf16 v[156:159], v[44:47], v[52:55], v[156:159]
    v_mfma_f32_16x16x32_bf16 v[184:187], v[44:47], v[56:59], v[184:187]
    v_mfma_f32_16x16x32_bf16 v[188:191], v[44:47], v[60:63], v[188:191]
    ds_read_b64_tr_b16 v[44:45], v15 offset:8192
    ds_read_b64_tr_b16 v[46:47], v15 offset:9216
    v_mfma_f32_16x16x32_bf16 v[160:163], v[64:67], v[48:51], v[160:163]
    v_mfma_f32_16x16x32_bf16 v[164:167], v[64:67], v[52:55], v[164:167]
    v_mfma_f32_16x16x32_bf16 v[192:195], v[64:67], v[56:59], v[192:195]
    v_mfma_f32_16x16x32_bf16 v[196:199], v[64:67], v[60:63], v[196:199]
    ds_read_b64_tr_b16 v[64:65], v14 offset:24576
    ds_read_b64_tr_b16 v[66:67], v14 offset:25600
    v_mfma_f32_16x16x32_bf16 v[168:171], v[68:71], v[48:51], v[168:171]
    v_mfma_f32_16x16x32_bf16 v[172:175], v[68:71], v[52:55], v[172:175]
    v_mfma_f32_16x16x32_bf16 v[200:203], v[68:71], v[56:59], v[200:203]
    v_mfma_f32_16x16x32_bf16 v[204:207], v[68:71], v[60:63], v[204:207]
    ds_read_b64_tr_b16 v[68:69], v15 offset:24576
    ds_read_b64_tr_b16 v[70:71], v15 offset:25600
    s_waitcnt lgkmcnt(6)
    v_mfma_f32_16x16x32_bf16 v[80:83], v[40:43], v[24:27], v[80:83]
    ds_read_b128 v[48:51], v77 offset:10240
    v_mfma_f32_16x16x32_bf16 v[84:87], v[40:43], v[28:31], v[84:87]
    ds_read_b128 v[52:55], v77 offset:10496
    v_mfma_f32_16x16x32_bf16 v[112:115], v[40:43], v[32:35], v[112:115]
    ds_read_b128 v[56:59], v77 offset:14336
    v_mfma_f32_16x16x32_bf16 v[116:119], v[40:43], v[36:39], v[116:119]
    ds_read_b128 v[60:63], v77 offset:14592
    s_waitcnt lgkmcnt(8)
    v_mfma_f32_16x16x32_bf16 v[88:91], v[44:47], v[24:27], v[88:91]
    v_mfma_f32_16x16x32_bf16 v[92:95], v[44:47], v[28:31], v[92:95]
    v_mfma_f32_16x16x32_bf16 v[120:123], v[44:47], v[32:35], v[120:123]
    v_mfma_f32_16x16x32_bf16 v[124:127], v[44:47], v[36:39], v[124:127]
    s_waitcnt lgkmcnt(6)
    v_mfma_f32_16x16x32_bf16 v[96:99], v[64:67], v[24:27], v[96:99]
    v_mfma_f32_16x16x32_bf16 v[100:103], v[64:67], v[28:31], v[100:103]
    v_mfma_f32_16x16x32_bf16 v[128:131], v[64:67], v[32:35], v[128:131]
    v_mfma_f32_16x16x32_bf16 v[132:135], v[64:67], v[36:39], v[132:135]
    s_waitcnt lgkmcnt(4)
    v_mfma_f32_16x16x32_bf16 v[104:107], v[68:71], v[24:27], v[104:107]
    v_mfma_f32_16x16x32_bf16 v[108:111], v[68:71], v[28:31], v[108:111]
    v_mfma_f32_16x16x32_bf16 v[136:139], v[68:71], v[32:35], v[136:139]
    v_mfma_f32_16x16x32_bf16 v[140:143], v[68:71], v[36:39], v[140:143]
    s_waitcnt lgkmcnt(0) vmcnt(2)
    s_barrier
    v_mfma_f32_16x16x32_bf16 v[144:147], v[40:43], v[48:51], v[144:147]
    ds_read_b128 v[24:27], v77 offset:32768
    s_mov_b32 m0, s23
    s_nop 0
    buffer_load_dwordx4 v73, s[68:71], s73 offen offset:0 lds
    v_mfma_f32_16x16x32_bf16 v[148:151], v[40:43], v[52:55], v[148:151]
    ds_read_b128 v[28:31], v77 offset:33024
    v_mfma_f32_16x16x32_bf16 v[176:179], v[40:43], v[56:59], v[176:179]
    ds_read_b128 v[32:35], v77 offset:36864
    buffer_load_dwordx4 v74, s[68:71], s73 offen offset:1024 lds
    v_mfma_f32_16x16x32_bf16 v[180:183], v[40:43], v[60:63], v[180:183]
    ds_read_b128 v[36:39], v77 offset:37120
    ds_read_b64_tr_b16 v[40:41], v14 offset:32768
    ds_read_b64_tr_b16 v[42:43], v14 offset:33792
    v_mfma_f32_16x16x32_bf16 v[152:155], v[44:47], v[48:51], v[152:155]
    buffer_load_dwordx4 v75, s[68:71], s73 offen offset:2048 lds
    v_mfma_f32_16x16x32_bf16 v[156:159], v[44:47], v[52:55], v[156:159]
    v_mfma_f32_16x16x32_bf16 v[184:187], v[44:47], v[56:59], v[184:187]
    buffer_load_dwordx4 v76, s[68:71], s73 offen offset:3072 lds
    s_add_u32 s73, s73, s75
    v_mfma_f32_16x16x32_bf16 v[188:191], v[44:47], v[60:63], v[188:191]
    ds_read_b64_tr_b16 v[44:45], v15 offset:32768
    ds_read_b64_tr_b16 v[46:47], v15 offset:33792
    v_mfma_f32_16x16x32_bf16 v[160:163], v[64:67], v[48:51], v[160:163]
    s_add_u32 m0, s23, 16384
    s_nop 0
    buffer_load_dwordx4 v20, s[84:87], s94 offen offset:0 lds
    v_mfma_f32_16x16x32_bf16 v[164:167], v[64:67], v[52:55], v[164:167]
    v_mfma_f32_16x16x32_bf16 v[192:195], v[64:67], v[56:59], v[192:195]
    buffer_load_dwordx4 v21, s[84:87], s94 offen offset:1024 lds
    v_mfma_f32_16x16x32_bf16 v[196:199], v[64:67], v[60:63], v[196:199]
    ds_read_b64_tr_b16 v[64:65], v14 offset:49152
    ds_read_b64_tr_b16 v[66:67], v14 offset:50176
    v_mfma_f32_16x16x32_bf16 v[168:171], v[68:71], v[48:51], v[168:171]
    buffer_load_dwordx4 v22, s[84:87], s94 offen offset:2048 lds
    v_mfma_f32_16x16x32_bf16 v[172:175], v[68:71], v[52:55], v[172:175]
    v_mfma_f32_16x16x32_bf16 v[200:203], v[68:71], v[56:59], v[200:203]
    buffer_load_dwordx4 v23, s[84:87], s94 offen offset:3072 lds
    s_add_u32 s94, s94, s76
    v_mfma_f32_16x16x32_bf16 v[204:207], v[68:71], v[60:63], v[204:207]
    ds_read_b64_tr_b16 v[68:69], v15 offset:49152
    ds_read_b64_tr_b16 v[70:71], v15 offset:50176
    s_waitcnt lgkmcnt(6)
    v_mfma_f32_16x16x32_bf16 v[80:83], v[40:43], v[24:27], v[80:83]
    ds_read_b128 v[48:51], v77 offset:40960
    s_mov_b32 m0, s20
    s_nop 0
    buffer_load_dwordx4 v72, s[64:67], s72 offen offset:0 lds
    v_mfma_f32_16x16x32_bf16 v[84:87], v[40:43], v[28:31], v[84:87]
    ds_read_b128 v[52:55], v77 offset:41216
    buffer_load_dwordx4 v72, s[64:67], s72 offen offset:1024 lds
    v_mfma_f32_16x16x32_bf16 v[112:115], v[40:43], v[32:35], v[112:115]
    ds_read_b128 v[56:59], v77 offset:45056
    v_mfma_f32_16x16x32_bf16 v[116:119], v[40:43], v[36:39], v[116:119]
    ds_read_b128 v[60:63], v77 offset:45312
    buffer_load_dwordx4 v72, s[64:67], s72 offen offset:2048 lds
    s_waitcnt lgkmcnt(8)
    v_mfma_f32_16x16x32_bf16 v[88:91], v[44:47], v[24:27], v[88:91]
    v_mfma_f32_16x16x32_bf16 v[92:95], v[44:47], v[28:31], v[92:95]
    buffer_load_dwordx4 v72, s[64:67], s72 offen offset:3072 lds
    s_add_u32 s72, s72, s74
    v_mfma_f32_16x16x32_bf16 v[120:123], v[44:47], v[32:35], v[120:123]
    v_mfma_f32_16x16x32_bf16 v[124:127], v[44:47], v[36:39], v[124:127]
    s_add_u32 m0, s20, 4096
    s_nop 0
    buffer_load_dwordx4 v72, s[64:67], s25 offen offset:0 lds
    s_waitcnt lgkmcnt(6)
    v_mfma_f32_16x16x32_bf16 v[96:99], v[64:67], v[24:27], v[96:99]
    buffer_load_dwordx4 v72, s[64:67], s25 offen offset:1024 lds
    v_mfma_f32_16x16x32_bf16 v[100:103], v[64:67], v[28:31], v[100:103]
    v_mfma_f32_16x16x32_bf16 v[128:131], v[64:67], v[32:35], v[128:131]
    buffer_load_dwordx4 v72, s[64:67], s25 offen offset:2048 lds
    v_mfma_f32_16x16x32_bf16 v[132:135], v[64:67], v[36:39], v[132:135]
    s_waitcnt lgkmcnt(4)
    v_mfma_f32_16x16x32_bf16 v[104:107], v[68:71], v[24:27], v[104:107]
    buffer_load_dwordx4 v72, s[64:67], s25 offen offset:3072 lds
    s_add_u32 s25, s25, s74
    v_mfma_f32_16x16x32_bf16 v[108:111], v[68:71], v[28:31], v[108:111]
    v_mfma_f32_16x16x32_bf16 v[136:139], v[68:71], v[32:35], v[136:139]
    buffer_store_dwordx4 v[10:13], v1, s[12:15], s100 offen offset:2048 sc1
    v_mfma_f32_16x16x32_bf16 v[140:143], v[68:71], v[36:39], v[140:143]
    s_waitcnt lgkmcnt(3)
    v_mfma_f32_16x16x32_bf16 v[144:147], v[40:43], v[48:51], v[144:147]
    ds_read_b128 v[24:27], v77 offset:34816
    buffer_store_dwordx4 v[16:19], v1, s[12:15], s100 offen offset:3072 sc1
    s_add_u32 s100, s100, 8192
    s_waitcnt lgkmcnt(3)
    v_mfma_f32_16x16x32_bf16 v[148:151], v[40:43], v[52:55], v[148:151]
    ds_read_b128 v[28:31], v77 offset:35072
    s_waitcnt lgkmcnt(3)
    v_mfma_f32_16x16x32_bf16 v[176:179], v[40:43], v[56:59], v[176:179]
    ds_read_b128 v[32:35], v77 offset:38912
    s_waitcnt lgkmcnt(3)
    v_mfma_f32_16x16x32_bf16 v[180:183], v[40:43], v[60:63], v[180:183]
    ds_read_b128 v[36:39], v77 offset:39168
    ds_read_b64_tr_b16 v[40:41], v14 offset:40960
    ds_read_b64_tr_b16 v[42:43], v14 offset:41984
    v_mfma_f32_16x16x32_bf16 v[152:155], v[44:47], v[48:51], v[152:155]
    v_mfma_f32_16x16x32_bf16 v[156:159], v[44:47], v[52:55], v[156:159]
    v_mfma_f32_16x16x32_bf16 v[184:187], v[44:47], v[56:59], v[184:187]
    v_mfma_f32_16x16x32_bf16 v[188:191], v[44:47], v[60:63], v[188:191]
    ds_read_b64_tr_b16 v[44:45], v15 offset:40960
    ds_read_b64_tr_b16 v[46:47], v15 offset:41984
    v_mfma_f32_16x16x32_bf16 v[160:163], v[64:67], v[48:51], v[160:163]
    v_mfma_f32_16x16x32_bf16 v[164:167], v[64:67], v[52:55], v[164:167]
    v_mfma_f32_16x16x32_bf16 v[192:195], v[64:67], v[56:59], v[192:195]
    v_mfma_f32_16x16x32_bf16 v[196:199], v[64:67], v[60:63], v[196:199]
    ds_read_b64_tr_b16 v[64:65], v14 offset:57344
    ds_read_b64_tr_b16 v[66:67], v14 offset:58368
    v_mfma_f32_16x16x32_bf16 v[168:171], v[68:71], v[48:51], v[168:171]
    v_mfma_f32_16x16x32_bf16 v[172:175], v[68:71], v[52:55], v[172:175]
    v_mfma_f32_16x16x32_bf16 v[200:203], v[68:71], v[56:59], v[200:203]
    v_mfma_f32_16x16x32_bf16 v[204:207], v[68:71], v[60:63], v[204:207]
    ds_read_b64_tr_b16 v[68:69], v15 offset:57344
    ds_read_b64_tr_b16 v[70:71], v15 offset:58368
    s_waitcnt lgkmcnt(6)
    v_mfma_f32_16x16x32_bf16 v[80:83], v[40:43], v[24:27], v[80:83]
    ds_read_b128 v[48:51], v77 offset:43008
    s_cmp_lg_u32 s19, 0
    s_cbranch_scc1 L_nops2_7
    v_xor_b32 v208, s95, v208
    v_xor_b32 v209, s95, v209
    v_xor_b32 v210, s95, v210
    v_xor_b32 v211, s95, v211
    v_or3_b32 v212, v208, v209, v210
    v_or_b32 v212, v212, v211
    v_cmp_ne_u32 vcc, 0, v212
    s_ff1_i32_b64 s79, vcc
    v_cmp_ne_u32 vcc, 0, v210
    s_nop 1
    v_cndmask_b32 v212, 3, 2, vcc
    v_cmp_ne_u32 vcc, 0, v209
    s_nop 1
    v_cndmask_b32 v212, v212, 1, vcc
    v_cmp_ne_u32 vcc, 0, v208
    s_nop 1
    v_cndmask_b32 v212, v212, 0, vcc
    s_nop 1
    v_readlane_b32 s78, v212, s79
    s_nop 3
    s_lshl2_add_u32 s78, s79, s78
    s_cmp_lt_i32 s79, 0
    s_cselect_b32 s78, -1, s78
    v_mov_b32 v208, s78
    v_mov_b32 v209, 147460
    ds_write_b32 v209, v208
L_nops2_7:
    v_mfma_f32_16x16x32_bf16 v[84:87], v[40:43], v[28:31], v[84:87]
    ds_read_b128 v[52:55], v77 offset:43264
    v_mfma_f32_16x16x32_bf16 v[112:115], v[40:43], v[32:35], v[112:115]
    ds_read_b128 v[56:59], v77 offset:47104
    v_mfma_f32_16x16x32_bf16 v[116:119], v[40:43], v[36:39], v[116:119]
    ds_read_b128 v[60:63], v77 offset:47360
    s_waitcnt lgkmcnt(8)
    v_mfma_f32_16x16x32_bf16 v[88:91], v[44:47], v[24:27], v[88:91]
    v_mfma_f32_16x16x32_bf16 v[92:95], v[44:47], v[28:31], v[92:95]
    v_mfma_f32_16x16x32_bf16 v[120:123], v[44:47], v[32:35], v[120:123]
    v_mfma_f32_16x16x32_bf16 v[124:127], v[44:47], v[36:39], v[124:127]
    s_waitcnt lgkmcnt(6)
    v_mfma_f32_16x16x32_bf16 v[96:99], v[64:67], v[24:27], v[96:99]
    v_mfma_f32_16x16x32_bf16 v[100:103], v[64:67], v[28:31], v[100:103]
    v_mfma_f32_16x16x32_bf16 v[128:131], v[64:67], v[32:35], v[128:131]
    v_mfma_f32_16x16x32_bf16 v[132:135], v[64:67], v[36:39], v[132:135]
    s_waitcnt lgkmcnt(4)
    v_mfma_f32_16x16x32_bf16 v[104:107], v[68:71], v[24:27], v[104:107]
    v_mfma_f32_16x16x32_bf16 v[108:111], v[68:71], v[28:31], v[108:111]
    v_mfma_f32_16x16x32_bf16 v[136:139], v[68:71], v[32:35], v[136:139]
    v_mfma_f32_16x16x32_bf16 v[140:143], v[68:71], v[36:39], v[140:143]
    s_waitcnt lgkmcnt(0) vmcnt(2)
    s_barrier
    v_mfma_f32_16x16x32_bf16 v[144:147], v[40:43], v[48:51], v[144:147]
    ds_read_b128 v[24:27], v77 offset:0
    s_mov_b32 m0, s24
    s_nop 0
    buffer_load_dwordx4 v73, s[68:71], s73 offen offset:0 lds
    v_mfma_f32_16x16x32_bf16 v[148:151], v[40:43], v[52:55], v[148:151]
    ds_read_b128 v[28:31], v77 offset:256
    v_mfma_f32_16x16x32_bf16 v[176:179], v[40:43], v[56:59], v[176:179]
    ds_read_b128 v[32:35], v77 offset:4096
    buffer_load_dwordx4 v74, s[68:71], s73 offen offset:1024 lds
    v_mfma_f32_16x16x32_bf16 v[180:183], v[40:43], v[60:63], v[180:183]
    ds_read_b128 v[36:39], v77 offset:4352
    ds_read_b64_tr_b16 v[40:41], v14 offset:0
    ds_read_b64_tr_b16 v[42:43], v14 offset:1024
    v_mfma_f32_16x16x32_bf16 v[152:155], v[44:47], v[48:51], v[152:155]
    buffer_load_dwordx4 v75, s[68:71], s73 offen offset:2048 lds
    v_mfma_f32_16x16x32_bf16 v[156:159], v[44:47], v[52:55], v[156:159]
    v_mfma_f32_16x16x32_bf16 v[184:187], v[44:47], v[56:59], v[184:187]
    buffer_load_dwordx4 v76, s[68:71], s73 offen offset:3072 lds
    s_add_u32 s73, s73, s75
    v_mfma_f32_16x16x32_bf16 v[188:191], v[44:47], v[60:63], v[188:191]
    ds_read_b64_tr_b16 v[44:45], v15 offset:0
    ds_read_b64_tr_b16 v[46:47], v15 offset:1024
    v_mfma_f32_16x16x32_bf16 v[160:163], v[64:67], v[48:51], v[160:163]
    s_add_u32 m0, s24, 16384
    s_nop 0
    buffer_load_dwordx4 v20, s[84:87], s94 offen offset:0 lds
    v_mfma_f32_16x16x32_bf16 v[164:167], v[64:67], v[52:55], v[164:167]
    v_mfma_f32_16x16x32_bf16 v[192:195], v[64:67], v[56:59], v[192:195]
    buffer_load_dwordx4 v21, s[84:87], s94 offen offset:1024 lds
    v_mfma_f32_16x16x32_bf16 v[196:199], v[64:67], v[60:63], v[196:199]
    ds_read_b64_tr_b16 v[64:65], v14 offset:16384
    ds_read_b64_tr_b16 v[66:67], v14 offset:17408
    v_mfma_f32_16x16x32_bf16 v[168:171], v[68:71], v[48:51], v[168:171]
    buffer_load_dwordx4 v22, s[84:87], s94 offen offset:2048 lds
    v_mfma_f32_16x16x32_bf16 v[172:175], v[68:71], v[52:55], v[172:175]
    v_mfma_f32_16x16x32_bf16 v[200:203], v[68:71], v[56:59], v[200:203]
    buffer_load_dwordx4 v23, s[84:87], s94 offen offset:3072 lds
    s_add_u32 s94, s94, s76
    v_mfma_f32_16x16x32_bf16 v[204:207], v[68:71], v[60:63], v[204:207]
    ds_read_b64_tr_b16 v[68:69], v15 offset:16384
    ds_read_b64_tr_b16 v[70:71], v15 offset:17408
    s_waitcnt lgkmcnt(6)
    v_mfma_f32_16x16x32_bf16 v[80:83], v[40:43], v[24:27], v[80:83]
    ds_read_b128 v[48:51], v77 offset:8192
    s_mov_b32 m0, s21
    s_nop 0
    buffer_load_dwordx4 v72, s[64:67], s72 offen offset:0 lds
    v_mfma_f32_16x16x32_bf16 v[84:87], v[40:43], v[28:31], v[84:87]
    ds_read_b128 v[52:55], v77 offset:8448
    v_mfma_f32_16x16x32_bf16 v[112:115], v[40:43], v[32:35], v[112:115]
    ds_read_b128 v[56:59], v77 offset:12288
    buffer_load_dwordx4 v72, s[64:67], s72 offen offset:1024 lds
    v_mfma_f32_16x16x32_bf16 v[116:119], v[40:43], v[36:39], v[116:119]
    ds_read_b128 v[60:63], v77 offset:12544
    s_waitcnt lgkmcnt(8)
    v_mfma_f32_16x16x32_bf16 v[88:91], v[44:47], v[24:27], v[88:91]
    buffer_load_dwordx4 v72, s[64:67], s72 offen offset:2048 lds
    v_mfma_f32_16x16x32_bf16 v[92:95], v[44:47], v[28:31], v[92:95]
    v_mfma_f32_16x16x32_bf16 v[120:123], v[44:47], v[32:35], v[120:123]
    buffer_load_dwordx4 v72, s[64:67], s72 offen offset:3072 lds
    s_add_u32 s72, s72, s74
    v_mfma_f32_16x16x32_bf16 v[124:127], v[44:47], v[36:39], v[124:127]
    s_waitcnt lgkmcnt(6)
    v_mfma_f32_16x16x32_bf16 v[96:99], v[64:67], v[24:27], v[96:99]
    s_add_u32 m0, s21, 4096
    s_nop 0
    buffer_load_dwordx4 v72, s[64:67], s25 offen offset:0 lds
    v_mfma_f32_16x16x32_bf16 v[100:103], v[64:67], v[28:31], v[100:103]
    v_mfma_f32_16x16x32_bf16 v[128:131], v[64:67], v[32:35], v[128:131]
    buffer_load_dwordx4 v72, s[64:67], s25 offen offset:1024 lds
    v_mfma_f32_16x16x32_bf16 v[132:135], v[64:67], v[36:39], v[132:135]
    s_waitcnt lgkmcnt(4)
    v_mfma_f32_16x16x32_bf16 v[104:107], v[68:71], v[24:27], v[104:107]
    buffer_load_dwordx4 v72, s[64:67], s25 offen offset:2048 lds
    v_mfma_f32_16x16x32_bf16 v[108:111], v[68:71], v[28:31], v[108:111]
    v_mfma_f32_16x16x32_bf16 v[136:139], v[68:71], v[32:35], v[136:139]
    buffer_load_dwordx4 v72, s[64:67], s25 offen offset:3072 lds
    s_add_u32 s25, s25, s74
    v_mfma_f32_16x16x32_bf16 v[140:143], v[68:71], v[36:39], v[140:143]
    s_waitcnt lgkmcnt(3)
    v_mfma_f32_16x16x32_bf16 v[144:147], v[40:43], v[48:51], v[144:147]
    ds_read_b128 v[24:27], v77 offset:2048
    s_waitcnt lgkmcnt(3)
    v_mfma_f32_16x16x32_bf16 v[148:151], v[40:43], v[52:55], v[148:151]
    ds_read_b128 v[28:31], v77 offset:2304
    s_waitcnt lgkmcnt(3)
    v_mfma_f32_16x16x32_bf16 v[176:179], v[40:43], v[56:59], v[176:179]
    ds_read_b128 v[32:35], v77 offset:6144
    s_waitcnt lgkmcnt(3)
    v_mfma_f32_16x16x32_bf16 v[180:183], v[40:43], v[60:63], v[180:183]
    ds_read_b128 v[36:39], v77 offset:6400
    ds_read_b64_tr_b16 v[40:41], v14 offset:8192
    ds_read_b64_tr_b16 v[42:43], v14 offset:9216
    v_mfma_f32_16x16x32_bf16 v[152:155], v[44:47], v[48:51], v[152:155]
    v_mfma_f32_16x16x32_bf16 v[156:159], v[44:47], v[52:55], v[156:159]
    v_mfma_f32_16x16x32_bf16 v[184:187], v[44:47], v[56:59], v[184:187]
    v_mfma_f32_16x16x32_bf16 v[188:191], v[44:47], v[60:63], v[188:191]
    ds_read_b64_tr_b16 v[44:45], v15 offset:8192
    ds_read_b64_tr_b16 v[46:47], v15 offset:9216
    v_mfma_f32_16x16x32_bf16 v[160:163], v[64:67], v[48:51], v[160:163]
    v_mfma_f32_16x16x32_bf16 v[164:167], v[64:67], v[52:55], v[164:167]
    v_mfma_f32_16x16x32_bf16 v[192:195], v[64:67], v[56:59], v[192:195]
    v_mfma_f32_16x16x32_bf16 v[196:199], v[64:67], v[60:63], v[196:199]
    ds_read_b64_tr_b16 v[64:65], v14 offset:24576
    ds_read_b64_tr_b16 v[66:67], v14 offset:25600
    v_mfma_f32_16x16x32_bf16 v[168:171], v[68:71], v[48:51], v[168:171]
    v_mfma_f32_16x16x32_bf16 v[172:175], v[68:71], v[52:55], v[172:175]
    v_mfma_f32_16x16x32_bf16 v[200:203], v[68:71], v[56:59], v[200:203]
    v_mfma_f32_16x16x32_bf16 v[204:207], v[68:71], v[60:63], v[204:207]
    ds_read_b64_tr_b16 v[68:69], v15 offset:24576
    ds_read_b64_tr_b16 v[70:71], v15 offset:25600
    s_waitcnt lgkmcnt(6)
    v_mfma_f32_16x16x32_bf16 v[80:83], v[40:43], v[24:27], v[80:83]
    ds_read_b128 v[48:51], v77 offset:10240
    v_mfma_f32_16x16x32_bf16 v[84:87], v[40:43], v[28:31], v[84:87]
    ds_read_b128 v[52:55], v77 offset:10496
    v_mfma_f32_16x16x32_bf16 v[112:115], v[40:43], v[32:35], v[112:115]
    ds_read_b128 v[56:59], v77 offset:14336
    v_mfma_f32_16x16x32_bf16 v[116:119], v[40:43], v[36:39], v[116:119]
    ds_read_b128 v[60:63], v77 offset:14592
    s_waitcnt lgkmcnt(8)
    v_mfma_f32_16x16x32_bf16 v[88:91], v[44:47], v[24:27], v[88:91]
    v_mfma_f32_16x16x32_bf16 v[92:95], v[44:47], v[28:31], v[92:95]
    v_mfma_f32_16x16x32_bf16 v[120:123], v[44:47], v[32:35], v[120:123]
    v_mfma_f32_16x16x32_bf16 v[124:127], v[44:47], v[36:39], v[124:127]
    s_waitcnt lgkmcnt(6)
    v_mfma_f32_16x16x32_bf16 v[96:99], v[64:67], v[24:27], v[96:99]
    v_mfma_f32_16x16x32_bf16 v[100:103], v[64:67], v[28:31], v[100:103]
    v_mfma_f32_16x16x32_bf16 v[128:131], v[64:67], v[32:35], v[128:131]
    v_mfma_f32_16x16x32_bf16 v[132:135], v[64:67], v[36:39], v[132:135]
    s_waitcnt lgkmcnt(4)
    v_mfma_f32_16x16x32_bf16 v[104:107], v[68:71], v[24:27], v[104:107]
    v_mfma_f32_16x16x32_bf16 v[108:111], v[68:71], v[28:31], v[108:111]
    v_mfma_f32_16x16x32_bf16 v[136:139], v[68:71], v[32:35], v[136:139]
    v_mfma_f32_16x16x32_bf16 v[140:143], v[68:71], v[36:39], v[140:143]
    s_waitcnt lgkmcnt(0) vmcnt(0)
    s_barrier
    v_mfma_f32_16x16x32_bf16 v[144:147], v[40:43], v[48:51], v[144:147]
    ds_read_b128 v[24:27], v77 offset:32768
    s_mov_b32 m0, s23
    s_nop 0
    buffer_load_dwordx4 v73, s[68:71], s73 offen offset:0 lds
    v_mfma_f32_16x16x32_bf16 v[148:151], v[40:43], v[52:55], v[148:151]
    ds_read_b128 v[28:31], v77 offset:33024
    v_mfma_f32_16x16x32_bf16 v[176:179], v[40:43], v[56:59], v[176:179]
    ds_read_b128 v[32:35], v77 offset:36864
    buffer_load_dwordx4 v74, s[68:71], s73 offen offset:1024 lds
    v_mfma_f32_16x16x32_bf16 v[180:183], v[40:43], v[60:63], v[180:183]
    ds_read_b128 v[36:39], v77 offset:37120
    ds_read_b64_tr_b16 v[40:41], v14 offset:32768
    ds_read_b64_tr_b16 v[42:43], v14 offset:33792
    v_mfma_f32_16x16x32_bf16 v[152:155], v[44:47], v[48:51], v[152:155]
    buffer_load_dwordx4 v75, s[68:71], s73 offen offset:2048 lds
    v_mfma_f32_16x16x32_bf16 v[156:159], v[44:47], v[52:55], v[156:159]
    v_mfma_f32_16x16x32_bf16 v[184:187], v[44:47], v[56:59], v[184:187]
    buffer_load_dwordx4 v76, s[68:71], s73 offen offset:3072 lds
    s_add_u32 s73, s73, s75
    v_mfma_f32_16x16x32_bf16 v[188:191], v[44:47], v[60:63], v[188:191]
    ds_read_b64_tr_b16 v[44:45], v15 offset:32768
    ds_read_b64_tr_b16 v[46:47], v15 offset:33792
    v_mfma_f32_16x16x32_bf16 v[160:163], v[64:67], v[48:51], v[160:163]
    s_add_u32 m0, s23, 16384
    s_nop 0
    buffer_load_dwordx4 v20, s[84:87], s94 offen offset:0 lds
    v_mfma_f32_16x16x32_bf16 v[164:167], v[64:67], v[52:55], v[164:167]
    v_mfma_f32_16x16x32_bf16 v[192:195], v[64:67], v[56:59], v[192:195]
    buffer_load_dwordx4 v21, s[84:87], s94 offen offset:1024 lds
    v_mfma_f32_16x16x32_bf16 v[196:199], v[64:67], v[60:63], v[196:199]
    ds_read_b64_tr_b16 v[64:65], v14 offset:49152
    ds_read_b64_tr_b16 v[66:67], v14 offset:50176
    v_mfma_f32_16x16x32_bf16 v[168:171], v[68:71], v[48:51], v[168:171]
    buffer_load_dwordx4 v22, s[84:87], s94 offen offset:2048 lds
    v_mfma_f32_16x16x32_bf16 v[172:175], v[68:71], v[52:55], v[172:175]
    v_mfma_f32_16x16x32_bf16 v[200:203], v[68:71], v[56:59], v[200:203]
    buffer_load_dwordx4 v23, s[84:87], s94 offen offset:3072 lds
    s_add_u32 s94, s94, s76
    v_mfma_f32_16x16x32_bf16 v[204:207], v[68:71], v[60:63], v[204:207]
    ds_read_b64_tr_b16 v[68:69], v15 offset:49152
    ds_read_b64_tr_b16 v[70:71], v15 offset:50176
    s_waitcnt lgkmcnt(6)
    v_mfma_f32_16x16x32_bf16 v[80:83], v[40:43], v[24:27], v[80:83]
    ds_read_b128 v[48:51], v77 offset:40960
    s_mov_b32 m0, s20
    s_nop 0
    buffer_load_dwordx4 v72, s[64:67], s72 offen offset:0 lds
    v_mfma_f32_16x16x32_bf16 v[84:87], v[40:43], v[28:31], v[84:87]
    ds_read_b128 v[52:55], v77 offset:41216
    v_mfma_f32_16x16x32_bf16 v[112:115], v[40:43], v[32:35], v[112:115]
    ds_read_b128 v[56:59], v77 offset:45056
    buffer_load_dwordx4 v72, s[64:67], s72 offen offset:1024 lds
    v_mfma_f32_16x16x32_bf16 v[116:119], v[40:43], v[36:39], v[116:119]
    ds_read_b128 v[60:63], v77 offset:45312
    s_waitcnt lgkmcnt(8)
    v_mfma_f32_16x16x32_bf16 v[88:91], v[44:47], v[24:27], v[88:91]
    buffer_load_dwordx4 v72, s[64:67], s72 offen offset:2048 lds
    v_mfma_f32_16x16x32_bf16 v[92:95], v[44:47], v[28:31], v[92:95]
    v_mfma_f32_16x16x32_bf16 v[120:123], v[44:47], v[32:35], v[120:123]
    buffer_load_dwordx4 v72, s[64:67], s72 offen offset:3072 lds
    s_add_u32 s72, s72, s74
    v_mfma_f32_16x16x32_bf16 v[124:127], v[44:47], v[36:39], v[124:127]
    s_waitcnt lgkmcnt(6)
    v_mfma_f32_16x16x32_bf16 v[96:99], v[64:67], v[24:27], v[96:99]
    s_add_u32 m0, s20, 4096
    s_nop 0
    buffer_load_dwordx4 v72, s[64:67], s25 offen offset:0 lds
    v_mfma_f32_16x16x32_bf16 v[100:103], v[64:67], v[28:31], v[100:103]
    v_mfma_f32_16x16x32_bf16 v[128:131], v[64:67], v[32:35], v[128:131]
    buffer_load_dwordx4 v72, s[64:67], s25 offen offset:1024 lds
    v_mfma_f32_16x16x32_bf16 v[132:135], v[64:67], v[36:39], v[132:135]
    s_waitcnt lgkmcnt(4)
    v_mfma_f32_16x16x32_bf16 v[104:107], v[68:71], v[24:27], v[104:107]
    buffer_load_dwordx4 v72, s[64:67], s25 offen offset:2048 lds
    v_mfma_f32_16x16x32_bf16 v[108:111], v[68:71], v[28:31], v[108:111]
    v_mfma_f32_16x16x32_bf16 v[136:139], v[68:71], v[32:35], v[136:139]
    buffer_load_dwordx4 v72, s[64:67], s25 offen offset:3072 lds
    s_add_u32 s25, s25, s74
    v_mfma_f32_16x16x32_bf16 v[140:143], v[68:71], v[36:39], v[140:143]
    s_waitcnt lgkmcnt(3)
    v_mfma_f32_16x16x32_bf16 v[144:147], v[40:43], v[48:51], v[144:147]
    ds_read_b128 v[24:27], v77 offset:34816
    s_waitcnt lgkmcnt(3)
    v_mfma_f32_16x16x32_bf16 v[148:151], v[40:43], v[52:55], v[148:151]
    ds_read_b128 v[28:31], v77 offset:35072
    s_waitcnt lgkmcnt(3)
    v_mfma_f32_16x16x32_bf16 v[176:179], v[40:43], v[56:59], v[176:179]
    ds_read_b128 v[32:35], v77 offset:38912
    s_waitcnt lgkmcnt(3)
    v_mfma_f32_16x16x32_bf16 v[180:183], v[40:43], v[60:63], v[180:183]
    ds_read_b128 v[36:39], v77 offset:39168
    ds_read_b64_tr_b16 v[40:41], v14 offset:40960
    ds_read_b64_tr_b16 v[42:43], v14 offset:41984
    v_mfma_f32_16x16x32_bf16 v[152:155], v[44:47], v[48:51], v[152:155]
    v_mfma_f32_16x16x32_bf16 v[156:159], v[44:47], v[52:55], v[156:159]
    v_mfma_f32_16x16x32_bf16 v[184:187], v[44:47], v[56:59], v[184:187]
    v_mfma_f32_16x16x32_bf16 v[188:191], v[44:47], v[60:63], v[188:191]
    ds_read_b64_tr_b16 v[44:45], v15 offset:40960
    ds_read_b64_tr_b16 v[46:47], v15 offset:41984
    v_mfma_f32_16x16x32_bf16 v[160:163], v[64:67], v[48:51], v[160:163]
    v_mfma_f32_16x16x32_bf16 v[164:167], v[64:67], v[52:55], v[164:167]
    v_mfma_f32_16x16x32_bf16 v[192:195], v[64:67], v[56:59], v[192:195]
    v_mfma_f32_16x16x32_bf16 v[196:199], v[64:67], v[60:63], v[196:199]
    ds_read_b64_tr_b16 v[64:65], v14 offset:57344
    ds_read_b64_tr_b16 v[66:67], v14 offset:58368
    v_mfma_f32_16x16x32_bf16 v[168:171], v[68:71], v[48:51], v[168:171]
    v_mfma_f32_16x16x32_bf16 v[172:175], v[68:71], v[52:55], v[172:175]
    v_mfma_f32_16x16x32_bf16 v[200:203], v[68:71], v[56:59], v[200:203]
    v_mfma_f32_16x16x32_bf16 v[204:207], v[68:71], v[60:63], v[204:207]
    ds_read_b64_tr_b16 v[68:69], v15 offset:57344
    ds_read_b64_tr_b16 v[70:71], v15 offset:58368
    s_waitcnt lgkmcnt(6)
    v_mfma_f32_16x16x32_bf16 v[80:83], v[40:43], v[24:27], v[80:83]
    ds_read_b128 v[48:51], v77 offset:43008
    v_mov_b32 v209, 147460
    ds_read_b32 v208, v209
    s_waitcnt lgkmcnt(0)
    v_readfirstlane_b32 s61, v208
    v_mfma_f32_16x16x32_bf16 v[84:87], v[40:43], v[28:31], v[84:87]
    ds_read_b128 v[52:55], v77 offset:43264
    v_mfma_f32_16x16x32_bf16 v[112:115], v[40:43], v[32:35], v[112:115]
    ds_read_b128 v[56:59], v77 offset:47104
    v_mfma_f32_16x16x32_bf16 v[116:119], v[40:43], v[36:39], v[116:119]
    ds_read_b128 v[60:63], v77 offset:47360
    v_mfma_f32_16x16x32_bf16 v[88:91], v[44:47], v[24:27], v[88:91]
    v_mfma_f32_16x16x32_bf16 v[92:95], v[44:47], v[28:31], v[92:95]
    v_mfma_f32_16x16x32_bf16 v[120:123], v[44:47], v[32:35], v[120:123]
    v_mfma_f32_16x16x32_bf16 v[124:127], v[44:47], v[36:39], v[124:127]
    v_mfma_f32_16x16x32_bf16 v[96:99], v[64:67], v[24:27], v[96:99]
    v_mfma_f32_16x16x32_bf16 v[100:103], v[64:67], v[28:31], v[100:103]
    v_mfma_f32_16x16x32_bf16 v[128:131], v[64:67], v[32:35], v[128:131]
    v_mfma_f32_16x16x32_bf16 v[132:135], v[64:67], v[36:39], v[132:135]
    v_mfma_f32_16x16x32_bf16 v[104:107], v[68:71], v[24:27], v[104:107]
    v_mfma_f32_16x16x32_bf16 v[108:111], v[68:71], v[28:31], v[108:111]
    v_mfma_f32_16x16x32_bf16 v[136:139], v[68:71], v[32:35], v[136:139]
    v_mfma_f32_16x16x32_bf16 v[140:143], v[68:71], v[36:39], v[140:143]
    s_waitcnt lgkmcnt(0) vmcnt(0)
    s_barrier
    v_mfma_f32_16x16x32_bf16 v[144:147], v[40:43], v[48:51], v[144:147]
    ds_read_b128 v[24:27], v77 offset:0
    s_mov_b32 m0, s24
    s_nop 0
    buffer_load_dwordx4 v73, s[68:71], s73 offen offset:0 lds
    v_mfma_f32_16x16x32_bf16 v[148:151], v[40:43], v[52:55], v[148:151]
    ds_read_b128 v[28:31], v77 offset:256
    v_mfma_f32_16x16x32_bf16 v[176:179], v[40:43], v[56:59], v[176:179]
    ds_read_b128 v[32:35], v77 offset:4096
    buffer_load_dwordx4 v74, s[68:71], s73 offen offset:1024 lds
    v_mfma_f32_16x16x32_bf16 v[180:183], v[40:43], v[60:63], v[180:183]
    ds_read_b128 v[36:39], v77 offset:4352
    ds_read_b64_tr_b16 v[40:41], v14 offset:0
    ds_read_b64_tr_b16 v[42:43], v14 offset:1024
    v_mfma_f32_16x16x32_bf16 v[152:155], v[44:47], v[48:51], v[152:155]
    buffer_load_dwordx4 v75, s[68:71], s73 offen offset:2048 lds
    v_mfma_f32_16x16x32_bf16 v[156:159], v[44:47], v[52:55], v[156:159]
    v_mfma_f32_16x16x32_bf16 v[184:187], v[44:47], v[56:59], v[184:187]
    buffer_load_dwordx4 v76, s[68:71], s73 offen offset:3072 lds
    s_add_u32 s73, s73, s75
    v_mfma_f32_16x16x32_bf16 v[188:191], v[44:47], v[60:63], v[188:191]
    ds_read_b64_tr_b16 v[44:45], v15 offset:0
    ds_read_b64_tr_b16 v[46:47], v15 offset:1024
    v_mfma_f32_16x16x32_bf16 v[160:163], v[64:67], v[48:51], v[160:163]
    s_add_u32 m0, s24, 16384
    s_nop 0
    buffer_load_dwordx4 v20, s[84:87], s94 offen offset:0 lds
    v_mfma_f32_16x16x32_bf16 v[164:167], v[64:67], v[52:55], v[164:167]
    v_mfma_f32_16x16x32_bf16 v[192:195], v[64:67], v[56:59], v[192:195]
    buffer_load_dwordx4 v21, s[84:87], s94 offen offset:1024 lds
    v_mfma_f32_16x16x32_bf16 v[196:199], v[64:67], v[60:63], v[196:199]
    ds_read_b64_tr_b16 v[64:65], v14 offset:16384
    ds_read_b64_tr_b16 v[66:67], v14 offset:17408
    v_mfma_f32_16x16x32_bf16 v[168:171], v[68:71], v[48:51], v[168:171]
    buffer_load_dwordx4 v22, s[84:87], s94 offen offset:2048 lds
    v_mfma_f32_16x16x32_bf16 v[172:175], v[68:71], v[52:55], v[172:175]
    v_mfma_f32_16x16x32_bf16 v[200:203], v[68:71], v[56:59], v[200:203]
    buffer_load_dwordx4 v23, s[84:87], s94 offen offset:3072 lds
    s_add_u32 s94, s94, s76
    v_mfma_f32_16x16x32_bf16 v[204:207], v[68:71], v[60:63], v[204:207]
    ds_read_b64_tr_b16 v[68:69], v15 offset:16384
    ds_read_b64_tr_b16 v[70:71], v15 offset:17408
    s_waitcnt lgkmcnt(6)
    v_mfma_f32_16x16x32_bf16 v[80:83], v[40:43], v[24:27], v[80:83]
    ds_read_b128 v[48:51], v77 offset:8192
    s_mov_b32 m0, s21
    s_nop 0
    buffer_load_dwordx4 v72, s[64:67], s72 offen offset:0 lds
    v_mfma_f32_16x16x32_bf16 v[84:87], v[40:43], v[28:31], v[84:87]
    ds_read_b128 v[52:55], v77 offset:8448
    buffer_load_dwordx4 v72, s[64:67], s72 offen offset:1024 lds
    v_mfma_f32_16x16x32_bf16 v[112:115], v[40:43], v[32:35], v[112:115]
    ds_read_b128 v[56:59], v77 offset:12288
    buffer_load_dwordx4 v72, s[64:67], s72 offen offset:2048 lds
    v_mfma_f32_16x16x32_bf16 v[116:119], v[40:43], v[36:39], v[116:119]
    ds_read_b128 v[60:63], v77 offset:12544
    s_waitcnt lgkmcnt(8)
    v_mfma_f32_16x16x32_bf16 v[88:91], v[44:47], v[24:27], v[88:91]
    buffer_load_dwordx4 v72, s[64:67], s72 offen offset:3072 lds
    s_add_u32 s72, s72, s74
    v_mfma_f32_16x16x32_bf16 v[92:95], v[44:47], v[28:31], v[92:95]
    s_add_u32 m0, s21, 4096
    s_nop 0
    buffer_load_dwordx4 v72, s[64:67], s25 offen offset:0 lds
    v_mfma_f32_16x16x32_bf16 v[120:123], v[44:47], v[32:35], v[120:123]
    v_mfma_f32_16x16x32_bf16 v[124:127], v[44:47], v[36:39], v[124:127]
    buffer_load_dwordx4 v72, s[64:67], s25 offen offset:1024 lds
    s_waitcnt lgkmcnt(6)
    v_mfma_f32_16x16x32_bf16 v[96:99], v[64:67], v[24:27], v[96:99]
    buffer_load_dwordx4 v72, s[64:67], s25 offen offset:2048 lds
    v_mfma_f32_16x16x32_bf16 v[100:103], v[64:67], v[28:31], v[100:103]
    v_mfma_f32_16x16x32_bf16 v[128:131], v[64:67], v[32:35], v[128:131]
    buffer_load_dwordx4 v72, s[64:67], s25 offen offset:3072 lds
    s_add_u32 s25, s25, s74
    v_mfma_f32_16x16x32_bf16 v[132:135], v[64:67], v[36:39], v[132:135]
    s_mul_i32 s35, s97, s99
    s_lshl_b32 s35, s35, 8
    s_lshl_b32 s101, s28, 6
    s_add_u32 s35, s35, s101
    s_sub_u32 s101, 7168, s35
    s_add_u32 s36, s54, s35
    s_addc_u32 s37, s55, 0
    s_mov_b32 s38, s101
    s_mov_b32 s39, 0x00020000
    v_bfe_u32 v18, v0, 4, 2
    v_lshlrev_b32 v18, 3, v18
    s_waitcnt lgkmcnt(4)
    v_mfma_f32_16x16x32_bf16 v[104:107], v[68:71], v[24:27], v[104:107]
    v_mfma_f32_16x16x32_bf16 v[108:111], v[68:71], v[28:31], v[108:111]
    buffer_load_dwordx2 v[240:241], v18, s[36:39], 0 offen offset:0
    v_mfma_f32_16x16x32_bf16 v[136:139], v[68:71], v[32:35], v[136:139]
    buffer_load_dwordx2 v[242:243], v18, s[36:39], 0 offen offset:32
    v_mfma_f32_16x16x32_bf16 v[140:143], v[68:71], v[36:39], v[140:143]
    s_waitcnt lgkmcnt(3)
    v_mfma_f32_16x16x32_bf16 v[144:147], v[40:43], v[48:51], v[144:147]
    ds_read_b128 v[24:27], v77 offset:2048
    s_waitcnt lgkmcnt(3)
    v_mfma_f32_16x16x32_bf16 v[148:151], v[40:43], v[52:55], v[148:151]
    ds_read_b128 v[28:31], v77 offset:2304
    s_waitcnt lgkmcnt(3)
    v_mfma_f32_16x16x32_bf16 v[176:179], v[40:43], v[56:59], v[176:179]
    ds_read_b128 v[32:35], v77 offset:6144
    s_waitcnt lgkmcnt(3)
    v_mfma_f32_16x16x32_bf16 v[180:183], v[40:43], v[60:63], v[180:183]
    ds_read_b128 v[36:39], v77 offset:6400
    ds_read_b64_tr_b16 v[40:41], v14 offset:8192
    ds_read_b64_tr_b16 v[42:43], v14 offset:9216
    v_mfma_f32_16x16x32_bf16 v[152:155], v[44:47], v[48:51], v[152:155]
    v_mfma_f32_16x16x32_bf16 v[156:159], v[44:47], v[52:55], v[156:159]
    v_mfma_f32_16x16x32_bf16 v[184:187], v[44:47], v[56:59], v[184:187]
    v_mfma_f32_16x16x32_bf16 v[188:191], v[44:47], v[60:63], v[188:191]
    ds_read_b64_tr_b16 v[44:45], v15 offset:8192
    ds_read_b64_tr_b16 v[46:47], v15 offset:9216
    v_mfma_f32_16x16x32_bf16 v[160:163], v[64:67], v[48:51], v[160:163]
    v_mfma_f32_16x16x32_bf16 v[164:167], v[64:67], v[52:55], v[164:167]
    v_mfma_f32_16x16x32_bf16 v[192:195], v[64:67], v[56:59], v[192:195]
    v_mfma_f32_16x16x32_bf16 v[196:199], v[64:67], v[60:63], v[196:199]
    ds_read_b64_tr_b16 v[64:65], v14 offset:24576
    ds_read_b64_tr_b16 v[66:67], v14 offset:25600
    v_mfma_f32_16x16x32_bf16 v[168:171], v[68:71], v[48:51], v[168:171]
    v_mfma_f32_16x16x32_bf16 v[172:175], v[68:71], v[52:55], v[172:175]
    v_mfma_f32_16x16x32_bf16 v[200:203], v[68:71], v[56:59], v[200:203]
    v_mfma_f32_16x16x32_bf16 v[204:207], v[68:71], v[60:63], v[204:207]
    ds_read_b64_tr_b16 v[68:69], v15 offset:24576
    ds_read_b64_tr_b16 v[70:71], v15 offset:25600
    s_waitcnt lgkmcnt(6)
    v_mfma_f32_16x16x32_bf16 v[80:83], v[40:43], v[24:27], v[80:83]
    ds_read_b128 v[48:51], v77 offset:10240
    v_mfma_f32_16x16x32_bf16 v[84:87], v[40:43], v[28:31], v[84:87]
    ds_read_b128 v[52:55], v77 offset:10496
    v_mfma_f32_16x16x32_bf16 v[112:115], v[40:43], v[32:35], v[112:115]
    ds_read_b128 v[56:59], v77 offset:14336
    v_mfma_f32_16x16x32_bf16 v[116:119], v[40:43], v[36:39], v[116:119]
    ds_read_b128 v[60:63], v77 offset:14592
    s_waitcnt lgkmcnt(8)
    v_mfma_f32_16x16x32_bf16 v[88:91], v[44:47], v[24:27], v[88:91]
    v_mfma_f32_16x16x32_bf16 v[92:95], v[44:47], v[28:31], v[92:95]
    v_mfma_f32_16x16x32_bf16 v[120:123], v[44:47], v[32:35], v[120:123]
    v_mfma_f32_16x16x32_bf16 v[124:127], v[44:47], v[36:39], v[124:127]
    s_waitcnt lgkmcnt(6)
    v_mfma_f32_16x16x32_bf16 v[96:99], v[64:67], v[24:27], v[96:99]
    v_mfma_f32_16x16x32_bf16 v[100:103], v[64:67], v[28:31], v[100:103]
    v_mfma_f32_16x16x32_bf16 v[128:131], v[64:67], v[32:35], v[128:131]
    v_mfma_f32_16x16x32_bf16 v[132:135], v[64:67], v[36:39], v[132:135]
    s_waitcnt lgkmcnt(4)
    v_mfma_f32_16x16x32_bf16 v[104:107], v[68:71], v[24:27], v[104:107]
    v_mfma_f32_16x16x32_bf16 v[108:111], v[68:71], v[28:31], v[108:111]
    v_mfma_f32_16x16x32_bf16 v[136:139], v[68:71], v[32:35], v[136:139]
    v_mfma_f32_16x16x32_bf16 v[140:143], v[68:71], v[36:39], v[140:143]
    s_waitcnt lgkmcnt(0) vmcnt(2)
    s_barrier
    v_mfma_f32_16x16x32_bf16 v[144:147], v[40:43], v[48:51], v[144:147]
    ds_read_b128 v[24:27], v77 offset:32768
    s_mov_b32 m0, s23
    s_nop 0
    buffer_load_dwordx4 v73, s[68:71], s73 offen offset:0 lds
    v_mfma_f32_16x16x32_bf16 v[148:151], v[40:43], v[52:55], v[148:151]
    ds_read_b128 v[28:31], v77 offset:33024
    v_mfma_f32_16x16x32_bf16 v[176:179], v[40:43], v[56:59], v[176:179]
    ds_read_b128 v[32:35], v77 offset:36864
    buffer_load_dwordx4 v74, s[68:71], s73 offen offset:1024 lds
    v_mfma_f32_16x16x32_bf16 v[180:183], v[40:43], v[60:63], v[180:183]
    ds_read_b128 v[36:39], v77 offset:37120
    ds_read_b64_tr_b16 v[40:41], v14 offset:32768
    ds_read_b64_tr_b16 v[42:43], v14 offset:33792
    v_mfma_f32_16x16x32_bf16 v[152:155], v[44:47], v[48:51], v[152:155]
    buffer_load_dwordx4 v75, s[68:71], s73 offen offset:2048 lds
    v_mfma_f32_16x16x32_bf16 v[156:159], v[44:47], v[52:55], v[156:159]
    v_mfma_f32_16x16x32_bf16 v[184:187], v[44:47], v[56:59], v[184:187]
    buffer_load_dwordx4 v76, s[68:71], s73 offen offset:3072 lds
    s_add_u32 s73, s73, s75
    v_mfma_f32_16x16x32_bf16 v[188:191], v[44:47], v[60:63], v[188:191]
    ds_read_b64_tr_b16 v[44:45], v15 offset:32768
    ds_read_b64_tr_b16 v[46:47], v15 offset:33792
    v_mfma_f32_16x16x32_bf16 v[160:163], v[64:67], v[48:51], v[160:163]
    s_add_u32 m0, s23, 16384
    s_nop 0
    buffer_load_dwordx4 v20, s[84:87], s94 offen offset:0 lds
    v_mfma_f32_16x16x32_bf16 v[164:167], v[64:67], v[52:55], v[164:167]
    v_mfma_f32_16x16x32_bf16 v[192:195], v[64:67], v[56:59], v[192:195]
    buffer_load_dwordx4 v21, s[84:87], s94 offen offset:1024 lds
    v_mfma_f32_16x16x32_bf16 v[196:199], v[64:67], v[60:63], v[196:199]
    ds_read_b64_tr_b16 v[64:65], v14 offset:49152
    ds_read_b64_tr_b16 v[66:67], v14 offset:50176
    v_mfma_f32_16x16x32_bf16 v[168:171], v[68:71], v[48:51], v[168:171]
    buffer_load_dwordx4 v22, s[84:87], s94 offen offset:2048 lds
    v_mfma_f32_16x16x32_bf16 v[172:175], v[68:71], v[52:55], v[172:175]
    v_mfma_f32_16x16x32_bf16 v[200:203], v[68:71], v[56:59], v[200:203]
    buffer_load_dwordx4 v23, s[84:87], s94 offen offset:3072 lds
    s_add_u32 s94, s94, s76
    v_mfma_f32_16x16x32_bf16 v[204:207], v[68:71], v[60:63], v[204:207]
    ds_read_b64_tr_b16 v[68:69], v15 offset:49152
    ds_read_b64_tr_b16 v[70:71], v15 offset:50176
    s_waitcnt lgkmcnt(6)
    v_mfma_f32_16x16x32_bf16 v[80:83], v[40:43], v[24:27], v[80:83]
    ds_read_b128 v[48:51], v77 offset:40960
    s_mov_b32 m0, s20
    s_nop 0
    buffer_load_dwordx4 v72, s[64:67], s72 offen offset:0 lds
    v_mfma_f32_16x16x32_bf16 v[84:87], v[40:43], v[28:31], v[84:87]
    ds_read_b128 v[52:55], v77 offset:41216
    buffer_load_dwordx4 v72, s[64:67], s72 offen offset:1024 lds
    v_mfma_f32_16x16x32_bf16 v[112:115], v[40:43], v[32:35], v[112:115]
    ds_read_b128 v[56:59], v77 offset:45056
    buffer_load_dwordx4 v72, s[64:67], s72 offen offset:2048 lds
    v_mfma_f32_16x16x32_bf16 v[116:119], v[40:43], v[36:39], v[116:119]
    ds_read_b128 v[60:63], v77 offset:45312
    buffer_load_dwordx4 v72, s[64:67], s72 offen offset:3072 lds
    s_add_u32 s72, s72, s74
    s_waitcnt lgkmcnt(8)
    v_mfma_f32_16x16x32_bf16 v[88:91], v[44:47], v[24:27], v[88:91]
    s_add_u32 m0, s20, 4096
    s_nop 0
    buffer_load_dwordx4 v72, s[64:67], s25 offen offset:0 lds
    v_mfma_f32_16x16x32_bf16 v[92:95], v[44:47], v[28:31], v[92:95]
    v_mfma_f32_16x16x32_bf16 v[120:123], v[44:47], v[32:35], v[120:123]
    buffer_load_dwordx4 v72, s[64:67], s25 offen offset:1024 lds
    v_mfma_f32_16x16x32_bf16 v[124:127], v[44:47], v[36:39], v[124:127]
    buffer_load_dwordx4 v72, s[64:67], s25 offen offset:2048 lds
    s_waitcnt lgkmcnt(6)
    v_mfma_f32_16x16x32_bf16 v[96:99], v[64:67], v[24:27], v[96:99]
    buffer_load_dwordx4 v72, s[64:67], s25 offen offset:3072 lds
    s_add_u32 s25, s25, s74
    v_mfma_f32_16x16x32_bf16 v[100:103], v[64:67], v[28:31], v[100:103]
    s_waitcnt vmcnt(16)
    v_mfma_f32_16x16x32_bf16 v[128:131], v[64:67], v[32:35], v[128:131]
    v_mfma_f32_16x16x32_bf16 v[132:135], v[64:67], v[36:39], v[132:135]
    v_lshlrev_b32 v224, 16, v240
    s_waitcnt lgkmcnt(4)
    v_mfma_f32_16x16x32_bf16 v[104:107], v[68:71], v[24:27], v[104:107]
    v_and_b32 v225, 0xffff0000, v240
    v_mfma_f32_16x16x32_bf16 v[108:111], v[68:71], v[28:31], v[108:111]
    v_lshlrev_b32 v226, 16, v241
    v_mfma_f32_16x16x32_bf16 v[136:139], v[68:71], v[32:35], v[136:139]
    v_and_b32 v227, 0xffff0000, v241
    v_mfma_f32_16x16x32_bf16 v[140:143], v[68:71], v[36:39], v[140:143]
    s_waitcnt lgkmcnt(3)
    v_mfma_f32_16x16x32_bf16 v[144:147], v[40:43], v[48:51], v[144:147]
    ds_read_b128 v[24:27], v77 offset:34816
    v_lshlrev_b32 v228, 16, v240
    s_waitcnt lgkmcnt(3)
    v_mfma_f32_16x16x32_bf16 v[148:151], v[40:43], v[52:55], v[148:151]
    ds_read_b128 v[28:31], v77 offset:35072
    s_waitcnt lgkmcnt(3)
    v_mfma_f32_16x16x32_bf16 v[176:179], v[40:43], v[56:59], v[176:179]
    ds_read_b128 v[32:35], v77 offset:38912
    v_and_b32 v229, 0xffff0000, v240
    s_waitcnt lgkmcnt(3)
    v_mfma_f32_16x16x32_bf16 v[180:183], v[40:43], v[60:63], v[180:183]
    ds_read_b128 v[36:39], v77 offset:39168
    ds_read_b64_tr_b16 v[40:41], v14 offset:40960
    ds_read_b64_tr_b16 v[42:43], v14 offset:41984
    v_mfma_f32_16x16x32_bf16 v[152:155], v[44:47], v[48:51], v[152:155]
    v_mfma_f32_16x16x32_bf16 v[156:159], v[44:47], v[52:55], v[156:159]
    v_lshlrev_b32 v230, 16, v241
    v_mfma_f32_16x16x32_bf16 v[184:187], v[44:47], v[56:59], v[184:187]
    v_mfma_f32_16x16x32_bf16 v[188:191], v[44:47], v[60:63], v[188:191]
    ds_read_b64_tr_b16 v[44:45], v15 offset:40960
    ds_read_b64_tr_b16 v[46:47], v15 offset:41984
    v_mfma_f32_16x16x32_bf16 v[160:163], v[64:67], v[48:51], v[160:163]
    v_and_b32 v231, 0xffff0000, v241
    v_mfma_f32_16x16x32_bf16 v[164:167], v[64:67], v[52:55], v[164:167]
    v_mfma_f32_16x16x32_bf16 v[192:195], v[64:67], v[56:59], v[192:195]
    v_lshlrev_b32 v232, 16, v242
    v_mfma_f32_16x16x32_bf16 v[196:199], v[64:67], v[60:63], v[196:199]
    ds_read_b64_tr_b16 v[64:65], v14 offset:57344
    ds_read_b64_tr_b16 v[66:67], v14 offset:58368
    v_mfma_f32_16x16x32_bf16 v[168:171], v[68:71], v[48:51], v[168:171]
    v_mfma_f32_16x16x32_bf16 v[172:175], v[68:71], v[52:55], v[172:175]
    v_and_b32 v233, 0xffff0000, v242
    v_mfma_f32_16x16x32_bf16 v[200:203], v[68:71], v[56:59], v[200:203]
    v_mfma_f32_16x16x32_bf16 v[204:207], v[68:71], v[60:63], v[204:207]
    ds_read_b64_tr_b16 v[68:69], v15 offset:57344
    ds_read_b64_tr_b16 v[70:71], v15 offset:58368
    s_waitcnt lgkmcnt(6)
    v_mfma_f32_16x16x32_bf16 v[80:83], v[40:43], v[24:27], v[80:83]
    ds_read_b128 v[48:51], v77 offset:43008
    v_lshlrev_b32 v234, 16, v243
    v_mfma_f32_16x16x32_bf16 v[84:87], v[40:43], v[28:31], v[84:87]
    ds_read_b128 v[52:55], v77 offset:43264
    v_mfma_f32_16x16x32_bf16 v[112:115], v[40:43], v[32:35], v[112:115]
    ds_read_b128 v[56:59], v77 offset:47104
    v_and_b32 v235, 0xffff0000, v243
    v_mfma_f32_16x16x32_bf16 v[116:119], v[40:43], v[36:39], v[116:119]
    ds_read_b128 v[60:63], v77 offset:47360
    s_waitcnt lgkmcnt(8)
    v_mfma_f32_16x16x32_bf16 v[88:91], v[44:47], v[24:27], v[88:91]
    v_mfma_f32_16x16x32_bf16 v[92:95], v[44:47], v[28:31], v[92:95]
    v_lshlrev_b32 v236, 16, v242
    v_mfma_f32_16x16x32_bf16 v[120:123], v[44:47], v[32:35], v[120:123]
    v_mfma_f32_16x16x32_bf16 v[124:127], v[44:47], v[36:39], v[124:127]
    s_waitcnt lgkmcnt(6)
    v_mfma_f32_16x16x32_bf16 v[96:99], v[64:67], v[24:27], v[96:99]
    v_and_b32 v237, 0xffff0000, v242
    v_mfma_f32_16x16x32_bf16 v[100:103], v[64:67], v[28:31], v[100:103]
    v_mfma_f32_16x16x32_bf16 v[128:131], v[64:67], v[32:35], v[128:131]
    v_lshlrev_b32 v238, 16, v243
    v_mfma_f32_16x16x32_bf16 v[132:135], v[64:67], v[36:39], v[132:135]
    s_waitcnt lgkmcnt(4)
    v_mfma_f32_16x16x32_bf16 v[104:107], v[68:71], v[24:27], v[104:107]
    v_mfma_f32_16x16x32_bf16 v[108:111], v[68:71], v[28:31], v[108:111]
    v_and_b32 v239, 0xffff0000, v243
    v_mfma_f32_16x16x32_bf16 v[136:139], v[68:71], v[32:35], v[136:139]
    v_mfma_f32_16x16x32_bf16 v[140:143], v[68:71], v[36:39], v[140:143]
    s_waitcnt lgkmcnt(0) vmcnt(0)
    s_barrier
    v_mfma_f32_16x16x32_bf16 v[144:147], v[40:43], v[48:51], v[144:147]
    ds_read_b128 v[24:27], v77 offset:0
    s_mov_b32 m0, s24
    s_nop 0
    buffer_load_dwordx4 v73, s[68:71], s73 offen offset:0 lds
    v_mfma_f32_16x16x32_bf16 v[148:151], v[40:43], v[52:55], v[148:151]
    ds_read_b128 v[28:31], v77 offset:256
    v_mfma_f32_16x16x32_bf16 v[176:179], v[40:43], v[56:59], v[176:179]
    ds_read_b128 v[32:35], v77 offset:4096
    buffer_load_dwordx4 v74, s[68:71], s73 offen offset:1024 lds
    v_mfma_f32_16x16x32_bf16 v[180:183], v[40:43], v[60:63], v[180:183]
    ds_read_b128 v[36:39], v77 offset:4352
    ds_read_b64_tr_b16 v[40:41], v14 offset:0
    ds_read_b64_tr_b16 v[42:43], v14 offset:1024
    v_mfma_f32_16x16x32_bf16 v[152:155], v[44:47], v[48:51], v[152:155]
    buffer_load_dwordx4 v75, s[68:71], s73 offen offset:2048 lds
    v_mfma_f32_16x16x32_bf16 v[156:159], v[44:47], v[52:55], v[156:159]
    v_mfma_f32_16x16x32_bf16 v[184:187], v[44:47], v[56:59], v[184:187]
    buffer_load_dwordx4 v76, s[68:71], s73 offen offset:3072 lds
    s_add_u32 s73, s73, s75
    v_mfma_f32_16x16x32_bf16 v[188:191], v[44:47], v[60:63], v[188:191]
    ds_read_b64_tr_b16 v[44:45], v15 offset:0
    ds_read_b64_tr_b16 v[46:47], v15 offset:1024
    v_mfma_f32_16x16x32_bf16 v[160:163], v[64:67], v[48:51], v[160:163]
    s_add_u32 m0, s24, 16384
    s_nop 0
    buffer_load_dwordx4 v20, s[84:87], s94 offen offset:0 lds
    v_mfma_f32_16x16x32_bf16 v[164:167], v[64:67], v[52:55], v[164:167]
    v_mfma_f32_16x16x32_bf16 v[192:195], v[64:67], v[56:59], v[192:195]
    buffer_load_dwordx4 v21, s[84:87], s94 offen offset:1024 lds
    v_mfma_f32_16x16x32_bf16 v[196:199], v[64:67], v[60:63], v[196:199]
    ds_read_b64_tr_b16 v[64:65], v14 offset:16384
    ds_read_b64_tr_b16 v[66:67], v14 offset:17408
    v_mfma_f32_16x16x32_bf16 v[168:171], v[68:71], v[48:51], v[168:171]
    buffer_load_dwordx4 v22, s[84:87], s94 offen offset:2048 lds
    v_mfma_f32_16x16x32_bf16 v[172:175], v[68:71], v[52:55], v[172:175]
    v_mfma_f32_16x16x32_bf16 v[200:203], v[68:71], v[56:59], v[200:203]
    buffer_load_dwordx4 v23, s[84:87], s94 offen offset:3072 lds
    s_add_u32 s94, s94, s76
    v_mfma_f32_16x16x32_bf16 v[204:207], v[68:71], v[60:63], v[204:207]
    ds_read_b64_tr_b16 v[68:69], v15 offset:16384
    ds_read_b64_tr_b16 v[70:71], v15 offset:17408
    s_waitcnt lgkmcnt(6)
    v_mfma_f32_16x16x32_bf16 v[80:83], v[40:43], v[24:27], v[80:83]
    ds_read_b128 v[48:51], v77 offset:8192
    s_mov_b32 m0, s21
    s_nop 0
    buffer_load_dwordx4 v72, s[64:67], s72 offen offset:0 lds
    v_mfma_f32_16x16x32_bf16 v[84:87], v[40:43], v[28:31], v[84:87]
    ds_read_b128 v[52:55], v77 offset:8448
    v_mfma_f32_16x16x32_bf16 v[112:115], v[40:43], v[32:35], v[112:115]
    ds_read_b128 v[56:59], v77 offset:12288
    buffer_load_dwordx4 v72, s[64:67], s72 offen offset:1024 lds
    v_mfma_f32_16x16x32_bf16 v[116:119], v[40:43], v[36:39], v[116:119]
    ds_read_b128 v[60:63], v77 offset:12544
    s_waitcnt lgkmcnt(8)
    v_mfma_f32_16x16x32_bf16 v[88:91], v[44:47], v[24:27], v[88:91]
    buffer_load_dwordx4 v72, s[64:67], s72 offen offset:2048 lds
    v_mfma_f32_16x16x32_bf16 v[92:95], v[44:47], v[28:31], v[92:95]
    v_mfma_f32_16x16x32_bf16 v[120:123], v[44:47], v[32:35], v[120:123]
    buffer_load_dwordx4 v72, s[64:67], s72 offen offset:3072 lds
    s_add_u32 s72, s72, s74
    v_mfma_f32_16x16x32_bf16 v[124:127], v[44:47], v[36:39], v[124:127]
    s_waitcnt lgkmcnt(6)
    v_mfma_f32_16x16x32_bf16 v[96:99], v[64:67], v[24:27], v[96:99]
    s_add_u32 m0, s21, 4096
    s_nop 0
    buffer_load_dwordx4 v72, s[64:67], s25 offen offset:0 lds
    v_mfma_f32_16x16x32_bf16 v[100:103], v[64:67], v[28:31], v[100:103]
    v_mfma_f32_16x16x32_bf16 v[128:131], v[64:67], v[32:35], v[128:131]
    buffer_load_dwordx4 v72, s[64:67], s25 offen offset:1024 lds
    v_mfma_f32_16x16x32_bf16 v[132:135], v[64:67], v[36:39], v[132:135]
    s_waitcnt lgkmcnt(4)
    v_mfma_f32_16x16x32_bf16 v[104:107], v[68:71], v[24:27], v[104:107]
    buffer_load_dwordx4 v72, s[64:67], s25 offen offset:2048 lds
    v_mfma_f32_16x16x32_bf16 v[108:111], v[68:71], v[28:31], v[108:111]
    v_mfma_f32_16x16x32_bf16 v[136:139], v[68:71], v[32:35], v[136:139]
    buffer_load_dwordx4 v72, s[64:67], s25 offen offset:3072 lds
    s_add_u32 s25, s25, s74
    v_mfma_f32_16x16x32_bf16 v[140:143], v[68:71], v[36:39], v[140:143]
    s_waitcnt lgkmcnt(3)
    v_mfma_f32_16x16x32_bf16 v[144:147], v[40:43], v[48:51], v[144:147]
    ds_read_b128 v[24:27], v77 offset:2048
    s_waitcnt lgkmcnt(3)
    v_mfma_f32_16x16x32_bf16 v[148:151], v[40:43], v[52:55], v[148:151]
    ds_read_b128 v[28:31], v77 offset:2304
    s_waitcnt lgkmcnt(3)
    v_mfma_f32_16x16x32_bf16 v[176:179], v[40:43], v[56:59], v[176:179]
    ds_read_b128 v[32:35], v77 offset:6144
    s_waitcnt lgkmcnt(3)
    v_mfma_f32_16x16x32_bf16 v[180:183], v[40:43], v[60:63], v[180:183]
    ds_read_b128 v[36:39], v77 offset:6400
    ds_read_b64_tr_b16 v[40:41], v14 offset:8192
    ds_read_b64_tr_b16 v[42:43], v14 offset:9216
    v_mfma_f32_16x16x32_bf16 v[152:155], v[44:47], v[48:51], v[152:155]
    v_mfma_f32_16x16x32_bf16 v[156:159], v[44:47], v[52:55], v[156:159]
    v_mfma_f32_16x16x32_bf16 v[184:187], v[44:47], v[56:59], v[184:187]
    v_mfma_f32_16x16x32_bf16 v[188:191], v[44:47], v[60:63], v[188:191]
    ds_read_b64_tr_b16 v[44:45], v15 offset:8192
    ds_read_b64_tr_b16 v[46:47], v15 offset:9216
    v_mfma_f32_16x16x32_bf16 v[160:163], v[64:67], v[48:51], v[160:163]
    v_mfma_f32_16x16x32_bf16 v[164:167], v[64:67], v[52:55], v[164:167]
    v_mfma_f32_16x16x32_bf16 v[192:195], v[64:67], v[56:59], v[192:195]
    v_mfma_f32_16x16x32_bf16 v[196:199], v[64:67], v[60:63], v[196:199]
    ds_read_b64_tr_b16 v[64:65], v14 offset:24576
    ds_read_b64_tr_b16 v[66:67], v14 offset:25600
    v_mfma_f32_16x16x32_bf16 v[168:171], v[68:71], v[48:51], v[168:171]
    v_mfma_f32_16x16x32_bf16 v[172:175], v[68:71], v[52:55], v[172:175]
    v_mfma_f32_16x16x32_bf16 v[200:203], v[68:71], v[56:59], v[200:203]
    v_mfma_f32_16x16x32_bf16 v[204:207], v[68:71], v[60:63], v[204:207]
    ds_read_b64_tr_b16 v[68:69], v15 offset:24576
    ds_read_b64_tr_b16 v[70:71], v15 offset:25600
    s_waitcnt lgkmcnt(6)
    v_mfma_f32_16x16x32_bf16 v[80:83], v[40:43], v[24:27], v[80:83]
    ds_read_b128 v[48:51], v77 offset:10240
    s_and_b32 s35, s2, 7
    s_bfe_u32 s101, s2, 0x20003
    s_lshl2_add_u32 s35, s35, s101
    s_lshr_b32 s35, s35, 1
    s_lshl_b32 s35, s35, 5
    s_add_u32 s35, s35, 3072
    v_and_b32 v17, 7, v0
    v_lshlrev_b32 v17, 2, v17
    v_bfe_u32 v16, v0, 3, 1
    v_lshl_add_u32 v17, v16, 9, v17
    v_add_u32 v17, s35, v17
    buffer_load_dword v16, v17, s[88:91], 0 offen sc1
    v_mfma_f32_16x16x32_bf16 v[84:87], v[40:43], v[28:31], v[84:87]
    ds_read_b128 v[52:55], v77 offset:10496
    v_mfma_f32_16x16x32_bf16 v[112:115], v[40:43], v[32:35], v[112:115]
    ds_read_b128 v[56:59], v77 offset:14336
    v_mfma_f32_16x16x32_bf16 v[116:119], v[40:43], v[36:39], v[116:119]
    ds_read_b128 v[60:63], v77 offset:14592
    s_waitcnt lgkmcnt(8)
    v_mfma_f32_16x16x32_bf16 v[88:91], v[44:47], v[24:27], v[88:91]
    v_mfma_f32_16x16x32_bf16 v[92:95], v[44:47], v[28:31], v[92:95]
    v_mfma_f32_16x16x32_bf16 v[120:123], v[44:47], v[32:35], v[120:123]
    v_mfma_f32_16x16x32_bf16 v[124:127], v[44:47], v[36:39], v[124:127]
    s_waitcnt lgkmcnt(6)
    v_mfma_f32_16x16x32_bf16 v[96:99], v[64:67], v[24:27], v[96:99]
    v_mfma_f32_16x16x32_bf16 v[100:103], v[64:67], v[28:31], v[100:103]
    v_mfma_f32_16x16x32_bf16 v[128:131], v[64:67], v[32:35], v[128:131]
    v_mfma_f32_16x16x32_bf16 v[132:135], v[64:67], v[36:39], v[132:135]
    s_waitcnt lgkmcnt(4)
    v_mfma_f32_16x16x32_bf16 v[104:107], v[68:71], v[24:27], v[104:107]
    v_mfma_f32_16x16x32_bf16 v[108:111], v[68:71], v[28:31], v[108:111]
    v_mfma_f32_16x16x32_bf16 v[136:139], v[68:71], v[32:35], v[136:139]
    v_mfma_f32_16x16x32_bf16 v[140:143], v[68:71], v[36:39], v[140:143]
    s_waitcnt lgkmcnt(0) vmcnt(1)
    s_barrier
    v_mfma_f32_16x16x32_bf16 v[144:147], v[40:43], v[48:51], v[144:147]
    ds_read_b128 v[24:27], v77 offset:32768
    v_mfma_f32_16x16x32_bf16 v[148:151], v[40:43], v[52:55], v[148:151]
    ds_read_b128 v[28:31], v77 offset:33024
    v_mfma_f32_16x16x32_bf16 v[176:179], v[40:43], v[56:59], v[176:179]
    ds_read_b128 v[32:35], v77 offset:36864
    v_mfma_f32_16x16x32_bf16 v[180:183], v[40:43], v[60:63], v[180:183]
    ds_read_b128 v[36:39], v77 offset:37120
    ds_read_b64_tr_b16 v[40:41], v14 offset:32768
    ds_read_b64_tr_b16 v[42:43], v14 offset:33792
    v_mfma_f32_16x16x32_bf16 v[152:155], v[44:47], v[48:51], v[152:155]
    v_mfma_f32_16x16x32_bf16 v[156:159], v[44:47], v[52:55], v[156:159]
    v_mfma_f32_16x16x32_bf16 v[184:187], v[44:47], v[56:59], v[184:187]
    v_mfma_f32_16x16x32_bf16 v[188:191], v[44:47], v[60:63], v[188:191]
    ds_read_b64_tr_b16 v[44:45], v15 offset:32768
    ds_read_b64_tr_b16 v[46:47], v15 offset:33792
    v_mfma_f32_16x16x32_bf16 v[160:163], v[64:67], v[48:51], v[160:163]
    v_mfma_f32_16x16x32_bf16 v[164:167], v[64:67], v[52:55], v[164:167]
    v_mfma_f32_16x16x32_bf16 v[192:195], v[64:67], v[56:59], v[192:195]
    v_mfma_f32_16x16x32_bf16 v[196:199], v[64:67], v[60:63], v[196:199]
    ds_read_b64_tr_b16 v[64:65], v14 offset:49152
    ds_read_b64_tr_b16 v[66:67], v14 offset:50176
    v_mfma_f32_16x16x32_bf16 v[168:171], v[68:71], v[48:51], v[168:171]
    v_mfma_f32_16x16x32_bf16 v[172:175], v[68:71], v[52:55], v[172:175]
    v_mfma_f32_16x16x32_bf16 v[200:203], v[68:71], v[56:59], v[200:203]
    v_mfma_f32_16x16x32_bf16 v[204:207], v[68:71], v[60:63], v[204:207]
    ds_read_b64_tr_b16 v[68:69], v15 offset:49152
    ds_read_b64_tr_b16 v[70:71], v15 offset:50176
    s_waitcnt lgkmcnt(6)
    v_mfma_f32_16x16x32_bf16 v[80:83], v[40:43], v[24:27], v[80:83]
    ds_read_b128 v[48:51], v77 offset:40960
    v_mfma_f32_16x16x32_bf16 v[84:87], v[40:43], v[28:31], v[84:87]
    ds_read_b128 v[52:55], v77 offset:41216
    v_mfma_f32_16x16x32_bf16 v[112:115], v[40:43], v[32:35], v[112:115]
    ds_read_b128 v[56:59], v77 offset:45056
    v_mfma_f32_16x16x32_bf16 v[116:119], v[40:43], v[36:39], v[116:119]
    ds_read_b128 v[60:63], v77 offset:45312
    s_waitcnt lgkmcnt(8)
    v_mfma_f32_16x16x32_bf16 v[88:91], v[44:47], v[24:27], v[88:91]
    v_mfma_f32_16x16x32_bf16 v[92:95], v[44:47], v[28:31], v[92:95]
    v_mfma_f32_16x16x32_bf16 v[120:123], v[44:47], v[32:35], v[120:123]
    v_mfma_f32_16x16x32_bf16 v[124:127], v[44:47], v[36:39], v[124:127]
    s_waitcnt lgkmcnt(6)
    v_mfma_f32_16x16x32_bf16 v[96:99], v[64:67], v[24:27], v[96:99]
    v_mfma_f32_16x16x32_bf16 v[100:103], v[64:67], v[28:31], v[100:103]
    v_mfma_f32_16x16x32_bf16 v[128:131], v[64:67], v[32:35], v[128:131]
    v_mfma_f32_16x16x32_bf16 v[132:135], v[64:67], v[36:39], v[132:135]
    s_waitcnt lgkmcnt(4)
    v_mfma_f32_16x16x32_bf16 v[104:107], v[68:71], v[24:27], v[104:107]
    v_mfma_f32_16x16x32_bf16 v[108:111], v[68:71], v[28:31], v[108:111]
    v_mfma_f32_16x16x32_bf16 v[136:139], v[68:71], v[32:35], v[136:139]
    v_mfma_f32_16x16x32_bf16 v[140:143], v[68:71], v[36:39], v[140:143]
    s_waitcnt lgkmcnt(3)
    v_mfma_f32_16x16x32_bf16 v[144:147], v[40:43], v[48:51], v[144:147]
    ds_read_b128 v[24:27], v77 offset:34816
    s_waitcnt lgkmcnt(3)
    v_mfma_f32_16x16x32_bf16 v[148:151], v[40:43], v[52:55], v[148:151]
    ds_read_b128 v[28:31], v77 offset:35072
    s_waitcnt lgkmcnt(3)
    v_mfma_f32_16x16x32_bf16 v[176:179], v[40:43], v[56:59], v[176:179]
    ds_read_b128 v[32:35], v77 offset:38912
    s_waitcnt lgkmcnt(3)
    v_mfma_f32_16x16x32_bf16 v[180:183], v[40:43], v[60:63], v[180:183]
    ds_read_b128 v[36:39], v77 offset:39168
    ds_read_b64_tr_b16 v[40:41], v14 offset:40960
    ds_read_b64_tr_b16 v[42:43], v14 offset:41984
    v_mfma_f32_16x16x32_bf16 v[152:155], v[44:47], v[48:51], v[152:155]
    v_mfma_f32_16x16x32_bf16 v[156:159], v[44:47], v[52:55], v[156:159]
    v_mfma_f32_16x16x32_bf16 v[184:187], v[44:47], v[56:59], v[184:187]
    v_mfma_f32_16x16x32_bf16 v[188:191], v[44:47], v[60:63], v[188:191]
    ds_read_b64_tr_b16 v[44:45], v15 offset:40960
    ds_read_b64_tr_b16 v[46:47], v15 offset:41984
    v_mfma_f32_16x16x32_bf16 v[160:163], v[64:67], v[48:51], v[160:163]
    v_mfma_f32_16x16x32_bf16 v[164:167], v[64:67], v[52:55], v[164:167]
    v_mfma_f32_16x16x32_bf16 v[192:195], v[64:67], v[56:59], v[192:195]
    v_mfma_f32_16x16x32_bf16 v[196:199], v[64:67], v[60:63], v[196:199]
    ds_read_b64_tr_b16 v[64:65], v14 offset:57344
    ds_read_b64_tr_b16 v[66:67], v14 offset:58368
    v_mfma_f32_16x16x32_bf16 v[168:171], v[68:71], v[48:51], v[168:171]
    v_mfma_f32_16x16x32_bf16 v[172:175], v[68:71], v[52:55], v[172:175]
    v_mfma_f32_16x16x32_bf16 v[200:203], v[68:71], v[56:59], v[200:203]
    v_mfma_f32_16x16x32_bf16 v[204:207], v[68:71], v[60:63], v[204:207]
    ds_read_b64_tr_b16 v[68:69], v15 offset:57344
    ds_read_b64_tr_b16 v[70:71], v15 offset:58368
    s_waitcnt lgkmcnt(6)
    v_mfma_f32_16x16x32_bf16 v[80:83], v[40:43], v[24:27], v[80:83]
    ds_read_b128 v[48:51], v77 offset:43008
    v_mfma_f32_16x16x32_bf16 v[84:87], v[40:43], v[28:31], v[84:87]
    ds_read_b128 v[52:55], v77 offset:43264
    v_mfma_f32_16x16x32_bf16 v[112:115], v[40:43], v[32:35], v[112:115]
    ds_read_b128 v[56:59], v77 offset:47104
    v_mfma_f32_16x16x32_bf16 v[116:119], v[40:43], v[36:39], v[116:119]
    ds_read_b128 v[60:63], v77 offset:47360
    s_waitcnt lgkmcnt(8)
    v_mfma_f32_16x16x32_bf16 v[88:91], v[44:47], v[24:27], v[88:91]
    v_mfma_f32_16x16x32_bf16 v[92:95], v[44:47], v[28:31], v[92:95]
    v_mfma_f32_16x16x32_bf16 v[120:123], v[44:47], v[32:35], v[120:123]
    v_mfma_f32_16x16x32_bf16 v[124:127], v[44:47], v[36:39], v[124:127]
    s_waitcnt lgkmcnt(6)
    v_mfma_f32_16x16x32_bf16 v[96:99], v[64:67], v[24:27], v[96:99]
    v_mfma_f32_16x16x32_bf16 v[100:103], v[64:67], v[28:31], v[100:103]
    v_mfma_f32_16x16x32_bf16 v[128:131], v[64:67], v[32:35], v[128:131]
    v_mfma_f32_16x16x32_bf16 v[132:135], v[64:67], v[36:39], v[132:135]
    s_waitcnt lgkmcnt(4)
    v_mfma_f32_16x16x32_bf16 v[104:107], v[68:71], v[24:27], v[104:107]
    v_mfma_f32_16x16x32_bf16 v[108:111], v[68:71], v[28:31], v[108:111]
    v_mfma_f32_16x16x32_bf16 v[136:139], v[68:71], v[32:35], v[136:139]
    v_mfma_f32_16x16x32_bf16 v[140:143], v[68:71], v[36:39], v[140:143]
    s_waitcnt lgkmcnt(3)
    v_mfma_f32_16x16x32_bf16 v[144:147], v[40:43], v[48:51], v[144:147]
    s_waitcnt lgkmcnt(2)
    v_mfma_f32_16x16x32_bf16 v[148:151], v[40:43], v[52:55], v[148:151]
    s_waitcnt lgkmcnt(1)
    v_mfma_f32_16x16x32_bf16 v[176:179], v[40:43], v[56:59], v[176:179]
    s_waitcnt lgkmcnt(0)
    v_mfma_f32_16x16x32_bf16 v[180:183], v[40:43], v[60:63], v[180:183]
    v_mfma_f32_16x16x32_bf16 v[152:155], v[44:47], v[48:51], v[152:155]
    v_mfma_f32_16x16x32_bf16 v[156:159], v[44:47], v[52:55], v[156:159]
    v_mfma_f32_16x16x32_bf16 v[184:187], v[44:47], v[56:59], v[184:187]
    v_mfma_f32_16x16x32_bf16 v[188:191], v[44:47], v[60:63], v[188:191]
    v_mfma_f32_16x16x32_bf16 v[160:163], v[64:67], v[48:51], v[160:163]
    v_mfma_f32_16x16x32_bf16 v[164:167], v[64:67], v[52:55], v[164:167]
    v_mfma_f32_16x16x32_bf16 v[192:195], v[64:67], v[56:59], v[192:195]
    v_mfma_f32_16x16x32_bf16 v[196:199], v[64:67], v[60:63], v[196:199]
    v_mfma_f32_16x16x32_bf16 v[168:171], v[68:71], v[48:51], v[168:171]
    v_mfma_f32_16x16x32_bf16 v[172:175], v[68:71], v[52:55], v[172:175]
    v_mfma_f32_16x16x32_bf16 v[200:203], v[68:71], v[56:59], v[200:203]
    v_mfma_f32_16x16x32_bf16 v[204:207], v[68:71], v[60:63], v[204:207]
    s_branch L_pj_epi
L_pj_roleP:
    s_barrier
    s_cmp_eq_u32 s96, 0
    s_cbranch_scc0 L_pj_VP
    ds_read_b64_tr_b16 v[40:41], v12 offset:0
    ds_read_b64_tr_b16 v[42:43], v12 offset:2048
    ds_read_b128 v[24:27], v10 offset:0
    ds_read_b128 v[28:31], v10 offset:2048
    ds_read_b128 v[32:35], v10 offset:4096
    ds_read_b128 v[36:39], v10 offset:6144
    ds_read_b64_tr_b16 v[44:45], v13 offset:0
    ds_read_b64_tr_b16 v[46:47], v13 offset:2048
    ds_read_b64_tr_b16 v[64:65], v14 offset:0
    ds_read_b64_tr_b16 v[66:67], v14 offset:2048
    ds_read_b64_tr_b16 v[68:69], v15 offset:0
    ds_read_b64_tr_b16 v[70:71], v15 offset:2048
    s_waitcnt lgkmcnt(9)
    v_mfma_f32_16x16x32_bf16 v[80:83], v[40:43], v[24:27], 0
    ds_read_b128 v[48:51], v10 offset:8192
    s_waitcnt vmcnt(3)
    v_lshlrev_b32 v208, 16, v248
    s_waitcnt lgkmcnt(9)
    v_mfma_f32_16x16x32_bf16 v[84:87], v[40:43], v[28:31], 0
    ds_read_b128 v[52:55], v10 offset:10240
    v_and_b32 v209, 0xffff0000, v248
    v_lshlrev_b32 v210, 16, v249
    s_waitcnt lgkmcnt(9)
    v_mfma_f32_16x16x32_bf16 v[112:115], v[40:43], v[32:35], 0
    ds_read_b128 v[56:59], v10 offset:12288
    v_and_b32 v211, 0xffff0000, v249
    v_lshlrev_b32 v212, 16, v250
    s_waitcnt lgkmcnt(9)
    v_mfma_f32_16x16x32_bf16 v[116:119], v[40:43], v[36:39], 0
    ds_read_b128 v[60:63], v10 offset:14336
    v_and_b32 v213, 0xffff0000, v250
    v_lshlrev_b32 v214, 16, v251
    s_waitcnt lgkmcnt(8)
    v_mfma_f32_16x16x32_bf16 v[88:91], v[44:47], v[24:27], 0
    v_and_b32 v215, 0xffff0000, v251
    v_lshlrev_b32 v216, 16, v252
    v_mfma_f32_16x16x32_bf16 v[92:95], v[44:47], v[28:31], 0
    v_and_b32 v217, 0xffff0000, v252
    v_mfma_f32_16x16x32_bf16 v[120:123], v[44:47], v[32:35], 0
    v_lshlrev_b32 v218, 16, v253
    v_and_b32 v219, 0xffff0000, v253
    v_mfma_f32_16x16x32_bf16 v[124:127], v[44:47], v[36:39], 0
    v_lshlrev_b32 v220, 16, v254
    v_and_b32 v221, 0xffff0000, v254
    s_waitcnt lgkmcnt(6)
    v_mfma_f32_16x16x32_bf16 v[96:99], v[64:67], v[24:27], 0
    v_lshlrev_b32 v222, 16, v255
    v_and_b32 v223, 0xffff0000, v255
    v_mfma_f32_16x16x32_bf16 v[100:103], v[64:67], v[28:31], 0
    v_add_f32 v224, v208, v209
    v_add_f32 v226, v210, v211
    v_mfma_f32_16x16x32_bf16 v[128:131], v[64:67], v[32:35], 0
    v_add_f32 v224, v224, v212
    v_mfma_f32_16x16x32_bf16 v[132:135], v[64:67], v[36:39], 0
    v_add_f32 v226, v226, v213
    v_add_f32 v224, v224, v214
    s_waitcnt lgkmcnt(4)
    v_mfma_f32_16x16x32_bf16 v[104:107], v[68:71], v[24:27], 0
    v_add_f32 v226, v226, v215
    v_add_f32 v224, v224, v216
    v_mfma_f32_16x16x32_bf16 v[108:111], v[68:71], v[28:31], 0
    v_add_f32 v226, v226, v217
    v_add_f32 v224, v224, v218
    v_mfma_f32_16x16x32_bf16 v[136:139], v[68:71], v[32:35], 0
    v_add_f32 v226, v226, v219
    v_add_f32 v224, v224, v220
    v_mfma_f32_16x16x32_bf16 v[140:143], v[68:71], v[36:39], 0
    v_add_f32 v226, v226, v221
    s_waitcnt lgkmcnt(3)
    v_mfma_f32_16x16x32_bf16 v[144:147], v[40:43], v[48:51], 0
    ds_read_b128 v[24:27], v11 offset:0
    v_add_f32 v224, v224, v222
    v_add_f32 v226, v226, v223
    s_waitcnt lgkmcnt(3)
    v_mfma_f32_16x16x32_bf16 v[148:151], v[40:43], v[52:55], 0
    ds_read_b128 v[28:31], v11 offset:2048
    v_add_f32 v224, v224, v226
    s_nop 1
    s_waitcnt lgkmcnt(3)
    v_mfma_f32_16x16x32_bf16 v[176:179], v[40:43], v[56:59], 0
    ds_read_b128 v[32:35], v11 offset:4096
    v_add_f32_dpp v224, v224, v224 quad_perm:[1,0,3,2] row_mask:0xf bank_mask:0xf
    s_nop 1
    s_waitcnt lgkmcnt(3)
    v_mfma_f32_16x16x32_bf16 v[180:183], v[40:43], v[60:63], 0
    ds_read_b128 v[36:39], v11 offset:6144
    ds_read_b64_tr_b16 v[40:41], v12 offset:16384
    ds_read_b64_tr_b16 v[42:43], v12 offset:18432
    v_add_f32_dpp v224, v224, v224 quad_perm:[2,3,0,1] row_mask:0xf bank_mask:0xf
    s_nop 1
    v_mfma_f32_16x16x32_bf16 v[152:155], v[44:47], v[48:51], 0
    v_add_f32_dpp v224, v224, v224 row_half_mirror row_mask:0xf bank_mask:0xf
    s_nop 1
    v_mfma_f32_16x16x32_bf16 v[156:159], v[44:47], v[52:55], 0
    v_add_f32_dpp v224, v224, v224 row_mirror row_mask:0xf bank_mask:0xf
    v_mov_b32 v226, v224
    v_mfma_f32_16x16x32_bf16 v[184:187], v[44:47], v[56:59], 0
    s_nop 1
    v_permlane16_swap_b32 v226, v224
    v_mfma_f32_16x16x32_bf16 v[188:191], v[44:47], v[60:63], 0
    ds_read_b64_tr_b16 v[44:45], v13 offset:16384
    ds_read_b64_tr_b16 v[46:47], v13 offset:18432
    v_add_f32 v224, v224, v226
    v_mov_b32 v226, v224
    v_mfma_f32_16x16x32_bf16 v[160:163], v[64:67], v[48:51], 0
    s_nop 1
    v_permlane32_swap_b32 v226, v224
    v_mfma_f32_16x16x32_bf16 v[164:167], v[64:67], v[52:55], 0
    v_add_f32 v224, v224, v226
    v_mul_f32 v224, 0x3a800000, v224
    v_mfma_f32_16x16x32_bf16 v[192:195], v[64:67], v[56:59], 0
    v_sub_f32 v227, v208, v224
    v_mul_f32 v225, v227, v227
    v_mfma_f32_16x16x32_bf16 v[196:199], v[64:67], v[60:63], 0
    ds_read_b64_tr_b16 v[64:65], v14 offset:16384
    ds_read_b64_tr_b16 v[66:67], v14 offset:18432
    v_sub_f32 v227, v209, v224
    v_fmac_f32 v225, v227, v227
    v_mfma_f32_16x16x32_bf16 v[168:171], v[68:71], v[48:51], 0
    v_sub_f32 v227, v210, v224
    v_fmac_f32 v225, v227, v227
    v_mfma_f32_16x16x32_bf16 v[172:175], v[68:71], v[52:55], 0
    v_sub_f32 v227, v211, v224
    v_fmac_f32 v225, v227, v227
    v_mfma_f32_16x16x32_bf16 v[200:203], v[68:71], v[56:59], 0
    v_sub_f32 v227, v212, v224
    s_add_u32 s84, s44, 0
    s_addc_u32 s85, s45, 0
    s_mov_b32 s86, 4194304
    s_mov_b32 s87, 0x00020000
    s_mov_b32 s92, 2097152
    buffer_load_dword v22, v23, s[84:87], s92 offen
    v_mfma_f32_16x16x32_bf16 v[204:207], v[68:71], v[60:63], 0
    ds_read_b64_tr_b16 v[68:69], v15 offset:16384
    ds_read_b64_tr_b16 v[70:71], v15 offset:18432
    s_add_u32 s84, s46, 0
    s_addc_u32 s85, s47, 0
    s_mov_b32 s86, 4194304
    s_mov_b32 s87, 0x00020000
    s_mov_b32 s92, 2097152
    buffer_load_dword v22, v23, s[84:87], s92 offen
    s_waitcnt lgkmcnt(6)
    v_mfma_f32_16x16x32_bf16 v[80:83], v[40:43], v[24:27], v[80:83]
    ds_read_b128 v[48:51], v11 offset:8192
    v_fmac_f32 v225, v227, v227
    v_sub_f32 v227, v213, v224
    v_mfma_f32_16x16x32_bf16 v[84:87], v[40:43], v[28:31], v[84:87]
    ds_read_b128 v[52:55], v11 offset:10240
    v_fmac_f32 v225, v227, v227
    v_sub_f32 v227, v214, v224
    v_mfma_f32_16x16x32_bf16 v[112:115], v[40:43], v[32:35], v[112:115]
    ds_read_b128 v[56:59], v11 offset:12288
    v_fmac_f32 v225, v227, v227
    v_sub_f32 v227, v215, v224
    v_mfma_f32_16x16x32_bf16 v[116:119], v[40:43], v[36:39], v[116:119]
    ds_read_b128 v[60:63], v11 offset:14336
    v_fmac_f32 v225, v227, v227
    v_sub_f32 v227, v216, v224
    s_waitcnt lgkmcnt(8)
    v_mfma_f32_16x16x32_bf16 v[88:91], v[44:47], v[24:27], v[88:91]
    v_fmac_f32 v225, v227, v227
    v_sub_f32 v227, v217, v224
    v_mfma_f32_16x16x32_bf16 v[92:95], v[44:47], v[28:31], v[92:95]
    v_fmac_f32 v225, v227, v227
    v_mfma_f32_16x16x32_bf16 v[120:123], v[44:47], v[32:35], v[120:123]
    v_sub_f32 v227, v218, v224
    v_fmac_f32 v225, v227, v227
    v_mfma_f32_16x16x32_bf16 v[124:127], v[44:47], v[36:39], v[124:127]
    v_sub_f32 v227, v219, v224
    v_fmac_f32 v225, v227, v227
    s_waitcnt lgkmcnt(6)
    v_mfma_f32_16x16x32_bf16 v[96:99], v[64:67], v[24:27], v[96:99]
    v_sub_f32 v227, v220, v224
    v_fmac_f32 v225, v227, v227
    v_mfma_f32_16x16x32_bf16 v[100:103], v[64:67], v[28:31], v[100:103]
    v_sub_f32 v227, v221, v224
    v_fmac_f32 v225, v227, v227
    v_mfma_f32_16x16x32_bf16 v[128:131], v[64:67], v[32:35], v[128:131]
    v_sub_f32 v227, v222, v224
    v_mfma_f32_16x16x32_bf16 v[132:135], v[64:67], v[36:39], v[132:135]
    v_fmac_f32 v225, v227, v227
    v_sub_f32 v227, v223, v224
    s_waitcnt lgkmcnt(4)
    v_mfma_f32_16x16x32_bf16 v[104:107], v[68:71], v[24:27], v[104:107]
    v_fmac_f32 v225, v227, v227
    s_nop 1
    v_mfma_f32_16x16x32_bf16 v[108:111], v[68:71], v[28:31], v[108:111]
    v_add_f32_dpp v225, v225, v225 quad_perm:[1,0,3,2] row_mask:0xf bank_mask:0xf
    s_nop 1
    v_mfma_f32_16x16x32_bf16 v[136:139], v[68:71], v[32:35], v[136:139]
    v_add_f32_dpp v225, v225, v225 quad_perm:[2,3,0,1] row_mask:0xf bank_mask:0xf
    s_nop 1
    v_mfma_f32_16x16x32_bf16 v[140:143], v[68:71], v[36:39], v[140:143]
    v_add_f32_dpp v225, v225, v225 row_half_mirror row_mask:0xf bank_mask:0xf
    s_waitcnt lgkmcnt(0)
    s_barrier
    v_mfma_f32_16x16x32_bf16 v[144:147], v[40:43], v[48:51], v[144:147]
    ds_read_b128 v[24:27], v10 offset:32768
    v_mfma_f32_16x16x32_bf16 v[148:151], v[40:43], v[52:55], v[148:151]
    ds_read_b128 v[28:31], v10 offset:34816
    v_mfma_f32_16x16x32_bf16 v[176:179], v[40:43], v[56:59], v[176:179]
    ds_read_b128 v[32:35], v10 offset:36864
    v_mfma_f32_16x16x32_bf16 v[180:183], v[40:43], v[60:63], v[180:183]
    ds_read_b128 v[36:39], v10 offset:38912
    ds_read_b64_tr_b16 v[40:41], v12 offset:32768
    ds_read_b64_tr_b16 v[42:43], v12 offset:34816
    v_mfma_f32_16x16x32_bf16 v[152:155], v[44:47], v[48:51], v[152:155]
    v_mfma_f32_16x16x32_bf16 v[156:159], v[44:47], v[52:55], v[156:159]
    v_mfma_f32_16x16x32_bf16 v[184:187], v[44:47], v[56:59], v[184:187]
    v_mfma_f32_16x16x32_bf16 v[188:191], v[44:47], v[60:63], v[188:191]
    ds_read_b64_tr_b16 v[44:45], v13 offset:32768
    ds_read_b64_tr_b16 v[46:47], v13 offset:34816
    v_mfma_f32_16x16x32_bf16 v[160:163], v[64:67], v[48:51], v[160:163]
    v_mfma_f32_16x16x32_bf16 v[164:167], v[64:67], v[52:55], v[164:167]
    v_mfma_f32_16x16x32_bf16 v[192:195], v[64:67], v[56:59], v[192:195]
    v_mfma_f32_16x16x32_bf16 v[196:199], v[64:67], v[60:63], v[196:199]
    ds_read_b64_tr_b16 v[64:65], v14 offset:32768
    ds_read_b64_tr_b16 v[66:67], v14 offset:34816
    v_mfma_f32_16x16x32_bf16 v[168:171], v[68:71], v[48:51], v[168:171]
    v_mfma_f32_16x16x32_bf16 v[172:175], v[68:71], v[52:55], v[172:175]
    v_mfma_f32_16x16x32_bf16 v[200:203], v[68:71], v[56:59], v[200:203]
    v_mfma_f32_16x16x32_bf16 v[204:207], v[68:71], v[60:63], v[204:207]
    ds_read_b64_tr_b16 v[68:69], v15 offset:32768
    ds_read_b64_tr_b16 v[70:71], v15 offset:34816
    s_waitcnt lgkmcnt(6)
    v_mfma_f32_16x16x32_bf16 v[80:83], v[40:43], v[24:27], v[80:83]
    ds_read_b128 v[48:51], v10 offset:40960
    s_nop 1
    v_add_f32_dpp v225, v225, v225 row_mirror row_mask:0xf bank_mask:0xf
    v_mfma_f32_16x16x32_bf16 v[84:87], v[40:43], v[28:31], v[84:87]
    ds_read_b128 v[52:55], v10 offset:43008
    v_mov_b32 v226, v225
    s_nop 1
    v_mfma_f32_16x16x32_bf16 v[112:115], v[40:43], v[32:35], v[112:115]
    ds_read_b128 v[56:59], v10 offset:45056
    v_permlane16_swap_b32 v226, v225
    v_add_f32 v225, v225, v226
    v_mfma_f32_16x16x32_bf16 v[116:119], v[40:43], v[36:39], v[116:119]
    ds_read_b128 v[60:63], v10 offset:47104
    v_mov_b32 v226, v225
    s_nop 1
    s_waitcnt lgkmcnt(8)
    v_mfma_f32_16x16x32_bf16 v[88:91], v[44:47], v[24:27], v[88:91]
    v_permlane32_swap_b32 v226, v225
    v_add_f32 v225, v225, v226
    v_mfma_f32_16x16x32_bf16 v[92:95], v[44:47], v[28:31], v[92:95]
    v_mul_f32 v225, 0x3a800000, v225
    v_mfma_f32_16x16x32_bf16 v[120:123], v[44:47], v[32:35], v[120:123]
    v_cvt_pk_bf16_f32 v224, v224, v224
    v_lshlrev_b32 v224, 16, v224
    v_mfma_f32_16x16x32_bf16 v[124:127], v[44:47], v[36:39], v[124:127]
    v_cvt_pk_bf16_f32 v225, v225, v225
    v_lshlrev_b32 v225, 16, v225
    s_waitcnt lgkmcnt(6)
    v_mfma_f32_16x16x32_bf16 v[96:99], v[64:67], v[24:27], v[96:99]
    v_add_f32 v225, 0x3727c5ac, v225
    v_cvt_pk_bf16_f32 v225, v225, v225
    v_mfma_f32_16x16x32_bf16 v[100:103], v[64:67], v[28:31], v[100:103]
    v_lshlrev_b32 v225, 16, v225
    v_sqrt_f32 v225, v225
    v_mfma_f32_16x16x32_bf16 v[128:131], v[64:67], v[32:35], v[128:131]
    s_nop 0
    v_mfma_f32_16x16x32_bf16 v[132:135], v[64:67], v[36:39], v[132:135]
    v_cvt_pk_bf16_f32 v225, v225, v225
    v_lshlrev_b32 v225, 16, v225
    s_waitcnt lgkmcnt(4)
    v_mfma_f32_16x16x32_bf16 v[104:107], v[68:71], v[24:27], v[104:107]
    v_rcp_f32 v225, v225
    v_sub_f32 v208, v208, v224
    v_mfma_f32_16x16x32_bf16 v[108:111], v[68:71], v[28:31], v[108:111]
    v_sub_f32 v209, v209, v224
    v_sub_f32 v210, v210, v224
    v_mfma_f32_16x16x32_bf16 v[136:139], v[68:71], v[32:35], v[136:139]
    v_sub_f32 v211, v211, v224
    v_sub_f32 v212, v212, v224
    v_mfma_f32_16x16x32_bf16 v[140:143], v[68:71], v[36:39], v[140:143]
    v_sub_f32 v213, v213, v224
    s_waitcnt lgkmcnt(3)
    v_mfma_f32_16x16x32_bf16 v[144:147], v[40:43], v[48:51], v[144:147]
    ds_read_b128 v[24:27], v11 offset:32768
    v_sub_f32 v214, v214, v224
    v_sub_f32 v215, v215, v224
    s_waitcnt lgkmcnt(3)
    v_mfma_f32_16x16x32_bf16 v[148:151], v[40:43], v[52:55], v[148:151]
    ds_read_b128 v[28:31], v11 offset:34816
    v_sub_f32 v216, v216, v224
    v_sub_f32 v217, v217, v224
    s_waitcnt lgkmcnt(3)
    v_mfma_f32_16x16x32_bf16 v[176:179], v[40:43], v[56:59], v[176:179]
    ds_read_b128 v[32:35], v11 offset:36864
    v_sub_f32 v218, v218, v224
    v_sub_f32 v219, v219, v224
    s_waitcnt lgkmcnt(3)
    v_mfma_f32_16x16x32_bf16 v[180:183], v[40:43], v[60:63], v[180:183]
    ds_read_b128 v[36:39], v11 offset:38912
    ds_read_b64_tr_b16 v[40:41], v12 offset:49152
    ds_read_b64_tr_b16 v[42:43], v12 offset:51200
    v_sub_f32 v220, v220, v224
    v_sub_f32 v221, v221, v224
    v_mfma_f32_16x16x32_bf16 v[152:155], v[44:47], v[48:51], v[152:155]
    v_sub_f32 v222, v222, v224
    v_sub_f32 v223, v223, v224
    v_mfma_f32_16x16x32_bf16 v[156:159], v[44:47], v[52:55], v[156:159]
    v_cvt_pk_bf16_f32 v248, v208, v209
    v_cvt_pk_bf16_f32 v249, v210, v211
    v_mfma_f32_16x16x32_bf16 v[184:187], v[44:47], v[56:59], v[184:187]
    v_cvt_pk_bf16_f32 v250, v212, v213
    v_cvt_pk_bf16_f32 v251, v214, v215
    v_mfma_f32_16x16x32_bf16 v[188:191], v[44:47], v[60:63], v[188:191]
    ds_read_b64_tr_b16 v[44:45], v13 offset:49152
    ds_read_b64_tr_b16 v[46:47], v13 offset:51200
    v_cvt_pk_bf16_f32 v252, v216, v217
    v_cvt_pk_bf16_f32 v253, v218, v219
    v_mfma_f32_16x16x32_bf16 v[160:163], v[64:67], v[48:51], v[160:163]
    v_cvt_pk_bf16_f32 v254, v220, v221
    v_cvt_pk_bf16_f32 v255, v222, v223
    v_mfma_f32_16x16x32_bf16 v[164:167], v[64:67], v[52:55], v[164:167]
    v_lshlrev_b32 v208, 16, v248
    v_and_b32 v209, 0xffff0000, v248
    v_mfma_f32_16x16x32_bf16 v[192:195], v[64:67], v[56:59], v[192:195]
    v_lshlrev_b32 v210, 16, v249
    v_and_b32 v211, 0xffff0000, v249
    v_mfma_f32_16x16x32_bf16 v[196:199], v[64:67], v[60:63], v[196:199]
    ds_read_b64_tr_b16 v[64:65], v14 offset:49152
    ds_read_b64_tr_b16 v[66:67], v14 offset:51200
    v_lshlrev_b32 v212, 16, v250
    v_and_b32 v213, 0xffff0000, v250
    v_mfma_f32_16x16x32_bf16 v[168:171], v[68:71], v[48:51], v[168:171]
    v_lshlrev_b32 v214, 16, v251
    v_and_b32 v215, 0xffff0000, v251
    v_mfma_f32_16x16x32_bf16 v[172:175], v[68:71], v[52:55], v[172:175]
    v_lshlrev_b32 v216, 16, v252
    v_and_b32 v217, 0xffff0000, v252
    v_mfma_f32_16x16x32_bf16 v[200:203], v[68:71], v[56:59], v[200:203]
    v_lshlrev_b32 v218, 16, v253
    s_add_u32 s84, s44, 0
    s_addc_u32 s85, s45, 0
    s_mov_b32 s86, 4194304
    s_mov_b32 s87, 0x00020000
    s_mov_b32 s92, 3145728
    buffer_load_dword v22, v23, s[84:87], s92 offen
    v_mfma_f32_16x16x32_bf16 v[204:207], v[68:71], v[60:63], v[204:207]
    ds_read_b64_tr_b16 v[68:69], v15 offset:49152
    ds_read_b64_tr_b16 v[70:71], v15 offset:51200
    s_add_u32 s84, s46, 0
    s_addc_u32 s85, s47, 0
    s_mov_b32 s86, 4194304
    s_mov_b32 s87, 0x00020000
    s_mov_b32 s92, 3145728
    buffer_load_dword v22, v23, s[84:87], s92 offen
    s_waitcnt lgkmcnt(6)
    v_mfma_f32_16x16x32_bf16 v[80:83], v[40:43], v[24:27], v[80:83]
    ds_read_b128 v[48:51], v11 offset:40960
    v_and_b32 v219, 0xffff0000, v253
    v_lshlrev_b32 v220, 16, v254
    v_mfma_f32_16x16x32_bf16 v[84:87], v[40:43], v[28:31], v[84:87]
    ds_read_b128 v[52:55], v11 offset:43008
    v_and_b32 v221, 0xffff0000, v254
    v_lshlrev_b32 v222, 16, v255
    v_mfma_f32_16x16x32_bf16 v[112:115], v[40:43], v[32:35], v[112:115]
    ds_read_b128 v[56:59], v11 offset:45056
    v_and_b32 v223, 0xffff0000, v255
    v_mul_f32 v208, v208, v225
    v_mfma_f32_16x16x32_bf16 v[116:119], v[40:43], v[36:39], v[116:119]
    ds_read_b128 v[60:63], v11 offset:47104
    v_mul_f32 v209, v209, v225
    v_mul_f32 v210, v210, v225
    s_waitcnt lgkmcnt(8)
    v_mfma_f32_16x16x32_bf16 v[88:91], v[44:47], v[24:27], v[88:91]
    v_mul_f32 v211, v211, v225
    v_mul_f32 v212, v212, v225
    v_mfma_f32_16x16x32_bf16 v[92:95], v[44:47], v[28:31], v[92:95]
    v_mul_f32 v213, v213, v225
    v_mul_f32 v214, v214, v225
    v_mfma_f32_16x16x32_bf16 v[120:123], v[44:47], v[32:35], v[120:123]
    v_mul_f32 v215, v215, v225
    v_mul_f32 v216, v216, v225
    v_mfma_f32_16x16x32_bf16 v[124:127], v[44:47], v[36:39], v[124:127]
    v_mul_f32 v217, v217, v225
    s_waitcnt lgkmcnt(6)
    v_mfma_f32_16x16x32_bf16 v[96:99], v[64:67], v[24:27], v[96:99]
    v_mul_f32 v218, v218, v225
    v_mul_f32 v219, v219, v225
    v_mfma_f32_16x16x32_bf16 v[100:103], v[64:67], v[28:31], v[100:103]
    v_mul_f32 v220, v220, v225
    v_mul_f32 v221, v221, v225
    v_mfma_f32_16x16x32_bf16 v[128:131], v[64:67], v[32:35], v[128:131]
    v_mul_f32 v222, v222, v225
    v_mul_f32 v223, v223, v225
    v_mfma_f32_16x16x32_bf16 v[132:135], v[64:67], v[36:39], v[132:135]
    v_cvt_pk_bf16_f32 v248, v208, v209
    v_cvt_pk_bf16_f32 v249, v210, v211
    s_waitcnt lgkmcnt(4)
    v_mfma_f32_16x16x32_bf16 v[104:107], v[68:71], v[24:27], v[104:107]
    v_cvt_pk_bf16_f32 v250, v212, v213
    v_cvt_pk_bf16_f32 v251, v214, v215
    v_mfma_f32_16x16x32_bf16 v[108:111], v[68:71], v[28:31], v[108:111]
    v_cvt_pk_bf16_f32 v252, v216, v217
    v_cvt_pk_bf16_f32 v253, v218, v219
    v_mfma_f32_16x16x32_bf16 v[136:139], v[68:71], v[32:35], v[136:139]
    v_cvt_pk_bf16_f32 v254, v220, v221
    v_cvt_pk_bf16_f32 v255, v222, v223
    v_mfma_f32_16x16x32_bf16 v[140:143], v[68:71], v[36:39], v[140:143]
    s_lshl_b32 s35, s19, 4
    s_add_u32 s35, s35, 131072
    v_lshl_add_u32 v228, v1, 4, s35
    ds_write_b128 v228, v[248:251]
    ds_write_b128 v228, v[252:255] offset:128
    s_waitcnt lgkmcnt(0)
    s_barrier
    v_mfma_f32_16x16x32_bf16 v[144:147], v[40:43], v[48:51], v[144:147]
    ds_read_b128 v[24:27], v10 offset:0
    v_mfma_f32_16x16x32_bf16 v[148:151], v[40:43], v[52:55], v[148:151]
    ds_read_b128 v[28:31], v10 offset:2048
    v_mfma_f32_16x16x32_bf16 v[176:179], v[40:43], v[56:59], v[176:179]
    ds_read_b128 v[32:35], v10 offset:4096
    v_mfma_f32_16x16x32_bf16 v[180:183], v[40:43], v[60:63], v[180:183]
    ds_read_b128 v[36:39], v10 offset:6144
    ds_read_b64_tr_b16 v[40:41], v12 offset:0
    ds_read_b64_tr_b16 v[42:43], v12 offset:2048
    v_mfma_f32_16x16x32_bf16 v[152:155], v[44:47], v[48:51], v[152:155]
    v_mfma_f32_16x16x32_bf16 v[156:159], v[44:47], v[52:55], v[156:159]
    v_mfma_f32_16x16x32_bf16 v[184:187], v[44:47], v[56:59], v[184:187]
    v_mfma_f32_16x16x32_bf16 v[188:191], v[44:47], v[60:63], v[188:191]
    ds_read_b64_tr_b16 v[44:45], v13 offset:0
    ds_read_b64_tr_b16 v[46:47], v13 offset:2048
    v_mfma_f32_16x16x32_bf16 v[160:163], v[64:67], v[48:51], v[160:163]
    v_mfma_f32_16x16x32_bf16 v[164:167], v[64:67], v[52:55], v[164:167]
    v_mfma_f32_16x16x32_bf16 v[192:195], v[64:67], v[56:59], v[192:195]
    v_mfma_f32_16x16x32_bf16 v[196:199], v[64:67], v[60:63], v[196:199]
    ds_read_b64_tr_b16 v[64:65], v14 offset:0
    ds_read_b64_tr_b16 v[66:67], v14 offset:2048
    v_mfma_f32_16x16x32_bf16 v[168:171], v[68:71], v[48:51], v[168:171]
    v_mfma_f32_16x16x32_bf16 v[172:175], v[68:71], v[52:55], v[172:175]
    v_mfma_f32_16x16x32_bf16 v[200:203], v[68:71], v[56:59], v[200:203]
    v_mfma_f32_16x16x32_bf16 v[204:207], v[68:71], v[60:63], v[204:207]
    ds_read_b64_tr_b16 v[68:69], v15 offset:0
    ds_read_b64_tr_b16 v[70:71], v15 offset:2048
    s_waitcnt lgkmcnt(6)
    v_mfma_f32_16x16x32_bf16 v[80:83], v[40:43], v[24:27], v[80:83]
    ds_read_b128 v[48:51], v10 offset:8192
    s_and_b32 s35, s19, 3
    s_lshl_b32 s35, s35, 12
    s_add_u32 s35, s35, 131072
    v_add_u32 v228, s35, v1
    ds_read_b128 v[208:211], v228 offset:0
    ds_read_b128 v[212:215], v228 offset:1024
    ds_read_b128 v[216:219], v228 offset:2048
    ds_read_b128 v[220:223], v228 offset:3072
    v_mfma_f32_16x16x32_bf16 v[84:87], v[40:43], v[28:31], v[84:87]
    ds_read_b128 v[52:55], v10 offset:10240
    v_mfma_f32_16x16x32_bf16 v[112:115], v[40:43], v[32:35], v[112:115]
    ds_read_b128 v[56:59], v10 offset:12288
    v_mfma_f32_16x16x32_bf16 v[116:119], v[40:43], v[36:39], v[116:119]
    ds_read_b128 v[60:63], v10 offset:14336
    s_waitcnt lgkmcnt(12)
    v_mfma_f32_16x16x32_bf16 v[88:91], v[44:47], v[24:27], v[88:91]
    v_mfma_f32_16x16x32_bf16 v[92:95], v[44:47], v[28:31], v[92:95]
    v_mfma_f32_16x16x32_bf16 v[120:123], v[44:47], v[32:35], v[120:123]
    v_mfma_f32_16x16x32_bf16 v[124:127], v[44:47], v[36:39], v[124:127]
    s_waitcnt lgkmcnt(10)
    v_mfma_f32_16x16x32_bf16 v[96:99], v[64:67], v[24:27], v[96:99]
    v_lshrrev_b32 v229, 8, v1
    v_lshlrev_b32 v229, 10, v229
    v_bfe_u32 v230, v1, 7, 1
    v_lshl_add_u32 v229, v230, 9, v229
    v_and_b32 v230, 0x70, v1
    v_add_u32 v229, v229, v230
    v_mfma_f32_16x16x32_bf16 v[100:103], v[64:67], v[28:31], v[100:103]
    v_mfma_f32_16x16x32_bf16 v[128:131], v[64:67], v[32:35], v[128:131]
    v_mfma_f32_16x16x32_bf16 v[132:135], v[64:67], v[36:39], v[132:135]
    s_waitcnt lgkmcnt(8)
    v_mfma_f32_16x16x32_bf16 v[104:107], v[68:71], v[24:27], v[104:107]
    v_mfma_f32_16x16x32_bf16 v[108:111], v[68:71], v[28:31], v[108:111]
    v_mfma_f32_16x16x32_bf16 v[136:139], v[68:71], v[32:35], v[136:139]
    v_mfma_f32_16x16x32_bf16 v[140:143], v[68:71], v[36:39], v[140:143]
    s_waitcnt lgkmcnt(7)
    v_mfma_f32_16x16x32_bf16 v[144:147], v[40:43], v[48:51], v[144:147]
    ds_read_b128 v[24:27], v11 offset:0
    s_lshr_b32 s35, s2, 2
    s_lshl_b32 s35, s35, 16
    s_and_b32 s101, s19, 3
    s_lshl_b32 s101, s101, 14
    s_add_u32 s35, s35, s101
    s_and_b32 s101, s2, 3
    s_lshl_b32 s101, s101, 7
    s_add_u32 s35, s35, s101
    s_waitcnt lgkmcnt(4)
    buffer_store_dwordx4 v[208:211], v229, s[80:83], s35 offen sc1
    s_add_u32 s35, s35, 4096
    buffer_store_dwordx4 v[212:215], v229, s[80:83], s35 offen sc1
    s_add_u32 s35, s35, 4096
    buffer_store_dwordx4 v[216:219], v229, s[80:83], s35 offen sc1
    s_add_u32 s35, s35, 4096
    buffer_store_dwordx4 v[220:223], v229, s[80:83], s35 offen sc1
    s_nop 1
    s_waitcnt lgkmcnt(3)
    v_mfma_f32_16x16x32_bf16 v[148:151], v[40:43], v[52:55], v[148:151]
    ds_read_b128 v[28:31], v11 offset:2048
    s_waitcnt lgkmcnt(3)
    v_mfma_f32_16x16x32_bf16 v[176:179], v[40:43], v[56:59], v[176:179]
    ds_read_b128 v[32:35], v11 offset:4096
    s_waitcnt lgkmcnt(3)
    v_mfma_f32_16x16x32_bf16 v[180:183], v[40:43], v[60:63], v[180:183]
    ds_read_b128 v[36:39], v11 offset:6144
    ds_read_b64_tr_b16 v[40:41], v12 offset:16384
    ds_read_b64_tr_b16 v[42:43], v12 offset:18432
    v_mfma_f32_16x16x32_bf16 v[152:155], v[44:47], v[48:51], v[152:155]
    v_mfma_f32_16x16x32_bf16 v[156:159], v[44:47], v[52:55], v[156:159]
    v_mfma_f32_16x16x32_bf16 v[184:187], v[44:47], v[56:59], v[184:187]
    v_mfma_f32_16x16x32_bf16 v[188:191], v[44:47], v[60:63], v[188:191]
    ds_read_b64_tr_b16 v[44:45], v13 offset:16384
    ds_read_b64_tr_b16 v[46:47], v13 offset:18432
    v_mfma_f32_16x16x32_bf16 v[160:163], v[64:67], v[48:51], v[160:163]
    v_mfma_f32_16x16x32_bf16 v[164:167], v[64:67], v[52:55], v[164:167]
    v_mfma_f32_16x16x32_bf16 v[192:195], v[64:67], v[56:59], v[192:195]
    v_mfma_f32_16x16x32_bf16 v[196:199], v[64:67], v[60:63], v[196:199]
    ds_read_b64_tr_b16 v[64:65], v14 offset:16384
    ds_read_b64_tr_b16 v[66:67], v14 offset:18432
    v_mfma_f32_16x16x32_bf16 v[168:171], v[68:71], v[48:51], v[168:171]
    v_mfma_f32_16x16x32_bf16 v[172:175], v[68:71], v[52:55], v[172:175]
    v_mfma_f32_16x16x32_bf16 v[200:203], v[68:71], v[56:59], v[200:203]
    v_mfma_f32_16x16x32_bf16 v[204:207], v[68:71], v[60:63], v[204:207]
    ds_read_b64_tr_b16 v[68:69], v15 offset:16384
    ds_read_b64_tr_b16 v[70:71], v15 offset:18432
    s_waitcnt lgkmcnt(6)
    v_mfma_f32_16x16x32_bf16 v[80:83], v[40:43], v[24:27], v[80:83]
    ds_read_b128 v[48:51], v11 offset:8192
    s_cmp_lg_u32 s19, 7
    s_cbranch_scc1 L_non2_8
    v_cmp_eq_u32 vcc, 0, v240
    v_mov_b32 v241, 147456
    s_nop 0
    v_cndmask_b32 v240, v240, v242, vcc
    s_mov_b64 exec, 1
    ds_write_b32 v241, v240
    s_mov_b64 exec, -1
L_non2_8:
    v_mfma_f32_16x16x32_bf16 v[84:87], v[40:43], v[28:31], v[84:87]
    ds_read_b128 v[52:55], v11 offset:10240
    v_mfma_f32_16x16x32_bf16 v[112:115], v[40:43], v[32:35], v[112:115]
    ds_read_b128 v[56:59], v11 offset:12288
    v_mfma_f32_16x16x32_bf16 v[116:119], v[40:43], v[36:39], v[116:119]
    ds_read_b128 v[60:63], v11 offset:14336
    s_waitcnt lgkmcnt(8)
    v_mfma_f32_16x16x32_bf16 v[88:91], v[44:47], v[24:27], v[88:91]
    v_mfma_f32_16x16x32_bf16 v[92:95], v[44:47], v[28:31], v[92:95]
    v_mfma_f32_16x16x32_bf16 v[120:123], v[44:47], v[32:35], v[120:123]
    v_mfma_f32_16x16x32_bf16 v[124:127], v[44:47], v[36:39], v[124:127]
    s_waitcnt lgkmcnt(6)
    v_mfma_f32_16x16x32_bf16 v[96:99], v[64:67], v[24:27], v[96:99]
    v_mfma_f32_16x16x32_bf16 v[100:103], v[64:67], v[28:31], v[100:103]
    v_mfma_f32_16x16x32_bf16 v[128:131], v[64:67], v[32:35], v[128:131]
    v_mfma_f32_16x16x32_bf16 v[132:135], v[64:67], v[36:39], v[132:135]
    s_waitcnt lgkmcnt(4)
    v_mfma_f32_16x16x32_bf16 v[104:107], v[68:71], v[24:27], v[104:107]
    v_mfma_f32_16x16x32_bf16 v[108:111], v[68:71], v[28:31], v[108:111]
    v_mfma_f32_16x16x32_bf16 v[136:139], v[68:71], v[32:35], v[136:139]
    v_mfma_f32_16x16x32_bf16 v[140:143], v[68:71], v[36:39], v[140:143]
    s_waitcnt lgkmcnt(0)
    s_barrier
    v_mfma_f32_16x16x32_bf16 v[144:147], v[40:43], v[48:51], v[144:147]
    ds_read_b128 v[24:27], v10 offset:32768
    v_mfma_f32_16x16x32_bf16 v[148:151], v[40:43], v[52:55], v[148:151]
    ds_read_b128 v[28:31], v10 offset:34816
    v_mfma_f32_16x16x32_bf16 v[176:179], v[40:43], v[56:59], v[176:179]
    ds_read_b128 v[32:35], v10 offset:36864
    v_mfma_f32_16x16x32_bf16 v[180:183], v[40:43], v[60:63], v[180:183]
    ds_read_b128 v[36:39], v10 offset:38912
    ds_read_b64_tr_b16 v[40:41], v12 offset:32768
    ds_read_b64_tr_b16 v[42:43], v12 offset:34816
    v_mfma_f32_16x16x32_bf16 v[152:155], v[44:47], v[48:51], v[152:155]
    v_mfma_f32_16x16x32_bf16 v[156:159], v[44:47], v[52:55], v[156:159]
    v_mfma_f32_16x16x32_bf16 v[184:187], v[44:47], v[56:59], v[184:187]
    v_mfma_f32_16x16x32_bf16 v[188:191], v[44:47], v[60:63], v[188:191]
    ds_read_b64_tr_b16 v[44:45], v13 offset:32768
    ds_read_b64_tr_b16 v[46:47], v13 offset:34816
    v_mfma_f32_16x16x32_bf16 v[160:163], v[64:67], v[48:51], v[160:163]
    v_mfma_f32_16x16x32_bf16 v[164:167], v[64:67], v[52:55], v[164:167]
    v_mfma_f32_16x16x32_bf16 v[192:195], v[64:67], v[56:59], v[192:195]
    v_mfma_f32_16x16x32_bf16 v[196:199], v[64:67], v[60:63], v[196:199]
    ds_read_b64_tr_b16 v[64:65], v14 offset:32768
    ds_read_b64_tr_b16 v[66:67], v14 offset:34816
    v_mfma_f32_16x16x32_bf16 v[168:171], v[68:71], v[48:51], v[168:171]
    v_mfma_f32_16x16x32_bf16 v[172:175], v[68:71], v[52:55], v[172:175]
    v_mfma_f32_16x16x32_bf16 v[200:203], v[68:71], v[56:59], v[200:203]
    v_mfma_f32_16x16x32_bf16 v[204:207], v[68:71], v[60:63], v[204:207]
    ds_read_b64_tr_b16 v[68:69], v15 offset:32768
    ds_read_b64_tr_b16 v[70:71], v15 offset:34816
    s_waitcnt lgkmcnt(6)
    v_mfma_f32_16x16x32_bf16 v[80:83], v[40:43], v[24:27], v[80:83]
    ds_read_b128 v[48:51], v10 offset:40960
    v_mov_b32 v241, 147456
    ds_read_b32 v240, v241
    v_mfma_f32_16x16x32_bf16 v[84:87], v[40:43], v[28:31], v[84:87]
    ds_read_b128 v[52:55], v10 offset:43008
    v_mfma_f32_16x16x32_bf16 v[112:115], v[40:43], v[32:35], v[112:115]
    ds_read_b128 v[56:59], v10 offset:45056
    v_mfma_f32_16x16x32_bf16 v[116:119], v[40:43], v[36:39], v[116:119]
    ds_read_b128 v[60:63], v10 offset:47104
    s_waitcnt lgkmcnt(9)
    v_mfma_f32_16x16x32_bf16 v[88:91], v[44:47], v[24:27], v[88:91]
    v_mfma_f32_16x16x32_bf16 v[92:95], v[44:47], v[28:31], v[92:95]
    v_mfma_f32_16x16x32_bf16 v[120:123], v[44:47], v[32:35], v[120:123]
    v_mfma_f32_16x16x32_bf16 v[124:127], v[44:47], v[36:39], v[124:127]
    s_waitcnt lgkmcnt(7)
    v_mfma_f32_16x16x32_bf16 v[96:99], v[64:67], v[24:27], v[96:99]
    v_mfma_f32_16x16x32_bf16 v[100:103], v[64:67], v[28:31], v[100:103]
    v_mfma_f32_16x16x32_bf16 v[128:131], v[64:67], v[32:35], v[128:131]
    v_mfma_f32_16x16x32_bf16 v[132:135], v[64:67], v[36:39], v[132:135]
    s_waitcnt lgkmcnt(5)
    v_mfma_f32_16x16x32_bf16 v[104:107], v[68:71], v[24:27], v[104:107]
    v_mfma_f32_16x16x32_bf16 v[108:111], v[68:71], v[28:31], v[108:111]
    v_mfma_f32_16x16x32_bf16 v[136:139], v[68:71], v[32:35], v[136:139]
    v_mfma_f32_16x16x32_bf16 v[140:143], v[68:71], v[36:39], v[140:143]
    s_waitcnt lgkmcnt(4)
    v_mfma_f32_16x16x32_bf16 v[144:147], v[40:43], v[48:51], v[144:147]
    ds_read_b128 v[24:27], v11 offset:32768
    s_waitcnt lgkmcnt(4)
    v_readfirstlane_b32 s95, v240
    s_waitcnt lgkmcnt(3)
    v_mfma_f32_16x16x32_bf16 v[148:151], v[40:43], v[52:55], v[148:151]
    ds_read_b128 v[28:31], v11 offset:34816
    s_waitcnt lgkmcnt(3)
    v_mfma_f32_16x16x32_bf16 v[176:179], v[40:43], v[56:59], v[176:179]
    ds_read_b128 v[32:35], v11 offset:36864
    s_waitcnt lgkmcnt(3)
    v_mfma_f32_16x16x32_bf16 v[180:183], v[40:43], v[60:63], v[180:183]
    ds_read_b128 v[36:39], v11 offset:38912
    ds_read_b64_tr_b16 v[40:41], v12 offset:49152
    ds_read_b64_tr_b16 v[42:43], v12 offset:51200
    v_mfma_f32_16x16x32_bf16 v[152:155], v[44:47], v[48:51], v[152:155]
    v_mfma_f32_16x16x32_bf16 v[156:159], v[44:47], v[52:55], v[156:159]
    v_mfma_f32_16x16x32_bf16 v[184:187], v[44:47], v[56:59], v[184:187]
    v_mfma_f32_16x16x32_bf16 v[188:191], v[44:47], v[60:63], v[188:191]
    ds_read_b64_tr_b16 v[44:45], v13 offset:49152
    ds_read_b64_tr_b16 v[46:47], v13 offset:51200
    v_mfma_f32_16x16x32_bf16 v[160:163], v[64:67], v[48:51], v[160:163]
    v_mfma_f32_16x16x32_bf16 v[164:167], v[64:67], v[52:55], v[164:167]
    v_mfma_f32_16x16x32_bf16 v[192:195], v[64:67], v[56:59], v[192:195]
    v_mfma_f32_16x16x32_bf16 v[196:199], v[64:67], v[60:63], v[196:199]
    ds_read_b64_tr_b16 v[64:65], v14 offset:49152
    ds_read_b64_tr_b16 v[66:67], v14 offset:51200
    v_mfma_f32_16x16x32_bf16 v[168:171], v[68:71], v[48:51], v[168:171]
    v_mfma_f32_16x16x32_bf16 v[172:175], v[68:71], v[52:55], v[172:175]
    v_mfma_f32_16x16x32_bf16 v[200:203], v[68:71], v[56:59], v[200:203]
    v_mfma_f32_16x16x32_bf16 v[204:207], v[68:71], v[60:63], v[204:207]
    ds_read_b64_tr_b16 v[68:69], v15 offset:49152
    ds_read_b64_tr_b16 v[70:71], v15 offset:51200
    s_waitcnt lgkmcnt(6)
    v_mfma_f32_16x16x32_bf16 v[80:83], v[40:43], v[24:27], v[80:83]
    ds_read_b128 v[48:51], v11 offset:40960
    v_mfma_f32_16x16x32_bf16 v[84:87], v[40:43], v[28:31], v[84:87]
    ds_read_b128 v[52:55], v11 offset:43008
    v_mfma_f32_16x16x32_bf16 v[112:115], v[40:43], v[32:35], v[112:115]
    ds_read_b128 v[56:59], v11 offset:45056
    v_mfma_f32_16x16x32_bf16 v[116:119], v[40:43], v[36:39], v[116:119]
    ds_read_b128 v[60:63], v11 offset:47104
    s_waitcnt lgkmcnt(8)
    v_mfma_f32_16x16x32_bf16 v[88:91], v[44:47], v[24:27], v[88:91]
    v_mfma_f32_16x16x32_bf16 v[92:95], v[44:47], v[28:31], v[92:95]
    v_mfma_f32_16x16x32_bf16 v[120:123], v[44:47], v[32:35], v[120:123]
    v_mfma_f32_16x16x32_bf16 v[124:127], v[44:47], v[36:39], v[124:127]
    s_waitcnt lgkmcnt(6)
    v_mfma_f32_16x16x32_bf16 v[96:99], v[64:67], v[24:27], v[96:99]
    v_mfma_f32_16x16x32_bf16 v[100:103], v[64:67], v[28:31], v[100:103]
    v_mfma_f32_16x16x32_bf16 v[128:131], v[64:67], v[32:35], v[128:131]
    v_mfma_f32_16x16x32_bf16 v[132:135], v[64:67], v[36:39], v[132:135]
    s_waitcnt lgkmcnt(4)
    v_mfma_f32_16x16x32_bf16 v[104:107], v[68:71], v[24:27], v[104:107]
    v_mfma_f32_16x16x32_bf16 v[108:111], v[68:71], v[28:31], v[108:111]
    v_mfma_f32_16x16x32_bf16 v[136:139], v[68:71], v[32:35], v[136:139]
    v_mfma_f32_16x16x32_bf16 v[140:143], v[68:71], v[36:39], v[140:143]
    s_waitcnt lgkmcnt(0) vmcnt(0)
    s_barrier
    s_cmp_lg_u32 s19, 4
    s_cbranch_scc1 L_nosig_9
    s_lshl_b32 s35, s2, 2
    v_mov_b32 v216, 0
    v_mov_b32 v217, s95
    s_mov_b64 exec, 1
    s_add_u32 s35, s35, 1024
    buffer_store_dword v217, v216, s[88:91], s35 offen sc1
    s_mov_b64 exec, -1
L_nosig_9:
    s_cmp_lg_u32 s19, 4
    s_cbranch_scc1 L_nosig_10
    s_lshl_b32 s35, s2, 2
    v_mov_b32 v216, 0
    v_mov_b32 v217, s95
    s_mov_b64 exec, 1
    s_add_u32 s35, s35, 2048
    buffer_store_dword v217, v216, s[88:91], s35 offen sc1
    s_mov_b64 exec, -1
L_nosig_10:
    v_mfma_f32_16x16x32_bf16 v[144:147], v[40:43], v[48:51], v[144:147]
    ds_read_b128 v[24:27], v10 offset:0
    s_add_u32 s84, s50, 0
    s_addc_u32 s85, s51, 0
    s_mov_b32 s86, 8388608
    s_mov_b32 s87, 0x00020000
    s_mov_b32 s92, 0
    buffer_load_dword v22, v21, s[84:87], s92 offen
    v_mfma_f32_16x16x32_bf16 v[148:151], v[40:43], v[52:55], v[148:151]
    ds_read_b128 v[28:31], v10 offset:2048
    v_mfma_f32_16x16x32_bf16 v[176:179], v[40:43], v[56:59], v[176:179]
    ds_read_b128 v[32:35], v10 offset:4096
    v_mfma_f32_16x16x32_bf16 v[180:183], v[40:43], v[60:63], v[180:183]
    ds_read_b128 v[36:39], v10 offset:6144
    ds_read_b64_tr_b16 v[40:41], v12 offset:0
    ds_read_b64_tr_b16 v[42:43], v12 offset:2048
    v_mfma_f32_16x16x32_bf16 v[152:155], v[44:47], v[48:51], v[152:155]
    v_mfma_f32_16x16x32_bf16 v[156:159], v[44:47], v[52:55], v[156:159]
    v_mfma_f32_16x16x32_bf16 v[184:187], v[44:47], v[56:59], v[184:187]
    v_mfma_f32_16x16x32_bf16 v[188:191], v[44:47], v[60:63], v[188:191]
    ds_read_b64_tr_b16 v[44:45], v13 offset:0
    ds_read_b64_tr_b16 v[46:47], v13 offset:2048
    v_mfma_f32_16x16x32_bf16 v[160:163], v[64:67], v[48:51], v[160:163]
    v_mfma_f32_16x16x32_bf16 v[164:167], v[64:67], v[52:55], v[164:167]
    v_mfma_f32_16x16x32_bf16 v[192:195], v[64:67], v[56:59], v[192:195]
    v_mfma_f32_16x16x32_bf16 v[196:199], v[64:67], v[60:63], v[196:199]
    ds_read_b64_tr_b16 v[64:65], v14 offset:0
    ds_read_b64_tr_b16 v[66:67], v14 offset:2048
    v_mfma_f32_16x16x32_bf16 v[168:171], v[68:71], v[48:51], v[168:171]
    v_mfma_f32_16x16x32_bf16 v[172:175], v[68:71], v[52:55], v[172:175]
    v_mfma_f32_16x16x32_bf16 v[200:203], v[68:71], v[56:59], v[200:203]
    v_mfma_f32_16x16x32_bf16 v[204:207], v[68:71], v[60:63], v[204:207]
    ds_read_b64_tr_b16 v[68:69], v15 offset:0
    ds_read_b64_tr_b16 v[70:71], v15 offset:2048
    s_waitcnt lgkmcnt(6)
    v_mfma_f32_16x16x32_bf16 v[80:83], v[40:43], v[24:27], v[80:83]
    ds_read_b128 v[48:51], v10 offset:8192
    v_mfma_f32_16x16x32_bf16 v[84:87], v[40:43], v[28:31], v[84:87]
    ds_read_b128 v[52:55], v10 offset:10240
    v_mfma_f32_16x16x32_bf16 v[112:115], v[40:43], v[32:35], v[112:115]
    ds_read_b128 v[56:59], v10 offset:12288
    v_mfma_f32_16x16x32_bf16 v[116:119], v[40:43], v[36:39], v[116:119]
    ds_read_b128 v[60:63], v10 offset:14336
    s_waitcnt lgkmcnt(8)
    v_mfma_f32_16x16x32_bf16 v[88:91], v[44:47], v[24:27], v[88:91]
    v_mfma_f32_16x16x32_bf16 v[92:95], v[44:47], v[28:31], v[92:95]
    v_mfma_f32_16x16x32_bf16 v[120:123], v[44:47], v[32:35], v[120:123]
    v_mfma_f32_16x16x32_bf16 v[124:127], v[44:47], v[36:39], v[124:127]
    s_waitcnt lgkmcnt(6)
    v_mfma_f32_16x16x32_bf16 v[96:99], v[64:67], v[24:27], v[96:99]
    v_mfma_f32_16x16x32_bf16 v[100:103], v[64:67], v[28:31], v[100:103]
    v_mfma_f32_16x16x32_bf16 v[128:131], v[64:67], v[32:35], v[128:131]
    v_mfma_f32_16x16x32_bf16 v[132:135], v[64:67], v[36:39], v[132:135]
    s_waitcnt lgkmcnt(4)
    v_mfma_f32_16x16x32_bf16 v[104:107], v[68:71], v[24:27], v[104:107]
    v_mfma_f32_16x16x32_bf16 v[108:111], v[68:71], v[28:31], v[108:111]
    v_mfma_f32_16x16x32_bf16 v[136:139], v[68:71], v[32:35], v[136:139]
    v_mfma_f32_16x16x32_bf16 v[140:143], v[68:71], v[36:39], v[140:143]
    s_waitcnt lgkmcnt(3)
    v_mfma_f32_16x16x32_bf16 v[144:147], v[40:43], v[48:51], v[144:147]
    ds_read_b128 v[24:27], v11 offset:0
    s_waitcnt lgkmcnt(3)
    v_mfma_f32_16x16x32_bf16 v[148:151], v[40:43], v[52:55], v[148:151]
    ds_read_b128 v[28:31], v11 offset:2048
    s_waitcnt lgkmcnt(3)
    v_mfma_f32_16x16x32_bf16 v[176:179], v[40:43], v[56:59], v[176:179]
    ds_read_b128 v[32:35], v11 offset:4096
    s_waitcnt lgkmcnt(3)
    v_mfma_f32_16x16x32_bf16 v[180:183], v[40:43], v[60:63], v[180:183]
    ds_read_b128 v[36:39], v11 offset:6144
    ds_read_b64_tr_b16 v[40:41], v12 offset:16384
    ds_read_b64_tr_b16 v[42:43], v12 offset:18432
    v_mfma_f32_16x16x32_bf16 v[152:155], v[44:47], v[48:51], v[152:155]
    v_mfma_f32_16x16x32_bf16 v[156:159], v[44:47], v[52:55], v[156:159]
    v_mfma_f32_16x16x32_bf16 v[184:187], v[44:47], v[56:59], v[184:187]
    v_mfma_f32_16x16x32_bf16 v[188:191], v[44:47], v[60:63], v[188:191]
    ds_read_b64_tr_b16 v[44:45], v13 offset:16384
    ds_read_b64_tr_b16 v[46:47], v13 offset:18432
    v_mfma_f32_16x16x32_bf16 v[160:163], v[64:67], v[48:51], v[160:163]
    v_mfma_f32_16x16x32_bf16 v[164:167], v[64:67], v[52:55], v[164:167]
    v_mfma_f32_16x16x32_bf16 v[192:195], v[64:67], v[56:59], v[192:195]
    v_mfma_f32_16x16x32_bf16 v[196:199], v[64:67], v[60:63], v[196:199]
    ds_read_b64_tr_b16 v[64:65], v14 offset:16384
    ds_read_b64_tr_b16 v[66:67], v14 offset:18432
    v_mfma_f32_16x16x32_bf16 v[168:171], v[68:71], v[48:51], v[168:171]
    v_mfma_f32_16x16x32_bf16 v[172:175], v[68:71], v[52:55], v[172:175]
    v_mfma_f32_16x16x32_bf16 v[200:203], v[68:71], v[56:59], v[200:203]
    v_mfma_f32_16x16x32_bf16 v[204:207], v[68:71], v[60:63], v[204:207]
    ds_read_b64_tr_b16 v[68:69], v15 offset:16384
    ds_read_b64_tr_b16 v[70:71], v15 offset:18432
    s_waitcnt lgkmcnt(6)
    v_mfma_f32_16x16x32_bf16 v[80:83], v[40:43], v[24:27], v[80:83]
    ds_read_b128 v[48:51], v11 offset:8192
    v_mfma_f32_16x16x32_bf16 v[84:87], v[40:43], v[28:31], v[84:87]
    ds_read_b128 v[52:55], v11 offset:10240
    v_mfma_f32_16x16x32_bf16 v[112:115], v[40:43], v[32:35], v[112:115]
    ds_read_b128 v[56:59], v11 offset:12288
    v_mfma_f32_16x16x32_bf16 v[116:119], v[40:43], v[36:39], v[116:119]
    ds_read_b128 v[60:63], v11 offset:14336
    s_waitcnt lgkmcnt(8)
    v_mfma_f32_16x16x32_bf16 v[88:91], v[44:47], v[24:27], v[88:91]
    v_mfma_f32_16x16x32_bf16 v[92:95], v[44:47], v[28:31], v[92:95]
    v_mfma_f32_16x16x32_bf16 v[120:123], v[44:47], v[32:35], v[120:123]
    v_mfma_f32_16x16x32_bf16 v[124:127], v[44:47], v[36:39], v[124:127]
    s_waitcnt lgkmcnt(6)
    v_mfma_f32_16x16x32_bf16 v[96:99], v[64:67], v[24:27], v[96:99]
    v_mfma_f32_16x16x32_bf16 v[100:103], v[64:67], v[28:31], v[100:103]
    v_mfma_f32_16x16x32_bf16 v[128:131], v[64:67], v[32:35], v[128:131]
    v_mfma_f32_16x16x32_bf16 v[132:135], v[64:67], v[36:39], v[132:135]
    s_waitcnt lgkmcnt(4)
    v_mfma_f32_16x16x32_bf16 v[104:107], v[68:71], v[24:27], v[104:107]
    v_mfma_f32_16x16x32_bf16 v[108:111], v[68:71], v[28:31], v[108:111]
    v_mfma_f32_16x16x32_bf16 v[136:139], v[68:71], v[32:35], v[136:139]
    v_mfma_f32_16x16x32_bf16 v[140:143], v[68:71], v[36:39], v[140:143]
    s_waitcnt lgkmcnt(0)
    s_barrier
    v_mfma_f32_16x16x32_bf16 v[144:147], v[40:43], v[48:51], v[144:147]
    ds_read_b128 v[24:27], v10 offset:32768
    s_add_u32 s84, s52, 0
    s_addc_u32 s85, s53, 0
    s_mov_b32 s86, 7340032
    s_mov_b32 s87, 0x00020000
    s_mov_b32 s92, 0
    buffer_load_dword v22, v21, s[84:87], s92 offen
    v_mfma_f32_16x16x32_bf16 v[148:151], v[40:43], v[52:55], v[148:151]
    ds_read_b128 v[28:31], v10 offset:34816
    v_mfma_f32_16x16x32_bf16 v[176:179], v[40:43], v[56:59], v[176:179]
    ds_read_b128 v[32:35], v10 offset:36864
    v_mfma_f32_16x16x32_bf16 v[180:183], v[40:43], v[60:63], v[180:183]
    ds_read_b128 v[36:39], v10 offset:38912
    ds_read_b64_tr_b16 v[40:41], v12 offset:32768
    ds_read_b64_tr_b16 v[42:43], v12 offset:34816
    v_mfma_f32_16x16x32_bf16 v[152:155], v[44:47], v[48:51], v[152:155]
    v_mfma_f32_16x16x32_bf16 v[156:159], v[44:47], v[52:55], v[156:159]
    v_mfma_f32_16x16x32_bf16 v[184:187], v[44:47], v[56:59], v[184:187]
    v_mfma_f32_16x16x32_bf16 v[188:191], v[44:47], v[60:63], v[188:191]
    ds_read_b64_tr_b16 v[44:45], v13 offset:32768
    ds_read_b64_tr_b16 v[46:47], v13 offset:34816
    v_mfma_f32_16x16x32_bf16 v[160:163], v[64:67], v[48:51], v[160:163]
    v_mfma_f32_16x16x32_bf16 v[164:167], v[64:67], v[52:55], v[164:167]
    v_mfma_f32_16x16x32_bf16 v[192:195], v[64:67], v[56:59], v[192:195]
    v_mfma_f32_16x16x32_bf16 v[196:199], v[64:67], v[60:63], v[196:199]
    ds_read_b64_tr_b16 v[64:65], v14 offset:32768
    ds_read_b64_tr_b16 v[66:67], v14 offset:34816
    v_mfma_f32_16x16x32_bf16 v[168:171], v[68:71], v[48:51], v[168:171]
    v_mfma_f32_16x16x32_bf16 v[172:175], v[68:71], v[52:55], v[172:175]
    v_mfma_f32_16x16x32_bf16 v[200:203], v[68:71], v[56:59], v[200:203]
    v_mfma_f32_16x16x32_bf16 v[204:207], v[68:71], v[60:63], v[204:207]
    ds_read_b64_tr_b16 v[68:69], v15 offset:32768
    ds_read_b64_tr_b16 v[70:71], v15 offset:34816
    s_waitcnt lgkmcnt(6)
    v_mfma_f32_16x16x32_bf16 v[80:83], v[40:43], v[24:27], v[80:83]
    ds_read_b128 v[48:51], v10 offset:40960
    v_mfma_f32_16x16x32_bf16 v[84:87], v[40:43], v[28:31], v[84:87]
    ds_read_b128 v[52:55], v10 offset:43008
    v_mfma_f32_16x16x32_bf16 v[112:115], v[40:43], v[32:35], v[112:115]
    ds_read_b128 v[56:59], v10 offset:45056
    v_mfma_f32_16x16x32_bf16 v[116:119], v[40:43], v[36:39], v[116:119]
    ds_read_b128 v[60:63], v10 offset:47104
    s_waitcnt lgkmcnt(8)
    v_mfma_f32_16x16x32_bf16 v[88:91], v[44:47], v[24:27], v[88:91]
    v_mfma_f32_16x16x32_bf16 v[92:95], v[44:47], v[28:31], v[92:95]
    v_mfma_f32_16x16x32_bf16 v[120:123], v[44:47], v[32:35], v[120:123]
    v_mfma_f32_16x16x32_bf16 v[124:127], v[44:47], v[36:39], v[124:127]
    s_waitcnt lgkmcnt(6)
    v_mfma_f32_16x16x32_bf16 v[96:99], v[64:67], v[24:27], v[96:99]
    v_mfma_f32_16x16x32_bf16 v[100:103], v[64:67], v[28:31], v[100:103]
    v_mfma_f32_16x16x32_bf16 v[128:131], v[64:67], v[32:35], v[128:131]
    v_mfma_f32_16x16x32_bf16 v[132:135], v[64:67], v[36:39], v[132:135]
    s_waitcnt lgkmcnt(4)
    v_mfma_f32_16x16x32_bf16 v[104:107], v[68:71], v[24:27], v[104:107]
    v_mfma_f32_16x16x32_bf16 v[108:111], v[68:71], v[28:31], v[108:111]
    v_mfma_f32_16x16x32_bf16 v[136:139], v[68:71], v[32:35], v[136:139]
    v_mfma_f32_16x16x32_bf16 v[140:143], v[68:71], v[36:39], v[140:143]
    s_waitcnt lgkmcnt(3)
    v_mfma_f32_16x16x32_bf16 v[144:147], v[40:43], v[48:51], v[144:147]
    ds_read_b128 v[24:27], v11 offset:32768
    s_waitcnt lgkmcnt(3)
    v_mfma_f32_16x16x32_bf16 v[148:151], v[40:43], v[52:55], v[148:151]
    ds_read_b128 v[28:31], v11 offset:34816
    s_waitcnt lgkmcnt(3)
    v_mfma_f32_16x16x32_bf16 v[176:179], v[40:43], v[56:59], v[176:179]
    ds_read_b128 v[32:35], v11 offset:36864
    s_waitcnt lgkmcnt(3)
    v_mfma_f32_16x16x32_bf16 v[180:183], v[40:43], v[60:63], v[180:183]
    ds_read_b128 v[36:39], v11 offset:38912
    ds_read_b64_tr_b16 v[40:41], v12 offset:49152
    ds_read_b64_tr_b16 v[42:43], v12 offset:51200
    v_mfma_f32_16x16x32_bf16 v[152:155], v[44:47], v[48:51], v[152:155]
    v_mfma_f32_16x16x32_bf16 v[156:159], v[44:47], v[52:55], v[156:159]
    v_mfma_f32_16x16x32_bf16 v[184:187], v[44:47], v[56:59], v[184:187]
    v_mfma_f32_16x16x32_bf16 v[188:191], v[44:47], v[60:63], v[188:191]
    ds_read_b64_tr_b16 v[44:45], v13 offset:49152
    ds_read_b64_tr_b16 v[46:47], v13 offset:51200
    v_mfma_f32_16x16x32_bf16 v[160:163], v[64:67], v[48:51], v[160:163]
    v_mfma_f32_16x16x32_bf16 v[164:167], v[64:67], v[52:55], v[164:167]
    v_mfma_f32_16x16x32_bf16 v[192:195], v[64:67], v[56:59], v[192:195]
    v_mfma_f32_16x16x32_bf16 v[196:199], v[64:67], v[60:63], v[196:199]
    ds_read_b64_tr_b16 v[64:65], v14 offset:49152
    ds_read_b64_tr_b16 v[66:67], v14 offset:51200
    v_mfma_f32_16x16x32_bf16 v[168:171], v[68:71], v[48:51], v[168:171]
    v_mfma_f32_16x16x32_bf16 v[172:175], v[68:71], v[52:55], v[172:175]
    v_mfma_f32_16x16x32_bf16 v[200:203], v[68:71], v[56:59], v[200:203]
    v_mfma_f32_16x16x32_bf16 v[204:207], v[68:71], v[60:63], v[204:207]
    ds_read_b64_tr_b16 v[68:69], v15 offset:49152
    ds_read_b64_tr_b16 v[70:71], v15 offset:51200
    s_waitcnt lgkmcnt(6)
    v_mfma_f32_16x16x32_bf16 v[80:83], v[40:43], v[24:27], v[80:83]
    ds_read_b128 v[48:51], v11 offset:40960
    v_mfma_f32_16x16x32_bf16 v[84:87], v[40:43], v[28:31], v[84:87]
    ds_read_b128 v[52:55], v11 offset:43008
    v_mfma_f32_16x16x32_bf16 v[112:115], v[40:43], v[32:35], v[112:115]
    ds_read_b128 v[56:59], v11 offset:45056
    v_mfma_f32_16x16x32_bf16 v[116:119], v[40:43], v[36:39], v[116:119]
    ds_read_b128 v[60:63], v11 offset:47104
    s_waitcnt lgkmcnt(8)
    v_mfma_f32_16x16x32_bf16 v[88:91], v[44:47], v[24:27], v[88:91]
    v_mfma_f32_16x16x32_bf16 v[92:95], v[44:47], v[28:31], v[92:95]
    v_mfma_f32_16x16x32_bf16 v[120:123], v[44:47], v[32:35], v[120:123]
    v_mfma_f32_16x16x32_bf16 v[124:127], v[44:47], v[36:39], v[124:127]
    s_waitcnt lgkmcnt(6)
    v_mfma_f32_16x16x32_bf16 v[96:99], v[64:67], v[24:27], v[96:99]
    v_mfma_f32_16x16x32_bf16 v[100:103], v[64:67], v[28:31], v[100:103]
    v_mfma_f32_16x16x32_bf16 v[128:131], v[64:67], v[32:35], v[128:131]
    v_mfma_f32_16x16x32_bf16 v[132:135], v[64:67], v[36:39], v[132:135]
    s_waitcnt lgkmcnt(4)
    v_mfma_f32_16x16x32_bf16 v[104:107], v[68:71], v[24:27], v[104:107]
    v_mfma_f32_16x16x32_bf16 v[108:111], v[68:71], v[28:31], v[108:111]
    v_mfma_f32_16x16x32_bf16 v[136:139], v[68:71], v[32:35], v[136:139]
    v_mfma_f32_16x16x32_bf16 v[140:143], v[68:71], v[36:39], v[140:143]
    s_waitcnt lgkmcnt(0)
    s_barrier
    v_mfma_f32_16x16x32_bf16 v[144:147], v[40:43], v[48:51], v[144:147]
    ds_read_b128 v[24:27], v10 offset:0
    s_add_u32 s84, s50, 0
    s_addc_u32 s85, s51, 0
    s_mov_b32 s86, 8388608
    s_mov_b32 s87, 0x00020000
    s_mov_b32 s92, 4194304
    buffer_load_dword v22, v21, s[84:87], s92 offen
    v_mfma_f32_16x16x32_bf16 v[148:151], v[40:43], v[52:55], v[148:151]
    ds_read_b128 v[28:31], v10 offset:2048
    v_mfma_f32_16x16x32_bf16 v[176:179], v[40:43], v[56:59], v[176:179]
    ds_read_b128 v[32:35], v10 offset:4096
    v_mfma_f32_16x16x32_bf16 v[180:183], v[40:43], v[60:63], v[180:183]
    ds_read_b128 v[36:39], v10 offset:6144
    ds_read_b64_tr_b16 v[40:41], v12 offset:0
    ds_read_b64_tr_b16 v[42:43], v12 offset:2048
    v_mfma_f32_16x16x32_bf16 v[152:155], v[44:47], v[48:51], v[152:155]
    v_mfma_f32_16x16x32_bf16 v[156:159], v[44:47], v[52:55], v[156:159]
    v_mfma_f32_16x16x32_bf16 v[184:187], v[44:47], v[56:59], v[184:187]
    v_mfma_f32_16x16x32_bf16 v[188:191], v[44:47], v[60:63], v[188:191]
    ds_read_b64_tr_b16 v[44:45], v13 offset:0
    ds_read_b64_tr_b16 v[46:47], v13 offset:2048
    v_mfma_f32_16x16x32_bf16 v[160:163], v[64:67], v[48:51], v[160:163]
    v_mfma_f32_16x16x32_bf16 v[164:167], v[64:67], v[52:55], v[164:167]
    v_mfma_f32_16x16x32_bf16 v[192:195], v[64:67], v[56:59], v[192:195]
    v_mfma_f32_16x16x32_bf16 v[196:199], v[64:67], v[60:63], v[196:199]
    ds_read_b64_tr_b16 v[64:65], v14 offset:0
    ds_read_b64_tr_b16 v[66:67], v14 offset:2048
    v_mfma_f32_16x16x32_bf16 v[168:171], v[68:71], v[48:51], v[168:171]
    v_mfma_f32_16x16x32_bf16 v[172:175], v[68:71], v[52:55], v[172:175]
    v_mfma_f32_16x16x32_bf16 v[200:203], v[68:71], v[56:59], v[200:203]
    v_mfma_f32_16x16x32_bf16 v[204:207], v[68:71], v[60:63], v[204:207]
    ds_read_b64_tr_b16 v[68:69], v15 offset:0
    ds_read_b64_tr_b16 v[70:71], v15 offset:2048
    s_waitcnt lgkmcnt(6)
    v_mfma_f32_16x16x32_bf16 v[80:83], v[40:43], v[24:27], v[80:83]
    ds_read_b128 v[48:51], v10 offset:8192
    v_mfma_f32_16x16x32_bf16 v[84:87], v[40:43], v[28:31], v[84:87]
    ds_read_b128 v[52:55], v10 offset:10240
    v_mfma_f32_16x16x32_bf16 v[112:115], v[40:43], v[32:35], v[112:115]
    ds_read_b128 v[56:59], v10 offset:12288
    v_mfma_f32_16x16x32_bf16 v[116:119], v[40:43], v[36:39], v[116:119]
    ds_read_b128 v[60:63], v10 offset:14336
    s_waitcnt lgkmcnt(8)
    v_mfma_f32_16x16x32_bf16 v[88:91], v[44:47], v[24:27], v[88:91]
    v_mfma_f32_16x16x32_bf16 v[92:95], v[44:47], v[28:31], v[92:95]
    v_mfma_f32_16x16x32_bf16 v[120:123], v[44:47], v[32:35], v[120:123]
    v_mfma_f32_16x16x32_bf16 v[124:127], v[44:47], v[36:39], v[124:127]
    s_waitcnt lgkmcnt(6)
    v_mfma_f32_16x16x32_bf16 v[96:99], v[64:67], v[24:27], v[96:99]
    v_mfma_f32_16x16x32_bf16 v[100:103], v[64:67], v[28:31], v[100:103]
    v_mfma_f32_16x16x32_bf16 v[128:131], v[64:67], v[32:35], v[128:131]
    v_mfma_f32_16x16x32_bf16 v[132:135], v[64:67], v[36:39], v[132:135]
    s_waitcnt lgkmcnt(4)
    v_mfma_f32_16x16x32_bf16 v[104:107], v[68:71], v[24:27], v[104:107]
    v_mfma_f32_16x16x32_bf16 v[108:111], v[68:71], v[28:31], v[108:111]
    v_mfma_f32_16x16x32_bf16 v[136:139], v[68:71], v[32:35], v[136:139]
    v_mfma_f32_16x16x32_bf16 v[140:143], v[68:71], v[36:39], v[140:143]
    s_waitcnt lgkmcnt(3)
    v_mfma_f32_16x16x32_bf16 v[144:147], v[40:43], v[48:51], v[144:147]
    ds_read_b128 v[24:27], v11 offset:0
    s_waitcnt lgkmcnt(3)
    v_mfma_f32_16x16x32_bf16 v[148:151], v[40:43], v[52:55], v[148:151]
    ds_read_b128 v[28:31], v11 offset:2048
    s_waitcnt lgkmcnt(3)
    v_mfma_f32_16x16x32_bf16 v[176:179], v[40:43], v[56:59], v[176:179]
    ds_read_b128 v[32:35], v11 offset:4096
    s_waitcnt lgkmcnt(3)
    v_mfma_f32_16x16x32_bf16 v[180:183], v[40:43], v[60:63], v[180:183]
    ds_read_b128 v[36:39], v11 offset:6144
    ds_read_b64_tr_b16 v[40:41], v12 offset:16384
    ds_read_b64_tr_b16 v[42:43], v12 offset:18432
    v_mfma_f32_16x16x32_bf16 v[152:155], v[44:47], v[48:51], v[152:155]
    v_mfma_f32_16x16x32_bf16 v[156:159], v[44:47], v[52:55], v[156:159]
    v_mfma_f32_16x16x32_bf16 v[184:187], v[44:47], v[56:59], v[184:187]
    v_mfma_f32_16x16x32_bf16 v[188:191], v[44:47], v[60:63], v[188:191]
    ds_read_b64_tr_b16 v[44:45], v13 offset:16384
    ds_read_b64_tr_b16 v[46:47], v13 offset:18432
    v_mfma_f32_16x16x32_bf16 v[160:163], v[64:67], v[48:51], v[160:163]
    v_mfma_f32_16x16x32_bf16 v[164:167], v[64:67], v[52:55], v[164:167]
    v_mfma_f32_16x16x32_bf16 v[192:195], v[64:67], v[56:59], v[192:195]
    v_mfma_f32_16x16x32_bf16 v[196:199], v[64:67], v[60:63], v[196:199]
    ds_read_b64_tr_b16 v[64:65], v14 offset:16384
    ds_read_b64_tr_b16 v[66:67], v14 offset:18432
    v_mfma_f32_16x16x32_bf16 v[168:171], v[68:71], v[48:51], v[168:171]
    v_mfma_f32_16x16x32_bf16 v[172:175], v[68:71], v[52:55], v[172:175]
    v_mfma_f32_16x16x32_bf16 v[200:203], v[68:71], v[56:59], v[200:203]
    v_mfma_f32_16x16x32_bf16 v[204:207], v[68:71], v[60:63], v[204:207]
    ds_read_b64_tr_b16 v[68:69], v15 offset:16384
    ds_read_b64_tr_b16 v[70:71], v15 offset:18432
    s_waitcnt lgkmcnt(6)
    v_mfma_f32_16x16x32_bf16 v[80:83], v[40:43], v[24:27], v[80:83]
    ds_read_b128 v[48:51], v11 offset:8192
    v_mfma_f32_16x16x32_bf16 v[84:87], v[40:43], v[28:31], v[84:87]
    ds_read_b128 v[52:55], v11 offset:10240
    v_mfma_f32_16x16x32_bf16 v[112:115], v[40:43], v[32:35], v[112:115]
    ds_read_b128 v[56:59], v11 offset:12288
    v_mfma_f32_16x16x32_bf16 v[116:119], v[40:43], v[36:39], v[116:119]
    ds_read_b128 v[60:63], v11 offset:14336
    s_waitcnt lgkmcnt(8)
    v_mfma_f32_16x16x32_bf16 v[88:91], v[44:47], v[24:27], v[88:91]
    v_mfma_f32_16x16x32_bf16 v[92:95], v[44:47], v[28:31], v[92:95]
    v_mfma_f32_16x16x32_bf16 v[120:123], v[44:47], v[32:35], v[120:123]
    v_mfma_f32_16x16x32_bf16 v[124:127], v[44:47], v[36:39], v[124:127]
    s_waitcnt lgkmcnt(6)
    v_mfma_f32_16x16x32_bf16 v[96:99], v[64:67], v[24:27], v[96:99]
    v_mfma_f32_16x16x32_bf16 v[100:103], v[64:67], v[28:31], v[100:103]
    v_mfma_f32_16x16x32_bf16 v[128:131], v[64:67], v[32:35], v[128:131]
    v_mfma_f32_16x16x32_bf16 v[132:135], v[64:67], v[36:39], v[132:135]
    s_waitcnt lgkmcnt(4)
    v_mfma_f32_16x16x32_bf16 v[104:107], v[68:71], v[24:27], v[104:107]
    v_mfma_f32_16x16x32_bf16 v[108:111], v[68:71], v[28:31], v[108:111]
    v_mfma_f32_16x16x32_bf16 v[136:139], v[68:71], v[32:35], v[136:139]
    v_mfma_f32_16x16x32_bf16 v[140:143], v[68:71], v[36:39], v[140:143]
    s_waitcnt lgkmcnt(0)
    s_barrier
    v_mfma_f32_16x16x32_bf16 v[144:147], v[40:43], v[48:51], v[144:147]
    ds_read_b128 v[24:27], v10 offset:32768
    s_add_u32 s84, s52, 0
    s_addc_u32 s85, s53, 0
    s_mov_b32 s86, 7340032
    s_mov_b32 s87, 0x00020000
    s_mov_b32 s92, 4194304
    buffer_load_dword v22, v21, s[84:87], s92 offen
    v_mfma_f32_16x16x32_bf16 v[148:151], v[40:43], v[52:55], v[148:151]
    ds_read_b128 v[28:31], v10 offset:34816
    v_mfma_f32_16x16x32_bf16 v[176:179], v[40:43], v[56:59], v[176:179]
    ds_read_b128 v[32:35], v10 offset:36864
    v_mfma_f32_16x16x32_bf16 v[180:183], v[40:43], v[60:63], v[180:183]
    ds_read_b128 v[36:39], v10 offset:38912
    ds_read_b64_tr_b16 v[40:41], v12 offset:32768
    ds_read_b64_tr_b16 v[42:43], v12 offset:34816
    v_mfma_f32_16x16x32_bf16 v[152:155], v[44:47], v[48:51], v[152:155]
    v_mfma_f32_16x16x32_bf16 v[156:159], v[44:47], v[52:55], v[156:159]
    v_mfma_f32_16x16x32_bf16 v[184:187], v[44:47], v[56:59], v[184:187]
    v_mfma_f32_16x16x32_bf16 v[188:191], v[44:47], v[60:63], v[188:191]
    ds_read_b64_tr_b16 v[44:45], v13 offset:32768
    ds_read_b64_tr_b16 v[46:47], v13 offset:34816
    v_mfma_f32_16x16x32_bf16 v[160:163], v[64:67], v[48:51], v[160:163]
    v_mfma_f32_16x16x32_bf16 v[164:167], v[64:67], v[52:55], v[164:167]
    v_mfma_f32_16x16x32_bf16 v[192:195], v[64:67], v[56:59], v[192:195]
    v_mfma_f32_16x16x32_bf16 v[196:199], v[64:67], v[60:63], v[196:199]
    ds_read_b64_tr_b16 v[64:65], v14 offset:32768
    ds_read_b64_tr_b16 v[66:67], v14 offset:34816
    v_mfma_f32_16x16x32_bf16 v[168:171], v[68:71], v[48:51], v[168:171]
    v_mfma_f32_16x16x32_bf16 v[172:175], v[68:71], v[52:55], v[172:175]
    v_mfma_f32_16x16x32_bf16 v[200:203], v[68:71], v[56:59], v[200:203]
    v_mfma_f32_16x16x32_bf16 v[204:207], v[68:71], v[60:63], v[204:207]
    ds_read_b64_tr_b16 v[68:69], v15 offset:32768
    ds_read_b64_tr_b16 v[70:71], v15 offset:34816
    s_waitcnt lgkmcnt(6)
    v_mfma_f32_16x16x32_bf16 v[80:83], v[40:43], v[24:27], v[80:83]
    ds_read_b128 v[48:51], v10 offset:40960
    v_mfma_f32_16x16x32_bf16 v[84:87], v[40:43], v[28:31], v[84:87]
    ds_read_b128 v[52:55], v10 offset:43008
    v_mfma_f32_16x16x32_bf16 v[112:115], v[40:43], v[32:35], v[112:115]
    ds_read_b128 v[56:59], v10 offset:45056
    v_mfma_f32_16x16x32_bf16 v[116:119], v[40:43], v[36:39], v[116:119]
    ds_read_b128 v[60:63], v10 offset:47104
    s_waitcnt lgkmcnt(8)
    v_mfma_f32_16x16x32_bf16 v[88:91], v[44:47], v[24:27], v[88:91]
    v_mfma_f32_16x16x32_bf16 v[92:95], v[44:47], v[28:31], v[92:95]
    v_mfma_f32_16x16x32_bf16 v[120:123], v[44:47], v[32:35], v[120:123]
    v_mfma_f32_16x16x32_bf16 v[124:127], v[44:47], v[36:39], v[124:127]
    s_waitcnt lgkmcnt(6)
    v_mfma_f32_16x16x32_bf16 v[96:99], v[64:67], v[24:27], v[96:99]
    v_mfma_f32_16x16x32_bf16 v[100:103], v[64:67], v[28:31], v[100:103]
    v_mfma_f32_16x16x32_bf16 v[128:131], v[64:67], v[32:35], v[128:131]
    v_mfma_f32_16x16x32_bf16 v[132:135], v[64:67], v[36:39], v[132:135]
    s_waitcnt lgkmcnt(4)
    v_mfma_f32_16x16x32_bf16 v[104:107], v[68:71], v[24:27], v[104:107]
    v_mfma_f32_16x16x32_bf16 v[108:111], v[68:71], v[28:31], v[108:111]
    v_mfma_f32_16x16x32_bf16 v[136:139], v[68:71], v[32:35], v[136:139]
    v_mfma_f32_16x16x32_bf16 v[140:143], v[68:71], v[36:39], v[140:143]
    s_waitcnt lgkmcnt(3)
    v_mfma_f32_16x16x32_bf16 v[144:147], v[40:43], v[48:51], v[144:147]
    ds_read_b128 v[24:27], v11 offset:32768
    s_waitcnt lgkmcnt(3)
    v_mfma_f32_16x16x32_bf16 v[148:151], v[40:43], v[52:55], v[148:151]
    ds_read_b128 v[28:31], v11 offset:34816
    s_waitcnt lgkmcnt(3)
    v_mfma_f32_16x16x32_bf16 v[176:179], v[40:43], v[56:59], v[176:179]
    ds_read_b128 v[32:35], v11 offset:36864
    s_waitcnt lgkmcnt(3)
    v_mfma_f32_16x16x32_bf16 v[180:183], v[40:43], v[60:63], v[180:183]
    ds_read_b128 v[36:39], v11 offset:38912
    ds_read_b64_tr_b16 v[40:41], v12 offset:49152
    ds_read_b64_tr_b16 v[42:43], v12 offset:51200
    v_mfma_f32_16x16x32_bf16 v[152:155], v[44:47], v[48:51], v[152:155]
    v_mfma_f32_16x16x32_bf16 v[156:159], v[44:47], v[52:55], v[156:159]
    v_mfma_f32_16x16x32_bf16 v[184:187], v[44:47], v[56:59], v[184:187]
    v_mfma_f32_16x16x32_bf16 v[188:191], v[44:47], v[60:63], v[188:191]
    ds_read_b64_tr_b16 v[44:45], v13 offset:49152
    ds_read_b64_tr_b16 v[46:47], v13 offset:51200
    v_mfma_f32_16x16x32_bf16 v[160:163], v[64:67], v[48:51], v[160:163]
    v_mfma_f32_16x16x32_bf16 v[164:167], v[64:67], v[52:55], v[164:167]
    v_mfma_f32_16x16x32_bf16 v[192:195], v[64:67], v[56:59], v[192:195]
    v_mfma_f32_16x16x32_bf16 v[196:199], v[64:67], v[60:63], v[196:199]
    ds_read_b64_tr_b16 v[64:65], v14 offset:49152
    ds_read_b64_tr_b16 v[66:67], v14 offset:51200
    v_mfma_f32_16x16x32_bf16 v[168:171], v[68:71], v[48:51], v[168:171]
    v_mfma_f32_16x16x32_bf16 v[172:175], v[68:71], v[52:55], v[172:175]
    v_mfma_f32_16x16x32_bf16 v[200:203], v[68:71], v[56:59], v[200:203]
    v_mfma_f32_16x16x32_bf16 v[204:207], v[68:71], v[60:63], v[204:207]
    ds_read_b64_tr_b16 v[68:69], v15 offset:49152
    ds_read_b64_tr_b16 v[70:71], v15 offset:51200
    s_waitcnt lgkmcnt(6)
    v_mfma_f32_16x16x32_bf16 v[80:83], v[40:43], v[24:27], v[80:83]
    ds_read_b128 v[48:51], v11 offset:40960
    v_mfma_f32_16x16x32_bf16 v[84:87], v[40:43], v[28:31], v[84:87]
    ds_read_b128 v[52:55], v11 offset:43008
    v_mfma_f32_16x16x32_bf16 v[112:115], v[40:43], v[32:35], v[112:115]
    ds_read_b128 v[56:59], v11 offset:45056
    v_mfma_f32_16x16x32_bf16 v[116:119], v[40:43], v[36:39], v[116:119]
    ds_read_b128 v[60:63], v11 offset:47104
    s_waitcnt lgkmcnt(8)
    v_mfma_f32_16x16x32_bf16 v[88:91], v[44:47], v[24:27], v[88:91]
    v_mfma_f32_16x16x32_bf16 v[92:95], v[44:47], v[28:31], v[92:95]
    v_mfma_f32_16x16x32_bf16 v[120:123], v[44:47], v[32:35], v[120:123]
    v_mfma_f32_16x16x32_bf16 v[124:127], v[44:47], v[36:39], v[124:127]
    s_waitcnt lgkmcnt(6)
    v_mfma_f32_16x16x32_bf16 v[96:99], v[64:67], v[24:27], v[96:99]
    v_mfma_f32_16x16x32_bf16 v[100:103], v[64:67], v[28:31], v[100:103]
    v_mfma_f32_16x16x32_bf16 v[128:131], v[64:67], v[32:35], v[128:131]
    v_mfma_f32_16x16x32_bf16 v[132:135], v[64:67], v[36:39], v[132:135]
    s_waitcnt lgkmcnt(4)
    v_mfma_f32_16x16x32_bf16 v[104:107], v[68:71], v[24:27], v[104:107]
    v_mfma_f32_16x16x32_bf16 v[108:111], v[68:71], v[28:31], v[108:111]
    v_mfma_f32_16x16x32_bf16 v[136:139], v[68:71], v[32:35], v[136:139]
    v_mfma_f32_16x16x32_bf16 v[140:143], v[68:71], v[36:39], v[140:143]
    s_waitcnt lgkmcnt(0)
    s_barrier
    v_bfe_u32 v18, v1, 6, 2
    v_lshrrev_b32 v17, 8, v1
    v_lshl_add_u32 v17, v17, 3, v18
    v_and_b32 v16, 3, v17
    v_lshlrev_b32 v16, 2, v16
    v_bfe_u32 v19, v17, 3, 1
    v_lshl_or_b32 v16, v19, 1, v16
    v_lshlrev_b32 v17, 8, v17
    v_bfe_u32 v18, v1, 4, 1
    v_lshl_add_u32 v17, v18, 3, v17
    v_bfe_u32 v18, v1, 5, 1
    s_lshl_b32 s31, s28, 2
    s_add_u32 s31, s31, 0
    v_add_u32 v19, s31, v18
    v_xor_b32 v19, v19, v16
    v_lshl_add_u32 v19, v19, 4, v17
    v_add_u32 v14, 65536, v19
    s_lshl_b32 s31, s28, 2
    s_add_u32 s31, s31, 2
    v_add_u32 v19, s31, v18
    v_xor_b32 v19, v19, v16
    v_lshl_add_u32 v19, v19, 4, v17
    v_add_u32 v15, 65536, v19
    v_mfma_f32_16x16x32_bf16 v[144:147], v[40:43], v[48:51], v[144:147]
    ds_read_b128 v[24:27], v77 offset:0
    v_mfma_f32_16x16x32_bf16 v[148:151], v[40:43], v[52:55], v[148:151]
    ds_read_b128 v[28:31], v77 offset:256
    v_mfma_f32_16x16x32_bf16 v[176:179], v[40:43], v[56:59], v[176:179]
    ds_read_b128 v[32:35], v77 offset:4096
    v_mfma_f32_16x16x32_bf16 v[180:183], v[40:43], v[60:63], v[180:183]
    ds_read_b128 v[36:39], v77 offset:4352
    ds_read_b64_tr_b16 v[40:41], v14 offset:0
    ds_read_b64_tr_b16 v[42:43], v14 offset:1024
    v_mfma_f32_16x16x32_bf16 v[152:155], v[44:47], v[48:51], v[152:155]
    v_mfma_f32_16x16x32_bf16 v[156:159], v[44:47], v[52:55], v[156:159]
    v_mfma_f32_16x16x32_bf16 v[184:187], v[44:47], v[56:59], v[184:187]
    v_mfma_f32_16x16x32_bf16 v[188:191], v[44:47], v[60:63], v[188:191]
    ds_read_b64_tr_b16 v[44:45], v15 offset:0
    ds_read_b64_tr_b16 v[46:47], v15 offset:1024
    v_mfma_f32_16x16x32_bf16 v[160:163], v[64:67], v[48:51], v[160:163]
    v_mfma_f32_16x16x32_bf16 v[164:167], v[64:67], v[52:55], v[164:167]
    v_mfma_f32_16x16x32_bf16 v[192:195], v[64:67], v[56:59], v[192:195]
    v_mfma_f32_16x16x32_bf16 v[196:199], v[64:67], v[60:63], v[196:199]
    ds_read_b64_tr_b16 v[64:65], v14 offset:16384
    ds_read_b64_tr_b16 v[66:67], v14 offset:17408
    v_mfma_f32_16x16x32_bf16 v[168:171], v[68:71], v[48:51], v[168:171]
    v_mfma_f32_16x16x32_bf16 v[172:175], v[68:71], v[52:55], v[172:175]
    v_mfma_f32_16x16x32_bf16 v[200:203], v[68:71], v[56:59], v[200:203]
    v_mfma_f32_16x16x32_bf16 v[204:207], v[68:71], v[60:63], v[204:207]
    ds_read_b64_tr_b16 v[68:69], v15 offset:16384
    ds_read_b64_tr_b16 v[70:71], v15 offset:17408
    s_branch L_pj_TP
L_pj_VP:
    ds_read_b64_tr_b16 v[40:41], v12 offset:0
    ds_read_b64_tr_b16 v[42:43], v12 offset:2048
    ds_read_b128 v[24:27], v10 offset:0
    ds_read_b128 v[28:31], v10 offset:2048
    ds_read_b128 v[32:35], v10 offset:4096
    ds_read_b128 v[36:39], v10 offset:6144
    ds_read_b64_tr_b16 v[44:45], v13 offset:0
    ds_read_b64_tr_b16 v[46:47], v13 offset:2048
    ds_read_b64_tr_b16 v[64:65], v14 offset:0
    ds_read_b64_tr_b16 v[66:67], v14 offset:2048
    ds_read_b64_tr_b16 v[68:69], v15 offset:0
    ds_read_b64_tr_b16 v[70:71], v15 offset:2048
    s_waitcnt lgkmcnt(9)
    v_mfma_f32_16x16x32_bf16 v[80:83], v[24:27], v[40:43], 0
    ds_read_b128 v[48:51], v10 offset:8192
    s_waitcnt vmcnt(3)
    v_lshlrev_b32 v208, 16, v248
    s_waitcnt lgkmcnt(9)
    v_mfma_f32_16x16x32_bf16 v[88:91], v[28:31], v[40:43], 0
    ds_read_b128 v[52:55], v10 offset:10240
    v_and_b32 v209, 0xffff0000, v248
    v_lshlrev_b32 v210, 16, v249
    s_waitcnt lgkmcnt(9)
    v_mfma_f32_16x16x32_bf16 v[112:115], v[32:35], v[40:43], 0
    ds_read_b128 v[56:59], v10 offset:12288
    v_and_b32 v211, 0xffff0000, v249
    v_lshlrev_b32 v212, 16, v250
    s_waitcnt lgkmcnt(9)
    v_mfma_f32_16x16x32_bf16 v[120:123], v[36:39], v[40:43], 0
    ds_read_b128 v[60:63], v10 offset:14336
    v_and_b32 v213, 0xffff0000, v250
    v_lshlrev_b32 v214, 16, v251
    s_waitcnt lgkmcnt(8)
    v_mfma_f32_16x16x32_bf16 v[84:87], v[24:27], v[44:47], 0
    v_and_b32 v215, 0xffff0000, v251
    v_lshlrev_b32 v216, 16, v252
    v_mfma_f32_16x16x32_bf16 v[92:95], v[28:31], v[44:47], 0
    v_and_b32 v217, 0xffff0000, v252
    v_mfma_f32_16x16x32_bf16 v[116:119], v[32:35], v[44:47], 0
    v_lshlrev_b32 v218, 16, v253
    v_and_b32 v219, 0xffff0000, v253
    v_mfma_f32_16x16x32_bf16 v[124:127], v[36:39], v[44:47], 0
    v_lshlrev_b32 v220, 16, v254
    v_and_b32 v221, 0xffff0000, v254
    s_waitcnt lgkmcnt(6)
    v_mfma_f32_16x16x32_bf16 v[96:99], v[24:27], v[64:67], 0
    v_lshlrev_b32 v222, 16, v255
    v_and_b32 v223, 0xffff0000, v255
    v_mfma_f32_16x16x32_bf16 v[104:107], v[28:31], v[64:67], 0
    v_add_f32 v224, v208, v209
    v_add_f32 v226, v210, v211
    v_mfma_f32_16x16x32_bf16 v[128:131], v[32:35], v[64:67], 0
    v_add_f32 v224, v224, v212
    v_mfma_f32_16x16x32_bf16 v[136:139], v[36:39], v[64:67], 0
    v_add_f32 v226, v226, v213
    v_add_f32 v224, v224, v214
    s_waitcnt lgkmcnt(4)
    v_mfma_f32_16x16x32_bf16 v[100:103], v[24:27], v[68:71], 0
    v_add_f32 v226, v226, v215
    v_add_f32 v224, v224, v216
    v_mfma_f32_16x16x32_bf16 v[108:111], v[28:31], v[68:71], 0
    v_add_f32 v226, v226, v217
    v_add_f32 v224, v224, v218
    v_mfma_f32_16x16x32_bf16 v[132:135], v[32:35], v[68:71], 0
    v_add_f32 v226, v226, v219
    v_add_f32 v224, v224, v220
    v_mfma_f32_16x16x32_bf16 v[140:143], v[36:39], v[68:71], 0
    v_add_f32 v226, v226, v221
    s_waitcnt lgkmcnt(3)
    v_mfma_f32_16x16x32_bf16 v[144:147], v[48:51], v[40:43], 0
    ds_read_b128 v[24:27], v11 offset:0
    v_add_f32 v224, v224, v222
    v_add_f32 v226, v226, v223
    s_waitcnt lgkmcnt(3)
    v_mfma_f32_16x16x32_bf16 v[152:155], v[52:55], v[40:43], 0
    ds_read_b128 v[28:31], v11 offset:2048
    v_add_f32 v224, v224, v226
    s_nop 1
    s_waitcnt lgkmcnt(3)
    v_mfma_f32_16x16x32_bf16 v[176:179], v[56:59], v[40:43], 0
    ds_read_b128 v[32:35], v11 offset:4096
    v_add_f32_dpp v224, v224, v224 quad_perm:[1,0,3,2] row_mask:0xf bank_mask:0xf
    s_nop 1
    s_waitcnt lgkmcnt(3)
    v_mfma_f32_16x16x32_bf16 v[184:187], v[60:63], v[40:43], 0
    ds_read_b128 v[36:39], v11 offset:6144
    ds_read_b64_tr_b16 v[40:41], v12 offset:16384
    ds_read_b64_tr_b16 v[42:43], v12 offset:18432
    v_add_f32_dpp v224, v224, v224 quad_perm:[2,3,0,1] row_mask:0xf bank_mask:0xf
    s_nop 1
    v_mfma_f32_16x16x32_bf16 v[148:151], v[48:51], v[44:47], 0
    v_add_f32_dpp v224, v224, v224 row_half_mirror row_mask:0xf bank_mask:0xf
    s_nop 1
    v_mfma_f32_16x16x32_bf16 v[156:159], v[52:55], v[44:47], 0
    v_add_f32_dpp v224, v224, v224 row_mirror row_mask:0xf bank_mask:0xf
    v_mov_b32 v226, v224
    v_mfma_f32_16x16x32_bf16 v[180:183], v[56:59], v[44:47], 0
    s_nop 1
    v_permlane16_swap_b32 v226, v224
    v_mfma_f32_16x16x32_bf16 v[188:191], v[60:63], v[44:47], 0
    ds_read_b64_tr_b16 v[44:45], v13 offset:16384
    ds_read_b64_tr_b16 v[46:47], v13 offset:18432
    v_add_f32 v224, v224, v226
    v_mov_b32 v226, v224
    v_mfma_f32_16x16x32_bf16 v[160:163], v[48:51], v[64:67], 0
    s_nop 1
    v_permlane32_swap_b32 v226, v224
    v_mfma_f32_16x16x32_bf16 v[168:171], v[52:55], v[64:67], 0
    v_add_f32 v224, v224, v226
    v_mul_f32 v224, 0x3a800000, v224
    v_mfma_f32_16x16x32_bf16 v[192:195], v[56:59], v[64:67], 0
    v_sub_f32 v227, v208, v224
    v_mul_f32 v225, v227, v227
    v_mfma_f32_16x16x32_bf16 v[200:203], v[60:63], v[64:67], 0
    ds_read_b64_tr_b16 v[64:65], v14 offset:16384
    ds_read_b64_tr_b16 v[66:67], v14 offset:18432
    v_sub_f32 v227, v209, v224
    v_fmac_f32 v225, v227, v227
    v_mfma_f32_16x16x32_bf16 v[164:167], v[48:51], v[68:71], 0
    v_sub_f32 v227, v210, v224
    v_fmac_f32 v225, v227, v227
    v_mfma_f32_16x16x32_bf16 v[172:175], v[52:55], v[68:71], 0
    v_sub_f32 v227, v211, v224
    v_fmac_f32 v225, v227, v227
    v_mfma_f32_16x16x32_bf16 v[196:199], v[56:59], v[68:71], 0
    v_sub_f32 v227, v212, v224
    s_add_u32 s84, s44, 0
    s_addc_u32 s85, s45, 0
    s_mov_b32 s86, 4194304
    s_mov_b32 s87, 0x00020000
    s_mov_b32 s92, 2097152
    buffer_load_dword v22, v23, s[84:87], s92 offen
    v_mfma_f32_16x16x32_bf16 v[204:207], v[60:63], v[68:71], 0
    ds_read_b64_tr_b16 v[68:69], v15 offset:16384
    ds_read_b64_tr_b16 v[70:71], v15 offset:18432
    s_add_u32 s84, s46, 0
    s_addc_u32 s85, s47, 0
    s_mov_b32 s86, 4194304
    s_mov_b32 s87, 0x00020000
    s_mov_b32 s92, 2097152
    buffer_load_dword v22, v23, s[84:87], s92 offen
    s_waitcnt lgkmcnt(6)
    v_mfma_f32_16x16x32_bf16 v[80:83], v[24:27], v[40:43], v[80:83]
    ds_read_b128 v[48:51], v11 offset:8192
    v_fmac_f32 v225, v227, v227
    v_sub_f32 v227, v213, v224
    v_mfma_f32_16x16x32_bf16 v[88:91], v[28:31], v[40:43], v[88:91]
    ds_read_b128 v[52:55], v11 offset:10240
    v_fmac_f32 v225, v227, v227
    v_sub_f32 v227, v214, v224
    v_mfma_f32_16x16x32_bf16 v[112:115], v[32:35], v[40:43], v[112:115]
    ds_read_b128 v[56:59], v11 offset:12288
    v_fmac_f32 v225, v227, v227
    v_sub_f32 v227, v215, v224
    v_mfma_f32_16x16x32_bf16 v[120:123], v[36:39], v[40:43], v[120:123]
    ds_read_b128 v[60:63], v11 offset:14336
    v_fmac_f32 v225, v227, v227
    v_sub_f32 v227, v216, v224
    s_waitcnt lgkmcnt(8)
    v_mfma_f32_16x16x32_bf16 v[84:87], v[24:27], v[44:47], v[84:87]
    v_fmac_f32 v225, v227, v227
    v_sub_f32 v227, v217, v224
    v_mfma_f32_16x16x32_bf16 v[92:95], v[28:31], v[44:47], v[92:95]
    v_fmac_f32 v225, v227, v227
    v_mfma_f32_16x16x32_bf16 v[116:119], v[32:35], v[44:47], v[116:119]
    v_sub_f32 v227, v218, v224
    v_fmac_f32 v225, v227, v227
    v_mfma_f32_16x16x32_bf16 v[124:127], v[36:39], v[44:47], v[124:127]
    v_sub_f32 v227, v219, v224
    v_fmac_f32 v225, v227, v227
    s_waitcnt lgkmcnt(6)
    v_mfma_f32_16x16x32_bf16 v[96:99], v[24:27], v[64:67], v[96:99]
    v_sub_f32 v227, v220, v224
    v_fmac_f32 v225, v227, v227
    v_mfma_f32_16x16x32_bf16 v[104:107], v[28:31], v[64:67], v[104:107]
    v_sub_f32 v227, v221, v224
    v_fmac_f32 v225, v227, v227
    v_mfma_f32_16x16x32_bf16 v[128:131], v[32:35], v[64:67], v[128:131]
    v_sub_f32 v227, v222, v224
    v_mfma_f32_16x16x32_bf16 v[136:139], v[36:39], v[64:67], v[136:139]
    v_fmac_f32 v225, v227, v227
    v_sub_f32 v227, v223, v224
    s_waitcnt lgkmcnt(4)
    v_mfma_f32_16x16x32_bf16 v[100:103], v[24:27], v[68:71], v[100:103]
    v_fmac_f32 v225, v227, v227
    s_nop 1
    v_mfma_f32_16x16x32_bf16 v[108:111], v[28:31], v[68:71], v[108:111]
    v_add_f32_dpp v225, v225, v225 quad_perm:[1,0,3,2] row_mask:0xf bank_mask:0xf
    s_nop 1
    v_mfma_f32_16x16x32_bf16 v[132:135], v[32:35], v[68:71], v[132:135]
    v_add_f32_dpp v225, v225, v225 quad_perm:[2,3,0,1] row_mask:0xf bank_mask:0xf
    s_nop 1
    v_mfma_f32_16x16x32_bf16 v[140:143], v[36:39], v[68:71], v[140:143]
    v_add_f32_dpp v225, v225, v225 row_half_mirror row_mask:0xf bank_mask:0xf
    s_waitcnt lgkmcnt(0)
    s_barrier
    v_mfma_f32_16x16x32_bf16 v[144:147], v[48:51], v[40:43], v[144:147]
    ds_read_b128 v[24:27], v10 offset:32768
    v_mfma_f32_16x16x32_bf16 v[152:155], v[52:55], v[40:43], v[152:155]
    ds_read_b128 v[28:31], v10 offset:34816
    v_mfma_f32_16x16x32_bf16 v[176:179], v[56:59], v[40:43], v[176:179]
    ds_read_b128 v[32:35], v10 offset:36864
    v_mfma_f32_16x16x32_bf16 v[184:187], v[60:63], v[40:43], v[184:187]
    ds_read_b128 v[36:39], v10 offset:38912
    ds_read_b64_tr_b16 v[40:41], v12 offset:32768
    ds_read_b64_tr_b16 v[42:43], v12 offset:34816
    v_mfma_f32_16x16x32_bf16 v[148:151], v[48:51], v[44:47], v[148:151]
    v_mfma_f32_16x16x32_bf16 v[156:159], v[52:55], v[44:47], v[156:159]
    v_mfma_f32_16x16x32_bf16 v[180:183], v[56:59], v[44:47], v[180:183]
    v_mfma_f32_16x16x32_bf16 v[188:191], v[60:63], v[44:47], v[188:191]
    ds_read_b64_tr_b16 v[44:45], v13 offset:32768
    ds_read_b64_tr_b16 v[46:47], v13 offset:34816
    v_mfma_f32_16x16x32_bf16 v[160:163], v[48:51], v[64:67], v[160:163]
    v_mfma_f32_16x16x32_bf16 v[168:171], v[52:55], v[64:67], v[168:171]
    v_mfma_f32_16x16x32_bf16 v[192:195], v[56:59], v[64:67], v[192:195]
    v_mfma_f32_16x16x32_bf16 v[200:203], v[60:63], v[64:67], v[200:203]
    ds_read_b64_tr_b16 v[64:65], v14 offset:32768
    ds_read_b64_tr_b16 v[66:67], v14 offset:34816
    v_mfma_f32_16x16x32_bf16 v[164:167], v[48:51], v[68:71], v[164:167]
    v_mfma_f32_16x16x32_bf16 v[172:175], v[52:55], v[68:71], v[172:175]
    v_mfma_f32_16x16x32_bf16 v[196:199], v[56:59], v[68:71], v[196:199]
    v_mfma_f32_16x16x32_bf16 v[204:207], v[60:63], v[68:71], v[204:207]
    ds_read_b64_tr_b16 v[68:69], v15 offset:32768
    ds_read_b64_tr_b16 v[70:71], v15 offset:34816
    s_waitcnt lgkmcnt(6)
    v_mfma_f32_16x16x32_bf16 v[80:83], v[24:27], v[40:43], v[80:83]
    ds_read_b128 v[48:51], v10 offset:40960
    s_nop 1
    v_add_f32_dpp v225, v225, v225 row_mirror row_mask:0xf bank_mask:0xf
    v_mfma_f32_16x16x32_bf16 v[88:91], v[28:31], v[40:43], v[88:91]
    ds_read_b128 v[52:55], v10 offset:43008
    v_mov_b32 v226, v225
    s_nop 1
    v_mfma_f32_16x16x32_bf16 v[112:115], v[32:35], v[40:43], v[112:115]
    ds_read_b128 v[56:59], v10 offset:45056
    v_permlane16_swap_b32 v226, v225
    v_add_f32 v225, v225, v226
    v_mfma_f32_16x16x32_bf16 v[120:123], v[36:39], v[40:43], v[120:123]
    ds_read_b128 v[60:63], v10 offset:47104
    v_mov_b32 v226, v225
    s_nop 1
    s_waitcnt lgkmcnt(8)
    v_mfma_f32_16x16x32_bf16 v[84:87], v[24:27], v[44:47], v[84:87]
    v_permlane32_swap_b32 v226, v225
    v_add_f32 v225, v225, v226
    v_mfma_f32_16x16x32_bf16 v[92:95], v[28:31], v[44:47], v[92:95]
    v_mul_f32 v225, 0x3a800000, v225
    v_mfma_f32_16x16x32_bf16 v[116:119], v[32:35], v[44:47], v[116:119]
    v_cvt_pk_bf16_f32 v224, v224, v224
    v_lshlrev_b32 v224, 16, v224
    v_mfma_f32_16x16x32_bf16 v[124:127], v[36:39], v[44:47], v[124:127]
    v_cvt_pk_bf16_f32 v225, v225, v225
    v_lshlrev_b32 v225, 16, v225
    s_waitcnt lgkmcnt(6)
    v_mfma_f32_16x16x32_bf16 v[96:99], v[24:27], v[64:67], v[96:99]
    v_add_f32 v225, 0x3727c5ac, v225
    v_cvt_pk_bf16_f32 v225, v225, v225
    v_mfma_f32_16x16x32_bf16 v[104:107], v[28:31], v[64:67], v[104:107]
    v_lshlrev_b32 v225, 16, v225
    v_sqrt_f32 v225, v225
    v_mfma_f32_16x16x32_bf16 v[128:131], v[32:35], v[64:67], v[128:131]
    s_nop 0
    v_mfma_f32_16x16x32_bf16 v[136:139], v[36:39], v[64:67], v[136:139]
    v_cvt_pk_bf16_f32 v225, v225, v225
    v_lshlrev_b32 v225, 16, v225
    s_waitcnt lgkmcnt(4)
    v_mfma_f32_16x16x32_bf16 v[100:103], v[24:27], v[68:71], v[100:103]
    v_rcp_f32 v225, v225
    v_sub_f32 v208, v208, v224
    v_mfma_f32_16x16x32_bf16 v[108:111], v[28:31], v[68:71], v[108:111]
    v_sub_f32 v209, v209, v224
    v_sub_f32 v210, v210, v224
    v_mfma_f32_16x16x32_bf16 v[132:135], v[32:35], v[68:71], v[132:135]
    v_sub_f32 v211, v211, v224
    v_sub_f32 v212, v212, v224
    v_mfma_f32_16x16x32_bf16 v[140:143], v[36:39], v[68:71], v[140:143]
    v_sub_f32 v213, v213, v224
    s_waitcnt lgkmcnt(3)
    v_mfma_f32_16x16x32_bf16 v[144:147], v[48:51], v[40:43], v[144:147]
    ds_read_b128 v[24:27], v11 offset:32768
    v_sub_f32 v214, v214, v224
    v_sub_f32 v215, v215, v224
    s_waitcnt lgkmcnt(3)
    v_mfma_f32_16x16x32_bf16 v[152:155], v[52:55], v[40:43], v[152:155]
    ds_read_b128 v[28:31], v11 offset:34816
    v_sub_f32 v216, v216, v224
    v_sub_f32 v217, v217, v224
    s_waitcnt lgkmcnt(3)
    v_mfma_f32_16x16x32_bf16 v[176:179], v[56:59], v[40:43], v[176:179]
    ds_read_b128 v[32:35], v11 offset:36864
    v_sub_f32 v218, v218, v224
    v_sub_f32 v219, v219, v224
    s_waitcnt lgkmcnt(3)
    v_mfma_f32_16x16x32_bf16 v[184:187], v[60:63], v[40:43], v[184:187]
    ds_read_b128 v[36:39], v11 offset:38912
    ds_read_b64_tr_b16 v[40:41], v12 offset:49152
    ds_read_b64_tr_b16 v[42:43], v12 offset:51200
    v_sub_f32 v220, v220, v224
    v_sub_f32 v221, v221, v224
    v_mfma_f32_16x16x32_bf16 v[148:151], v[48:51], v[44:47], v[148:151]
    v_sub_f32 v222, v222, v224
    v_sub_f32 v223, v223, v224
    v_mfma_f32_16x16x32_bf16 v[156:159], v[52:55], v[44:47], v[156:159]
    v_cvt_pk_bf16_f32 v248, v208, v209
    v_cvt_pk_bf16_f32 v249, v210, v211
    v_mfma_f32_16x16x32_bf16 v[180:183], v[56:59], v[44:47], v[180:183]
    v_cvt_pk_bf16_f32 v250, v212, v213
    v_cvt_pk_bf16_f32 v251, v214, v215
    v_mfma_f32_16x16x32_bf16 v[188:191], v[60:63], v[44:47], v[188:191]
    ds_read_b64_tr_b16 v[44:45], v13 offset:49152
    ds_read_b64_tr_b16 v[46:47], v13 offset:51200
    v_cvt_pk_bf16_f32 v252, v216, v217
    v_cvt_pk_bf16_f32 v253, v218, v219
    v_mfma_f32_16x16x32_bf16 v[160:163], v[48:51], v[64:67], v[160:163]
    v_cvt_pk_bf16_f32 v254, v220, v221
    v_cvt_pk_bf16_f32 v255, v222, v223
    v_mfma_f32_16x16x32_bf16 v[168:171], v[52:55], v[64:67], v[168:171]
    v_lshlrev_b32 v208, 16, v248
    v_and_b32 v209, 0xffff0000, v248
    v_mfma_f32_16x16x32_bf16 v[192:195], v[56:59], v[64:67], v[192:195]
    v_lshlrev_b32 v210, 16, v249
    v_and_b32 v211, 0xffff0000, v249
    v_mfma_f32_16x16x32_bf16 v[200:203], v[60:63], v[64:67], v[200:203]
    ds_read_b64_tr_b16 v[64:65], v14 offset:49152
    ds_read_b64_tr_b16 v[66:67], v14 offset:51200
    v_lshlrev_b32 v212, 16, v250
    v_and_b32 v213, 0xffff0000, v250
    v_mfma_f32_16x16x32_bf16 v[164:167], v[48:51], v[68:71], v[164:167]
    v_lshlrev_b32 v214, 16, v251
    v_and_b32 v215, 0xffff0000, v251
    v_mfma_f32_16x16x32_bf16 v[172:175], v[52:55], v[68:71], v[172:175]
    v_lshlrev_b32 v216, 16, v252
    v_and_b32 v217, 0xffff0000, v252
    v_mfma_f32_16x16x32_bf16 v[196:199], v[56:59], v[68:71], v[196:199]
    v_lshlrev_b32 v218, 16, v253
    s_add_u32 s84, s44, 0
    s_addc_u32 s85, s45, 0
    s_mov_b32 s86, 4194304
    s_mov_b32 s87, 0x00020000
    s_mov_b32 s92, 3145728
    buffer_load_dword v22, v23, s[84:87], s92 offen
    v_mfma_f32_16x16x32_bf16 v[204:207], v[60:63], v[68:71], v[204:207]
    ds_read_b64_tr_b16 v[68:69], v15 offset:49152
    ds_read_b64_tr_b16 v[70:71], v15 offset:51200
    s_add_u32 s84, s46, 0
    s_addc_u32 s85, s47, 0
    s_mov_b32 s86, 4194304
    s_mov_b32 s87, 0x00020000
    s_mov_b32 s92, 3145728
    buffer_load_dword v22, v23, s[84:87], s92 offen
    s_waitcnt lgkmcnt(6)
    v_mfma_f32_16x16x32_bf16 v[80:83], v[24:27], v[40:43], v[80:83]
    ds_read_b128 v[48:51], v11 offset:40960
    v_and_b32 v219, 0xffff0000, v253
    v_lshlrev_b32 v220, 16, v254
    v_mfma_f32_16x16x32_bf16 v[88:91], v[28:31], v[40:43], v[88:91]
    ds_read_b128 v[52:55], v11 offset:43008
    v_and_b32 v221, 0xffff0000, v254
    v_lshlrev_b32 v222, 16, v255
    v_mfma_f32_16x16x32_bf16 v[112:115], v[32:35], v[40:43], v[112:115]
    ds_read_b128 v[56:59], v11 offset:45056
    v_and_b32 v223, 0xffff0000, v255
    v_mul_f32 v208, v208, v225
    v_mfma_f32_16x16x32_bf16 v[120:123], v[36:39], v[40:43], v[120:123]
    ds_read_b128 v[60:63], v11 offset:47104
    v_mul_f32 v209, v209, v225
    v_mul_f32 v210, v210, v225
    s_waitcnt lgkmcnt(8)
    v_mfma_f32_16x16x32_bf16 v[84:87], v[24:27], v[44:47], v[84:87]
    v_mul_f32 v211, v211, v225
    v_mul_f32 v212, v212, v225
    v_mfma_f32_16x16x32_bf16 v[92:95], v[28:31], v[44:47], v[92:95]
    v_mul_f32 v213, v213, v225
    v_mul_f32 v214, v214, v225
    v_mfma_f32_16x16x32_bf16 v[116:119], v[32:35], v[44:47], v[116:119]
    v_mul_f32 v215, v215, v225
    v_mul_f32 v216, v216, v225
    v_mfma_f32_16x16x32_bf16 v[124:127], v[36:39], v[44:47], v[124:127]
    v_mul_f32 v217, v217, v225
    s_waitcnt lgkmcnt(6)
    v_mfma_f32_16x16x32_bf16 v[96:99], v[24:27], v[64:67], v[96:99]
    v_mul_f32 v218, v218, v225
    v_mul_f32 v219, v219, v225
    v_mfma_f32_16x16x32_bf16 v[104:107], v[28:31], v[64:67], v[104:107]
    v_mul_f32 v220, v220, v225
    v_mul_f32 v221, v221, v225
    v_mfma_f32_16x16x32_bf16 v[128:131], v[32:35], v[64:67], v[128:131]
    v_mul_f32 v222, v222, v225
    v_mul_f32 v223, v223, v225
    v_mfma_f32_16x16x32_bf16 v[136:139], v[36:39], v[64:67], v[136:139]
    v_cvt_pk_bf16_f32 v248, v208, v209
    v_cvt_pk_bf16_f32 v249, v210, v211
    s_waitcnt lgkmcnt(4)
    v_mfma_f32_16x16x32_bf16 v[100:103], v[24:27], v[68:71], v[100:103]
    v_cvt_pk_bf16_f32 v250, v212, v213
    v_cvt_pk_bf16_f32 v251, v214, v215
    v_mfma_f32_16x16x32_bf16 v[108:111], v[28:31], v[68:71], v[108:111]
    v_cvt_pk_bf16_f32 v252, v216, v217
    v_cvt_pk_bf16_f32 v253, v218, v219
    v_mfma_f32_16x16x32_bf16 v[132:135], v[32:35], v[68:71], v[132:135]
    v_cvt_pk_bf16_f32 v254, v220, v221
    v_cvt_pk_bf16_f32 v255, v222, v223
    v_mfma_f32_16x16x32_bf16 v[140:143], v[36:39], v[68:71], v[140:143]
    s_lshl_b32 s35, s19, 4
    s_add_u32 s35, s35, 131072
    v_lshl_add_u32 v228, v1, 4, s35
    ds_write_b128 v228, v[248:251]
    ds_write_b128 v228, v[252:255] offset:128
    s_waitcnt lgkmcnt(0)
    s_barrier
    v_mfma_f32_16x16x32_bf16 v[144:147], v[48:51], v[40:43], v[144:147]
    ds_read_b128 v[24:27], v10 offset:0
    v_mfma_f32_16x16x32_bf16 v[152:155], v[52:55], v[40:43], v[152:155]
    ds_read_b128 v[28:31], v10 offset:2048
    v_mfma_f32_16x16x32_bf16 v[176:179], v[56:59], v[40:43], v[176:179]
    ds_read_b128 v[32:35], v10 offset:4096
    v_mfma_f32_16x16x32_bf16 v[184:187], v[60:63], v[40:43], v[184:187]
    ds_read_b128 v[36:39], v10 offset:6144
    ds_read_b64_tr_b16 v[40:41], v12 offset:0
    ds_read_b64_tr_b16 v[42:43], v12 offset:2048
    v_mfma_f32_16x16x32_bf16 v[148:151], v[48:51], v[44:47], v[148:151]
    v_mfma_f32_16x16x32_bf16 v[156:159], v[52:55], v[44:47], v[156:159]
    v_mfma_f32_16x16x32_bf16 v[180:183], v[56:59], v[44:47], v[180:183]
    v_mfma_f32_16x16x32_bf16 v[188:191], v[60:63], v[44:47], v[188:191]
    ds_read_b64_tr_b16 v[44:45], v13 offset:0
    ds_read_b64_tr_b16 v[46:47], v13 offset:2048
    v_mfma_f32_16x16x32_bf16 v[160:163], v[48:51], v[64:67], v[160:163]
    v_mfma_f32_16x16x32_bf16 v[168:171], v[52:55], v[64:67], v[168:171]
    v_mfma_f32_16x16x32_bf16 v[192:195], v[56:59], v[64:67], v[192:195]
    v_mfma_f32_16x16x32_bf16 v[200:203], v[60:63], v[64:67], v[200:203]
    ds_read_b64_tr_b16 v[64:65], v14 offset:0
    ds_read_b64_tr_b16 v[66:67], v14 offset:2048
    v_mfma_f32_16x16x32_bf16 v[164:167], v[48:51], v[68:71], v[164:167]
    v_mfma_f32_16x16x32_bf16 v[172:175], v[52:55], v[68:71], v[172:175]
    v_mfma_f32_16x16x32_bf16 v[196:199], v[56:59], v[68:71], v[196:199]
    v_mfma_f32_16x16x32_bf16 v[204:207], v[60:63], v[68:71], v[204:207]
    ds_read_b64_tr_b16 v[68:69], v15 offset:0
    ds_read_b64_tr_b16 v[70:71], v15 offset:2048
    s_waitcnt lgkmcnt(6)
    v_mfma_f32_16x16x32_bf16 v[80:83], v[24:27], v[40:43], v[80:83]
    ds_read_b128 v[48:51], v10 offset:8192
    s_and_b32 s35, s19, 3
    s_lshl_b32 s35, s35, 12
    s_add_u32 s35, s35, 131072
    v_add_u32 v228, s35, v1
    ds_read_b128 v[208:211], v228 offset:0
    ds_read_b128 v[212:215], v228 offset:1024
    ds_read_b128 v[216:219], v228 offset:2048
    ds_read_b128 v[220:223], v228 offset:3072
    v_mfma_f32_16x16x32_bf16 v[88:91], v[28:31], v[40:43], v[88:91]
    ds_read_b128 v[52:55], v10 offset:10240
    v_mfma_f32_16x16x32_bf16 v[112:115], v[32:35], v[40:43], v[112:115]
    ds_read_b128 v[56:59], v10 offset:12288
    v_mfma_f32_16x16x32_bf16 v[120:123], v[36:39], v[40:43], v[120:123]
    ds_read_b128 v[60:63], v10 offset:14336
    s_waitcnt lgkmcnt(12)
    v_mfma_f32_16x16x32_bf16 v[84:87], v[24:27], v[44:47], v[84:87]
    v_mfma_f32_16x16x32_bf16 v[92:95], v[28:31], v[44:47], v[92:95]
    v_mfma_f32_16x16x32_bf16 v[116:119], v[32:35], v[44:47], v[116:119]
    v_mfma_f32_16x16x32_bf16 v[124:127], v[36:39], v[44:47], v[124:127]
    s_waitcnt lgkmcnt(10)
    v_mfma_f32_16x16x32_bf16 v[96:99], v[24:27], v[64:67], v[96:99]
    v_lshrrev_b32 v229, 8, v1
    v_lshlrev_b32 v229, 10, v229
    v_bfe_u32 v230, v1, 7, 1
    v_lshl_add_u32 v229, v230, 9, v229
    v_and_b32 v230, 0x70, v1
    v_add_u32 v229, v229, v230
    v_mfma_f32_16x16x32_bf16 v[104:107], v[28:31], v[64:67], v[104:107]
    v_mfma_f32_16x16x32_bf16 v[128:131], v[32:35], v[64:67], v[128:131]
    v_mfma_f32_16x16x32_bf16 v[136:139], v[36:39], v[64:67], v[136:139]
    s_waitcnt lgkmcnt(8)
    v_mfma_f32_16x16x32_bf16 v[100:103], v[24:27], v[68:71], v[100:103]
    v_mfma_f32_16x16x32_bf16 v[108:111], v[28:31], v[68:71], v[108:111]
    v_mfma_f32_16x16x32_bf16 v[132:135], v[32:35], v[68:71], v[132:135]
    v_mfma_f32_16x16x32_bf16 v[140:143], v[36:39], v[68:71], v[140:143]
    s_waitcnt lgkmcnt(7)
    v_mfma_f32_16x16x32_bf16 v[144:147], v[48:51], v[40:43], v[144:147]
    ds_read_b128 v[24:27], v11 offset:0
    s_lshr_b32 s35, s2, 2
    s_lshl_b32 s35, s35, 16
    s_and_b32 s101, s19, 3
    s_lshl_b32 s101, s101, 14
    s_add_u32 s35, s35, s101
    s_and_b32 s101, s2, 3
    s_lshl_b32 s101, s101, 7
    s_add_u32 s35, s35, s101
    s_waitcnt lgkmcnt(4)
    buffer_store_dwordx4 v[208:211], v229, s[80:83], s35 offen sc1
    s_add_u32 s35, s35, 4096
    buffer_store_dwordx4 v[212:215], v229, s[80:83], s35 offen sc1
    s_add_u32 s35, s35, 4096
    buffer_store_dwordx4 v[216:219], v229, s[80:83], s35 offen sc1
    s_add_u32 s35, s35, 4096
    buffer_store_dwordx4 v[220:223], v229, s[80:83], s35 offen sc1
    s_nop 1
    s_waitcnt lgkmcnt(3)
    v_mfma_f32_16x16x32_bf16 v[152:155], v[52:55], v[40:43], v[152:155]
    ds_read_b128 v[28:31], v11 offset:2048
    s_waitcnt lgkmcnt(3)
    v_mfma_f32_16x16x32_bf16 v[176:179], v[56:59], v[40:43], v[176:179]
    ds_read_b128 v[32:35], v11 offset:4096
    s_waitcnt lgkmcnt(3)
    v_mfma_f32_16x16x32_bf16 v[184:187], v[60:63], v[40:43], v[184:187]
    ds_read_b128 v[36:39], v11 offset:6144
    ds_read_b64_tr_b16 v[40:41], v12 offset:16384
    ds_read_b64_tr_b16 v[42:43], v12 offset:18432
    v_mfma_f32_16x16x32_bf16 v[148:151], v[48:51], v[44:47], v[148:151]
    v_mfma_f32_16x16x32_bf16 v[156:159], v[52:55], v[44:47], v[156:159]
    v_mfma_f32_16x16x32_bf16 v[180:183], v[56:59], v[44:47], v[180:183]
    v_mfma_f32_16x16x32_bf16 v[188:191], v[60:63], v[44:47], v[188:191]
    ds_read_b64_tr_b16 v[44:45], v13 offset:16384
    ds_read_b64_tr_b16 v[46:47], v13 offset:18432
    v_mfma_f32_16x16x32_bf16 v[160:163], v[48:51], v[64:67], v[160:163]
    v_mfma_f32_16x16x32_bf16 v[168:171], v[52:55], v[64:67], v[168:171]
    v_mfma_f32_16x16x32_bf16 v[192:195], v[56:59], v[64:67], v[192:195]
    v_mfma_f32_16x16x32_bf16 v[200:203], v[60:63], v[64:67], v[200:203]
    ds_read_b64_tr_b16 v[64:65], v14 offset:16384
    ds_read_b64_tr_b16 v[66:67], v14 offset:18432
    v_mfma_f32_16x16x32_bf16 v[164:167], v[48:51], v[68:71], v[164:167]
    v_mfma_f32_16x16x32_bf16 v[172:175], v[52:55], v[68:71], v[172:175]
    v_mfma_f32_16x16x32_bf16 v[196:199], v[56:59], v[68:71], v[196:199]
    v_mfma_f32_16x16x32_bf16 v[204:207], v[60:63], v[68:71], v[204:207]
    ds_read_b64_tr_b16 v[68:69], v15 offset:16384
    ds_read_b64_tr_b16 v[70:71], v15 offset:18432
    s_waitcnt lgkmcnt(6)
    v_mfma_f32_16x16x32_bf16 v[80:83], v[24:27], v[40:43], v[80:83]
    ds_read_b128 v[48:51], v11 offset:8192
    s_cmp_lg_u32 s19, 7
    s_cbranch_scc1 L_non2_11
    v_cmp_eq_u32 vcc, 0, v240
    v_mov_b32 v241, 147456
    s_nop 0
    v_cndmask_b32 v240, v240, v242, vcc
    s_mov_b64 exec, 1
    ds_write_b32 v241, v240
    s_mov_b64 exec, -1
L_non2_11:
    v_mfma_f32_16x16x32_bf16 v[88:91], v[28:31], v[40:43], v[88:91]
    ds_read_b128 v[52:55], v11 offset:10240
    v_mfma_f32_16x16x32_bf16 v[112:115], v[32:35], v[40:43], v[112:115]
    ds_read_b128 v[56:59], v11 offset:12288
    v_mfma_f32_16x16x32_bf16 v[120:123], v[36:39], v[40:43], v[120:123]
    ds_read_b128 v[60:63], v11 offset:14336
    s_waitcnt lgkmcnt(8)
    v_mfma_f32_16x16x32_bf16 v[84:87], v[24:27], v[44:47], v[84:87]
    v_mfma_f32_16x16x32_bf16 v[92:95], v[28:31], v[44:47], v[92:95]
    v_mfma_f32_16x16x32_bf16 v[116:119], v[32:35], v[44:47], v[116:119]
    v_mfma_f32_16x16x32_bf16 v[124:127], v[36:39], v[44:47], v[124:127]
    s_waitcnt lgkmcnt(6)
    v_mfma_f32_16x16x32_bf16 v[96:99], v[24:27], v[64:67], v[96:99]
    v_mfma_f32_16x16x32_bf16 v[104:107], v[28:31], v[64:67], v[104:107]
    v_mfma_f32_16x16x32_bf16 v[128:131], v[32:35], v[64:67], v[128:131]
    v_mfma_f32_16x16x32_bf16 v[136:139], v[36:39], v[64:67], v[136:139]
    s_waitcnt lgkmcnt(4)
    v_mfma_f32_16x16x32_bf16 v[100:103], v[24:27], v[68:71], v[100:103]
    v_mfma_f32_16x16x32_bf16 v[108:111], v[28:31], v[68:71], v[108:111]
    v_mfma_f32_16x16x32_bf16 v[132:135], v[32:35], v[68:71], v[132:135]
    v_mfma_f32_16x16x32_bf16 v[140:143], v[36:39], v[68:71], v[140:143]
    s_waitcnt lgkmcnt(0)
    s_barrier
    v_mfma_f32_16x16x32_bf16 v[144:147], v[48:51], v[40:43], v[144:147]
    ds_read_b128 v[24:27], v10 offset:32768
    v_mfma_f32_16x16x32_bf16 v[152:155], v[52:55], v[40:43], v[152:155]
    ds_read_b128 v[28:31], v10 offset:34816
    v_mfma_f32_16x16x32_bf16 v[176:179], v[56:59], v[40:43], v[176:179]
    ds_read_b128 v[32:35], v10 offset:36864
    v_mfma_f32_16x16x32_bf16 v[184:187], v[60:63], v[40:43], v[184:187]
    ds_read_b128 v[36:39], v10 offset:38912
    ds_read_b64_tr_b16 v[40:41], v12 offset:32768
    ds_read_b64_tr_b16 v[42:43], v12 offset:34816
    v_mfma_f32_16x16x32_bf16 v[148:151], v[48:51], v[44:47], v[148:151]
    v_mfma_f32_16x16x32_bf16 v[156:159], v[52:55], v[44:47], v[156:159]
    v_mfma_f32_16x16x32_bf16 v[180:183], v[56:59], v[44:47], v[180:183]
    v_mfma_f32_16x16x32_bf16 v[188:191], v[60:63], v[44:47], v[188:191]
    ds_read_b64_tr_b16 v[44:45], v13 offset:32768
    ds_read_b64_tr_b16 v[46:47], v13 offset:34816
    v_mfma_f32_16x16x32_bf16 v[160:163], v[48:51], v[64:67], v[160:163]
    v_mfma_f32_16x16x32_bf16 v[168:171], v[52:55], v[64:67], v[168:171]
    v_mfma_f32_16x16x32_bf16 v[192:195], v[56:59], v[64:67], v[192:195]
    v_mfma_f32_16x16x32_bf16 v[200:203], v[60:63], v[64:67], v[200:203]
    ds_read_b64_tr_b16 v[64:65], v14 offset:32768
    ds_read_b64_tr_b16 v[66:67], v14 offset:34816
    v_mfma_f32_16x16x32_bf16 v[164:167], v[48:51], v[68:71], v[164:167]
    v_mfma_f32_16x16x32_bf16 v[172:175], v[52:55], v[68:71], v[172:175]
    v_mfma_f32_16x16x32_bf16 v[196:199], v[56:59], v[68:71], v[196:199]
    v_mfma_f32_16x16x32_bf16 v[204:207], v[60:63], v[68:71], v[204:207]
    ds_read_b64_tr_b16 v[68:69], v15 offset:32768
    ds_read_b64_tr_b16 v[70:71], v15 offset:34816
    s_waitcnt lgkmcnt(6)
    v_mfma_f32_16x16x32_bf16 v[80:83], v[24:27], v[40:43], v[80:83]
    ds_read_b128 v[48:51], v10 offset:40960
    v_mov_b32 v241, 147456
    ds_read_b32 v240, v241
    v_mfma_f32_16x16x32_bf16 v[88:91], v[28:31], v[40:43], v[88:91]
    ds_read_b128 v[52:55], v10 offset:43008
    v_mfma_f32_16x16x32_bf16 v[112:115], v[32:35], v[40:43], v[112:115]
    ds_read_b128 v[56:59], v10 offset:45056
    v_mfma_f32_16x16x32_bf16 v[120:123], v[36:39], v[40:43], v[120:123]
    ds_read_b128 v[60:63], v10 offset:47104
    s_waitcnt lgkmcnt(9)
    v_mfma_f32_16x16x32_bf16 v[84:87], v[24:27], v[44:47], v[84:87]
    v_mfma_f32_16x16x32_bf16 v[92:95], v[28:31], v[44:47], v[92:95]
    v_mfma_f32_16x16x32_bf16 v[116:119], v[32:35], v[44:47], v[116:119]
    v_mfma_f32_16x16x32_bf16 v[124:127], v[36:39], v[44:47], v[124:127]
    s_waitcnt lgkmcnt(7)
    v_mfma_f32_16x16x32_bf16 v[96:99], v[24:27], v[64:67], v[96:99]
    v_mfma_f32_16x16x32_bf16 v[104:107], v[28:31], v[64:67], v[104:107]
    v_mfma_f32_16x16x32_bf16 v[128:131], v[32:35], v[64:67], v[128:131]
    v_mfma_f32_16x16x32_bf16 v[136:139], v[36:39], v[64:67], v[136:139]
    s_waitcnt lgkmcnt(5)
    v_mfma_f32_16x16x32_bf16 v[100:103], v[24:27], v[68:71], v[100:103]
    v_mfma_f32_16x16x32_bf16 v[108:111], v[28:31], v[68:71], v[108:111]
    v_mfma_f32_16x16x32_bf16 v[132:135], v[32:35], v[68:71], v[132:135]
    v_mfma_f32_16x16x32_bf16 v[140:143], v[36:39], v[68:71], v[140:143]
    s_waitcnt lgkmcnt(4)
    v_mfma_f32_16x16x32_bf16 v[144:147], v[48:51], v[40:43], v[144:147]
    ds_read_b128 v[24:27], v11 offset:32768
    s_waitcnt lgkmcnt(4)
    v_readfirstlane_b32 s95, v240
    s_waitcnt lgkmcnt(3)
    v_mfma_f32_16x16x32_bf16 v[152:155], v[52:55], v[40:43], v[152:155]
    ds_read_b128 v[28:31], v11 offset:34816
    s_waitcnt lgkmcnt(3)
    v_mfma_f32_16x16x32_bf16 v[176:179], v[56:59], v[40:43], v[176:179]
    ds_read_b128 v[32:35], v11 offset:36864
    s_waitcnt lgkmcnt(3)
    v_mfma_f32_16x16x32_bf16 v[184:187], v[60:63], v[40:43], v[184:187]
    ds_read_b128 v[36:39], v11 offset:38912
    ds_read_b64_tr_b16 v[40:41], v12 offset:49152
    ds_read_b64_tr_b16 v[42:43], v12 offset:51200
    v_mfma_f32_16x16x32_bf16 v[148:151], v[48:51], v[44:47], v[148:151]
    v_mfma_f32_16x16x32_bf16 v[156:159], v[52:55], v[44:47], v[156:159]
    v_mfma_f32_16x16x32_bf16 v[180:183], v[56:59], v[44:47], v[180:183]
    v_mfma_f32_16x16x32_bf16 v[188:191], v[60:63], v[44:47], v[188:191]
    ds_read_b64_tr_b16 v[44:45], v13 offset:49152
    ds_read_b64_tr_b16 v[46:47], v13 offset:51200
    v_mfma_f32_16x16x32_bf16 v[160:163], v[48:51], v[64:67], v[160:163]
    v_mfma_f32_16x16x32_bf16 v[168:171], v[52:55], v[64:67], v[168:171]
    v_mfma_f32_16x16x32_bf16 v[192:195], v[56:59], v[64:67], v[192:195]
    v_mfma_f32_16x16x32_bf16 v[200:203], v[60:63], v[64:67], v[200:203]
    ds_read_b64_tr_b16 v[64:65], v14 offset:49152
    ds_read_b64_tr_b16 v[66:67], v14 offset:51200
    v_mfma_f32_16x16x32_bf16 v[164:167], v[48:51], v[68:71], v[164:167]
    v_mfma_f32_16x16x32_bf16 v[172:175], v[52:55], v[68:71], v[172:175]
    v_mfma_f32_16x16x32_bf16 v[196:199], v[56:59], v[68:71], v[196:199]
    v_mfma_f32_16x16x32_bf16 v[204:207], v[60:63], v[68:71], v[204:207]
    ds_read_b64_tr_b16 v[68:69], v15 offset:49152
    ds_read_b64_tr_b16 v[70:71], v15 offset:51200
    s_waitcnt lgkmcnt(6)
    v_mfma_f32_16x16x32_bf16 v[80:83], v[24:27], v[40:43], v[80:83]
    ds_read_b128 v[48:51], v11 offset:40960
    v_mfma_f32_16x16x32_bf16 v[88:91], v[28:31], v[40:43], v[88:91]
    ds_read_b128 v[52:55], v11 offset:43008
    v_mfma_f32_16x16x32_bf16 v[112:115], v[32:35], v[40:43], v[112:115]
    ds_read_b128 v[56:59], v11 offset:45056
    v_mfma_f32_16x16x32_bf16 v[120:123], v[36:39], v[40:43], v[120:123]
    ds_read_b128 v[60:63], v11 offset:47104
    s_waitcnt lgkmcnt(8)
    v_mfma_f32_16x16x32_bf16 v[84:87], v[24:27], v[44:47], v[84:87]
    v_mfma_f32_16x16x32_bf16 v[92:95], v[28:31], v[44:47], v[92:95]
    v_mfma_f32_16x16x32_bf16 v[116:119], v[32:35], v[44:47], v[116:119]
    v_mfma_f32_16x16x32_bf16 v[124:127], v[36:39], v[44:47], v[124:127]
    s_waitcnt lgkmcnt(6)
    v_mfma_f32_16x16x32_bf16 v[96:99], v[24:27], v[64:67], v[96:99]
    v_mfma_f32_16x16x32_bf16 v[104:107], v[28:31], v[64:67], v[104:107]
    v_mfma_f32_16x16x32_bf16 v[128:131], v[32:35], v[64:67], v[128:131]
    v_mfma_f32_16x16x32_bf16 v[136:139], v[36:39], v[64:67], v[136:139]
    s_waitcnt lgkmcnt(4)
    v_mfma_f32_16x16x32_bf16 v[100:103], v[24:27], v[68:71], v[100:103]
    v_mfma_f32_16x16x32_bf16 v[108:111], v[28:31], v[68:71], v[108:111]
    v_mfma_f32_16x16x32_bf16 v[132:135], v[32:35], v[68:71], v[132:135]
    v_mfma_f32_16x16x32_bf16 v[140:143], v[36:39], v[68:71], v[140:143]
    s_waitcnt lgkmcnt(0) vmcnt(0)
    s_barrier
    s_cmp_lg_u32 s19, 4
    s_cbranch_scc1 L_nosig_12
    s_lshl_b32 s35, s2, 2
    v_mov_b32 v216, 0
    v_mov_b32 v217, s95
    s_mov_b64 exec, 1
    s_add_u32 s35, s35, 1024
    buffer_store_dword v217, v216, s[88:91], s35 offen sc1
    s_mov_b64 exec, -1
L_nosig_12:
    s_cmp_lg_u32 s19, 4
    s_cbranch_scc1 L_nosig_13
    s_lshl_b32 s35, s2, 2
    v_mov_b32 v216, 0
    v_mov_b32 v217, s95
    s_mov_b64 exec, 1
    s_add_u32 s35, s35, 2048
    buffer_store_dword v217, v216, s[88:91], s35 offen sc1
    s_mov_b64 exec, -1
L_nosig_13:
    v_mfma_f32_16x16x32_bf16 v[144:147], v[48:51], v[40:43], v[144:147]
    ds_read_b128 v[24:27], v10 offset:0
    s_add_u32 s84, s50, 0
    s_addc_u32 s85, s51, 0
    s_mov_b32 s86, 8388608
    s_mov_b32 s87, 0x00020000
    s_mov_b32 s92, 0
    buffer_load_dword v22, v21, s[84:87], s92 offen
    v_mfma_f32_16x16x32_bf16 v[152:155], v[52:55], v[40:43], v[152:155]
    ds_read_b128 v[28:31], v10 offset:2048
    v_mfma_f32_16x16x32_bf16 v[176:179], v[56:59], v[40:43], v[176:179]
    ds_read_b128 v[32:35], v10 offset:4096
    v_mfma_f32_16x16x32_bf16 v[184:187], v[60:63], v[40:43], v[184:187]
    ds_read_b128 v[36:39], v10 offset:6144
    ds_read_b64_tr_b16 v[40:41], v12 offset:0
    ds_read_b64_tr_b16 v[42:43], v12 offset:2048
    v_mfma_f32_16x16x32_bf16 v[148:151], v[48:51], v[44:47], v[148:151]
    v_mfma_f32_16x16x32_bf16 v[156:159], v[52:55], v[44:47], v[156:159]
    v_mfma_f32_16x16x32_bf16 v[180:183], v[56:59], v[44:47], v[180:183]
    v_mfma_f32_16x16x32_bf16 v[188:191], v[60:63], v[44:47], v[188:191]
    ds_read_b64_tr_b16 v[44:45], v13 offset:0
    ds_read_b64_tr_b16 v[46:47], v13 offset:2048
    v_mfma_f32_16x16x32_bf16 v[160:163], v[48:51], v[64:67], v[160:163]
    v_mfma_f32_16x16x32_bf16 v[168:171], v[52:55], v[64:67], v[168:171]
    v_mfma_f32_16x16x32_bf16 v[192:195], v[56:59], v[64:67], v[192:195]
    v_mfma_f32_16x16x32_bf16 v[200:203], v[60:63], v[64:67], v[200:203]
    ds_read_b64_tr_b16 v[64:65], v14 offset:0
    ds_read_b64_tr_b16 v[66:67], v14 offset:2048
    v_mfma_f32_16x16x32_bf16 v[164:167], v[48:51], v[68:71], v[164:167]
    v_mfma_f32_16x16x32_bf16 v[172:175], v[52:55], v[68:71], v[172:175]
    v_mfma_f32_16x16x32_bf16 v[196:199], v[56:59], v[68:71], v[196:199]
    v_mfma_f32_16x16x32_bf16 v[204:207], v[60:63], v[68:71], v[204:207]
    ds_read_b64_tr_b16 v[68:69], v15 offset:0
    ds_read_b64_tr_b16 v[70:71], v15 offset:2048
    s_waitcnt lgkmcnt(6)
    v_mfma_f32_16x16x32_bf16 v[80:83], v[24:27], v[40:43], v[80:83]
    ds_read_b128 v[48:51], v10 offset:8192
    v_mfma_f32_16x16x32_bf16 v[88:91], v[28:31], v[40:43], v[88:91]
    ds_read_b128 v[52:55], v10 offset:10240
    v_mfma_f32_16x16x32_bf16 v[112:115], v[32:35], v[40:43], v[112:115]
    ds_read_b128 v[56:59], v10 offset:12288
    v_mfma_f32_16x16x32_bf16 v[120:123], v[36:39], v[40:43], v[120:123]
    ds_read_b128 v[60:63], v10 offset:14336
    s_waitcnt lgkmcnt(8)
    v_mfma_f32_16x16x32_bf16 v[84:87], v[24:27], v[44:47], v[84:87]
    v_mfma_f32_16x16x32_bf16 v[92:95], v[28:31], v[44:47], v[92:95]
    v_mfma_f32_16x16x32_bf16 v[116:119], v[32:35], v[44:47], v[116:119]
    v_mfma_f32_16x16x32_bf16 v[124:127], v[36:39], v[44:47], v[124:127]
    s_waitcnt lgkmcnt(6)
    v_mfma_f32_16x16x32_bf16 v[96:99], v[24:27], v[64:67], v[96:99]
    v_mfma_f32_16x16x32_bf16 v[104:107], v[28:31], v[64:67], v[104:107]
    v_mfma_f32_16x16x32_bf16 v[128:131], v[32:35], v[64:67], v[128:131]
    v_mfma_f32_16x16x32_bf16 v[136:139], v[36:39], v[64:67], v[136:139]
    s_waitcnt lgkmcnt(4)
    v_mfma_f32_16x16x32_bf16 v[100:103], v[24:27], v[68:71], v[100:103]
    v_mfma_f32_16x16x32_bf16 v[108:111], v[28:31], v[68:71], v[108:111]
    v_mfma_f32_16x16x32_bf16 v[132:135], v[32:35], v[68:71], v[132:135]
    v_mfma_f32_16x16x32_bf16 v[140:143], v[36:39], v[68:71], v[140:143]
    s_waitcnt lgkmcnt(3)
    v_mfma_f32_16x16x32_bf16 v[144:147], v[48:51], v[40:43], v[144:147]
    ds_read_b128 v[24:27], v11 offset:0
    s_waitcnt lgkmcnt(3)
    v_mfma_f32_16x16x32_bf16 v[152:155], v[52:55], v[40:43], v[152:155]
    ds_read_b128 v[28:31], v11 offset:2048
    s_waitcnt lgkmcnt(3)
    v_mfma_f32_16x16x32_bf16 v[176:179], v[56:59], v[40:43], v[176:179]
    ds_read_b128 v[32:35], v11 offset:4096
    s_waitcnt lgkmcnt(3)
    v_mfma_f32_16x16x32_bf16 v[184:187], v[60:63], v[40:43], v[184:187]
    ds_read_b128 v[36:39], v11 offset:6144
    ds_read_b64_tr_b16 v[40:41], v12 offset:16384
    ds_read_b64_tr_b16 v[42:43], v12 offset:18432
    v_mfma_f32_16x16x32_bf16 v[148:151], v[48:51], v[44:47], v[148:151]
    v_mfma_f32_16x16x32_bf16 v[156:159], v[52:55], v[44:47], v[156:159]
    v_mfma_f32_16x16x32_bf16 v[180:183], v[56:59], v[44:47], v[180:183]
    v_mfma_f32_16x16x32_bf16 v[188:191], v[60:63], v[44:47], v[188:191]
    ds_read_b64_tr_b16 v[44:45], v13 offset:16384
    ds_read_b64_tr_b16 v[46:47], v13 offset:18432
    v_mfma_f32_16x16x32_bf16 v[160:163], v[48:51], v[64:67], v[160:163]
    v_mfma_f32_16x16x32_bf16 v[168:171], v[52:55], v[64:67], v[168:171]
    v_mfma_f32_16x16x32_bf16 v[192:195], v[56:59], v[64:67], v[192:195]
    v_mfma_f32_16x16x32_bf16 v[200:203], v[60:63], v[64:67], v[200:203]
    ds_read_b64_tr_b16 v[64:65], v14 offset:16384
    ds_read_b64_tr_b16 v[66:67], v14 offset:18432
    v_mfma_f32_16x16x32_bf16 v[164:167], v[48:51], v[68:71], v[164:167]
    v_mfma_f32_16x16x32_bf16 v[172:175], v[52:55], v[68:71], v[172:175]
    v_mfma_f32_16x16x32_bf16 v[196:199], v[56:59], v[68:71], v[196:199]
    v_mfma_f32_16x16x32_bf16 v[204:207], v[60:63], v[68:71], v[204:207]
    ds_read_b64_tr_b16 v[68:69], v15 offset:16384
    ds_read_b64_tr_b16 v[70:71], v15 offset:18432
    s_waitcnt lgkmcnt(6)
    v_mfma_f32_16x16x32_bf16 v[80:83], v[24:27], v[40:43], v[80:83]
    ds_read_b128 v[48:51], v11 offset:8192
    v_mfma_f32_16x16x32_bf16 v[88:91], v[28:31], v[40:43], v[88:91]
    ds_read_b128 v[52:55], v11 offset:10240
    v_mfma_f32_16x16x32_bf16 v[112:115], v[32:35], v[40:43], v[112:115]
    ds_read_b128 v[56:59], v11 offset:12288
    v_mfma_f32_16x16x32_bf16 v[120:123], v[36:39], v[40:43], v[120:123]
    ds_read_b128 v[60:63], v11 offset:14336
    s_waitcnt lgkmcnt(8)
    v_mfma_f32_16x16x32_bf16 v[84:87], v[24:27], v[44:47], v[84:87]
    v_mfma_f32_16x16x32_bf16 v[92:95], v[28:31], v[44:47], v[92:95]
    v_mfma_f32_16x16x32_bf16 v[116:119], v[32:35], v[44:47], v[116:119]
    v_mfma_f32_16x16x32_bf16 v[124:127], v[36:39], v[44:47], v[124:127]
    s_waitcnt lgkmcnt(6)
    v_mfma_f32_16x16x32_bf16 v[96:99], v[24:27], v[64:67], v[96:99]
    v_mfma_f32_16x16x32_bf16 v[104:107], v[28:31], v[64:67], v[104:107]
    v_mfma_f32_16x16x32_bf16 v[128:131], v[32:35], v[64:67], v[128:131]
    v_mfma_f32_16x16x32_bf16 v[136:139], v[36:39], v[64:67], v[136:139]
    s_waitcnt lgkmcnt(4)
    v_mfma_f32_16x16x32_bf16 v[100:103], v[24:27], v[68:71], v[100:103]
    v_mfma_f32_16x16x32_bf16 v[108:111], v[28:31], v[68:71], v[108:111]
    v_mfma_f32_16x16x32_bf16 v[132:135], v[32:35], v[68:71], v[132:135]
    v_mfma_f32_16x16x32_bf16 v[140:143], v[36:39], v[68:71], v[140:143]
    s_waitcnt lgkmcnt(0)
    s_barrier
    v_mfma_f32_16x16x32_bf16 v[144:147], v[48:51], v[40:43], v[144:147]
    ds_read_b128 v[24:27], v10 offset:32768
    s_add_u32 s84, s52, 0
    s_addc_u32 s85, s53, 0
    s_mov_b32 s86, 7340032
    s_mov_b32 s87, 0x00020000
    s_mov_b32 s92, 0
    buffer_load_dword v22, v21, s[84:87], s92 offen
    v_mfma_f32_16x16x32_bf16 v[152:155], v[52:55], v[40:43], v[152:155]
    ds_read_b128 v[28:31], v10 offset:34816
    v_mfma_f32_16x16x32_bf16 v[176:179], v[56:59], v[40:43], v[176:179]
    ds_read_b128 v[32:35], v10 offset:36864
    v_mfma_f32_16x16x32_bf16 v[184:187], v[60:63], v[40:43], v[184:187]
    ds_read_b128 v[36:39], v10 offset:38912
    ds_read_b64_tr_b16 v[40:41], v12 offset:32768
    ds_read_b64_tr_b16 v[42:43], v12 offset:34816
    v_mfma_f32_16x16x32_bf16 v[148:151], v[48:51], v[44:47], v[148:151]
    v_mfma_f32_16x16x32_bf16 v[156:159], v[52:55], v[44:47], v[156:159]
    v_mfma_f32_16x16x32_bf16 v[180:183], v[56:59], v[44:47], v[180:183]
    v_mfma_f32_16x16x32_bf16 v[188:191], v[60:63], v[44:47], v[188:191]
    ds_read_b64_tr_b16 v[44:45], v13 offset:32768
    ds_read_b64_tr_b16 v[46:47], v13 offset:34816
    v_mfma_f32_16x16x32_bf16 v[160:163], v[48:51], v[64:67], v[160:163]
    v_mfma_f32_16x16x32_bf16 v[168:171], v[52:55], v[64:67], v[168:171]
    v_mfma_f32_16x16x32_bf16 v[192:195], v[56:59], v[64:67], v[192:195]
    v_mfma_f32_16x16x32_bf16 v[200:203], v[60:63], v[64:67], v[200:203]
    ds_read_b64_tr_b16 v[64:65], v14 offset:32768
    ds_read_b64_tr_b16 v[66:67], v14 offset:34816
    v_mfma_f32_16x16x32_bf16 v[164:167], v[48:51], v[68:71], v[164:167]
    v_mfma_f32_16x16x32_bf16 v[172:175], v[52:55], v[68:71], v[172:175]
    v_mfma_f32_16x16x32_bf16 v[196:199], v[56:59], v[68:71], v[196:199]
    v_mfma_f32_16x16x32_bf16 v[204:207], v[60:63], v[68:71], v[204:207]
    ds_read_b64_tr_b16 v[68:69], v15 offset:32768
    ds_read_b64_tr_b16 v[70:71], v15 offset:34816
    s_waitcnt lgkmcnt(6)
    v_mfma_f32_16x16x32_bf16 v[80:83], v[24:27], v[40:43], v[80:83]
    ds_read_b128 v[48:51], v10 offset:40960
    v_mfma_f32_16x16x32_bf16 v[88:91], v[28:31], v[40:43], v[88:91]
    ds_read_b128 v[52:55], v10 offset:43008
    v_mfma_f32_16x16x32_bf16 v[112:115], v[32:35], v[40:43], v[112:115]
    ds_read_b128 v[56:59], v10 offset:45056
    v_mfma_f32_16x16x32_bf16 v[120:123], v[36:39], v[40:43], v[120:123]
    ds_read_b128 v[60:63], v10 offset:47104
    s_waitcnt lgkmcnt(8)
    v_mfma_f32_16x16x32_bf16 v[84:87], v[24:27], v[44:47], v[84:87]
    v_mfma_f32_16x16x32_bf16 v[92:95], v[28:31], v[44:47], v[92:95]
    v_mfma_f32_16x16x32_bf16 v[116:119], v[32:35], v[44:47], v[116:119]
    v_mfma_f32_16x16x32_bf16 v[124:127], v[36:39], v[44:47], v[124:127]
    s_waitcnt lgkmcnt(6)
    v_mfma_f32_16x16x32_bf16 v[96:99], v[24:27], v[64:67], v[96:99]
    v_mfma_f32_16x16x32_bf16 v[104:107], v[28:31], v[64:67], v[104:107]
    v_mfma_f32_16x16x32_bf16 v[128:131], v[32:35], v[64:67], v[128:131]
    v_mfma_f32_16x16x32_bf16 v[136:139], v[36:39], v[64:67], v[136:139]
    s_waitcnt lgkmcnt(4)
    v_mfma_f32_16x16x32_bf16 v[100:103], v[24:27], v[68:71], v[100:103]
    v_mfma_f32_16x16x32_bf16 v[108:111], v[28:31], v[68:71], v[108:111]
    v_mfma_f32_16x16x32_bf16 v[132:135], v[32:35], v[68:71], v[132:135]
    v_mfma_f32_16x16x32_bf16 v[140:143], v[36:39], v[68:71], v[140:143]
    s_waitcnt lgkmcnt(3)
    v_mfma_f32_16x16x32_bf16 v[144:147], v[48:51], v[40:43], v[144:147]
    ds_read_b128 v[24:27], v11 offset:32768
    s_waitcnt lgkmcnt(3)
    v_mfma_f32_16x16x32_bf16 v[152:155], v[52:55], v[40:43], v[152:155]
    ds_read_b128 v[28:31], v11 offset:34816
    s_waitcnt lgkmcnt(3)
    v_mfma_f32_16x16x32_bf16 v[176:179], v[56:59], v[40:43], v[176:179]
    ds_read_b128 v[32:35], v11 offset:36864
    s_waitcnt lgkmcnt(3)
    v_mfma_f32_16x16x32_bf16 v[184:187], v[60:63], v[40:43], v[184:187]
    ds_read_b128 v[36:39], v11 offset:38912
    ds_read_b64_tr_b16 v[40:41], v12 offset:49152
    ds_read_b64_tr_b16 v[42:43], v12 offset:51200
    v_mfma_f32_16x16x32_bf16 v[148:151], v[48:51], v[44:47], v[148:151]
    v_mfma_f32_16x16x32_bf16 v[156:159], v[52:55], v[44:47], v[156:159]
    v_mfma_f32_16x16x32_bf16 v[180:183], v[56:59], v[44:47], v[180:183]
    v_mfma_f32_16x16x32_bf16 v[188:191], v[60:63], v[44:47], v[188:191]
    ds_read_b64_tr_b16 v[44:45], v13 offset:49152
    ds_read_b64_tr_b16 v[46:47], v13 offset:51200
    v_mfma_f32_16x16x32_bf16 v[160:163], v[48:51], v[64:67], v[160:163]
    v_mfma_f32_16x16x32_bf16 v[168:171], v[52:55], v[64:67], v[168:171]
    v_mfma_f32_16x16x32_bf16 v[192:195], v[56:59], v[64:67], v[192:195]
    v_mfma_f32_16x16x32_bf16 v[200:203], v[60:63], v[64:67], v[200:203]
    ds_read_b64_tr_b16 v[64:65], v14 offset:49152
    ds_read_b64_tr_b16 v[66:67], v14 offset:51200
    v_mfma_f32_16x16x32_bf16 v[164:167], v[48:51], v[68:71], v[164:167]
    v_mfma_f32_16x16x32_bf16 v[172:175], v[52:55], v[68:71], v[172:175]
    v_mfma_f32_16x16x32_bf16 v[196:199], v[56:59], v[68:71], v[196:199]
    v_mfma_f32_16x16x32_bf16 v[204:207], v[60:63], v[68:71], v[204:207]
    ds_read_b64_tr_b16 v[68:69], v15 offset:49152
    ds_read_b64_tr_b16 v[70:71], v15 offset:51200
    s_waitcnt lgkmcnt(6)
    v_mfma_f32_16x16x32_bf16 v[80:83], v[24:27], v[40:43], v[80:83]
    ds_read_b128 v[48:51], v11 offset:40960
    v_mfma_f32_16x16x32_bf16 v[88:91], v[28:31], v[40:43], v[88:91]
    ds_read_b128 v[52:55], v11 offset:43008
    v_mfma_f32_16x16x32_bf16 v[112:115], v[32:35], v[40:43], v[112:115]
    ds_read_b128 v[56:59], v11 offset:45056
    v_mfma_f32_16x16x32_bf16 v[120:123], v[36:39], v[40:43], v[120:123]
    ds_read_b128 v[60:63], v11 offset:47104
    s_waitcnt lgkmcnt(8)
    v_mfma_f32_16x16x32_bf16 v[84:87], v[24:27], v[44:47], v[84:87]
    v_mfma_f32_16x16x32_bf16 v[92:95], v[28:31], v[44:47], v[92:95]
    v_mfma_f32_16x16x32_bf16 v[116:119], v[32:35], v[44:47], v[116:119]
    v_mfma_f32_16x16x32_bf16 v[124:127], v[36:39], v[44:47], v[124:127]
    s_waitcnt lgkmcnt(6)
    v_mfma_f32_16x16x32_bf16 v[96:99], v[24:27], v[64:67], v[96:99]
    v_mfma_f32_16x16x32_bf16 v[104:107], v[28:31], v[64:67], v[104:107]
    v_mfma_f32_16x16x32_bf16 v[128:131], v[32:35], v[64:67], v[128:131]
    v_mfma_f32_16x16x32_bf16 v[136:139], v[36:39], v[64:67], v[136:139]
    s_waitcnt lgkmcnt(4)
    v_mfma_f32_16x16x32_bf16 v[100:103], v[24:27], v[68:71], v[100:103]
    v_mfma_f32_16x16x32_bf16 v[108:111], v[28:31], v[68:71], v[108:111]
    v_mfma_f32_16x16x32_bf16 v[132:135], v[32:35], v[68:71], v[132:135]
    v_mfma_f32_16x16x32_bf16 v[140:143], v[36:39], v[68:71], v[140:143]
    s_waitcnt lgkmcnt(0)
    s_barrier
    v_mfma_f32_16x16x32_bf16 v[144:147], v[48:51], v[40:43], v[144:147]
    ds_read_b128 v[24:27], v10 offset:0
    s_add_u32 s84, s50, 0
    s_addc_u32 s85, s51, 0
    s_mov_b32 s86, 8388608
    s_mov_b32 s87, 0x00020000
    s_mov_b32 s92, 4194304
    buffer_load_dword v22, v21, s[84:87], s92 offen
    v_mfma_f32_16x16x32_bf16 v[152:155], v[52:55], v[40:43], v[152:155]
    ds_read_b128 v[28:31], v10 offset:2048
    v_mfma_f32_16x16x32_bf16 v[176:179], v[56:59], v[40:43], v[176:179]
    ds_read_b128 v[32:35], v10 offset:4096
    v_mfma_f32_16x16x32_bf16 v[184:187], v[60:63], v[40:43], v[184:187]
    ds_read_b128 v[36:39], v10 offset:6144
    ds_read_b64_tr_b16 v[40:41], v12 offset:0
    ds_read_b64_tr_b16 v[42:43], v12 offset:2048
    v_mfma_f32_16x16x32_bf16 v[148:151], v[48:51], v[44:47], v[148:151]
    v_mfma_f32_16x16x32_bf16 v[156:159], v[52:55], v[44:47], v[156:159]
    v_mfma_f32_16x16x32_bf16 v[180:183], v[56:59], v[44:47], v[180:183]
    v_mfma_f32_16x16x32_bf16 v[188:191], v[60:63], v[44:47], v[188:191]
    ds_read_b64_tr_b16 v[44:45], v13 offset:0
    ds_read_b64_tr_b16 v[46:47], v13 offset:2048
    v_mfma_f32_16x16x32_bf16 v[160:163], v[48:51], v[64:67], v[160:163]
    v_mfma_f32_16x16x32_bf16 v[168:171], v[52:55], v[64:67], v[168:171]
    v_mfma_f32_16x16x32_bf16 v[192:195], v[56:59], v[64:67], v[192:195]
    v_mfma_f32_16x16x32_bf16 v[200:203], v[60:63], v[64:67], v[200:203]
    ds_read_b64_tr_b16 v[64:65], v14 offset:0
    ds_read_b64_tr_b16 v[66:67], v14 offset:2048
    v_mfma_f32_16x16x32_bf16 v[164:167], v[48:51], v[68:71], v[164:167]
    v_mfma_f32_16x16x32_bf16 v[172:175], v[52:55], v[68:71], v[172:175]
    v_mfma_f32_16x16x32_bf16 v[196:199], v[56:59], v[68:71], v[196:199]
    v_mfma_f32_16x16x32_bf16 v[204:207], v[60:63], v[68:71], v[204:207]
    ds_read_b64_tr_b16 v[68:69], v15 offset:0
    ds_read_b64_tr_b16 v[70:71], v15 offset:2048
    s_waitcnt lgkmcnt(6)
    v_mfma_f32_16x16x32_bf16 v[80:83], v[24:27], v[40:43], v[80:83]
    ds_read_b128 v[48:51], v10 offset:8192
    v_mfma_f32_16x16x32_bf16 v[88:91], v[28:31], v[40:43], v[88:91]
    ds_read_b128 v[52:55], v10 offset:10240
    v_mfma_f32_16x16x32_bf16 v[112:115], v[32:35], v[40:43], v[112:115]
    ds_read_b128 v[56:59], v10 offset:12288
    v_mfma_f32_16x16x32_bf16 v[120:123], v[36:39], v[40:43], v[120:123]
    ds_read_b128 v[60:63], v10 offset:14336
    s_waitcnt lgkmcnt(8)
    v_mfma_f32_16x16x32_bf16 v[84:87], v[24:27], v[44:47], v[84:87]
    v_mfma_f32_16x16x32_bf16 v[92:95], v[28:31], v[44:47], v[92:95]
    v_mfma_f32_16x16x32_bf16 v[116:119], v[32:35], v[44:47], v[116:119]
    v_mfma_f32_16x16x32_bf16 v[124:127], v[36:39], v[44:47], v[124:127]
    s_waitcnt lgkmcnt(6)
    v_mfma_f32_16x16x32_bf16 v[96:99], v[24:27], v[64:67], v[96:99]
    v_mfma_f32_16x16x32_bf16 v[104:107], v[28:31], v[64:67], v[104:107]
    v_mfma_f32_16x16x32_bf16 v[128:131], v[32:35], v[64:67], v[128:131]
    v_mfma_f32_16x16x32_bf16 v[136:139], v[36:39], v[64:67], v[136:139]
    s_waitcnt lgkmcnt(4)
    v_mfma_f32_16x16x32_bf16 v[100:103], v[24:27], v[68:71], v[100:103]
    v_mfma_f32_16x16x32_bf16 v[108:111], v[28:31], v[68:71], v[108:111]
    v_mfma_f32_16x16x32_bf16 v[132:135], v[32:35], v[68:71], v[132:135]
    v_mfma_f32_16x16x32_bf16 v[140:143], v[36:39], v[68:71], v[140:143]
    s_waitcnt lgkmcnt(3)
    v_mfma_f32_16x16x32_bf16 v[144:147], v[48:51], v[40:43], v[144:147]
    ds_read_b128 v[24:27], v11 offset:0
    s_waitcnt lgkmcnt(3)
    v_mfma_f32_16x16x32_bf16 v[152:155], v[52:55], v[40:43], v[152:155]
    ds_read_b128 v[28:31], v11 offset:2048
    s_waitcnt lgkmcnt(3)
    v_mfma_f32_16x16x32_bf16 v[176:179], v[56:59], v[40:43], v[176:179]
    ds_read_b128 v[32:35], v11 offset:4096
    s_waitcnt lgkmcnt(3)
    v_mfma_f32_16x16x32_bf16 v[184:187], v[60:63], v[40:43], v[184:187]
    ds_read_b128 v[36:39], v11 offset:6144
    ds_read_b64_tr_b16 v[40:41], v12 offset:16384
    ds_read_b64_tr_b16 v[42:43], v12 offset:18432
    v_mfma_f32_16x16x32_bf16 v[148:151], v[48:51], v[44:47], v[148:151]
    v_mfma_f32_16x16x32_bf16 v[156:159], v[52:55], v[44:47], v[156:159]
    v_mfma_f32_16x16x32_bf16 v[180:183], v[56:59], v[44:47], v[180:183]
    v_mfma_f32_16x16x32_bf16 v[188:191], v[60:63], v[44:47], v[188:191]
    ds_read_b64_tr_b16 v[44:45], v13 offset:16384
    ds_read_b64_tr_b16 v[46:47], v13 offset:18432
    v_mfma_f32_16x16x32_bf16 v[160:163], v[48:51], v[64:67], v[160:163]
    v_mfma_f32_16x16x32_bf16 v[168:171], v[52:55], v[64:67], v[168:171]
    v_mfma_f32_16x16x32_bf16 v[192:195], v[56:59], v[64:67], v[192:195]
    v_mfma_f32_16x16x32_bf16 v[200:203], v[60:63], v[64:67], v[200:203]
    ds_read_b64_tr_b16 v[64:65], v14 offset:16384
    ds_read_b64_tr_b16 v[66:67], v14 offset:18432
    v_mfma_f32_16x16x32_bf16 v[164:167], v[48:51], v[68:71], v[164:167]
    v_mfma_f32_16x16x32_bf16 v[172:175], v[52:55], v[68:71], v[172:175]
    v_mfma_f32_16x16x32_bf16 v[196:199], v[56:59], v[68:71], v[196:199]
    v_mfma_f32_16x16x32_bf16 v[204:207], v[60:63], v[68:71], v[204:207]
    ds_read_b64_tr_b16 v[68:69], v15 offset:16384
    ds_read_b64_tr_b16 v[70:71], v15 offset:18432
    s_waitcnt lgkmcnt(6)
    v_mfma_f32_16x16x32_bf16 v[80:83], v[24:27], v[40:43], v[80:83]
    ds_read_b128 v[48:51], v11 offset:8192
    v_mfma_f32_16x16x32_bf16 v[88:91], v[28:31], v[40:43], v[88:91]
    ds_read_b128 v[52:55], v11 offset:10240
    v_mfma_f32_16x16x32_bf16 v[112:115], v[32:35], v[40:43], v[112:115]
    ds_read_b128 v[56:59], v11 offset:12288
    v_mfma_f32_16x16x32_bf16 v[120:123], v[36:39], v[40:43], v[120:123]
    ds_read_b128 v[60:63], v11 offset:14336
    s_waitcnt lgkmcnt(8)
    v_mfma_f32_16x16x32_bf16 v[84:87], v[24:27], v[44:47], v[84:87]
    v_mfma_f32_16x16x32_bf16 v[92:95], v[28:31], v[44:47], v[92:95]
    v_mfma_f32_16x16x32_bf16 v[116:119], v[32:35], v[44:47], v[116:119]
    v_mfma_f32_16x16x32_bf16 v[124:127], v[36:39], v[44:47], v[124:127]
    s_waitcnt lgkmcnt(6)
    v_mfma_f32_16x16x32_bf16 v[96:99], v[24:27], v[64:67], v[96:99]
    v_mfma_f32_16x16x32_bf16 v[104:107], v[28:31], v[64:67], v[104:107]
    v_mfma_f32_16x16x32_bf16 v[128:131], v[32:35], v[64:67], v[128:131]
    v_mfma_f32_16x16x32_bf16 v[136:139], v[36:39], v[64:67], v[136:139]
    s_waitcnt lgkmcnt(4)
    v_mfma_f32_16x16x32_bf16 v[100:103], v[24:27], v[68:71], v[100:103]
    v_mfma_f32_16x16x32_bf16 v[108:111], v[28:31], v[68:71], v[108:111]
    v_mfma_f32_16x16x32_bf16 v[132:135], v[32:35], v[68:71], v[132:135]
    v_mfma_f32_16x16x32_bf16 v[140:143], v[36:39], v[68:71], v[140:143]
    s_waitcnt lgkmcnt(0)
    s_barrier
    v_mfma_f32_16x16x32_bf16 v[144:147], v[48:51], v[40:43], v[144:147]
    ds_read_b128 v[24:27], v10 offset:32768
    s_add_u32 s84, s52, 0
    s_addc_u32 s85, s53, 0
    s_mov_b32 s86, 7340032
    s_mov_b32 s87, 0x00020000
    s_mov_b32 s92, 4194304
    buffer_load_dword v22, v21, s[84:87], s92 offen
    v_mfma_f32_16x16x32_bf16 v[152:155], v[52:55], v[40:43], v[152:155]
    ds_read_b128 v[28:31], v10 offset:34816
    v_mfma_f32_16x16x32_bf16 v[176:179], v[56:59], v[40:43], v[176:179]
    ds_read_b128 v[32:35], v10 offset:36864
    v_mfma_f32_16x16x32_bf16 v[184:187], v[60:63], v[40:43], v[184:187]
    ds_read_b128 v[36:39], v10 offset:38912
    ds_read_b64_tr_b16 v[40:41], v12 offset:32768
    ds_read_b64_tr_b16 v[42:43], v12 offset:34816
    v_mfma_f32_16x16x32_bf16 v[148:151], v[48:51], v[44:47], v[148:151]
    v_mfma_f32_16x16x32_bf16 v[156:159], v[52:55], v[44:47], v[156:159]
    v_mfma_f32_16x16x32_bf16 v[180:183], v[56:59], v[44:47], v[180:183]
    v_mfma_f32_16x16x32_bf16 v[188:191], v[60:63], v[44:47], v[188:191]
    ds_read_b64_tr_b16 v[44:45], v13 offset:32768
    ds_read_b64_tr_b16 v[46:47], v13 offset:34816
    v_mfma_f32_16x16x32_bf16 v[160:163], v[48:51], v[64:67], v[160:163]
    v_mfma_f32_16x16x32_bf16 v[168:171], v[52:55], v[64:67], v[168:171]
    v_mfma_f32_16x16x32_bf16 v[192:195], v[56:59], v[64:67], v[192:195]
    v_mfma_f32_16x16x32_bf16 v[200:203], v[60:63], v[64:67], v[200:203]
    ds_read_b64_tr_b16 v[64:65], v14 offset:32768
    ds_read_b64_tr_b16 v[66:67], v14 offset:34816
    v_mfma_f32_16x16x32_bf16 v[164:167], v[48:51], v[68:71], v[164:167]
    v_mfma_f32_16x16x32_bf16 v[172:175], v[52:55], v[68:71], v[172:175]
    v_mfma_f32_16x16x32_bf16 v[196:199], v[56:59], v[68:71], v[196:199]
    v_mfma_f32_16x16x32_bf16 v[204:207], v[60:63], v[68:71], v[204:207]
    ds_read_b64_tr_b16 v[68:69], v15 offset:32768
    ds_read_b64_tr_b16 v[70:71], v15 offset:34816
    s_waitcnt lgkmcnt(6)
    v_mfma_f32_16x16x32_bf16 v[80:83], v[24:27], v[40:43], v[80:83]
    ds_read_b128 v[48:51], v10 offset:40960
    v_mfma_f32_16x16x32_bf16 v[88:91], v[28:31], v[40:43], v[88:91]
    ds_read_b128 v[52:55], v10 offset:43008
    v_mfma_f32_16x16x32_bf16 v[112:115], v[32:35], v[40:43], v[112:115]
    ds_read_b128 v[56:59], v10 offset:45056
    v_mfma_f32_16x16x32_bf16 v[120:123], v[36:39], v[40:43], v[120:123]
    ds_read_b128 v[60:63], v10 offset:47104
    s_waitcnt lgkmcnt(8)
    v_mfma_f32_16x16x32_bf16 v[84:87], v[24:27], v[44:47], v[84:87]
    v_mfma_f32_16x16x32_bf16 v[92:95], v[28:31], v[44:47], v[92:95]
    v_mfma_f32_16x16x32_bf16 v[116:119], v[32:35], v[44:47], v[116:119]
    v_mfma_f32_16x16x32_bf16 v[124:127], v[36:39], v[44:47], v[124:127]
    s_waitcnt lgkmcnt(6)
    v_mfma_f32_16x16x32_bf16 v[96:99], v[24:27], v[64:67], v[96:99]
    v_mfma_f32_16x16x32_bf16 v[104:107], v[28:31], v[64:67], v[104:107]
    v_mfma_f32_16x16x32_bf16 v[128:131], v[32:35], v[64:67], v[128:131]
    v_mfma_f32_16x16x32_bf16 v[136:139], v[36:39], v[64:67], v[136:139]
    s_waitcnt lgkmcnt(4)
    v_mfma_f32_16x16x32_bf16 v[100:103], v[24:27], v[68:71], v[100:103]
    v_mfma_f32_16x16x32_bf16 v[108:111], v[28:31], v[68:71], v[108:111]
    v_mfma_f32_16x16x32_bf16 v[132:135], v[32:35], v[68:71], v[132:135]
    v_mfma_f32_16x16x32_bf16 v[140:143], v[36:39], v[68:71], v[140:143]
    s_waitcnt lgkmcnt(3)
    v_mfma_f32_16x16x32_bf16 v[144:147], v[48:51], v[40:43], v[144:147]
    ds_read_b128 v[24:27], v11 offset:32768
    s_waitcnt lgkmcnt(3)
    v_mfma_f32_16x16x32_bf16 v[152:155], v[52:55], v[40:43], v[152:155]
    ds_read_b128 v[28:31], v11 offset:34816
    s_waitcnt lgkmcnt(3)
    v_mfma_f32_16x16x32_bf16 v[176:179], v[56:59], v[40:43], v[176:179]
    ds_read_b128 v[32:35], v11 offset:36864
    s_waitcnt lgkmcnt(3)
    v_mfma_f32_16x16x32_bf16 v[184:187], v[60:63], v[40:43], v[184:187]
    ds_read_b128 v[36:39], v11 offset:38912
    ds_read_b64_tr_b16 v[40:41], v12 offset:49152
    ds_read_b64_tr_b16 v[42:43], v12 offset:51200
    v_mfma_f32_16x16x32_bf16 v[148:151], v[48:51], v[44:47], v[148:151]
    v_mfma_f32_16x16x32_bf16 v[156:159], v[52:55], v[44:47], v[156:159]
    v_mfma_f32_16x16x32_bf16 v[180:183], v[56:59], v[44:47], v[180:183]
    v_mfma_f32_16x16x32_bf16 v[188:191], v[60:63], v[44:47], v[188:191]
    ds_read_b64_tr_b16 v[44:45], v13 offset:49152
    ds_read_b64_tr_b16 v[46:47], v13 offset:51200
    v_mfma_f32_16x16x32_bf16 v[160:163], v[48:51], v[64:67], v[160:163]
    v_mfma_f32_16x16x32_bf16 v[168:171], v[52:55], v[64:67], v[168:171]
    v_mfma_f32_16x16x32_bf16 v[192:195], v[56:59], v[64:67], v[192:195]
    v_mfma_f32_16x16x32_bf16 v[200:203], v[60:63], v[64:67], v[200:203]
    ds_read_b64_tr_b16 v[64:65], v14 offset:49152
    ds_read_b64_tr_b16 v[66:67], v14 offset:51200
    v_mfma_f32_16x16x32_bf16 v[164:167], v[48:51], v[68:71], v[164:167]
    v_mfma_f32_16x16x32_bf16 v[172:175], v[52:55], v[68:71], v[172:175]
    v_mfma_f32_16x16x32_bf16 v[196:199], v[56:59], v[68:71], v[196:199]
    v_mfma_f32_16x16x32_bf16 v[204:207], v[60:63], v[68:71], v[204:207]
    ds_read_b64_tr_b16 v[68:69], v15 offset:49152
    ds_read_b64_tr_b16 v[70:71], v15 offset:51200
    s_waitcnt lgkmcnt(6)
    v_mfma_f32_16x16x32_bf16 v[80:83], v[24:27], v[40:43], v[80:83]
    ds_read_b128 v[48:51], v11 offset:40960
    v_mfma_f32_16x16x32_bf16 v[88:91], v[28:31], v[40:43], v[88:91]
    ds_read_b128 v[52:55], v11 offset:43008
    v_mfma_f32_16x16x32_bf16 v[112:115], v[32:35], v[40:43], v[112:115]
    ds_read_b128 v[56:59], v11 offset:45056
    v_mfma_f32_16x16x32_bf16 v[120:123], v[36:39], v[40:43], v[120:123]
    ds_read_b128 v[60:63], v11 offset:47104
    s_waitcnt lgkmcnt(8)
    v_mfma_f32_16x16x32_bf16 v[84:87], v[24:27], v[44:47], v[84:87]
    v_mfma_f32_16x16x32_bf16 v[92:95], v[28:31], v[44:47], v[92:95]
    v_mfma_f32_16x16x32_bf16 v[116:119], v[32:35], v[44:47], v[116:119]
    v_mfma_f32_16x16x32_bf16 v[124:127], v[36:39], v[44:47], v[124:127]
    s_waitcnt lgkmcnt(6)
    v_mfma_f32_16x16x32_bf16 v[96:99], v[24:27], v[64:67], v[96:99]
    v_mfma_f32_16x16x32_bf16 v[104:107], v[28:31], v[64:67], v[104:107]
    v_mfma_f32_16x16x32_bf16 v[128:131], v[32:35], v[64:67], v[128:131]
    v_mfma_f32_16x16x32_bf16 v[136:139], v[36:39], v[64:67], v[136:139]
    s_waitcnt lgkmcnt(4)
    v_mfma_f32_16x16x32_bf16 v[100:103], v[24:27], v[68:71], v[100:103]
    v_mfma_f32_16x16x32_bf16 v[108:111], v[28:31], v[68:71], v[108:111]
    v_mfma_f32_16x16x32_bf16 v[132:135], v[32:35], v[68:71], v[132:135]
    v_mfma_f32_16x16x32_bf16 v[140:143], v[36:39], v[68:71], v[140:143]
    s_waitcnt lgkmcnt(0)
    s_barrier
    v_bfe_u32 v18, v1, 6, 2
    v_lshrrev_b32 v17, 8, v1
    v_lshl_add_u32 v17, v17, 3, v18
    v_and_b32 v16, 3, v17
    v_lshlrev_b32 v16, 2, v16
    v_bfe_u32 v19, v17, 3, 1
    v_lshl_or_b32 v16, v19, 1, v16
    v_lshlrev_b32 v17, 8, v17
    v_bfe_u32 v18, v1, 4, 1
    v_lshl_add_u32 v17, v18, 3, v17
    v_bfe_u32 v18, v1, 5, 1
    s_lshl_b32 s31, s28, 2
    s_add_u32 s31, s31, 0
    v_add_u32 v19, s31, v18
    v_xor_b32 v19, v19, v16
    v_lshl_add_u32 v19, v19, 4, v17
    v_add_u32 v14, 65536, v19
    s_lshl_b32 s31, s28, 2
    s_add_u32 s31, s31, 2
    v_add_u32 v19, s31, v18
    v_xor_b32 v19, v19, v16
    v_lshl_add_u32 v19, v19, 4, v17
    v_add_u32 v15, 65536, v19
    v_mfma_f32_16x16x32_bf16 v[144:147], v[48:51], v[40:43], v[144:147]
    ds_read_b128 v[24:27], v77 offset:0
    v_mfma_f32_16x16x32_bf16 v[152:155], v[52:55], v[40:43], v[152:155]
    ds_read_b128 v[28:31], v77 offset:256
    v_mfma_f32_16x16x32_bf16 v[176:179], v[56:59], v[40:43], v[176:179]
    ds_read_b128 v[32:35], v77 offset:4096
    v_mfma_f32_16x16x32_bf16 v[184:187], v[60:63], v[40:43], v[184:187]
    ds_read_b128 v[36:39], v77 offset:4352
    ds_read_b64_tr_b16 v[40:41], v14 offset:0
    ds_read_b64_tr_b16 v[42:43], v14 offset:1024
    v_mfma_f32_16x16x32_bf16 v[148:151], v[48:51], v[44:47], v[148:151]
    v_mfma_f32_16x16x32_bf16 v[156:159], v[52:55], v[44:47], v[156:159]
    v_mfma_f32_16x16x32_bf16 v[180:183], v[56:59], v[44:47], v[180:183]
    v_mfma_f32_16x16x32_bf16 v[188:191], v[60:63], v[44:47], v[188:191]
    ds_read_b64_tr_b16 v[44:45], v15 offset:0
    ds_read_b64_tr_b16 v[46:47], v15 offset:1024
    v_mfma_f32_16x16x32_bf16 v[160:163], v[48:51], v[64:67], v[160:163]
    v_mfma_f32_16x16x32_bf16 v[168:171], v[52:55], v[64:67], v[168:171]
    v_mfma_f32_16x16x32_bf16 v[192:195], v[56:59], v[64:67], v[192:195]
    v_mfma_f32_16x16x32_bf16 v[200:203], v[60:63], v[64:67], v[200:203]
    ds_read_b64_tr_b16 v[64:65], v14 offset:16384
    ds_read_b64_tr_b16 v[66:67], v14 offset:17408
    v_mfma_f32_16x16x32_bf16 v[164:167], v[48:51], v[68:71], v[164:167]
    v_mfma_f32_16x16x32_bf16 v[172:175], v[52:55], v[68:71], v[172:175]
    v_mfma_f32_16x16x32_bf16 v[196:199], v[56:59], v[68:71], v[196:199]
    v_mfma_f32_16x16x32_bf16 v[204:207], v[60:63], v[68:71], v[204:207]
    ds_read_b64_tr_b16 v[68:69], v15 offset:16384
    ds_read_b64_tr_b16 v[70:71], v15 offset:17408
L_pj_TP:
    v_cvt_pk_bf16_f32 v208, v80, v81
    v_cvt_pk_bf16_f32 v209, v82, v83
    v_cvt_pk_bf16_f32 v210, v84, v85
    v_cvt_pk_bf16_f32 v211, v86, v87
    s_nop 1
    v_permlane16_swap_b32 v208, v210
    v_permlane16_swap_b32 v209, v211
    v_cvt_pk_bf16_f32 v212, v88, v89
    v_cvt_pk_bf16_f32 v213, v90, v91
    v_cvt_pk_bf16_f32 v214, v92, v93
    v_cvt_pk_bf16_f32 v215, v94, v95
    s_nop 1
    v_permlane16_swap_b32 v212, v214
    v_permlane16_swap_b32 v213, v215
    s_waitcnt lgkmcnt(6)
    v_mfma_f32_16x16x32_bf16 v[80:83], v[40:43], v[24:27], 0
    ds_read_b128 v[48:51], v77 offset:8192
    v_mfma_f32_16x16x32_bf16 v[84:87], v[40:43], v[28:31], 0
    ds_read_b128 v[52:55], v77 offset:8448
    v_cvt_pk_bf16_f32 v224, v112, v113
    v_cvt_pk_bf16_f32 v225, v114, v115
    v_cvt_pk_bf16_f32 v226, v116, v117
    v_cvt_pk_bf16_f32 v227, v118, v119
    s_nop 1
    v_permlane16_swap_b32 v224, v226
    v_permlane16_swap_b32 v225, v227
    v_cvt_pk_bf16_f32 v228, v120, v121
    v_cvt_pk_bf16_f32 v229, v122, v123
    v_cvt_pk_bf16_f32 v230, v124, v125
    v_cvt_pk_bf16_f32 v231, v126, v127
    s_nop 1
    v_permlane16_swap_b32 v228, v230
    v_permlane16_swap_b32 v229, v231
    v_mfma_f32_16x16x32_bf16 v[112:115], v[40:43], v[32:35], 0
    ds_read_b128 v[56:59], v77 offset:12288
    v_mfma_f32_16x16x32_bf16 v[116:119], v[40:43], v[36:39], 0
    ds_read_b128 v[60:63], v77 offset:12544
    s_waitcnt lgkmcnt(8)
    v_mfma_f32_16x16x32_bf16 v[88:91], v[44:47], v[24:27], 0
    v_mfma_f32_16x16x32_bf16 v[92:95], v[44:47], v[28:31], 0
    v_mfma_f32_16x16x32_bf16 v[120:123], v[44:47], v[32:35], 0
    v_mfma_f32_16x16x32_bf16 v[124:127], v[44:47], v[36:39], 0
    v_cvt_pk_bf16_f32 v216, v96, v97
    v_cvt_pk_bf16_f32 v217, v98, v99
    v_cvt_pk_bf16_f32 v218, v100, v101
    v_cvt_pk_bf16_f32 v219, v102, v103
    s_nop 1
    v_permlane16_swap_b32 v216, v218
    v_permlane16_swap_b32 v217, v219
    v_cvt_pk_bf16_f32 v220, v104, v105
    v_cvt_pk_bf16_f32 v221, v106, v107
    v_cvt_pk_bf16_f32 v222, v108, v109
    v_cvt_pk_bf16_f32 v223, v110, v111
    s_nop 1
    v_permlane16_swap_b32 v220, v222
    v_permlane16_swap_b32 v221, v223
    s_waitcnt lgkmcnt(6)
    v_mfma_f32_16x16x32_bf16 v[96:99], v[64:67], v[24:27], 0
    v_mfma_f32_16x16x32_bf16 v[100:103], v[64:67], v[28:31], 0
    v_cvt_pk_bf16_f32 v232, v128, v129
    v_cvt_pk_bf16_f32 v233, v130, v131
    v_cvt_pk_bf16_f32 v234, v132, v133
    v_cvt_pk_bf16_f32 v235, v134, v135
    s_nop 1
    v_permlane16_swap_b32 v232, v234
    v_permlane16_swap_b32 v233, v235
    v_cvt_pk_bf16_f32 v236, v136, v137
    v_cvt_pk_bf16_f32 v237, v138, v139
    v_cvt_pk_bf16_f32 v238, v140, v141
    v_cvt_pk_bf16_f32 v239, v142, v143
    s_nop 1
    v_permlane16_swap_b32 v236, v238
    v_permlane16_swap_b32 v237, v239
    v_mfma_f32_16x16x32_bf16 v[128:131], v[64:67], v[32:35], 0
    v_mfma_f32_16x16x32_bf16 v[132:135], v[64:67], v[36:39], 0
    s_waitcnt lgkmcnt(4)
    v_mfma_f32_16x16x32_bf16 v[104:107], v[68:71], v[24:27], 0
    v_mfma_f32_16x16x32_bf16 v[108:111], v[68:71], v[28:31], 0
    v_mfma_f32_16x16x32_bf16 v[136:139], v[68:71], v[32:35], 0
    v_mfma_f32_16x16x32_bf16 v[140:143], v[68:71], v[36:39], 0
    v_cvt_pk_bf16_f32 v240, v144, v145
    v_cvt_pk_bf16_f32 v241, v146, v147
    v_cvt_pk_bf16_f32 v242, v148, v149
    v_cvt_pk_bf16_f32 v243, v150, v151
    s_nop 1
    v_permlane16_swap_b32 v240, v242
    v_permlane16_swap_b32 v241, v243
    v_cvt_pk_bf16_f32 v244, v152, v153
    v_cvt_pk_bf16_f32 v245, v154, v155
    v_cvt_pk_bf16_f32 v246, v156, v157
    v_cvt_pk_bf16_f32 v247, v158, v159
    s_nop 1
    v_permlane16_swap_b32 v244, v246
    v_permlane16_swap_b32 v245, v247
    s_waitcnt lgkmcnt(3)
    v_mfma_f32_16x16x32_bf16 v[144:147], v[40:43], v[48:51], 0
    ds_read_b128 v[24:27], v77 offset:2048
    s_waitcnt lgkmcnt(3)
    v_mfma_f32_16x16x32_bf16 v[148:151], v[40:43], v[52:55], 0
    ds_read_b128 v[28:31], v77 offset:2304
    v_cvt_pk_bf16_f32 v2, v176, v177
    v_cvt_pk_bf16_f32 v3, v178, v179
    v_cvt_pk_bf16_f32 v4, v180, v181
    v_cvt_pk_bf16_f32 v5, v182, v183
    s_nop 1
    v_permlane16_swap_b32 v2, v4
    v_permlane16_swap_b32 v3, v5
    v_cvt_pk_bf16_f32 v6, v184, v185
    v_cvt_pk_bf16_f32 v7, v186, v187
    v_cvt_pk_bf16_f32 v8, v188, v189
    v_cvt_pk_bf16_f32 v9, v190, v191
    s_nop 1
    v_permlane16_swap_b32 v6, v8
    v_permlane16_swap_b32 v7, v9
    s_waitcnt lgkmcnt(3)
    v_mfma_f32_16x16x32_bf16 v[176:179], v[40:43], v[56:59], 0
    ds_read_b128 v[32:35], v77 offset:6144
    s_waitcnt lgkmcnt(3)
    v_mfma_f32_16x16x32_bf16 v[180:183], v[40:43], v[60:63], 0
    ds_read_b128 v[36:39], v77 offset:6400
    ds_read_b64_tr_b16 v[40:41], v14 offset:8192
    ds_read_b64_tr_b16 v[42:43], v14 offset:9216
    v_mfma_f32_16x16x32_bf16 v[152:155], v[44:47], v[48:51], 0
    v_mfma_f32_16x16x32_bf16 v[156:159], v[44:47], v[52:55], 0
    v_mfma_f32_16x16x32_bf16 v[184:187], v[44:47], v[56:59], 0
    v_mfma_f32_16x16x32_bf16 v[188:191], v[44:47], v[60:63], 0
    ds_read_b64_tr_b16 v[44:45], v15 offset:8192
    ds_read_b64_tr_b16 v[46:47], v15 offset:9216
    v_cvt_pk_bf16_f32 v248, v160, v161
    v_cvt_pk_bf16_f32 v249, v162, v163
    v_cvt_pk_bf16_f32 v250, v164, v165
    v_cvt_pk_bf16_f32 v251, v166, v167
    s_nop 1
    v_permlane16_swap_b32 v248, v250
    v_permlane16_swap_b32 v249, v251
    v_cvt_pk_bf16_f32 v252, v168, v169
    v_cvt_pk_bf16_f32 v253, v170, v171
    v_cvt_pk_bf16_f32 v254, v172, v173
    v_cvt_pk_bf16_f32 v255, v174, v175
    s_nop 1
    v_permlane16_swap_b32 v252, v254
    v_permlane16_swap_b32 v253, v255
    v_mfma_f32_16x16x32_bf16 v[160:163], v[64:67], v[48:51], 0
    v_mfma_f32_16x16x32_bf16 v[164:167], v[64:67], v[52:55], 0
    v_cvt_pk_bf16_f32 v10, v192, v193
    v_cvt_pk_bf16_f32 v11, v194, v195
    v_cvt_pk_bf16_f32 v12, v196, v197
    v_cvt_pk_bf16_f32 v13, v198, v199
    s_nop 1
    v_permlane16_swap_b32 v10, v12
    v_permlane16_swap_b32 v11, v13
    v_cvt_pk_bf16_f32 v16, v200, v201
    v_cvt_pk_bf16_f32 v17, v202, v203
    v_cvt_pk_bf16_f32 v18, v204, v205
    v_cvt_pk_bf16_f32 v19, v206, v207
    s_nop 1
    v_permlane16_swap_b32 v16, v18
    v_permlane16_swap_b32 v17, v19
    v_mfma_f32_16x16x32_bf16 v[192:195], v[64:67], v[56:59], 0
    v_mfma_f32_16x16x32_bf16 v[196:199], v[64:67], v[60:63], 0
    ds_read_b64_tr_b16 v[64:65], v14 offset:24576
    ds_read_b64_tr_b16 v[66:67], v14 offset:25600
    v_mfma_f32_16x16x32_bf16 v[168:171], v[68:71], v[48:51], 0
    v_mfma_f32_16x16x32_bf16 v[172:175], v[68:71], v[52:55], 0
    v_mfma_f32_16x16x32_bf16 v[200:203], v[68:71], v[56:59], 0
    v_mfma_f32_16x16x32_bf16 v[204:207], v[68:71], v[60:63], 0
    ds_read_b64_tr_b16 v[68:69], v15 offset:24576
    ds_read_b64_tr_b16 v[70:71], v15 offset:25600
    s_waitcnt lgkmcnt(6)
    v_mfma_f32_16x16x32_bf16 v[80:83], v[40:43], v[24:27], v[80:83]
    ds_read_b128 v[48:51], v77 offset:10240
    buffer_store_dwordx4 v[208:211], v1, s[12:15], s100 offen offset:0 sc1
    v_mfma_f32_16x16x32_bf16 v[84:87], v[40:43], v[28:31], v[84:87]
    ds_read_b128 v[52:55], v77 offset:10496
    v_mfma_f32_16x16x32_bf16 v[112:115], v[40:43], v[32:35], v[112:115]
    ds_read_b128 v[56:59], v77 offset:14336
    v_mfma_f32_16x16x32_bf16 v[116:119], v[40:43], v[36:39], v[116:119]
    ds_read_b128 v[60:63], v77 offset:14592
    s_waitcnt lgkmcnt(8)
    v_mfma_f32_16x16x32_bf16 v[88:91], v[44:47], v[24:27], v[88:91]
    v_mfma_f32_16x16x32_bf16 v[92:95], v[44:47], v[28:31], v[92:95]
    v_mfma_f32_16x16x32_bf16 v[120:123], v[44:47], v[32:35], v[120:123]
    v_mfma_f32_16x16x32_bf16 v[124:127], v[44:47], v[36:39], v[124:127]
    s_waitcnt lgkmcnt(6)
    v_mfma_f32_16x16x32_bf16 v[96:99], v[64:67], v[24:27], v[96:99]
    v_mfma_f32_16x16x32_bf16 v[100:103], v[64:67], v[28:31], v[100:103]
    v_mfma_f32_16x16x32_bf16 v[128:131], v[64:67], v[32:35], v[128:131]
    v_mfma_f32_16x16x32_bf16 v[132:135], v[64:67], v[36:39], v[132:135]
    s_waitcnt lgkmcnt(4)
    v_mfma_f32_16x16x32_bf16 v[104:107], v[68:71], v[24:27], v[104:107]
    v_mfma_f32_16x16x32_bf16 v[108:111], v[68:71], v[28:31], v[108:111]
    v_mfma_f32_16x16x32_bf16 v[136:139], v[68:71], v[32:35], v[136:139]
    v_mfma_f32_16x16x32_bf16 v[140:143], v[68:71], v[36:39], v[140:143]
    s_waitcnt lgkmcnt(0)
    s_barrier
    v_mfma_f32_16x16x32_bf16 v[144:147], v[40:43], v[48:51], v[144:147]
    ds_read_b128 v[24:27], v77 offset:32768
    v_mfma_f32_16x16x32_bf16 v[148:151], v[40:43], v[52:55], v[148:151]
    ds_read_b128 v[28:31], v77 offset:33024
    v_mfma_f32_16x16x32_bf16 v[176:179], v[40:43], v[56:59], v[176:179]
    ds_read_b128 v[32:35], v77 offset:36864
    v_mfma_f32_16x16x32_bf16 v[180:183], v[40:43], v[60:63], v[180:183]
    ds_read_b128 v[36:39], v77 offset:37120
    ds_read_b64_tr_b16 v[40:41], v14 offset:32768
    ds_read_b64_tr_b16 v[42:43], v14 offset:33792
    v_mfma_f32_16x16x32_bf16 v[152:155], v[44:47], v[48:51], v[152:155]
    v_mfma_f32_16x16x32_bf16 v[156:159], v[44:47], v[52:55], v[156:159]
    v_mfma_f32_16x16x32_bf16 v[184:187], v[44:47], v[56:59], v[184:187]
    v_mfma_f32_16x16x32_bf16 v[188:191], v[44:47], v[60:63], v[188:191]
    ds_read_b64_tr_b16 v[44:45], v15 offset:32768
    ds_read_b64_tr_b16 v[46:47], v15 offset:33792
    v_mfma_f32_16x16x32_bf16 v[160:163], v[64:67], v[48:51], v[160:163]
    v_mfma_f32_16x16x32_bf16 v[164:167], v[64:67], v[52:55], v[164:167]
    v_mfma_f32_16x16x32_bf16 v[192:195], v[64:67], v[56:59], v[192:195]
    v_mfma_f32_16x16x32_bf16 v[196:199], v[64:67], v[60:63], v[196:199]
    ds_read_b64_tr_b16 v[64:65], v14 offset:49152
    ds_read_b64_tr_b16 v[66:67], v14 offset:50176
    v_mfma_f32_16x16x32_bf16 v[168:171], v[68:71], v[48:51], v[168:171]
    v_mfma_f32_16x16x32_bf16 v[172:175], v[68:71], v[52:55], v[172:175]
    v_mfma_f32_16x16x32_bf16 v[200:203], v[68:71], v[56:59], v[200:203]
    v_mfma_f32_16x16x32_bf16 v[204:207], v[68:71], v[60:63], v[204:207]
    ds_read_b64_tr_b16 v[68:69], v15 offset:49152
    ds_read_b64_tr_b16 v[70:71], v15 offset:50176
    s_waitcnt lgkmcnt(6)
    v_mfma_f32_16x16x32_bf16 v[80:83], v[40:43], v[24:27], v[80:83]
    ds_read_b128 v[48:51], v77 offset:40960
    buffer_store_dwordx4 v[212:215], v1, s[12:15], s100 offen offset:1024 sc1
    v_mfma_f32_16x16x32_bf16 v[84:87], v[40:43], v[28:31], v[84:87]
    ds_read_b128 v[52:55], v77 offset:41216
    v_mfma_f32_16x16x32_bf16 v[112:115], v[40:43], v[32:35], v[112:115]
    ds_read_b128 v[56:59], v77 offset:45056
    v_mfma_f32_16x16x32_bf16 v[116:119], v[40:43], v[36:39], v[116:119]
    ds_read_b128 v[60:63], v77 offset:45312
    s_waitcnt lgkmcnt(8)
    v_mfma_f32_16x16x32_bf16 v[88:91], v[44:47], v[24:27], v[88:91]
    v_mfma_f32_16x16x32_bf16 v[92:95], v[44:47], v[28:31], v[92:95]
    v_mfma_f32_16x16x32_bf16 v[120:123], v[44:47], v[32:35], v[120:123]
    v_mfma_f32_16x16x32_bf16 v[124:127], v[44:47], v[36:39], v[124:127]
    s_waitcnt lgkmcnt(6)
    v_mfma_f32_16x16x32_bf16 v[96:99], v[64:67], v[24:27], v[96:99]
    v_mfma_f32_16x16x32_bf16 v[100:103], v[64:67], v[28:31], v[100:103]
    v_mfma_f32_16x16x32_bf16 v[128:131], v[64:67], v[32:35], v[128:131]
    v_mfma_f32_16x16x32_bf16 v[132:135], v[64:67], v[36:39], v[132:135]
    s_waitcnt lgkmcnt(4)
    v_mfma_f32_16x16x32_bf16 v[104:107], v[68:71], v[24:27], v[104:107]
    v_mfma_f32_16x16x32_bf16 v[108:111], v[68:71], v[28:31], v[108:111]
    v_mfma_f32_16x16x32_bf16 v[136:139], v[68:71], v[32:35], v[136:139]
    v_mfma_f32_16x16x32_bf16 v[140:143], v[68:71], v[36:39], v[140:143]
    s_waitcnt lgkmcnt(3)
    v_mfma_f32_16x16x32_bf16 v[144:147], v[40:43], v[48:51], v[144:147]
    ds_read_b128 v[24:27], v77 offset:34816
    buffer_store_dwordx4 v[216:219], v1, s[12:15], s100 offen offset:2048 sc1
    s_waitcnt lgkmcnt(3)
    v_mfma_f32_16x16x32_bf16 v[148:151], v[40:43], v[52:55], v[148:151]
    ds_read_b128 v[28:31], v77 offset:35072
    s_waitcnt lgkmcnt(3)
    v_mfma_f32_16x16x32_bf16 v[176:179], v[40:43], v[56:59], v[176:179]
    ds_read_b128 v[32:35], v77 offset:38912
    s_waitcnt lgkmcnt(3)
    v_mfma_f32_16x16x32_bf16 v[180:183], v[40:43], v[60:63], v[180:183]
    ds_read_b128 v[36:39], v77 offset:39168
    ds_read_b64_tr_b16 v[40:41], v14 offset:40960
    ds_read_b64_tr_b16 v[42:43], v14 offset:41984
    v_mfma_f32_16x16x32_bf16 v[152:155], v[44:47], v[48:51], v[152:155]
    v_mfma_f32_16x16x32_bf16 v[156:159], v[44:47], v[52:55], v[156:159]
    v_mfma_f32_16x16x32_bf16 v[184:187], v[44:47], v[56:59], v[184:187]
    v_mfma_f32_16x16x32_bf16 v[188:191], v[44:47], v[60:63], v[188:191]
    ds_read_b64_tr_b16 v[44:45], v15 offset:40960
    ds_read_b64_tr_b16 v[46:47], v15 offset:41984
    v_mfma_f32_16x16x32_bf16 v[160:163], v[64:67], v[48:51], v[160:163]
    v_mfma_f32_16x16x32_bf16 v[164:167], v[64:67], v[52:55], v[164:167]
    v_mfma_f32_16x16x32_bf16 v[192:195], v[64:67], v[56:59], v[192:195]
    v_mfma_f32_16x16x32_bf16 v[196:199], v[64:67], v[60:63], v[196:199]
    ds_read_b64_tr_b16 v[64:65], v14 offset:57344
    ds_read_b64_tr_b16 v[66:67], v14 offset:58368
    v_mfma_f32_16x16x32_bf16 v[168:171], v[68:71], v[48:51], v[168:171]
    v_mfma_f32_16x16x32_bf16 v[172:175], v[68:71], v[52:55], v[172:175]
    v_mfma_f32_16x16x32_bf16 v[200:203], v[68:71], v[56:59], v[200:203]
    v_mfma_f32_16x16x32_bf16 v[204:207], v[68:71], v[60:63], v[204:207]
    ds_read_b64_tr_b16 v[68:69], v15 offset:57344
    ds_read_b64_tr_b16 v[70:71], v15 offset:58368
    s_waitcnt lgkmcnt(6)
    v_mfma_f32_16x16x32_bf16 v[80:83], v[40:43], v[24:27], v[80:83]
    ds_read_b128 v[48:51], v77 offset:43008
    v_mfma_f32_16x16x32_bf16 v[84:87], v[40:43], v[28:31], v[84:87]
    ds_read_b128 v[52:55], v77 offset:43264
    v_mfma_f32_16x16x32_bf16 v[112:115], v[40:43], v[32:35], v[112:115]
    ds_read_b128 v[56:59], v77 offset:47104
    v_mfma_f32_16x16x32_bf16 v[116:119], v[40:43], v[36:39], v[116:119]
    ds_read_b128 v[60:63], v77 offset:47360
    s_waitcnt lgkmcnt(8)
    v_mfma_f32_16x16x32_bf16 v[88:91], v[44:47], v[24:27], v[88:91]
    v_mfma_f32_16x16x32_bf16 v[92:95], v[44:47], v[28:31], v[92:95]
    v_mfma_f32_16x16x32_bf16 v[120:123], v[44:47], v[32:35], v[120:123]
    v_mfma_f32_16x16x32_bf16 v[124:127], v[44:47], v[36:39], v[124:127]
    s_waitcnt lgkmcnt(6)
    v_mfma_f32_16x16x32_bf16 v[96:99], v[64:67], v[24:27], v[96:99]
    v_mfma_f32_16x16x32_bf16 v[100:103], v[64:67], v[28:31], v[100:103]
    v_mfma_f32_16x16x32_bf16 v[128:131], v[64:67], v[32:35], v[128:131]
    v_mfma_f32_16x16x32_bf16 v[132:135], v[64:67], v[36:39], v[132:135]
    s_waitcnt lgkmcnt(4)
    v_mfma_f32_16x16x32_bf16 v[104:107], v[68:71], v[24:27], v[104:107]
    v_mfma_f32_16x16x32_bf16 v[108:111], v[68:71], v[28:31], v[108:111]
    v_mfma_f32_16x16x32_bf16 v[136:139], v[68:71], v[32:35], v[136:139]
    v_mfma_f32_16x16x32_bf16 v[140:143], v[68:71], v[36:39], v[140:143]
    s_waitcnt lgkmcnt(0)
    s_barrier
    v_mfma_f32_16x16x32_bf16 v[144:147], v[40:43], v[48:51], v[144:147]
    ds_read_b128 v[24:27], v77 offset:0
    v_mfma_f32_16x16x32_bf16 v[148:151], v[40:43], v[52:55], v[148:151]
    ds_read_b128 v[28:31], v77 offset:256
    v_mfma_f32_16x16x32_bf16 v[176:179], v[40:43], v[56:59], v[176:179]
    ds_read_b128 v[32:35], v77 offset:4096
    v_mfma_f32_16x16x32_bf16 v[180:183], v[40:43], v[60:63], v[180:183]
    ds_read_b128 v[36:39], v77 offset:4352
    ds_read_b64_tr_b16 v[40:41], v14 offset:0
    ds_read_b64_tr_b16 v[42:43], v14 offset:1024
    v_mfma_f32_16x16x32_bf16 v[152:155], v[44:47], v[48:51], v[152:155]
    v_mfma_f32_16x16x32_bf16 v[156:159], v[44:47], v[52:55], v[156:159]
    v_mfma_f32_16x16x32_bf16 v[184:187], v[44:47], v[56:59], v[184:187]
    v_mfma_f32_16x16x32_bf16 v[188:191], v[44:47], v[60:63], v[188:191]
    ds_read_b64_tr_b16 v[44:45], v15 offset:0
    ds_read_b64_tr_b16 v[46:47], v15 offset:1024
    v_mfma_f32_16x16x32_bf16 v[160:163], v[64:67], v[48:51], v[160:163]
    v_mfma_f32_16x16x32_bf16 v[164:167], v[64:67], v[52:55], v[164:167]
    v_mfma_f32_16x16x32_bf16 v[192:195], v[64:67], v[56:59], v[192:195]
    v_mfma_f32_16x16x32_bf16 v[196:199], v[64:67], v[60:63], v[196:199]
    ds_read_b64_tr_b16 v[64:65], v14 offset:16384
    ds_read_b64_tr_b16 v[66:67], v14 offset:17408
    v_mfma_f32_16x16x32_bf16 v[168:171], v[68:71], v[48:51], v[168:171]
    v_mfma_f32_16x16x32_bf16 v[172:175], v[68:71], v[52:55], v[172:175]
    v_mfma_f32_16x16x32_bf16 v[200:203], v[68:71], v[56:59], v[200:203]
    v_mfma_f32_16x16x32_bf16 v[204:207], v[68:71], v[60:63], v[204:207]
    ds_read_b64_tr_b16 v[68:69], v15 offset:16384
    ds_read_b64_tr_b16 v[70:71], v15 offset:17408
    s_waitcnt lgkmcnt(6)
    v_mfma_f32_16x16x32_bf16 v[80:83], v[40:43], v[24:27], v[80:83]
    ds_read_b128 v[48:51], v77 offset:8192
    buffer_store_dwordx4 v[220:223], v1, s[12:15], s100 offen offset:3072 sc1
    s_add_u32 s100, s100, 8192
    v_mfma_f32_16x16x32_bf16 v[84:87], v[40:43], v[28:31], v[84:87]
    ds_read_b128 v[52:55], v77 offset:8448
    v_mfma_f32_16x16x32_bf16 v[112:115], v[40:43], v[32:35], v[112:115]
    ds_read_b128 v[56:59], v77 offset:12288
    v_mfma_f32_16x16x32_bf16 v[116:119], v[40:43], v[36:39], v[116:119]
    ds_read_b128 v[60:63], v77 offset:12544
    s_waitcnt lgkmcnt(8)
    v_mfma_f32_16x16x32_bf16 v[88:91], v[44:47], v[24:27], v[88:91]
    v_mfma_f32_16x16x32_bf16 v[92:95], v[44:47], v[28:31], v[92:95]
    v_mfma_f32_16x16x32_bf16 v[120:123], v[44:47], v[32:35], v[120:123]
    v_mfma_f32_16x16x32_bf16 v[124:127], v[44:47], v[36:39], v[124:127]
    s_waitcnt lgkmcnt(6)
    v_mfma_f32_16x16x32_bf16 v[96:99], v[64:67], v[24:27], v[96:99]
    v_mfma_f32_16x16x32_bf16 v[100:103], v[64:67], v[28:31], v[100:103]
    v_mfma_f32_16x16x32_bf16 v[128:131], v[64:67], v[32:35], v[128:131]
    v_mfma_f32_16x16x32_bf16 v[132:135], v[64:67], v[36:39], v[132:135]
    s_waitcnt lgkmcnt(4)
    v_mfma_f32_16x16x32_bf16 v[104:107], v[68:71], v[24:27], v[104:107]
    v_mfma_f32_16x16x32_bf16 v[108:111], v[68:71], v[28:31], v[108:111]
    v_mfma_f32_16x16x32_bf16 v[136:139], v[68:71], v[32:35], v[136:139]
    v_mfma_f32_16x16x32_bf16 v[140:143], v[68:71], v[36:39], v[140:143]
    s_waitcnt lgkmcnt(3)
    v_mfma_f32_16x16x32_bf16 v[144:147], v[40:43], v[48:51], v[144:147]
    ds_read_b128 v[24:27], v77 offset:2048
    s_waitcnt lgkmcnt(3)
    v_mfma_f32_16x16x32_bf16 v[148:151], v[40:43], v[52:55], v[148:151]
    ds_read_b128 v[28:31], v77 offset:2304
    s_waitcnt lgkmcnt(3)
    v_mfma_f32_16x16x32_bf16 v[176:179], v[40:43], v[56:59], v[176:179]
    ds_read_b128 v[32:35], v77 offset:6144
    s_waitcnt lgkmcnt(3)
    v_mfma_f32_16x16x32_bf16 v[180:183], v[40:43], v[60:63], v[180:183]
    ds_read_b128 v[36:39], v77 offset:6400
    ds_read_b64_tr_b16 v[40:41], v14 offset:8192
    ds_read_b64_tr_b16 v[42:43], v14 offset:9216
    v_mfma_f32_16x16x32_bf16 v[152:155], v[44:47], v[48:51], v[152:155]
    v_mfma_f32_16x16x32_bf16 v[156:159], v[44:47], v[52:55], v[156:159]
    v_mfma_f32_16x16x32_bf16 v[184:187], v[44:47], v[56:59], v[184:187]
    v_mfma_f32_16x16x32_bf16 v[188:191], v[44:47], v[60:63], v[188:191]
    ds_read_b64_tr_b16 v[44:45], v15 offset:8192
    ds_read_b64_tr_b16 v[46:47], v15 offset:9216
    v_mfma_f32_16x16x32_bf16 v[160:163], v[64:67], v[48:51], v[160:163]
    v_mfma_f32_16x16x32_bf16 v[164:167], v[64:67], v[52:55], v[164:167]
    v_mfma_f32_16x16x32_bf16 v[192:195], v[64:67], v[56:59], v[192:195]
    v_mfma_f32_16x16x32_bf16 v[196:199], v[64:67], v[60:63], v[196:199]
    ds_read_b64_tr_b16 v[64:65], v14 offset:24576
    ds_read_b64_tr_b16 v[66:67], v14 offset:25600
    v_mfma_f32_16x16x32_bf16 v[168:171], v[68:71], v[48:51], v[168:171]
    v_mfma_f32_16x16x32_bf16 v[172:175], v[68:71], v[52:55], v[172:175]
    v_mfma_f32_16x16x32_bf16 v[200:203], v[68:71], v[56:59], v[200:203]
    v_mfma_f32_16x16x32_bf16 v[204:207], v[68:71], v[60:63], v[204:207]
    ds_read_b64_tr_b16 v[68:69], v15 offset:24576
    ds_read_b64_tr_b16 v[70:71], v15 offset:25600
    s_waitcnt lgkmcnt(6)
    v_mfma_f32_16x16x32_bf16 v[80:83], v[40:43], v[24:27], v[80:83]
    ds_read_b128 v[48:51], v77 offset:10240
    v_mfma_f32_16x16x32_bf16 v[84:87], v[40:43], v[28:31], v[84:87]
    ds_read_b128 v[52:55], v77 offset:10496
    v_mfma_f32_16x16x32_bf16 v[112:115], v[40:43], v[32:35], v[112:115]
    ds_read_b128 v[56:59], v77 offset:14336
    v_mfma_f32_16x16x32_bf16 v[116:119], v[40:43], v[36:39], v[116:119]
    ds_read_b128 v[60:63], v77 offset:14592
    s_waitcnt lgkmcnt(8)
    v_mfma_f32_16x16x32_bf16 v[88:91], v[44:47], v[24:27], v[88:91]
    v_mfma_f32_16x16x32_bf16 v[92:95], v[44:47], v[28:31], v[92:95]
    v_mfma_f32_16x16x32_bf16 v[120:123], v[44:47], v[32:35], v[120:123]
    v_mfma_f32_16x16x32_bf16 v[124:127], v[44:47], v[36:39], v[124:127]
    s_waitcnt lgkmcnt(6)
    v_mfma_f32_16x16x32_bf16 v[96:99], v[64:67], v[24:27], v[96:99]
    v_mfma_f32_16x16x32_bf16 v[100:103], v[64:67], v[28:31], v[100:103]
    v_mfma_f32_16x16x32_bf16 v[128:131], v[64:67], v[32:35], v[128:131]
    v_mfma_f32_16x16x32_bf16 v[132:135], v[64:67], v[36:39], v[132:135]
    s_waitcnt lgkmcnt(4)
    v_mfma_f32_16x16x32_bf16 v[104:107], v[68:71], v[24:27], v[104:107]
    v_mfma_f32_16x16x32_bf16 v[108:111], v[68:71], v[28:31], v[108:111]
    v_mfma_f32_16x16x32_bf16 v[136:139], v[68:71], v[32:35], v[136:139]
    v_mfma_f32_16x16x32_bf16 v[140:143], v[68:71], v[36:39], v[140:143]
    s_waitcnt lgkmcnt(0)
    s_barrier
    v_mfma_f32_16x16x32_bf16 v[144:147], v[40:43], v[48:51], v[144:147]
    ds_read_b128 v[24:27], v77 offset:32768
    v_mfma_f32_16x16x32_bf16 v[148:151], v[40:43], v[52:55], v[148:151]
    ds_read_b128 v[28:31], v77 offset:33024
    v_mfma_f32_16x16x32_bf16 v[176:179], v[40:43], v[56:59], v[176:179]
    ds_read_b128 v[32:35], v77 offset:36864
    v_mfma_f32_16x16x32_bf16 v[180:183], v[40:43], v[60:63], v[180:183]
    ds_read_b128 v[36:39], v77 offset:37120
    ds_read_b64_tr_b16 v[40:41], v14 offset:32768
    ds_read_b64_tr_b16 v[42:43], v14 offset:33792
    v_mfma_f32_16x16x32_bf16 v[152:155], v[44:47], v[48:51], v[152:155]
    v_mfma_f32_16x16x32_bf16 v[156:159], v[44:47], v[52:55], v[156:159]
    v_mfma_f32_16x16x32_bf16 v[184:187], v[44:47], v[56:59], v[184:187]
    v_mfma_f32_16x16x32_bf16 v[188:191], v[44:47], v[60:63], v[188:191]
    ds_read_b64_tr_b16 v[44:45], v15 offset:32768
    ds_read_b64_tr_b16 v[46:47], v15 offset:33792
    v_mfma_f32_16x16x32_bf16 v[160:163], v[64:67], v[48:51], v[160:163]
    v_mfma_f32_16x16x32_bf16 v[164:167], v[64:67], v[52:55], v[164:167]
    v_mfma_f32_16x16x32_bf16 v[192:195], v[64:67], v[56:59], v[192:195]
    v_mfma_f32_16x16x32_bf16 v[196:199], v[64:67], v[60:63], v[196:199]
    ds_read_b64_tr_b16 v[64:65], v14 offset:49152
    ds_read_b64_tr_b16 v[66:67], v14 offset:50176
    v_mfma_f32_16x16x32_bf16 v[168:171], v[68:71], v[48:51], v[168:171]
    v_mfma_f32_16x16x32_bf16 v[172:175], v[68:71], v[52:55], v[172:175]
    v_mfma_f32_16x16x32_bf16 v[200:203], v[68:71], v[56:59], v[200:203]
    v_mfma_f32_16x16x32_bf16 v[204:207], v[68:71], v[60:63], v[204:207]
    ds_read_b64_tr_b16 v[68:69], v15 offset:49152
    ds_read_b64_tr_b16 v[70:71], v15 offset:50176
    s_waitcnt lgkmcnt(6)
    v_mfma_f32_16x16x32_bf16 v[80:83], v[40:43], v[24:27], v[80:83]
    ds_read_b128 v[48:51], v77 offset:40960
    buffer_store_dwordx4 v[224:227], v1, s[12:15], s100 offen offset:0 sc1
    v_mfma_f32_16x16x32_bf16 v[84:87], v[40:43], v[28:31], v[84:87]
    ds_read_b128 v[52:55], v77 offset:41216
    v_mfma_f32_16x16x32_bf16 v[112:115], v[40:43], v[32:35], v[112:115]
    ds_read_b128 v[56:59], v77 offset:45056
    v_mfma_f32_16x16x32_bf16 v[116:119], v[40:43], v[36:39], v[116:119]
    ds_read_b128 v[60:63], v77 offset:45312
    s_waitcnt lgkmcnt(8)
    v_mfma_f32_16x16x32_bf16 v[88:91], v[44:47], v[24:27], v[88:91]
    v_mfma_f32_16x16x32_bf16 v[92:95], v[44:47], v[28:31], v[92:95]
    v_mfma_f32_16x16x32_bf16 v[120:123], v[44:47], v[32:35], v[120:123]
    v_mfma_f32_16x16x32_bf16 v[124:127], v[44:47], v[36:39], v[124:127]
    s_waitcnt lgkmcnt(6)
    v_mfma_f32_16x16x32_bf16 v[96:99], v[64:67], v[24:27], v[96:99]
    v_mfma_f32_16x16x32_bf16 v[100:103], v[64:67], v[28:31], v[100:103]
    v_mfma_f32_16x16x32_bf16 v[128:131], v[64:67], v[32:35], v[128:131]
    v_mfma_f32_16x16x32_bf16 v[132:135], v[64:67], v[36:39], v[132:135]
    s_waitcnt lgkmcnt(4)
    v_mfma_f32_16x16x32_bf16 v[104:107], v[68:71], v[24:27], v[104:107]
    v_mfma_f32_16x16x32_bf16 v[108:111], v[68:71], v[28:31], v[108:111]
    v_mfma_f32_16x16x32_bf16 v[136:139], v[68:71], v[32:35], v[136:139]
    v_mfma_f32_16x16x32_bf16 v[140:143], v[68:71], v[36:39], v[140:143]
    s_waitcnt lgkmcnt(3)
    v_mfma_f32_16x16x32_bf16 v[144:147], v[40:43], v[48:51], v[144:147]
    ds_read_b128 v[24:27], v77 offset:34816
    buffer_store_dwordx4 v[228:231], v1, s[12:15], s100 offen offset:1024 sc1
    s_waitcnt lgkmcnt(3)
    v_mfma_f32_16x16x32_bf16 v[148:151], v[40:43], v[52:55], v[148:151]
    ds_read_b128 v[28:31], v77 offset:35072
    s_waitcnt lgkmcnt(3)
    v_mfma_f32_16x16x32_bf16 v[176:179], v[40:43], v[56:59], v[176:179]
    ds_read_b128 v[32:35], v77 offset:38912
    s_waitcnt lgkmcnt(3)
    v_mfma_f32_16x16x32_bf16 v[180:183], v[40:43], v[60:63], v[180:183]
    ds_read_b128 v[36:39], v77 offset:39168
    ds_read_b64_tr_b16 v[40:41], v14 offset:40960
    ds_read_b64_tr_b16 v[42:43], v14 offset:41984
    v_mfma_f32_16x16x32_bf16 v[152:155], v[44:47], v[48:51], v[152:155]
    v_mfma_f32_16x16x32_bf16 v[156:159], v[44:47], v[52:55], v[156:159]
    v_mfma_f32_16x16x32_bf16 v[184:187], v[44:47], v[56:59], v[184:187]
    v_mfma_f32_16x16x32_bf16 v[188:191], v[44:47], v[60:63], v[188:191]
    ds_read_b64_tr_b16 v[44:45], v15 offset:40960
    ds_read_b64_tr_b16 v[46:47], v15 offset:41984
    v_mfma_f32_16x16x32_bf16 v[160:163], v[64:67], v[48:51], v[160:163]
    v_mfma_f32_16x16x32_bf16 v[164:167], v[64:67], v[52:55], v[164:167]
    v_mfma_f32_16x16x32_bf16 v[192:195], v[64:67], v[56:59], v[192:195]
    v_mfma_f32_16x16x32_bf16 v[196:199], v[64:67], v[60:63], v[196:199]
    ds_read_b64_tr_b16 v[64:65], v14 offset:57344
    ds_read_b64_tr_b16 v[66:67], v14 offset:58368
    v_mfma_f32_16x16x32_bf16 v[168:171], v[68:71], v[48:51], v[168:171]
    v_mfma_f32_16x16x32_bf16 v[172:175], v[68:71], v[52:55], v[172:175]
    v_mfma_f32_16x16x32_bf16 v[200:203], v[68:71], v[56:59], v[200:203]
    v_mfma_f32_16x16x32_bf16 v[204:207], v[68:71], v[60:63], v[204:207]
    ds_read_b64_tr_b16 v[68:69], v15 offset:57344
    ds_read_b64_tr_b16 v[70:71], v15 offset:58368
    s_waitcnt lgkmcnt(6)
    v_mfma_f32_16x16x32_bf16 v[80:83], v[40:43], v[24:27], v[80:83]
    ds_read_b128 v[48:51], v77 offset:43008
    v_mfma_f32_16x16x32_bf16 v[84:87], v[40:43], v[28:31], v[84:87]
    ds_read_b128 v[52:55], v77 offset:43264
    v_mfma_f32_16x16x32_bf16 v[112:115], v[40:43], v[32:35], v[112:115]
    ds_read_b128 v[56:59], v77 offset:47104
    v_mfma_f32_16x16x32_bf16 v[116:119], v[40:43], v[36:39], v[116:119]
    ds_read_b128 v[60:63], v77 offset:47360
    s_waitcnt lgkmcnt(8)
    v_mfma_f32_16x16x32_bf16 v[88:91], v[44:47], v[24:27], v[88:91]
    v_mfma_f32_16x16x32_bf16 v[92:95], v[44:47], v[28:31], v[92:95]
    v_mfma_f32_16x16x32_bf16 v[120:123], v[44:47], v[32:35], v[120:123]
    v_mfma_f32_16x16x32_bf16 v[124:127], v[44:47], v[36:39], v[124:127]
    s_waitcnt lgkmcnt(6)
    v_mfma_f32_16x16x32_bf16 v[96:99], v[64:67], v[24:27], v[96:99]
    v_mfma_f32_16x16x32_bf16 v[100:103], v[64:67], v[28:31], v[100:103]
    v_mfma_f32_16x16x32_bf16 v[128:131], v[64:67], v[32:35], v[128:131]
    v_mfma_f32_16x16x32_bf16 v[132:135], v[64:67], v[36:39], v[132:135]
    s_waitcnt lgkmcnt(4)
    v_mfma_f32_16x16x32_bf16 v[104:107], v[68:71], v[24:27], v[104:107]
    v_mfma_f32_16x16x32_bf16 v[108:111], v[68:71], v[28:31], v[108:111]
    v_mfma_f32_16x16x32_bf16 v[136:139], v[68:71], v[32:35], v[136:139]
    v_mfma_f32_16x16x32_bf16 v[140:143], v[68:71], v[36:39], v[140:143]
    s_waitcnt lgkmcnt(0)
    s_barrier
    v_mfma_f32_16x16x32_bf16 v[144:147], v[40:43], v[48:51], v[144:147]
    ds_read_b128 v[24:27], v77 offset:0
    v_mfma_f32_16x16x32_bf16 v[148:151], v[40:43], v[52:55], v[148:151]
    ds_read_b128 v[28:31], v77 offset:256
    v_mfma_f32_16x16x32_bf16 v[176:179], v[40:43], v[56:59], v[176:179]
    ds_read_b128 v[32:35], v77 offset:4096
    v_mfma_f32_16x16x32_bf16 v[180:183], v[40:43], v[60:63], v[180:183]
    ds_read_b128 v[36:39], v77 offset:4352
    ds_read_b64_tr_b16 v[40:41], v14 offset:0
    ds_read_b64_tr_b16 v[42:43], v14 offset:1024
    v_mfma_f32_16x16x32_bf16 v[152:155], v[44:47], v[48:51], v[152:155]
    v_mfma_f32_16x16x32_bf16 v[156:159], v[44:47], v[52:55], v[156:159]
    v_mfma_f32_16x16x32_bf16 v[184:187], v[44:47], v[56:59], v[184:187]
    v_mfma_f32_16x16x32_bf16 v[188:191], v[44:47], v[60:63], v[188:191]
    ds_read_b64_tr_b16 v[44:45], v15 offset:0
    ds_read_b64_tr_b16 v[46:47], v15 offset:1024
    v_mfma_f32_16x16x32_bf16 v[160:163], v[64:67], v[48:51], v[160:163]
    v_mfma_f32_16x16x32_bf16 v[164:167], v[64:67], v[52:55], v[164:167]
    v_mfma_f32_16x16x32_bf16 v[192:195], v[64:67], v[56:59], v[192:195]
    v_mfma_f32_16x16x32_bf16 v[196:199], v[64:67], v[60:63], v[196:199]
    ds_read_b64_tr_b16 v[64:65], v14 offset:16384
    ds_read_b64_tr_b16 v[66:67], v14 offset:17408
    v_mfma_f32_16x16x32_bf16 v[168:171], v[68:71], v[48:51], v[168:171]
    v_mfma_f32_16x16x32_bf16 v[172:175], v[68:71], v[52:55], v[172:175]
    v_mfma_f32_16x16x32_bf16 v[200:203], v[68:71], v[56:59], v[200:203]
    v_mfma_f32_16x16x32_bf16 v[204:207], v[68:71], v[60:63], v[204:207]
    ds_read_b64_tr_b16 v[68:69], v15 offset:16384
    ds_read_b64_tr_b16 v[70:71], v15 offset:17408
    s_waitcnt lgkmcnt(6)
    v_mfma_f32_16x16x32_bf16 v[80:83], v[40:43], v[24:27], v[80:83]
    ds_read_b128 v[48:51], v77 offset:8192
    buffer_store_dwordx4 v[232:235], v1, s[12:15], s100 offen offset:2048 sc1
    v_mfma_f32_16x16x32_bf16 v[84:87], v[40:43], v[28:31], v[84:87]
    ds_read_b128 v[52:55], v77 offset:8448
    v_mfma_f32_16x16x32_bf16 v[112:115], v[40:43], v[32:35], v[112:115]
    ds_read_b128 v[56:59], v77 offset:12288
    v_mfma_f32_16x16x32_bf16 v[116:119], v[40:43], v[36:39], v[116:119]
    ds_read_b128 v[60:63], v77 offset:12544
    s_waitcnt lgkmcnt(8)
    v_mfma_f32_16x16x32_bf16 v[88:91], v[44:47], v[24:27], v[88:91]
    v_mfma_f32_16x16x32_bf16 v[92:95], v[44:47], v[28:31], v[92:95]
    v_mfma_f32_16x16x32_bf16 v[120:123], v[44:47], v[32:35], v[120:123]
    v_mfma_f32_16x16x32_bf16 v[124:127], v[44:47], v[36:39], v[124:127]
    s_waitcnt lgkmcnt(6)
    v_mfma_f32_16x16x32_bf16 v[96:99], v[64:67], v[24:27], v[96:99]
    v_mfma_f32_16x16x32_bf16 v[100:103], v[64:67], v[28:31], v[100:103]
    v_mfma_f32_16x16x32_bf16 v[128:131], v[64:67], v[32:35], v[128:131]
    v_mfma_f32_16x16x32_bf16 v[132:135], v[64:67], v[36:39], v[132:135]
    s_waitcnt lgkmcnt(4)
    v_mfma_f32_16x16x32_bf16 v[104:107], v[68:71], v[24:27], v[104:107]
    v_mfma_f32_16x16x32_bf16 v[108:111], v[68:71], v[28:31], v[108:111]
    v_mfma_f32_16x16x32_bf16 v[136:139], v[68:71], v[32:35], v[136:139]
    v_mfma_f32_16x16x32_bf16 v[140:143], v[68:71], v[36:39], v[140:143]
    s_waitcnt lgkmcnt(3)
    v_mfma_f32_16x16x32_bf16 v[144:147], v[40:43], v[48:51], v[144:147]
    ds_read_b128 v[24:27], v77 offset:2048
    buffer_store_dwordx4 v[236:239], v1, s[12:15], s100 offen offset:3072 sc1
    s_add_u32 s100, s100, 8192
    s_waitcnt lgkmcnt(3)
    v_mfma_f32_16x16x32_bf16 v[148:151], v[40:43], v[52:55], v[148:151]
    ds_read_b128 v[28:31], v77 offset:2304
    s_waitcnt lgkmcnt(3)
    v_mfma_f32_16x16x32_bf16 v[176:179], v[40:43], v[56:59], v[176:179]
    ds_read_b128 v[32:35], v77 offset:6144
    s_waitcnt lgkmcnt(3)
    v_mfma_f32_16x16x32_bf16 v[180:183], v[40:43], v[60:63], v[180:183]
    ds_read_b128 v[36:39], v77 offset:6400
    ds_read_b64_tr_b16 v[40:41], v14 offset:8192
    ds_read_b64_tr_b16 v[42:43], v14 offset:9216
    v_mfma_f32_16x16x32_bf16 v[152:155], v[44:47], v[48:51], v[152:155]
    v_mfma_f32_16x16x32_bf16 v[156:159], v[44:47], v[52:55], v[156:159]
    v_mfma_f32_16x16x32_bf16 v[184:187], v[44:47], v[56:59], v[184:187]
    v_mfma_f32_16x16x32_bf16 v[188:191], v[44:47], v[60:63], v[188:191]
    ds_read_b64_tr_b16 v[44:45], v15 offset:8192
    ds_read_b64_tr_b16 v[46:47], v15 offset:9216
    v_mfma_f32_16x16x32_bf16 v[160:163], v[64:67], v[48:51], v[160:163]
    v_mfma_f32_16x16x32_bf16 v[164:167], v[64:67], v[52:55], v[164:167]
    v_mfma_f32_16x16x32_bf16 v[192:195], v[64:67], v[56:59], v[192:195]
    v_mfma_f32_16x16x32_bf16 v[196:199], v[64:67], v[60:63], v[196:199]
    ds_read_b64_tr_b16 v[64:65], v14 offset:24576
    ds_read_b64_tr_b16 v[66:67], v14 offset:25600
    v_mfma_f32_16x16x32_bf16 v[168:171], v[68:71], v[48:51], v[168:171]
    v_mfma_f32_16x16x32_bf16 v[172:175], v[68:71], v[52:55], v[172:175]
    v_mfma_f32_16x16x32_bf16 v[200:203], v[68:71], v[56:59], v[200:203]
    v_mfma_f32_16x16x32_bf16 v[204:207], v[68:71], v[60:63], v[204:207]
    ds_read_b64_tr_b16 v[68:69], v15 offset:24576
    ds_read_b64_tr_b16 v[70:71], v15 offset:25600
    s_waitcnt lgkmcnt(6)
    v_mfma_f32_16x16x32_bf16 v[80:83], v[40:43], v[24:27], v[80:83]
    ds_read_b128 v[48:51], v77 offset:10240
    v_mfma_f32_16x16x32_bf16 v[84:87], v[40:43], v[28:31], v[84:87]
    ds_read_b128 v[52:55], v77 offset:10496
    v_mfma_f32_16x16x32_bf16 v[112:115], v[40:43], v[32:35], v[112:115]
    ds_read_b128 v[56:59], v77 offset:14336
    v_mfma_f32_16x16x32_bf16 v[116:119], v[40:43], v[36:39], v[116:119]
    ds_read_b128 v[60:63], v77 offset:14592
    s_waitcnt lgkmcnt(8)
    v_mfma_f32_16x16x32_bf16 v[88:91], v[44:47], v[24:27], v[88:91]
    v_mfma_f32_16x16x32_bf16 v[92:95], v[44:47], v[28:31], v[92:95]
    v_mfma_f32_16x16x32_bf16 v[120:123], v[44:47], v[32:35], v[120:123]
    v_mfma_f32_16x16x32_bf16 v[124:127], v[44:47], v[36:39], v[124:127]
    s_waitcnt lgkmcnt(6)
    v_mfma_f32_16x16x32_bf16 v[96:99], v[64:67], v[24:27], v[96:99]
    v_mfma_f32_16x16x32_bf16 v[100:103], v[64:67], v[28:31], v[100:103]
    v_mfma_f32_16x16x32_bf16 v[128:131], v[64:67], v[32:35], v[128:131]
    v_mfma_f32_16x16x32_bf16 v[132:135], v[64:67], v[36:39], v[132:135]
    s_waitcnt lgkmcnt(4)
    v_mfma_f32_16x16x32_bf16 v[104:107], v[68:71], v[24:27], v[104:107]
    v_mfma_f32_16x16x32_bf16 v[108:111], v[68:71], v[28:31], v[108:111]
    v_mfma_f32_16x16x32_bf16 v[136:139], v[68:71], v[32:35], v[136:139]
    v_mfma_f32_16x16x32_bf16 v[140:143], v[68:71], v[36:39], v[140:143]
    s_waitcnt lgkmcnt(0)
    s_barrier
    v_mfma_f32_16x16x32_bf16 v[144:147], v[40:43], v[48:51], v[144:147]
    ds_read_b128 v[24:27], v77 offset:32768
    v_mfma_f32_16x16x32_bf16 v[148:151], v[40:43], v[52:55], v[148:151]
    ds_read_b128 v[28:31], v77 offset:33024
    v_mfma_f32_16x16x32_bf16 v[176:179], v[40:43], v[56:59], v[176:179]
    ds_read_b128 v[32:35], v77 offset:36864
    v_mfma_f32_16x16x32_bf16 v[180:183], v[40:43], v[60:63], v[180:183]
    ds_read_b128 v[36:39], v77 offset:37120
    ds_read_b64_tr_b16 v[40:41], v14 offset:32768
    ds_read_b64_tr_b16 v[42:43], v14 offset:33792
    v_mfma_f32_16x16x32_bf16 v[152:155], v[44:47], v[48:51], v[152:155]
    v_mfma_f32_16x16x32_bf16 v[156:159], v[44:47], v[52:55], v[156:159]
    v_mfma_f32_16x16x32_bf16 v[184:187], v[44:47], v[56:59], v[184:187]
    v_mfma_f32_16x16x32_bf16 v[188:191], v[44:47], v[60:63], v[188:191]
    ds_read_b64_tr_b16 v[44:45], v15 offset:32768
    ds_read_b64_tr_b16 v[46:47], v15 offset:33792
    v_mfma_f32_16x16x32_bf16 v[160:163], v[64:67], v[48:51], v[160:163]
    v_mfma_f32_16x16x32_bf16 v[164:167], v[64:67], v[52:55], v[164:167]
    v_mfma_f32_16x16x32_bf16 v[192:195], v[64:67], v[56:59], v[192:195]
    v_mfma_f32_16x16x32_bf16 v[196:199], v[64:67], v[60:63], v[196:199]
    ds_read_b64_tr_b16 v[64:65], v14 offset:49152
    ds_read_b64_tr_b16 v[66:67], v14 offset:50176
    v_mfma_f32_16x16x32_bf16 v[168:171], v[68:71], v[48:51], v[168:171]
    v_mfma_f32_16x16x32_bf16 v[172:175], v[68:71], v[52:55], v[172:175]
    v_mfma_f32_16x16x32_bf16 v[200:203], v[68:71], v[56:59], v[200:203]
    v_mfma_f32_16x16x32_bf16 v[204:207], v[68:71], v[60:63], v[204:207]
    ds_read_b64_tr_b16 v[68:69], v15 offset:49152
    ds_read_b64_tr_b16 v[70:71], v15 offset:50176
    s_waitcnt lgkmcnt(6)
    v_mfma_f32_16x16x32_bf16 v[80:83], v[40:43], v[24:27], v[80:83]
    ds_read_b128 v[48:51], v77 offset:40960
    buffer_store_dwordx4 v[240:243], v1, s[12:15], s100 offen offset:0 sc1
    v_mfma_f32_16x16x32_bf16 v[84:87], v[40:43], v[28:31], v[84:87]
    ds_read_b128 v[52:55], v77 offset:41216
    v_mfma_f32_16x16x32_bf16 v[112:115], v[40:43], v[32:35], v[112:115]
    ds_read_b128 v[56:59], v77 offset:45056
    v_mfma_f32_16x16x32_bf16 v[116:119], v[40:43], v[36:39], v[116:119]
    ds_read_b128 v[60:63], v77 offset:45312
    s_waitcnt lgkmcnt(8)
    v_mfma_f32_16x16x32_bf16 v[88:91], v[44:47], v[24:27], v[88:91]
    v_mfma_f32_16x16x32_bf16 v[92:95], v[44:47], v[28:31], v[92:95]
    v_mfma_f32_16x16x32_bf16 v[120:123], v[44:47], v[32:35], v[120:123]
    v_mfma_f32_16x16x32_bf16 v[124:127], v[44:47], v[36:39], v[124:127]
    s_waitcnt lgkmcnt(6)
    v_mfma_f32_16x16x32_bf16 v[96:99], v[64:67], v[24:27], v[96:99]
    v_mfma_f32_16x16x32_bf16 v[100:103], v[64:67], v[28:31], v[100:103]
    v_mfma_f32_16x16x32_bf16 v[128:131], v[64:67], v[32:35], v[128:131]
    v_mfma_f32_16x16x32_bf16 v[132:135], v[64:67], v[36:39], v[132:135]
    s_waitcnt lgkmcnt(4)
    v_mfma_f32_16x16x32_bf16 v[104:107], v[68:71], v[24:27], v[104:107]
    v_mfma_f32_16x16x32_bf16 v[108:111], v[68:71], v[28:31], v[108:111]
    v_mfma_f32_16x16x32_bf16 v[136:139], v[68:71], v[32:35], v[136:139]
    v_mfma_f32_16x16x32_bf16 v[140:143], v[68:71], v[36:39], v[140:143]
    s_waitcnt lgkmcnt(3)
    v_mfma_f32_16x16x32_bf16 v[144:147], v[40:43], v[48:51], v[144:147]
    ds_read_b128 v[24:27], v77 offset:34816
    s_waitcnt lgkmcnt(3)
    v_mfma_f32_16x16x32_bf16 v[148:151], v[40:43], v[52:55], v[148:151]
    ds_read_b128 v[28:31], v77 offset:35072
    s_waitcnt lgkmcnt(3)
    v_mfma_f32_16x16x32_bf16 v[176:179], v[40:43], v[56:59], v[176:179]
    ds_read_b128 v[32:35], v77 offset:38912
    s_waitcnt lgkmcnt(3)
    v_mfma_f32_16x16x32_bf16 v[180:183], v[40:43], v[60:63], v[180:183]
    ds_read_b128 v[36:39], v77 offset:39168
    ds_read_b64_tr_b16 v[40:41], v14 offset:40960
    ds_read_b64_tr_b16 v[42:43], v14 offset:41984
    v_mfma_f32_16x16x32_bf16 v[152:155], v[44:47], v[48:51], v[152:155]
    v_mfma_f32_16x16x32_bf16 v[156:159], v[44:47], v[52:55], v[156:159]
    v_mfma_f32_16x16x32_bf16 v[184:187], v[44:47], v[56:59], v[184:187]
    v_mfma_f32_16x16x32_bf16 v[188:191], v[44:47], v[60:63], v[188:191]
    ds_read_b64_tr_b16 v[44:45], v15 offset:40960
    ds_read_b64_tr_b16 v[46:47], v15 offset:41984
    v_mfma_f32_16x16x32_bf16 v[160:163], v[64:67], v[48:51], v[160:163]
    v_mfma_f32_16x16x32_bf16 v[164:167], v[64:67], v[52:55], v[164:167]
    v_mfma_f32_16x16x32_bf16 v[192:195], v[64:67], v[56:59], v[192:195]
    v_mfma_f32_16x16x32_bf16 v[196:199], v[64:67], v[60:63], v[196:199]
    ds_read_b64_tr_b16 v[64:65], v14 offset:57344
    ds_read_b64_tr_b16 v[66:67], v14 offset:58368
    v_mfma_f32_16x16x32_bf16 v[168:171], v[68:71], v[48:51], v[168:171]
    v_mfma_f32_16x16x32_bf16 v[172:175], v[68:71], v[52:55], v[172:175]
    v_mfma_f32_16x16x32_bf16 v[200:203], v[68:71], v[56:59], v[200:203]
    v_mfma_f32_16x16x32_bf16 v[204:207], v[68:71], v[60:63], v[204:207]
    ds_read_b64_tr_b16 v[68:69], v15 offset:57344
    ds_read_b64_tr_b16 v[70:71], v15 offset:58368
    s_waitcnt lgkmcnt(6)
    v_mfma_f32_16x16x32_bf16 v[80:83], v[40:43], v[24:27], v[80:83]
    ds_read_b128 v[48:51], v77 offset:43008
    v_mfma_f32_16x16x32_bf16 v[84:87], v[40:43], v[28:31], v[84:87]
    ds_read_b128 v[52:55], v77 offset:43264
    v_mfma_f32_16x16x32_bf16 v[112:115], v[40:43], v[32:35], v[112:115]
    ds_read_b128 v[56:59], v77 offset:47104
    v_mfma_f32_16x16x32_bf16 v[116:119], v[40:43], v[36:39], v[116:119]
    ds_read_b128 v[60:63], v77 offset:47360
    s_waitcnt lgkmcnt(8)
    v_mfma_f32_16x16x32_bf16 v[88:91], v[44:47], v[24:27], v[88:91]
    v_mfma_f32_16x16x32_bf16 v[92:95], v[44:47], v[28:31], v[92:95]
    v_mfma_f32_16x16x32_bf16 v[120:123], v[44:47], v[32:35], v[120:123]
    v_mfma_f32_16x16x32_bf16 v[124:127], v[44:47], v[36:39], v[124:127]
    s_waitcnt lgkmcnt(6)
    v_mfma_f32_16x16x32_bf16 v[96:99], v[64:67], v[24:27], v[96:99]
    v_mfma_f32_16x16x32_bf16 v[100:103], v[64:67], v[28:31], v[100:103]
    v_mfma_f32_16x16x32_bf16 v[128:131], v[64:67], v[32:35], v[128:131]
    v_mfma_f32_16x16x32_bf16 v[132:135], v[64:67], v[36:39], v[132:135]
    s_waitcnt lgkmcnt(4)
    v_mfma_f32_16x16x32_bf16 v[104:107], v[68:71], v[24:27], v[104:107]
    v_mfma_f32_16x16x32_bf16 v[108:111], v[68:71], v[28:31], v[108:111]
    v_mfma_f32_16x16x32_bf16 v[136:139], v[68:71], v[32:35], v[136:139]
    v_mfma_f32_16x16x32_bf16 v[140:143], v[68:71], v[36:39], v[140:143]
    s_waitcnt lgkmcnt(0)
    s_barrier
    v_mfma_f32_16x16x32_bf16 v[144:147], v[40:43], v[48:51], v[144:147]
    ds_read_b128 v[24:27], v77 offset:0
    v_mfma_f32_16x16x32_bf16 v[148:151], v[40:43], v[52:55], v[148:151]
    ds_read_b128 v[28:31], v77 offset:256
    v_mfma_f32_16x16x32_bf16 v[176:179], v[40:43], v[56:59], v[176:179]
    ds_read_b128 v[32:35], v77 offset:4096
    v_mfma_f32_16x16x32_bf16 v[180:183], v[40:43], v[60:63], v[180:183]
    ds_read_b128 v[36:39], v77 offset:4352
    ds_read_b64_tr_b16 v[40:41], v14 offset:0
    ds_read_b64_tr_b16 v[42:43], v14 offset:1024
    v_mfma_f32_16x16x32_bf16 v[152:155], v[44:47], v[48:51], v[152:155]
    v_mfma_f32_16x16x32_bf16 v[156:159], v[44:47], v[52:55], v[156:159]
    v_mfma_f32_16x16x32_bf16 v[184:187], v[44:47], v[56:59], v[184:187]
    v_mfma_f32_16x16x32_bf16 v[188:191], v[44:47], v[60:63], v[188:191]
    ds_read_b64_tr_b16 v[44:45], v15 offset:0
    ds_read_b64_tr_b16 v[46:47], v15 offset:1024
    v_mfma_f32_16x16x32_bf16 v[160:163], v[64:67], v[48:51], v[160:163]
    v_mfma_f32_16x16x32_bf16 v[164:167], v[64:67], v[52:55], v[164:167]
    v_mfma_f32_16x16x32_bf16 v[192:195], v[64:67], v[56:59], v[192:195]
    v_mfma_f32_16x16x32_bf16 v[196:199], v[64:67], v[60:63], v[196:199]
    ds_read_b64_tr_b16 v[64:65], v14 offset:16384
    ds_read_b64_tr_b16 v[66:67], v14 offset:17408
    v_mfma_f32_16x16x32_bf16 v[168:171], v[68:71], v[48:51], v[168:171]
    v_mfma_f32_16x16x32_bf16 v[172:175], v[68:71], v[52:55], v[172:175]
    v_mfma_f32_16x16x32_bf16 v[200:203], v[68:71], v[56:59], v[200:203]
    v_mfma_f32_16x16x32_bf16 v[204:207], v[68:71], v[60:63], v[204:207]
    ds_read_b64_tr_b16 v[68:69], v15 offset:16384
    ds_read_b64_tr_b16 v[70:71], v15 offset:17408
    s_waitcnt lgkmcnt(6)
    v_mfma_f32_16x16x32_bf16 v[80:83], v[40:43], v[24:27], v[80:83]
    ds_read_b128 v[48:51], v77 offset:8192
    buffer_store_dwordx4 v[244:247], v1, s[12:15], s100 offen offset:1024 sc1
    v_mfma_f32_16x16x32_bf16 v[84:87], v[40:43], v[28:31], v[84:87]
    ds_read_b128 v[52:55], v77 offset:8448
    v_mfma_f32_16x16x32_bf16 v[112:115], v[40:43], v[32:35], v[112:115]
    ds_read_b128 v[56:59], v77 offset:12288
    v_mfma_f32_16x16x32_bf16 v[116:119], v[40:43], v[36:39], v[116:119]
    ds_read_b128 v[60:63], v77 offset:12544
    s_waitcnt lgkmcnt(8)
    v_mfma_f32_16x16x32_bf16 v[88:91], v[44:47], v[24:27], v[88:91]
    v_mfma_f32_16x16x32_bf16 v[92:95], v[44:47], v[28:31], v[92:95]
    v_mfma_f32_16x16x32_bf16 v[120:123], v[44:47], v[32:35], v[120:123]
    v_mfma_f32_16x16x32_bf16 v[124:127], v[44:47], v[36:39], v[124:127]
    s_waitcnt lgkmcnt(6)
    v_mfma_f32_16x16x32_bf16 v[96:99], v[64:67], v[24:27], v[96:99]
    v_mfma_f32_16x16x32_bf16 v[100:103], v[64:67], v[28:31], v[100:103]
    v_mfma_f32_16x16x32_bf16 v[128:131], v[64:67], v[32:35], v[128:131]
    v_mfma_f32_16x16x32_bf16 v[132:135], v[64:67], v[36:39], v[132:135]
    s_waitcnt lgkmcnt(4)
    v_mfma_f32_16x16x32_bf16 v[104:107], v[68:71], v[24:27], v[104:107]
    v_mfma_f32_16x16x32_bf16 v[108:111], v[68:71], v[28:31], v[108:111]
    v_mfma_f32_16x16x32_bf16 v[136:139], v[68:71], v[32:35], v[136:139]
    v_mfma_f32_16x16x32_bf16 v[140:143], v[68:71], v[36:39], v[140:143]
    s_waitcnt lgkmcnt(3)
    v_mfma_f32_16x16x32_bf16 v[144:147], v[40:43], v[48:51], v[144:147]
    ds_read_b128 v[24:27], v77 offset:2048
    buffer_store_dwordx4 v[248:251], v1, s[12:15], s100 offen offset:2048 sc1
    s_waitcnt lgkmcnt(3)
    v_mfma_f32_16x16x32_bf16 v[148:151], v[40:43], v[52:55], v[148:151]
    ds_read_b128 v[28:31], v77 offset:2304
    s_waitcnt lgkmcnt(3)
    v_mfma_f32_16x16x32_bf16 v[176:179], v[40:43], v[56:59], v[176:179]
    ds_read_b128 v[32:35], v77 offset:6144
    s_waitcnt lgkmcnt(3)
    v_mfma_f32_16x16x32_bf16 v[180:183], v[40:43], v[60:63], v[180:183]
    ds_read_b128 v[36:39], v77 offset:6400
    ds_read_b64_tr_b16 v[40:41], v14 offset:8192
    ds_read_b64_tr_b16 v[42:43], v14 offset:9216
    v_mfma_f32_16x16x32_bf16 v[152:155], v[44:47], v[48:51], v[152:155]
    v_mfma_f32_16x16x32_bf16 v[156:159], v[44:47], v[52:55], v[156:159]
    v_mfma_f32_16x16x32_bf16 v[184:187], v[44:47], v[56:59], v[184:187]
    v_mfma_f32_16x16x32_bf16 v[188:191], v[44:47], v[60:63], v[188:191]
    ds_read_b64_tr_b16 v[44:45], v15 offset:8192
    ds_read_b64_tr_b16 v[46:47], v15 offset:9216
    v_mfma_f32_16x16x32_bf16 v[160:163], v[64:67], v[48:51], v[160:163]
    v_mfma_f32_16x16x32_bf16 v[164:167], v[64:67], v[52:55], v[164:167]
    v_mfma_f32_16x16x32_bf16 v[192:195], v[64:67], v[56:59], v[192:195]
    v_mfma_f32_16x16x32_bf16 v[196:199], v[64:67], v[60:63], v[196:199]
    ds_read_b64_tr_b16 v[64:65], v14 offset:24576
    ds_read_b64_tr_b16 v[66:67], v14 offset:25600
    v_mfma_f32_16x16x32_bf16 v[168:171], v[68:71], v[48:51], v[168:171]
    v_mfma_f32_16x16x32_bf16 v[172:175], v[68:71], v[52:55], v[172:175]
    v_mfma_f32_16x16x32_bf16 v[200:203], v[68:71], v[56:59], v[200:203]
    v_mfma_f32_16x16x32_bf16 v[204:207], v[68:71], v[60:63], v[204:207]
    ds_read_b64_tr_b16 v[68:69], v15 offset:24576
    ds_read_b64_tr_b16 v[70:71], v15 offset:25600
    s_waitcnt lgkmcnt(6)
    v_mfma_f32_16x16x32_bf16 v[80:83], v[40:43], v[24:27], v[80:83]
    ds_read_b128 v[48:51], v77 offset:10240
    v_mfma_f32_16x16x32_bf16 v[84:87], v[40:43], v[28:31], v[84:87]
    ds_read_b128 v[52:55], v77 offset:10496
    v_mfma_f32_16x16x32_bf16 v[112:115], v[40:43], v[32:35], v[112:115]
    ds_read_b128 v[56:59], v77 offset:14336
    v_mfma_f32_16x16x32_bf16 v[116:119], v[40:43], v[36:39], v[116:119]
    ds_read_b128 v[60:63], v77 offset:14592
    s_waitcnt lgkmcnt(8)
    v_mfma_f32_16x16x32_bf16 v[88:91], v[44:47], v[24:27], v[88:91]
    v_mfma_f32_16x16x32_bf16 v[92:95], v[44:47], v[28:31], v[92:95]
    v_mfma_f32_16x16x32_bf16 v[120:123], v[44:47], v[32:35], v[120:123]
    v_mfma_f32_16x16x32_bf16 v[124:127], v[44:47], v[36:39], v[124:127]
    s_waitcnt lgkmcnt(6)
    v_mfma_f32_16x16x32_bf16 v[96:99], v[64:67], v[24:27], v[96:99]
    v_mfma_f32_16x16x32_bf16 v[100:103], v[64:67], v[28:31], v[100:103]
    v_mfma_f32_16x16x32_bf16 v[128:131], v[64:67], v[32:35], v[128:131]
    v_mfma_f32_16x16x32_bf16 v[132:135], v[64:67], v[36:39], v[132:135]
    s_waitcnt lgkmcnt(4)
    v_mfma_f32_16x16x32_bf16 v[104:107], v[68:71], v[24:27], v[104:107]
    v_mfma_f32_16x16x32_bf16 v[108:111], v[68:71], v[28:31], v[108:111]
    v_mfma_f32_16x16x32_bf16 v[136:139], v[68:71], v[32:35], v[136:139]
    v_mfma_f32_16x16x32_bf16 v[140:143], v[68:71], v[36:39], v[140:143]
    s_waitcnt lgkmcnt(0)
    s_barrier
    v_mfma_f32_16x16x32_bf16 v[144:147], v[40:43], v[48:51], v[144:147]
    ds_read_b128 v[24:27], v77 offset:32768
    v_mfma_f32_16x16x32_bf16 v[148:151], v[40:43], v[52:55], v[148:151]
    ds_read_b128 v[28:31], v77 offset:33024
    v_mfma_f32_16x16x32_bf16 v[176:179], v[40:43], v[56:59], v[176:179]
    ds_read_b128 v[32:35], v77 offset:36864
    v_mfma_f32_16x16x32_bf16 v[180:183], v[40:43], v[60:63], v[180:183]
    ds_read_b128 v[36:39], v77 offset:37120
    ds_read_b64_tr_b16 v[40:41], v14 offset:32768
    ds_read_b64_tr_b16 v[42:43], v14 offset:33792
    v_mfma_f32_16x16x32_bf16 v[152:155], v[44:47], v[48:51], v[152:155]
    v_mfma_f32_16x16x32_bf16 v[156:159], v[44:47], v[52:55], v[156:159]
    v_mfma_f32_16x16x32_bf16 v[184:187], v[44:47], v[56:59], v[184:187]
    v_mfma_f32_16x16x32_bf16 v[188:191], v[44:47], v[60:63], v[188:191]
    ds_read_b64_tr_b16 v[44:45], v15 offset:32768
    ds_read_b64_tr_b16 v[46:47], v15 offset:33792
    v_mfma_f32_16x16x32_bf16 v[160:163], v[64:67], v[48:51], v[160:163]
    v_mfma_f32_16x16x32_bf16 v[164:167], v[64:67], v[52:55], v[164:167]
    v_mfma_f32_16x16x32_bf16 v[192:195], v[64:67], v[56:59], v[192:195]
    v_mfma_f32_16x16x32_bf16 v[196:199], v[64:67], v[60:63], v[196:199]
    ds_read_b64_tr_b16 v[64:65], v14 offset:49152
    ds_read_b64_tr_b16 v[66:67], v14 offset:50176
    v_mfma_f32_16x16x32_bf16 v[168:171], v[68:71], v[48:51], v[168:171]
    v_mfma_f32_16x16x32_bf16 v[172:175], v[68:71], v[52:55], v[172:175]
    v_mfma_f32_16x16x32_bf16 v[200:203], v[68:71], v[56:59], v[200:203]
    v_mfma_f32_16x16x32_bf16 v[204:207], v[68:71], v[60:63], v[204:207]
    ds_read_b64_tr_b16 v[68:69], v15 offset:49152
    ds_read_b64_tr_b16 v[70:71], v15 offset:50176
    s_waitcnt lgkmcnt(6)
    v_mfma_f32_16x16x32_bf16 v[80:83], v[40:43], v[24:27], v[80:83]
    ds_read_b128 v[48:51], v77 offset:40960
    buffer_store_dwordx4 v[252:255], v1, s[12:15], s100 offen offset:3072 sc1
    s_add_u32 s100, s100, 8192
    v_mfma_f32_16x16x32_bf16 v[84:87], v[40:43], v[28:31], v[84:87]
    ds_read_b128 v[52:55], v77 offset:41216
    v_mfma_f32_16x16x32_bf16 v[112:115], v[40:43], v[32:35], v[112:115]
    ds_read_b128 v[56:59], v77 offset:45056
    v_mfma_f32_16x16x32_bf16 v[116:119], v[40:43], v[36:39], v[116:119]
    ds_read_b128 v[60:63], v77 offset:45312
    s_waitcnt lgkmcnt(8)
    v_mfma_f32_16x16x32_bf16 v[88:91], v[44:47], v[24:27], v[88:91]
    v_mfma_f32_16x16x32_bf16 v[92:95], v[44:47], v[28:31], v[92:95]
    v_mfma_f32_16x16x32_bf16 v[120:123], v[44:47], v[32:35], v[120:123]
    v_mfma_f32_16x16x32_bf16 v[124:127], v[44:47], v[36:39], v[124:127]
    s_waitcnt lgkmcnt(6)
    v_mfma_f32_16x16x32_bf16 v[96:99], v[64:67], v[24:27], v[96:99]
    v_mfma_f32_16x16x32_bf16 v[100:103], v[64:67], v[28:31], v[100:103]
    v_mfma_f32_16x16x32_bf16 v[128:131], v[64:67], v[32:35], v[128:131]
    v_mfma_f32_16x16x32_bf16 v[132:135], v[64:67], v[36:39], v[132:135]
    s_waitcnt lgkmcnt(4)
    v_mfma_f32_16x16x32_bf16 v[104:107], v[68:71], v[24:27], v[104:107]
    v_mfma_f32_16x16x32_bf16 v[108:111], v[68:71], v[28:31], v[108:111]
    v_mfma_f32_16x16x32_bf16 v[136:139], v[68:71], v[32:35], v[136:139]
    v_mfma_f32_16x16x32_bf16 v[140:143], v[68:71], v[36:39], v[140:143]
    s_waitcnt lgkmcnt(3)
    v_mfma_f32_16x16x32_bf16 v[144:147], v[40:43], v[48:51], v[144:147]
    ds_read_b128 v[24:27], v77 offset:34816
    s_waitcnt lgkmcnt(3)
    v_mfma_f32_16x16x32_bf16 v[148:151], v[40:43], v[52:55], v[148:151]
    ds_read_b128 v[28:31], v77 offset:35072
    s_waitcnt lgkmcnt(3)
    v_mfma_f32_16x16x32_bf16 v[176:179], v[40:43], v[56:59], v[176:179]
    ds_read_b128 v[32:35], v77 offset:38912
    s_waitcnt lgkmcnt(3)
    v_mfma_f32_16x16x32_bf16 v[180:183], v[40:43], v[60:63], v[180:183]
    ds_read_b128 v[36:39], v77 offset:39168
    ds_read_b64_tr_b16 v[40:41], v14 offset:40960
    ds_read_b64_tr_b16 v[42:43], v14 offset:41984
    v_mfma_f32_16x16x32_bf16 v[152:155], v[44:47], v[48:51], v[152:155]
    v_mfma_f32_16x16x32_bf16 v[156:159], v[44:47], v[52:55], v[156:159]
    v_mfma_f32_16x16x32_bf16 v[184:187], v[44:47], v[56:59], v[184:187]
    v_mfma_f32_16x16x32_bf16 v[188:191], v[44:47], v[60:63], v[188:191]
    ds_read_b64_tr_b16 v[44:45], v15 offset:40960
    ds_read_b64_tr_b16 v[46:47], v15 offset:41984
    v_mfma_f32_16x16x32_bf16 v[160:163], v[64:67], v[48:51], v[160:163]
    v_mfma_f32_16x16x32_bf16 v[164:167], v[64:67], v[52:55], v[164:167]
    v_mfma_f32_16x16x32_bf16 v[192:195], v[64:67], v[56:59], v[192:195]
    v_mfma_f32_16x16x32_bf16 v[196:199], v[64:67], v[60:63], v[196:199]
    ds_read_b64_tr_b16 v[64:65], v14 offset:57344
    ds_read_b64_tr_b16 v[66:67], v14 offset:58368
    v_mfma_f32_16x16x32_bf16 v[168:171], v[68:71], v[48:51], v[168:171]
    v_mfma_f32_16x16x32_bf16 v[172:175], v[68:71], v[52:55], v[172:175]
    v_mfma_f32_16x16x32_bf16 v[200:203], v[68:71], v[56:59], v[200:203]
    v_mfma_f32_16x16x32_bf16 v[204:207], v[68:71], v[60:63], v[204:207]
    ds_read_b64_tr_b16 v[68:69], v15 offset:57344
    ds_read_b64_tr_b16 v[70:71], v15 offset:58368
    s_waitcnt lgkmcnt(6)
    v_mfma_f32_16x16x32_bf16 v[80:83], v[40:43], v[24:27], v[80:83]
    ds_read_b128 v[48:51], v77 offset:43008
    v_mfma_f32_16x16x32_bf16 v[84:87], v[40:43], v[28:31], v[84:87]
    ds_read_b128 v[52:55], v77 offset:43264
    v_mfma_f32_16x16x32_bf16 v[112:115], v[40:43], v[32:35], v[112:115]
    ds_read_b128 v[56:59], v77 offset:47104
    v_mfma_f32_16x16x32_bf16 v[116:119], v[40:43], v[36:39], v[116:119]
    ds_read_b128 v[60:63], v77 offset:47360
    s_waitcnt lgkmcnt(8)
    v_mfma_f32_16x16x32_bf16 v[88:91], v[44:47], v[24:27], v[88:91]
    v_mfma_f32_16x16x32_bf16 v[92:95], v[44:47], v[28:31], v[92:95]
    v_mfma_f32_16x16x32_bf16 v[120:123], v[44:47], v[32:35], v[120:123]
    v_mfma_f32_16x16x32_bf16 v[124:127], v[44:47], v[36:39], v[124:127]
    s_waitcnt lgkmcnt(6)
    v_mfma_f32_16x16x32_bf16 v[96:99], v[64:67], v[24:27], v[96:99]
    v_mfma_f32_16x16x32_bf16 v[100:103], v[64:67], v[28:31], v[100:103]
    v_mfma_f32_16x16x32_bf16 v[128:131], v[64:67], v[32:35], v[128:131]
    v_mfma_f32_16x16x32_bf16 v[132:135], v[64:67], v[36:39], v[132:135]
    s_waitcnt lgkmcnt(4)
    v_mfma_f32_16x16x32_bf16 v[104:107], v[68:71], v[24:27], v[104:107]
    v_mfma_f32_16x16x32_bf16 v[108:111], v[68:71], v[28:31], v[108:111]
    v_mfma_f32_16x16x32_bf16 v[136:139], v[68:71], v[32:35], v[136:139]
    v_mfma_f32_16x16x32_bf16 v[140:143], v[68:71], v[36:39], v[140:143]
    s_waitcnt lgkmcnt(0)
    s_barrier
    v_mfma_f32_16x16x32_bf16 v[144:147], v[40:43], v[48:51], v[144:147]
    ds_read_b128 v[24:27], v77 offset:0
    v_mfma_f32_16x16x32_bf16 v[148:151], v[40:43], v[52:55], v[148:151]
    ds_read_b128 v[28:31], v77 offset:256
    v_mfma_f32_16x16x32_bf16 v[176:179], v[40:43], v[56:59], v[176:179]
    ds_read_b128 v[32:35], v77 offset:4096
    v_mfma_f32_16x16x32_bf16 v[180:183], v[40:43], v[60:63], v[180:183]
    ds_read_b128 v[36:39], v77 offset:4352
    ds_read_b64_tr_b16 v[40:41], v14 offset:0
    ds_read_b64_tr_b16 v[42:43], v14 offset:1024
    v_mfma_f32_16x16x32_bf16 v[152:155], v[44:47], v[48:51], v[152:155]
    v_mfma_f32_16x16x32_bf16 v[156:159], v[44:47], v[52:55], v[156:159]
    v_mfma_f32_16x16x32_bf16 v[184:187], v[44:47], v[56:59], v[184:187]
    v_mfma_f32_16x16x32_bf16 v[188:191], v[44:47], v[60:63], v[188:191]
    ds_read_b64_tr_b16 v[44:45], v15 offset:0
    ds_read_b64_tr_b16 v[46:47], v15 offset:1024
    v_mfma_f32_16x16x32_bf16 v[160:163], v[64:67], v[48:51], v[160:163]
    v_mfma_f32_16x16x32_bf16 v[164:167], v[64:67], v[52:55], v[164:167]
    v_mfma_f32_16x16x32_bf16 v[192:195], v[64:67], v[56:59], v[192:195]
    v_mfma_f32_16x16x32_bf16 v[196:199], v[64:67], v[60:63], v[196:199]
    ds_read_b64_tr_b16 v[64:65], v14 offset:16384
    ds_read_b64_tr_b16 v[66:67], v14 offset:17408
    v_mfma_f32_16x16x32_bf16 v[168:171], v[68:71], v[48:51], v[168:171]
    v_mfma_f32_16x16x32_bf16 v[172:175], v[68:71], v[52:55], v[172:175]
    v_mfma_f32_16x16x32_bf16 v[200:203], v[68:71], v[56:59], v[200:203]
    v_mfma_f32_16x16x32_bf16 v[204:207], v[68:71], v[60:63], v[204:207]
    ds_read_b64_tr_b16 v[68:69], v15 offset:16384
    ds_read_b64_tr_b16 v[70:71], v15 offset:17408
    s_waitcnt lgkmcnt(6)
    v_mfma_f32_16x16x32_bf16 v[80:83], v[40:43], v[24:27], v[80:83]
    ds_read_b128 v[48:51], v77 offset:8192
    buffer_store_dwordx4 v[2:5], v1, s[12:15], s100 offen offset:0 sc1
    v_mfma_f32_16x16x32_bf16 v[84:87], v[40:43], v[28:31], v[84:87]
    ds_read_b128 v[52:55], v77 offset:8448
    v_mfma_f32_16x16x32_bf16 v[112:115], v[40:43], v[32:35], v[112:115]
    ds_read_b128 v[56:59], v77 offset:12288
    v_mfma_f32_16x16x32_bf16 v[116:119], v[40:43], v[36:39], v[116:119]
    ds_read_b128 v[60:63], v77 offset:12544
    s_waitcnt lgkmcnt(8)
    v_mfma_f32_16x16x32_bf16 v[88:91], v[44:47], v[24:27], v[88:91]
    v_mfma_f32_16x16x32_bf16 v[92:95], v[44:47], v[28:31], v[92:95]
    v_mfma_f32_16x16x32_bf16 v[120:123], v[44:47], v[32:35], v[120:123]
    v_mfma_f32_16x16x32_bf16 v[124:127], v[44:47], v[36:39], v[124:127]
    s_waitcnt lgkmcnt(6)
    v_mfma_f32_16x16x32_bf16 v[96:99], v[64:67], v[24:27], v[96:99]
    v_mfma_f32_16x16x32_bf16 v[100:103], v[64:67], v[28:31], v[100:103]
    v_mfma_f32_16x16x32_bf16 v[128:131], v[64:67], v[32:35], v[128:131]
    v_mfma_f32_16x16x32_bf16 v[132:135], v[64:67], v[36:39], v[132:135]
    s_waitcnt lgkmcnt(4)
    v_mfma_f32_16x16x32_bf16 v[104:107], v[68:71], v[24:27], v[104:107]
    v_mfma_f32_16x16x32_bf16 v[108:111], v[68:71], v[28:31], v[108:111]
    v_mfma_f32_16x16x32_bf16 v[136:139], v[68:71], v[32:35], v[136:139]
    v_mfma_f32_16x16x32_bf16 v[140:143], v[68:71], v[36:39], v[140:143]
    s_waitcnt lgkmcnt(3)
    v_mfma_f32_16x16x32_bf16 v[144:147], v[40:43], v[48:51], v[144:147]
    ds_read_b128 v[24:27], v77 offset:2048
    buffer_store_dwordx4 v[6:9], v1, s[12:15], s100 offen offset:1024 sc1
    s_waitcnt lgkmcnt(3)
    v_mfma_f32_16x16x32_bf16 v[148:151], v[40:43], v[52:55], v[148:151]
    ds_read_b128 v[28:31], v77 offset:2304
    s_waitcnt lgkmcnt(3)
    v_mfma_f32_16x16x32_bf16 v[176:179], v[40:43], v[56:59], v[176:179]
    ds_read_b128 v[32:35], v77 offset:6144
    s_waitcnt lgkmcnt(3)
    v_mfma_f32_16x16x32_bf16 v[180:183], v[40:43], v[60:63], v[180:183]
    ds_read_b128 v[36:39], v77 offset:6400
    ds_read_b64_tr_b16 v[40:41], v14 offset:8192
    ds_read_b64_tr_b16 v[42:43], v14 offset:9216
    v_mfma_f32_16x16x32_bf16 v[152:155], v[44:47], v[48:51], v[152:155]
    v_mfma_f32_16x16x32_bf16 v[156:159], v[44:47], v[52:55], v[156:159]
    v_mfma_f32_16x16x32_bf16 v[184:187], v[44:47], v[56:59], v[184:187]
    v_mfma_f32_16x16x32_bf16 v[188:191], v[44:47], v[60:63], v[188:191]
    ds_read_b64_tr_b16 v[44:45], v15 offset:8192
    ds_read_b64_tr_b16 v[46:47], v15 offset:9216
    v_mfma_f32_16x16x32_bf16 v[160:163], v[64:67], v[48:51], v[160:163]
    v_mfma_f32_16x16x32_bf16 v[164:167], v[64:67], v[52:55], v[164:167]
    v_mfma_f32_16x16x32_bf16 v[192:195], v[64:67], v[56:59], v[192:195]
    v_mfma_f32_16x16x32_bf16 v[196:199], v[64:67], v[60:63], v[196:199]
    ds_read_b64_tr_b16 v[64:65], v14 offset:24576
    ds_read_b64_tr_b16 v[66:67], v14 offset:25600
    v_mfma_f32_16x16x32_bf16 v[168:171], v[68:71], v[48:51], v[168:171]
    v_mfma_f32_16x16x32_bf16 v[172:175], v[68:71], v[52:55], v[172:175]
    v_mfma_f32_16x16x32_bf16 v[200:203], v[68:71], v[56:59], v[200:203]
    v_mfma_f32_16x16x32_bf16 v[204:207], v[68:71], v[60:63], v[204:207]
    ds_read_b64_tr_b16 v[68:69], v15 offset:24576
    ds_read_b64_tr_b16 v[70:71], v15 offset:25600
    s_waitcnt lgkmcnt(6)
    v_mfma_f32_16x16x32_bf16 v[80:83], v[40:43], v[24:27], v[80:83]
    ds_read_b128 v[48:51], v77 offset:10240
    v_mfma_f32_16x16x32_bf16 v[84:87], v[40:43], v[28:31], v[84:87]
    ds_read_b128 v[52:55], v77 offset:10496
    v_mfma_f32_16x16x32_bf16 v[112:115], v[40:43], v[32:35], v[112:115]
    ds_read_b128 v[56:59], v77 offset:14336
    v_mfma_f32_16x16x32_bf16 v[116:119], v[40:43], v[36:39], v[116:119]
    ds_read_b128 v[60:63], v77 offset:14592
    s_waitcnt lgkmcnt(8)
    v_mfma_f32_16x16x32_bf16 v[88:91], v[44:47], v[24:27], v[88:91]
    v_mfma_f32_16x16x32_bf16 v[92:95], v[44:47], v[28:31], v[92:95]
    v_mfma_f32_16x16x32_bf16 v[120:123], v[44:47], v[32:35], v[120:123]
    v_mfma_f32_16x16x32_bf16 v[124:127], v[44:47], v[36:39], v[124:127]
    s_waitcnt lgkmcnt(6)
    v_mfma_f32_16x16x32_bf16 v[96:99], v[64:67], v[24:27], v[96:99]
    v_mfma_f32_16x16x32_bf16 v[100:103], v[64:67], v[28:31], v[100:103]
    v_mfma_f32_16x16x32_bf16 v[128:131], v[64:67], v[32:35], v[128:131]
    v_mfma_f32_16x16x32_bf16 v[132:135], v[64:67], v[36:39], v[132:135]
    s_waitcnt lgkmcnt(4)
    v_mfma_f32_16x16x32_bf16 v[104:107], v[68:71], v[24:27], v[104:107]
    v_mfma_f32_16x16x32_bf16 v[108:111], v[68:71], v[28:31], v[108:111]
    v_mfma_f32_16x16x32_bf16 v[136:139], v[68:71], v[32:35], v[136:139]
    v_mfma_f32_16x16x32_bf16 v[140:143], v[68:71], v[36:39], v[140:143]
    s_waitcnt lgkmcnt(0)
    s_barrier
    v_mfma_f32_16x16x32_bf16 v[144:147], v[40:43], v[48:51], v[144:147]
    ds_read_b128 v[24:27], v77 offset:32768
    v_mfma_f32_16x16x32_bf16 v[148:151], v[40:43], v[52:55], v[148:151]
    ds_read_b128 v[28:31], v77 offset:33024
    v_mfma_f32_16x16x32_bf16 v[176:179], v[40:43], v[56:59], v[176:179]
    ds_read_b128 v[32:35], v77 offset:36864
    v_mfma_f32_16x16x32_bf16 v[180:183], v[40:43], v[60:63], v[180:183]
    ds_read_b128 v[36:39], v77 offset:37120
    ds_read_b64_tr_b16 v[40:41], v14 offset:32768
    ds_read_b64_tr_b16 v[42:43], v14 offset:33792
    v_mfma_f32_16x16x32_bf16 v[152:155], v[44:47], v[48:51], v[152:155]
    v_mfma_f32_16x16x32_bf16 v[156:159], v[44:47], v[52:55], v[156:159]
    v_mfma_f32_16x16x32_bf16 v[184:187], v[44:47], v[56:59], v[184:187]
    v_mfma_f32_16x16x32_bf16 v[188:191], v[44:47], v[60:63], v[188:191]
    ds_read_b64_tr_b16 v[44:45], v15 offset:32768
    ds_read_b64_tr_b16 v[46:47], v15 offset:33792
    v_mfma_f32_16x16x32_bf16 v[160:163], v[64:67], v[48:51], v[160:163]
    v_mfma_f32_16x16x32_bf16 v[164:167], v[64:67], v[52:55], v[164:167]
    v_mfma_f32_16x16x32_bf16 v[192:195], v[64:67], v[56:59], v[192:195]
    v_mfma_f32_16x16x32_bf16 v[196:199], v[64:67], v[60:63], v[196:199]
    ds_read_b64_tr_b16 v[64:65], v14 offset:49152
    ds_read_b64_tr_b16 v[66:67], v14 offset:50176
    v_mfma_f32_16x16x32_bf16 v[168:171], v[68:71], v[48:51], v[168:171]
    v_mfma_f32_16x16x32_bf16 v[172:175], v[68:71], v[52:55], v[172:175]
    v_mfma_f32_16x16x32_bf16 v[200:203], v[68:71], v[56:59], v[200:203]
    v_mfma_f32_16x16x32_bf16 v[204:207], v[68:71], v[60:63], v[204:207]
    ds_read_b64_tr_b16 v[68:69], v15 offset:49152
    ds_read_b64_tr_b16 v[70:71], v15 offset:50176
    s_waitcnt lgkmcnt(6)
    v_mfma_f32_16x16x32_bf16 v[80:83], v[40:43], v[24:27], v[80:83]
    ds_read_b128 v[48:51], v77 offset:40960
    buffer_store_dwordx4 v[10:13], v1, s[12:15], s100 offen offset:2048 sc1
    v_mfma_f32_16x16x32_bf16 v[84:87], v[40:43], v[28:31], v[84:87]
    ds_read_b128 v[52:55], v77 offset:41216
    v_mfma_f32_16x16x32_bf16 v[112:115], v[40:43], v[32:35], v[112:115]
    ds_read_b128 v[56:59], v77 offset:45056
    v_mfma_f32_16x16x32_bf16 v[116:119], v[40:43], v[36:39], v[116:119]
    ds_read_b128 v[60:63], v77 offset:45312
    s_waitcnt lgkmcnt(8)
    v_mfma_f32_16x16x32_bf16 v[88:91], v[44:47], v[24:27], v[88:91]
    v_mfma_f32_16x16x32_bf16 v[92:95], v[44:47], v[28:31], v[92:95]
    v_mfma_f32_16x16x32_bf16 v[120:123], v[44:47], v[32:35], v[120:123]
    v_mfma_f32_16x16x32_bf16 v[124:127], v[44:47], v[36:39], v[124:127]
    s_waitcnt lgkmcnt(6)
    v_mfma_f32_16x16x32_bf16 v[96:99], v[64:67], v[24:27], v[96:99]
    v_mfma_f32_16x16x32_bf16 v[100:103], v[64:67], v[28:31], v[100:103]
    v_mfma_f32_16x16x32_bf16 v[128:131], v[64:67], v[32:35], v[128:131]
    v_mfma_f32_16x16x32_bf16 v[132:135], v[64:67], v[36:39], v[132:135]
    s_waitcnt lgkmcnt(4)
    v_mfma_f32_16x16x32_bf16 v[104:107], v[68:71], v[24:27], v[104:107]
    v_mfma_f32_16x16x32_bf16 v[108:111], v[68:71], v[28:31], v[108:111]
    v_mfma_f32_16x16x32_bf16 v[136:139], v[68:71], v[32:35], v[136:139]
    v_mfma_f32_16x16x32_bf16 v[140:143], v[68:71], v[36:39], v[140:143]
    s_waitcnt lgkmcnt(3)
    v_mfma_f32_16x16x32_bf16 v[144:147], v[40:43], v[48:51], v[144:147]
    ds_read_b128 v[24:27], v77 offset:34816
    buffer_store_dwordx4 v[16:19], v1, s[12:15], s100 offen offset:3072 sc1
    s_add_u32 s100, s100, 8192
    s_waitcnt lgkmcnt(3)
    v_mfma_f32_16x16x32_bf16 v[148:151], v[40:43], v[52:55], v[148:151]
    ds_read_b128 v[28:31], v77 offset:35072
    s_waitcnt lgkmcnt(3)
    v_mfma_f32_16x16x32_bf16 v[176:179], v[40:43], v[56:59], v[176:179]
    ds_read_b128 v[32:35], v77 offset:38912
    s_waitcnt lgkmcnt(3)
    v_mfma_f32_16x16x32_bf16 v[180:183], v[40:43], v[60:63], v[180:183]
    ds_read_b128 v[36:39], v77 offset:39168
    ds_read_b64_tr_b16 v[40:41], v14 offset:40960
    ds_read_b64_tr_b16 v[42:43], v14 offset:41984
    v_mfma_f32_16x16x32_bf16 v[152:155], v[44:47], v[48:51], v[152:155]
    v_mfma_f32_16x16x32_bf16 v[156:159], v[44:47], v[52:55], v[156:159]
    v_mfma_f32_16x16x32_bf16 v[184:187], v[44:47], v[56:59], v[184:187]
    v_mfma_f32_16x16x32_bf16 v[188:191], v[44:47], v[60:63], v[188:191]
    ds_read_b64_tr_b16 v[44:45], v15 offset:40960
    ds_read_b64_tr_b16 v[46:47], v15 offset:41984
    v_mfma_f32_16x16x32_bf16 v[160:163], v[64:67], v[48:51], v[160:163]
    v_mfma_f32_16x16x32_bf16 v[164:167], v[64:67], v[52:55], v[164:167]
    v_mfma_f32_16x16x32_bf16 v[192:195], v[64:67], v[56:59], v[192:195]
    v_mfma_f32_16x16x32_bf16 v[196:199], v[64:67], v[60:63], v[196:199]
    ds_read_b64_tr_b16 v[64:65], v14 offset:57344
    ds_read_b64_tr_b16 v[66:67], v14 offset:58368
    v_mfma_f32_16x16x32_bf16 v[168:171], v[68:71], v[48:51], v[168:171]
    v_mfma_f32_16x16x32_bf16 v[172:175], v[68:71], v[52:55], v[172:175]
    v_mfma_f32_16x16x32_bf16 v[200:203], v[68:71], v[56:59], v[200:203]
    v_mfma_f32_16x16x32_bf16 v[204:207], v[68:71], v[60:63], v[204:207]
    ds_read_b64_tr_b16 v[68:69], v15 offset:57344
    ds_read_b64_tr_b16 v[70:71], v15 offset:58368
    s_waitcnt lgkmcnt(6)
    v_mfma_f32_16x16x32_bf16 v[80:83], v[40:43], v[24:27], v[80:83]
    ds_read_b128 v[48:51], v77 offset:43008
    v_mfma_f32_16x16x32_bf16 v[84:87], v[40:43], v[28:31], v[84:87]
    ds_read_b128 v[52:55], v77 offset:43264
    v_mfma_f32_16x16x32_bf16 v[112:115], v[40:43], v[32:35], v[112:115]
    ds_read_b128 v[56:59], v77 offset:47104
    v_mfma_f32_16x16x32_bf16 v[116:119], v[40:43], v[36:39], v[116:119]
    ds_read_b128 v[60:63], v77 offset:47360
    s_waitcnt lgkmcnt(8)
    v_mfma_f32_16x16x32_bf16 v[88:91], v[44:47], v[24:27], v[88:91]
    v_mfma_f32_16x16x32_bf16 v[92:95], v[44:47], v[28:31], v[92:95]
    v_mfma_f32_16x16x32_bf16 v[120:123], v[44:47], v[32:35], v[120:123]
    v_mfma_f32_16x16x32_bf16 v[124:127], v[44:47], v[36:39], v[124:127]
    s_waitcnt lgkmcnt(6)
    v_mfma_f32_16x16x32_bf16 v[96:99], v[64:67], v[24:27], v[96:99]
    v_mfma_f32_16x16x32_bf16 v[100:103], v[64:67], v[28:31], v[100:103]
    v_mfma_f32_16x16x32_bf16 v[128:131], v[64:67], v[32:35], v[128:131]
    v_mfma_f32_16x16x32_bf16 v[132:135], v[64:67], v[36:39], v[132:135]
    s_waitcnt lgkmcnt(4)
    v_mfma_f32_16x16x32_bf16 v[104:107], v[68:71], v[24:27], v[104:107]
    v_mfma_f32_16x16x32_bf16 v[108:111], v[68:71], v[28:31], v[108:111]
    v_mfma_f32_16x16x32_bf16 v[136:139], v[68:71], v[32:35], v[136:139]
    v_mfma_f32_16x16x32_bf16 v[140:143], v[68:71], v[36:39], v[140:143]
    s_waitcnt lgkmcnt(0)
    s_barrier
    v_mfma_f32_16x16x32_bf16 v[144:147], v[40:43], v[48:51], v[144:147]
    ds_read_b128 v[24:27], v77 offset:0
    v_mfma_f32_16x16x32_bf16 v[148:151], v[40:43], v[52:55], v[148:151]
    ds_read_b128 v[28:31], v77 offset:256
    v_mfma_f32_16x16x32_bf16 v[176:179], v[40:43], v[56:59], v[176:179]
    ds_read_b128 v[32:35], v77 offset:4096
    v_mfma_f32_16x16x32_bf16 v[180:183], v[40:43], v[60:63], v[180:183]
    ds_read_b128 v[36:39], v77 offset:4352
    ds_read_b64_tr_b16 v[40:41], v14 offset:0
    ds_read_b64_tr_b16 v[42:43], v14 offset:1024
    v_mfma_f32_16x16x32_bf16 v[152:155], v[44:47], v[48:51], v[152:155]
    v_mfma_f32_16x16x32_bf16 v[156:159], v[44:47], v[52:55], v[156:159]
    v_mfma_f32_16x16x32_bf16 v[184:187], v[44:47], v[56:59], v[184:187]
    v_mfma_f32_16x16x32_bf16 v[188:191], v[44:47], v[60:63], v[188:191]
    ds_read_b64_tr_b16 v[44:45], v15 offset:0
    ds_read_b64_tr_b16 v[46:47], v15 offset:1024
    v_mfma_f32_16x16x32_bf16 v[160:163], v[64:67], v[48:51], v[160:163]
    v_mfma_f32_16x16x32_bf16 v[164:167], v[64:67], v[52:55], v[164:167]
    v_mfma_f32_16x16x32_bf16 v[192:195], v[64:67], v[56:59], v[192:195]
    v_mfma_f32_16x16x32_bf16 v[196:199], v[64:67], v[60:63], v[196:199]
    ds_read_b64_tr_b16 v[64:65], v14 offset:16384
    ds_read_b64_tr_b16 v[66:67], v14 offset:17408
    v_mfma_f32_16x16x32_bf16 v[168:171], v[68:71], v[48:51], v[168:171]
    v_mfma_f32_16x16x32_bf16 v[172:175], v[68:71], v[52:55], v[172:175]
    v_mfma_f32_16x16x32_bf16 v[200:203], v[68:71], v[56:59], v[200:203]
    v_mfma_f32_16x16x32_bf16 v[204:207], v[68:71], v[60:63], v[204:207]
    ds_read_b64_tr_b16 v[68:69], v15 offset:16384
    ds_read_b64_tr_b16 v[70:71], v15 offset:17408
    s_waitcnt lgkmcnt(6)
    v_mfma_f32_16x16x32_bf16 v[80:83], v[40:43], v[24:27], v[80:83]
    ds_read_b128 v[48:51], v77 offset:8192
    v_mfma_f32_16x16x32_bf16 v[84:87], v[40:43], v[28:31], v[84:87]
    ds_read_b128 v[52:55], v77 offset:8448
    v_mfma_f32_16x16x32_bf16 v[112:115], v[40:43], v[32:35], v[112:115]
    ds_read_b128 v[56:59], v77 offset:12288
    v_mfma_f32_16x16x32_bf16 v[116:119], v[40:43], v[36:39], v[116:119]
    ds_read_b128 v[60:63], v77 offset:12544
    s_waitcnt lgkmcnt(8)
    v_mfma_f32_16x16x32_bf16 v[88:91], v[44:47], v[24:27], v[88:91]
    v_mfma_f32_16x16x32_bf16 v[92:95], v[44:47], v[28:31], v[92:95]
    v_mfma_f32_16x16x32_bf16 v[120:123], v[44:47], v[32:35], v[120:123]
    v_mfma_f32_16x16x32_bf16 v[124:127], v[44:47], v[36:39], v[124:127]
    s_waitcnt lgkmcnt(6)
    v_mfma_f32_16x16x32_bf16 v[96:99], v[64:67], v[24:27], v[96:99]
    v_mfma_f32_16x16x32_bf16 v[100:103], v[64:67], v[28:31], v[100:103]
    v_mfma_f32_16x16x32_bf16 v[128:131], v[64:67], v[32:35], v[128:131]
    v_mfma_f32_16x16x32_bf16 v[132:135], v[64:67], v[36:39], v[132:135]
    s_waitcnt lgkmcnt(4)
    v_mfma_f32_16x16x32_bf16 v[104:107], v[68:71], v[24:27], v[104:107]
    v_mfma_f32_16x16x32_bf16 v[108:111], v[68:71], v[28:31], v[108:111]
    v_mfma_f32_16x16x32_bf16 v[136:139], v[68:71], v[32:35], v[136:139]
    v_mfma_f32_16x16x32_bf16 v[140:143], v[68:71], v[36:39], v[140:143]
    s_waitcnt lgkmcnt(3)
    v_mfma_f32_16x16x32_bf16 v[144:147], v[40:43], v[48:51], v[144:147]
    ds_read_b128 v[24:27], v77 offset:2048
    s_waitcnt lgkmcnt(3)
    v_mfma_f32_16x16x32_bf16 v[148:151], v[40:43], v[52:55], v[148:151]
    ds_read_b128 v[28:31], v77 offset:2304
    s_waitcnt lgkmcnt(3)
    v_mfma_f32_16x16x32_bf16 v[176:179], v[40:43], v[56:59], v[176:179]
    ds_read_b128 v[32:35], v77 offset:6144
    s_waitcnt lgkmcnt(3)
    v_mfma_f32_16x16x32_bf16 v[180:183], v[40:43], v[60:63], v[180:183]
    ds_read_b128 v[36:39], v77 offset:6400
    ds_read_b64_tr_b16 v[40:41], v14 offset:8192
    ds_read_b64_tr_b16 v[42:43], v14 offset:9216
    v_mfma_f32_16x16x32_bf16 v[152:155], v[44:47], v[48:51], v[152:155]
    v_mfma_f32_16x16x32_bf16 v[156:159], v[44:47], v[52:55], v[156:159]
    v_mfma_f32_16x16x32_bf16 v[184:187], v[44:47], v[56:59], v[184:187]
    v_mfma_f32_16x16x32_bf16 v[188:191], v[44:47], v[60:63], v[188:191]
    ds_read_b64_tr_b16 v[44:45], v15 offset:8192
    ds_read_b64_tr_b16 v[46:47], v15 offset:9216
    v_mfma_f32_16x16x32_bf16 v[160:163], v[64:67], v[48:51], v[160:163]
    v_mfma_f32_16x16x32_bf16 v[164:167], v[64:67], v[52:55], v[164:167]
    v_mfma_f32_16x16x32_bf16 v[192:195], v[64:67], v[56:59], v[192:195]
    v_mfma_f32_16x16x32_bf16 v[196:199], v[64:67], v[60:63], v[196:199]
    ds_read_b64_tr_b16 v[64:65], v14 offset:24576
    ds_read_b64_tr_b16 v[66:67], v14 offset:25600
    v_mfma_f32_16x16x32_bf16 v[168:171], v[68:71], v[48:51], v[168:171]
    v_mfma_f32_16x16x32_bf16 v[172:175], v[68:71], v[52:55], v[172:175]
    v_mfma_f32_16x16x32_bf16 v[200:203], v[68:71], v[56:59], v[200:203]
    v_mfma_f32_16x16x32_bf16 v[204:207], v[68:71], v[60:63], v[204:207]
    ds_read_b64_tr_b16 v[68:69], v15 offset:24576
    ds_read_b64_tr_b16 v[70:71], v15 offset:25600
    s_waitcnt lgkmcnt(6)
    v_mfma_f32_16x16x32_bf16 v[80:83], v[40:43], v[24:27], v[80:83]
    ds_read_b128 v[48:51], v77 offset:10240
    v_mfma_f32_16x16x32_bf16 v[84:87], v[40:43], v[28:31], v[84:87]
    ds_read_b128 v[52:55], v77 offset:10496
    v_mfma_f32_16x16x32_bf16 v[112:115], v[40:43], v[32:35], v[112:115]
    ds_read_b128 v[56:59], v77 offset:14336
    v_mfma_f32_16x16x32_bf16 v[116:119], v[40:43], v[36:39], v[116:119]
    ds_read_b128 v[60:63], v77 offset:14592
    s_waitcnt lgkmcnt(8)
    v_mfma_f32_16x16x32_bf16 v[88:91], v[44:47], v[24:27], v[88:91]
    v_mfma_f32_16x16x32_bf16 v[92:95], v[44:47], v[28:31], v[92:95]
    v_mfma_f32_16x16x32_bf16 v[120:123], v[44:47], v[32:35], v[120:123]
    v_mfma_f32_16x16x32_bf16 v[124:127], v[44:47], v[36:39], v[124:127]
    s_waitcnt lgkmcnt(6)
    v_mfma_f32_16x16x32_bf16 v[96:99], v[64:67], v[24:27], v[96:99]
    v_mfma_f32_16x16x32_bf16 v[100:103], v[64:67], v[28:31], v[100:103]
    v_mfma_f32_16x16x32_bf16 v[128:131], v[64:67], v[32:35], v[128:131]
    v_mfma_f32_16x16x32_bf16 v[132:135], v[64:67], v[36:39], v[132:135]
    s_waitcnt lgkmcnt(4)
    v_mfma_f32_16x16x32_bf16 v[104:107], v[68:71], v[24:27], v[104:107]
    v_mfma_f32_16x16x32_bf16 v[108:111], v[68:71], v[28:31], v[108:111]
    v_mfma_f32_16x16x32_bf16 v[136:139], v[68:71], v[32:35], v[136:139]
    v_mfma_f32_16x16x32_bf16 v[140:143], v[68:71], v[36:39], v[140:143]
    s_waitcnt lgkmcnt(0)
    s_barrier
    v_mfma_f32_16x16x32_bf16 v[144:147], v[40:43], v[48:51], v[144:147]
    ds_read_b128 v[24:27], v77 offset:32768
    v_mfma_f32_16x16x32_bf16 v[148:151], v[40:43], v[52:55], v[148:151]
    ds_read_b128 v[28:31], v77 offset:33024
    v_mfma_f32_16x16x32_bf16 v[176:179], v[40:43], v[56:59], v[176:179]
    ds_read_b128 v[32:35], v77 offset:36864
    v_mfma_f32_16x16x32_bf16 v[180:183], v[40:43], v[60:63], v[180:183]
    ds_read_b128 v[36:39], v77 offset:37120
    ds_read_b64_tr_b16 v[40:41], v14 offset:32768
    ds_read_b64_tr_b16 v[42:43], v14 offset:33792
    v_mfma_f32_16x16x32_bf16 v[152:155], v[44:47], v[48:51], v[152:155]
    v_mfma_f32_16x16x32_bf16 v[156:159], v[44:47], v[52:55], v[156:159]
    v_mfma_f32_16x16x32_bf16 v[184:187], v[44:47], v[56:59], v[184:187]
    v_mfma_f32_16x16x32_bf16 v[188:191], v[44:47], v[60:63], v[188:191]
    ds_read_b64_tr_b16 v[44:45], v15 offset:32768
    ds_read_b64_tr_b16 v[46:47], v15 offset:33792
    v_mfma_f32_16x16x32_bf16 v[160:163], v[64:67], v[48:51], v[160:163]
    v_mfma_f32_16x16x32_bf16 v[164:167], v[64:67], v[52:55], v[164:167]
    v_mfma_f32_16x16x32_bf16 v[192:195], v[64:67], v[56:59], v[192:195]
    v_mfma_f32_16x16x32_bf16 v[196:199], v[64:67], v[60:63], v[196:199]
    ds_read_b64_tr_b16 v[64:65], v14 offset:49152
    ds_read_b64_tr_b16 v[66:67], v14 offset:50176
    v_mfma_f32_16x16x32_bf16 v[168:171], v[68:71], v[48:51], v[168:171]
    v_mfma_f32_16x16x32_bf16 v[172:175], v[68:71], v[52:55], v[172:175]
    v_mfma_f32_16x16x32_bf16 v[200:203], v[68:71], v[56:59], v[200:203]
    v_mfma_f32_16x16x32_bf16 v[204:207], v[68:71], v[60:63], v[204:207]
    ds_read_b64_tr_b16 v[68:69], v15 offset:49152
    ds_read_b64_tr_b16 v[70:71], v15 offset:50176
    s_waitcnt lgkmcnt(6)
    v_mfma_f32_16x16x32_bf16 v[80:83], v[40:43], v[24:27], v[80:83]
    ds_read_b128 v[48:51], v77 offset:40960
    v_mfma_f32_16x16x32_bf16 v[84:87], v[40:43], v[28:31], v[84:87]
    ds_read_b128 v[52:55], v77 offset:41216
    v_mfma_f32_16x16x32_bf16 v[112:115], v[40:43], v[32:35], v[112:115]
    ds_read_b128 v[56:59], v77 offset:45056
    v_mfma_f32_16x16x32_bf16 v[116:119], v[40:43], v[36:39], v[116:119]
    ds_read_b128 v[60:63], v77 offset:45312
    s_waitcnt lgkmcnt(8)
    v_mfma_f32_16x16x32_bf16 v[88:91], v[44:47], v[24:27], v[88:91]
    v_mfma_f32_16x16x32_bf16 v[92:95], v[44:47], v[28:31], v[92:95]
    v_mfma_f32_16x16x32_bf16 v[120:123], v[44:47], v[32:35], v[120:123]
    v_mfma_f32_16x16x32_bf16 v[124:127], v[44:47], v[36:39], v[124:127]
    s_waitcnt lgkmcnt(6)
    v_mfma_f32_16x16x32_bf16 v[96:99], v[64:67], v[24:27], v[96:99]
    v_mfma_f32_16x16x32_bf16 v[100:103], v[64:67], v[28:31], v[100:103]
    v_mfma_f32_16x16x32_bf16 v[128:131], v[64:67], v[32:35], v[128:131]
    v_mfma_f32_16x16x32_bf16 v[132:135], v[64:67], v[36:39], v[132:135]
    s_waitcnt lgkmcnt(4)
    v_mfma_f32_16x16x32_bf16 v[104:107], v[68:71], v[24:27], v[104:107]
    v_mfma_f32_16x16x32_bf16 v[108:111], v[68:71], v[28:31], v[108:111]
    v_mfma_f32_16x16x32_bf16 v[136:139], v[68:71], v[32:35], v[136:139]
    v_mfma_f32_16x16x32_bf16 v[140:143], v[68:71], v[36:39], v[140:143]
    s_waitcnt lgkmcnt(3)
    v_mfma_f32_16x16x32_bf16 v[144:147], v[40:43], v[48:51], v[144:147]
    ds_read_b128 v[24:27], v77 offset:34816
    s_waitcnt lgkmcnt(3)
    v_mfma_f32_16x16x32_bf16 v[148:151], v[40:43], v[52:55], v[148:151]
    ds_read_b128 v[28:31], v77 offset:35072
    s_waitcnt lgkmcnt(3)
    v_mfma_f32_16x16x32_bf16 v[176:179], v[40:43], v[56:59], v[176:179]
    ds_read_b128 v[32:35], v77 offset:38912
    s_waitcnt lgkmcnt(3)
    v_mfma_f32_16x16x32_bf16 v[180:183], v[40:43], v[60:63], v[180:183]
    ds_read_b128 v[36:39], v77 offset:39168
    ds_read_b64_tr_b16 v[40:41], v14 offset:40960
    ds_read_b64_tr_b16 v[42:43], v14 offset:41984
    v_mfma_f32_16x16x32_bf16 v[152:155], v[44:47], v[48:51], v[152:155]
    v_mfma_f32_16x16x32_bf16 v[156:159], v[44:47], v[52:55], v[156:159]
    v_mfma_f32_16x16x32_bf16 v[184:187], v[44:47], v[56:59], v[184:187]
    v_mfma_f32_16x16x32_bf16 v[188:191], v[44:47], v[60:63], v[188:191]
    ds_read_b64_tr_b16 v[44:45], v15 offset:40960
    ds_read_b64_tr_b16 v[46:47], v15 offset:41984
    v_mfma_f32_16x16x32_bf16 v[160:163], v[64:67], v[48:51], v[160:163]
    v_mfma_f32_16x16x32_bf16 v[164:167], v[64:67], v[52:55], v[164:167]
    v_mfma_f32_16x16x32_bf16 v[192:195], v[64:67], v[56:59], v[192:195]
    v_mfma_f32_16x16x32_bf16 v[196:199], v[64:67], v[60:63], v[196:199]
    ds_read_b64_tr_b16 v[64:65], v14 offset:57344
    ds_read_b64_tr_b16 v[66:67], v14 offset:58368
    v_mfma_f32_16x16x32_bf16 v[168:171], v[68:71], v[48:51], v[168:171]
    v_mfma_f32_16x16x32_bf16 v[172:175], v[68:71], v[52:55], v[172:175]
    v_mfma_f32_16x16x32_bf16 v[200:203], v[68:71], v[56:59], v[200:203]
    v_mfma_f32_16x16x32_bf16 v[204:207], v[68:71], v[60:63], v[204:207]
    ds_read_b64_tr_b16 v[68:69], v15 offset:57344
    ds_read_b64_tr_b16 v[70:71], v15 offset:58368
    s_waitcnt lgkmcnt(6)
    v_mfma_f32_16x16x32_bf16 v[80:83], v[40:43], v[24:27], v[80:83]
    ds_read_b128 v[48:51], v77 offset:43008
    v_mov_b32 v209, 147460
    ds_read_b32 v208, v209
    s_waitcnt lgkmcnt(0)
    v_readfirstlane_b32 s61, v208
    v_mfma_f32_16x16x32_bf16 v[84:87], v[40:43], v[28:31], v[84:87]
    ds_read_b128 v[52:55], v77 offset:43264
    v_mfma_f32_16x16x32_bf16 v[112:115], v[40:43], v[32:35], v[112:115]
    ds_read_b128 v[56:59], v77 offset:47104
    v_mfma_f32_16x16x32_bf16 v[116:119], v[40:43], v[36:39], v[116:119]
    ds_read_b128 v[60:63], v77 offset:47360
    v_mfma_f32_16x16x32_bf16 v[88:91], v[44:47], v[24:27], v[88:91]
    v_mfma_f32_16x16x32_bf16 v[92:95], v[44:47], v[28:31], v[92:95]
    v_mfma_f32_16x16x32_bf16 v[120:123], v[44:47], v[32:35], v[120:123]
    v_mfma_f32_16x16x32_bf16 v[124:127], v[44:47], v[36:39], v[124:127]
    v_mfma_f32_16x16x32_bf16 v[96:99], v[64:67], v[24:27], v[96:99]
    v_mfma_f32_16x16x32_bf16 v[100:103], v[64:67], v[28:31], v[100:103]
    v_mfma_f32_16x16x32_bf16 v[128:131], v[64:67], v[32:35], v[128:131]
    v_mfma_f32_16x16x32_bf16 v[132:135], v[64:67], v[36:39], v[132:135]
    v_mfma_f32_16x16x32_bf16 v[104:107], v[68:71], v[24:27], v[104:107]
    v_mfma_f32_16x16x32_bf16 v[108:111], v[68:71], v[28:31], v[108:111]
    v_mfma_f32_16x16x32_bf16 v[136:139], v[68:71], v[32:35], v[136:139]
    v_mfma_f32_16x16x32_bf16 v[140:143], v[68:71], v[36:39], v[140:143]
    s_waitcnt lgkmcnt(0) vmcnt(0)
    s_barrier
    s_cmp_lg_u32 s19, 4
    s_cbranch_scc1 L_nosig_14
    s_lshl4_add_u32 s35, s96, s63
    s_lshl3_add_u32 s35, s35, s62
    s_lshl_b32 s35, s35, 2
    v_mov_b32 v216, 0
    v_mov_b32 v217, s95
    s_mov_b64 exec, 1
    s_add_u32 s35, s35, 3072
    buffer_store_dword v217, v216, s[88:91], s35 offen sc1
    s_mov_b64 exec, -1
L_nosig_14:
    v_mfma_f32_16x16x32_bf16 v[144:147], v[40:43], v[48:51], v[144:147]
    ds_read_b128 v[24:27], v77 offset:0
    s_add_u32 s84, s56, 0
    s_addc_u32 s85, s57, 0
    s_mov_b32 s86, 8388608
    s_mov_b32 s87, 0x00020000
    s_mov_b32 s92, 0
    buffer_load_dword v22, v21, s[84:87], s92 offen
    v_mfma_f32_16x16x32_bf16 v[148:151], v[40:43], v[52:55], v[148:151]
    ds_read_b128 v[28:31], v77 offset:256
    v_mfma_f32_16x16x32_bf16 v[176:179], v[40:43], v[56:59], v[176:179]
    ds_read_b128 v[32:35], v77 offset:4096
    v_mfma_f32_16x16x32_bf16 v[180:183], v[40:43], v[60:63], v[180:183]
    ds_read_b128 v[36:39], v77 offset:4352
    ds_read_b64_tr_b16 v[40:41], v14 offset:0
    ds_read_b64_tr_b16 v[42:43], v14 offset:1024
    v_mfma_f32_16x16x32_bf16 v[152:155], v[44:47], v[48:51], v[152:155]
    v_mfma_f32_16x16x32_bf16 v[156:159], v[44:47], v[52:55], v[156:159]
    v_mfma_f32_16x16x32_bf16 v[184:187], v[44:47], v[56:59], v[184:187]
    v_mfma_f32_16x16x32_bf16 v[188:191], v[44:47], v[60:63], v[188:191]
    ds_read_b64_tr_b16 v[44:45], v15 offset:0
    ds_read_b64_tr_b16 v[46:47], v15 offset:1024
    v_mfma_f32_16x16x32_bf16 v[160:163], v[64:67], v[48:51], v[160:163]
    v_mfma_f32_16x16x32_bf16 v[164:167], v[64:67], v[52:55], v[164:167]
    v_mfma_f32_16x16x32_bf16 v[192:195], v[64:67], v[56:59], v[192:195]
    v_mfma_f32_16x16x32_bf16 v[196:199], v[64:67], v[60:63], v[196:199]
    ds_read_b64_tr_b16 v[64:65], v14 offset:16384
    ds_read_b64_tr_b16 v[66:67], v14 offset:17408
    v_mfma_f32_16x16x32_bf16 v[168:171], v[68:71], v[48:51], v[168:171]
    v_mfma_f32_16x16x32_bf16 v[172:175], v[68:71], v[52:55], v[172:175]
    v_mfma_f32_16x16x32_bf16 v[200:203], v[68:71], v[56:59], v[200:203]
    v_mfma_f32_16x16x32_bf16 v[204:207], v[68:71], v[60:63], v[204:207]
    ds_read_b64_tr_b16 v[68:69], v15 offset:16384
    ds_read_b64_tr_b16 v[70:71], v15 offset:17408
    s_waitcnt lgkmcnt(6)
    v_mfma_f32_16x16x32_bf16 v[80:83], v[40:43], v[24:27], v[80:83]
    ds_read_b128 v[48:51], v77 offset:8192
    s_mul_i32 s35, s97, s99
    s_lshl_b32 s35, s35, 8
    s_lshl_b32 s101, s28, 6
    s_add_u32 s35, s35, s101
    s_sub_u32 s101, 7168, s35
    s_add_u32 s36, s54, s35
    s_addc_u32 s37, s55, 0
    s_mov_b32 s38, s101
    s_mov_b32 s39, 0x00020000
    v_bfe_u32 v18, v0, 4, 2
    v_lshlrev_b32 v18, 3, v18
    v_mfma_f32_16x16x32_bf16 v[84:87], v[40:43], v[28:31], v[84:87]
    ds_read_b128 v[52:55], v77 offset:8448
    v_mfma_f32_16x16x32_bf16 v[112:115], v[40:43], v[32:35], v[112:115]
    ds_read_b128 v[56:59], v77 offset:12288
    v_mfma_f32_16x16x32_bf16 v[116:119], v[40:43], v[36:39], v[116:119]
    ds_read_b128 v[60:63], v77 offset:12544
    s_waitcnt lgkmcnt(8)
    v_mfma_f32_16x16x32_bf16 v[88:91], v[44:47], v[24:27], v[88:91]
    v_mfma_f32_16x16x32_bf16 v[92:95], v[44:47], v[28:31], v[92:95]
    buffer_load_dwordx2 v[240:241], v18, s[36:39], 0 offen offset:0
    v_mfma_f32_16x16x32_bf16 v[120:123], v[44:47], v[32:35], v[120:123]
    v_mfma_f32_16x16x32_bf16 v[124:127], v[44:47], v[36:39], v[124:127]
    s_waitcnt lgkmcnt(6)
    v_mfma_f32_16x16x32_bf16 v[96:99], v[64:67], v[24:27], v[96:99]
    v_mfma_f32_16x16x32_bf16 v[100:103], v[64:67], v[28:31], v[100:103]
    v_mfma_f32_16x16x32_bf16 v[128:131], v[64:67], v[32:35], v[128:131]
    buffer_load_dwordx2 v[242:243], v18, s[36:39], 0 offen offset:32
    v_mfma_f32_16x16x32_bf16 v[132:135], v[64:67], v[36:39], v[132:135]
    s_waitcnt lgkmcnt(4)
    v_mfma_f32_16x16x32_bf16 v[104:107], v[68:71], v[24:27], v[104:107]
    v_mfma_f32_16x16x32_bf16 v[108:111], v[68:71], v[28:31], v[108:111]
    v_mfma_f32_16x16x32_bf16 v[136:139], v[68:71], v[32:35], v[136:139]
    v_mfma_f32_16x16x32_bf16 v[140:143], v[68:71], v[36:39], v[140:143]
    s_waitcnt lgkmcnt(3)
    v_mfma_f32_16x16x32_bf16 v[144:147], v[40:43], v[48:51], v[144:147]
    ds_read_b128 v[24:27], v77 offset:2048
    s_waitcnt lgkmcnt(3)
    v_mfma_f32_16x16x32_bf16 v[148:151], v[40:43], v[52:55], v[148:151]
    ds_read_b128 v[28:31], v77 offset:2304
    s_waitcnt lgkmcnt(3)
    v_mfma_f32_16x16x32_bf16 v[176:179], v[40:43], v[56:59], v[176:179]
    ds_read_b128 v[32:35], v77 offset:6144
    s_waitcnt lgkmcnt(3)
    v_mfma_f32_16x16x32_bf16 v[180:183], v[40:43], v[60:63], v[180:183]
    ds_read_b128 v[36:39], v77 offset:6400
    ds_read_b64_tr_b16 v[40:41], v14 offset:8192
    ds_read_b64_tr_b16 v[42:43], v14 offset:9216
    v_mfma_f32_16x16x32_bf16 v[152:155], v[44:47], v[48:51], v[152:155]
    v_mfma_f32_16x16x32_bf16 v[156:159], v[44:47], v[52:55], v[156:159]
    v_mfma_f32_16x16x32_bf16 v[184:187], v[44:47], v[56:59], v[184:187]
    v_mfma_f32_16x16x32_bf16 v[188:191], v[44:47], v[60:63], v[188:191]
    ds_read_b64_tr_b16 v[44:45], v15 offset:8192
    ds_read_b64_tr_b16 v[46:47], v15 offset:9216
    v_mfma_f32_16x16x32_bf16 v[160:163], v[64:67], v[48:51], v[160:163]
    v_mfma_f32_16x16x32_bf16 v[164:167], v[64:67], v[52:55], v[164:167]
    v_mfma_f32_16x16x32_bf16 v[192:195], v[64:67], v[56:59], v[192:195]
    v_mfma_f32_16x16x32_bf16 v[196:199], v[64:67], v[60:63], v[196:199]
    ds_read_b64_tr_b16 v[64:65], v14 offset:24576
    ds_read_b64_tr_b16 v[66:67], v14 offset:25600
    v_mfma_f32_16x16x32_bf16 v[168:171], v[68:71], v[48:51], v[168:171]
    v_mfma_f32_16x16x32_bf16 v[172:175], v[68:71], v[52:55], v[172:175]
    v_mfma_f32_16x16x32_bf16 v[200:203], v[68:71], v[56:59], v[200:203]
    v_mfma_f32_16x16x32_bf16 v[204:207], v[68:71], v[60:63], v[204:207]
    ds_read_b64_tr_b16 v[68:69], v15 offset:24576
    ds_read_b64_tr_b16 v[70:71], v15 offset:25600
    s_waitcnt lgkmcnt(6)
    v_mfma_f32_16x16x32_bf16 v[80:83], v[40:43], v[24:27], v[80:83]
    ds_read_b128 v[48:51], v77 offset:10240
    v_mfma_f32_16x16x32_bf16 v[84:87], v[40:43], v[28:31], v[84:87]
    ds_read_b128 v[52:55], v77 offset:10496
    v_mfma_f32_16x16x32_bf16 v[112:115], v[40:43], v[32:35], v[112:115]
    ds_read_b128 v[56:59], v77 offset:14336
    v_mfma_f32_16x16x32_bf16 v[116:119], v[40:43], v[36:39], v[116:119]
    ds_read_b128 v[60:63], v77 offset:14592
    s_waitcnt lgkmcnt(8)
    v_mfma_f32_16x16x32_bf16 v[88:91], v[44:47], v[24:27], v[88:91]
    v_mfma_f32_16x16x32_bf16 v[92:95], v[44:47], v[28:31], v[92:95]
    v_mfma_f32_16x16x32_bf16 v[120:123], v[44:47], v[32:35], v[120:123]
    v_mfma_f32_16x16x32_bf16 v[124:127], v[44:47], v[36:39], v[124:127]
    s_waitcnt lgkmcnt(6)
    v_mfma_f32_16x16x32_bf16 v[96:99], v[64:67], v[24:27], v[96:99]
    v_mfma_f32_16x16x32_bf16 v[100:103], v[64:67], v[28:31], v[100:103]
    v_mfma_f32_16x16x32_bf16 v[128:131], v[64:67], v[32:35], v[128:131]
    v_mfma_f32_16x16x32_bf16 v[132:135], v[64:67], v[36:39], v[132:135]
    s_waitcnt lgkmcnt(4)
    v_mfma_f32_16x16x32_bf16 v[104:107], v[68:71], v[24:27], v[104:107]
    v_mfma_f32_16x16x32_bf16 v[108:111], v[68:71], v[28:31], v[108:111]
    v_mfma_f32_16x16x32_bf16 v[136:139], v[68:71], v[32:35], v[136:139]
    v_mfma_f32_16x16x32_bf16 v[140:143], v[68:71], v[36:39], v[140:143]
    s_waitcnt lgkmcnt(0)
    s_barrier
    v_mfma_f32_16x16x32_bf16 v[144:147], v[40:43], v[48:51], v[144:147]
    ds_read_b128 v[24:27], v77 offset:32768
    s_add_u32 s84, s56, 0
    s_addc_u32 s85, s57, 0
    s_mov_b32 s86, 8388608
    s_mov_b32 s87, 0x00020000
    s_mov_b32 s92, 4194304
    buffer_load_dword v22, v21, s[84:87], s92 offen
    v_mfma_f32_16x16x32_bf16 v[148:151], v[40:43], v[52:55], v[148:151]
    ds_read_b128 v[28:31], v77 offset:33024
    v_mfma_f32_16x16x32_bf16 v[176:179], v[40:43], v[56:59], v[176:179]
    ds_read_b128 v[32:35], v77 offset:36864
    v_mfma_f32_16x16x32_bf16 v[180:183], v[40:43], v[60:63], v[180:183]
    ds_read_b128 v[36:39], v77 offset:37120
    ds_read_b64_tr_b16 v[40:41], v14 offset:32768
    ds_read_b64_tr_b16 v[42:43], v14 offset:33792
    v_mfma_f32_16x16x32_bf16 v[152:155], v[44:47], v[48:51], v[152:155]
    v_mfma_f32_16x16x32_bf16 v[156:159], v[44:47], v[52:55], v[156:159]
    v_mfma_f32_16x16x32_bf16 v[184:187], v[44:47], v[56:59], v[184:187]
    v_mfma_f32_16x16x32_bf16 v[188:191], v[44:47], v[60:63], v[188:191]
    ds_read_b64_tr_b16 v[44:45], v15 offset:32768
    ds_read_b64_tr_b16 v[46:47], v15 offset:33792
    v_mfma_f32_16x16x32_bf16 v[160:163], v[64:67], v[48:51], v[160:163]
    v_mfma_f32_16x16x32_bf16 v[164:167], v[64:67], v[52:55], v[164:167]
    v_mfma_f32_16x16x32_bf16 v[192:195], v[64:67], v[56:59], v[192:195]
    v_mfma_f32_16x16x32_bf16 v[196:199], v[64:67], v[60:63], v[196:199]
    ds_read_b64_tr_b16 v[64:65], v14 offset:49152
    ds_read_b64_tr_b16 v[66:67], v14 offset:50176
    v_mfma_f32_16x16x32_bf16 v[168:171], v[68:71], v[48:51], v[168:171]
    v_mfma_f32_16x16x32_bf16 v[172:175], v[68:71], v[52:55], v[172:175]
    v_mfma_f32_16x16x32_bf16 v[200:203], v[68:71], v[56:59], v[200:203]
    v_mfma_f32_16x16x32_bf16 v[204:207], v[68:71], v[60:63], v[204:207]
    ds_read_b64_tr_b16 v[68:69], v15 offset:49152
    ds_read_b64_tr_b16 v[70:71], v15 offset:50176
    s_waitcnt lgkmcnt(6)
    v_mfma_f32_16x16x32_bf16 v[80:83], v[40:43], v[24:27], v[80:83]
    ds_read_b128 v[48:51], v77 offset:40960
    s_waitcnt vmcnt(1)
    v_mfma_f32_16x16x32_bf16 v[84:87], v[40:43], v[28:31], v[84:87]
    ds_read_b128 v[52:55], v77 offset:41216
    v_mfma_f32_16x16x32_bf16 v[112:115], v[40:43], v[32:35], v[112:115]
    ds_read_b128 v[56:59], v77 offset:45056
    v_mfma_f32_16x16x32_bf16 v[116:119], v[40:43], v[36:39], v[116:119]
    ds_read_b128 v[60:63], v77 offset:45312
    v_lshlrev_b32 v224, 16, v240
    s_waitcnt lgkmcnt(8)
    v_mfma_f32_16x16x32_bf16 v[88:91], v[44:47], v[24:27], v[88:91]
    v_mfma_f32_16x16x32_bf16 v[92:95], v[44:47], v[28:31], v[92:95]
    v_mfma_f32_16x16x32_bf16 v[120:123], v[44:47], v[32:35], v[120:123]
    v_and_b32 v225, 0xffff0000, v240
    v_mfma_f32_16x16x32_bf16 v[124:127], v[44:47], v[36:39], v[124:127]
    s_waitcnt lgkmcnt(6)
    v_mfma_f32_16x16x32_bf16 v[96:99], v[64:67], v[24:27], v[96:99]
    v_mfma_f32_16x16x32_bf16 v[100:103], v[64:67], v[28:31], v[100:103]
    v_lshlrev_b32 v226, 16, v241
    v_mfma_f32_16x16x32_bf16 v[128:131], v[64:67], v[32:35], v[128:131]
    v_mfma_f32_16x16x32_bf16 v[132:135], v[64:67], v[36:39], v[132:135]
    s_waitcnt lgkmcnt(4)
    v_mfma_f32_16x16x32_bf16 v[104:107], v[68:71], v[24:27], v[104:107]
    v_and_b32 v227, 0xffff0000, v241
    v_mfma_f32_16x16x32_bf16 v[108:111], v[68:71], v[28:31], v[108:111]
    v_mfma_f32_16x16x32_bf16 v[136:139], v[68:71], v[32:35], v[136:139]
    v_mfma_f32_16x16x32_bf16 v[140:143], v[68:71], v[36:39], v[140:143]
    s_waitcnt lgkmcnt(3)
    v_mfma_f32_16x16x32_bf16 v[144:147], v[40:43], v[48:51], v[144:147]
    ds_read_b128 v[24:27], v77 offset:34816
    v_lshlrev_b32 v228, 16, v240
    s_waitcnt lgkmcnt(3)
    v_mfma_f32_16x16x32_bf16 v[148:151], v[40:43], v[52:55], v[148:151]
    ds_read_b128 v[28:31], v77 offset:35072
    s_waitcnt lgkmcnt(3)
    v_mfma_f32_16x16x32_bf16 v[176:179], v[40:43], v[56:59], v[176:179]
    ds_read_b128 v[32:35], v77 offset:38912
    v_and_b32 v229, 0xffff0000, v240
    s_waitcnt lgkmcnt(3)
    v_mfma_f32_16x16x32_bf16 v[180:183], v[40:43], v[60:63], v[180:183]
    ds_read_b128 v[36:39], v77 offset:39168
    ds_read_b64_tr_b16 v[40:41], v14 offset:40960
    ds_read_b64_tr_b16 v[42:43], v14 offset:41984
    v_mfma_f32_16x16x32_bf16 v[152:155], v[44:47], v[48:51], v[152:155]
    v_mfma_f32_16x16x32_bf16 v[156:159], v[44:47], v[52:55], v[156:159]
    v_lshlrev_b32 v230, 16, v241
    v_mfma_f32_16x16x32_bf16 v[184:187], v[44:47], v[56:59], v[184:187]
    v_mfma_f32_16x16x32_bf16 v[188:191], v[44:47], v[60:63], v[188:191]
    ds_read_b64_tr_b16 v[44:45], v15 offset:40960
    ds_read_b64_tr_b16 v[46:47], v15 offset:41984
    v_mfma_f32_16x16x32_bf16 v[160:163], v[64:67], v[48:51], v[160:163]
    v_and_b32 v231, 0xffff0000, v241
    v_mfma_f32_16x16x32_bf16 v[164:167], v[64:67], v[52:55], v[164:167]
    v_mfma_f32_16x16x32_bf16 v[192:195], v[64:67], v[56:59], v[192:195]
    v_lshlrev_b32 v232, 16, v242
    v_mfma_f32_16x16x32_bf16 v[196:199], v[64:67], v[60:63], v[196:199]
    ds_read_b64_tr_b16 v[64:65], v14 offset:57344
    ds_read_b64_tr_b16 v[66:67], v14 offset:58368
    v_mfma_f32_16x16x32_bf16 v[168:171], v[68:71], v[48:51], v[168:171]
    v_mfma_f32_16x16x32_bf16 v[172:175], v[68:71], v[52:55], v[172:175]
    v_and_b32 v233, 0xffff0000, v242
    v_mfma_f32_16x16x32_bf16 v[200:203], v[68:71], v[56:59], v[200:203]
    v_mfma_f32_16x16x32_bf16 v[204:207], v[68:71], v[60:63], v[204:207]
    ds_read_b64_tr_b16 v[68:69], v15 offset:57344
    ds_read_b64_tr_b16 v[70:71], v15 offset:58368
    s_waitcnt lgkmcnt(6)
    v_mfma_f32_16x16x32_bf16 v[80:83], v[40:43], v[24:27], v[80:83]
    ds_read_b128 v[48:51], v77 offset:43008
    v_lshlrev_b32 v234, 16, v243
    v_mfma_f32_16x16x32_bf16 v[84:87], v[40:43], v[28:31], v[84:87]
    ds_read_b128 v[52:55], v77 offset:43264
    v_mfma_f32_16x16x32_bf16 v[112:115], v[40:43], v[32:35], v[112:115]
    ds_read_b128 v[56:59], v77 offset:47104
    v_and_b32 v235, 0xffff0000, v243
    v_mfma_f32_16x16x32_bf16 v[116:119], v[40:43], v[36:39], v[116:119]
    ds_read_b128 v[60:63], v77 offset:47360
    s_waitcnt lgkmcnt(8)
    v_mfma_f32_16x16x32_bf16 v[88:91], v[44:47], v[24:27], v[88:91]
    v_mfma_f32_16x16x32_bf16 v[92:95], v[44:47], v[28:31], v[92:95]
    v_lshlrev_b32 v236, 16, v242
    v_mfma_f32_16x16x32_bf16 v[120:123], v[44:47], v[32:35], v[120:123]
    v_mfma_f32_16x16x32_bf16 v[124:127], v[44:47], v[36:39], v[124:127]
    s_waitcnt lgkmcnt(6)
    v_mfma_f32_16x16x32_bf16 v[96:99], v[64:67], v[24:27], v[96:99]
    v_and_b32 v237, 0xffff0000, v242
    v_mfma_f32_16x16x32_bf16 v[100:103], v[64:67], v[28:31], v[100:103]
    v_mfma_f32_16x16x32_bf16 v[128:131], v[64:67], v[32:35], v[128:131]
    v_lshlrev_b32 v238, 16, v243
    v_mfma_f32_16x16x32_bf16 v[132:135], v[64:67], v[36:39], v[132:135]
    s_waitcnt lgkmcnt(4)
    v_mfma_f32_16x16x32_bf16 v[104:107], v[68:71], v[24:27], v[104:107]
    v_mfma_f32_16x16x32_bf16 v[108:111], v[68:71], v[28:31], v[108:111]
    v_and_b32 v239, 0xffff0000, v243
    v_mfma_f32_16x16x32_bf16 v[136:139], v[68:71], v[32:35], v[136:139]
    v_mfma_f32_16x16x32_bf16 v[140:143], v[68:71], v[36:39], v[140:143]
    s_waitcnt lgkmcnt(0)
    s_barrier
    v_mfma_f32_16x16x32_bf16 v[144:147], v[40:43], v[48:51], v[144:147]
    ds_read_b128 v[24:27], v77 offset:0
    s_add_u32 s84, s58, 0
    s_addc_u32 s85, s59, 0
    s_mov_b32 s86, 7340032
    s_mov_b32 s87, 0x00020000
    s_mov_b32 s92, 0
    buffer_load_dword v22, v21, s[84:87], s92 offen
    v_mfma_f32_16x16x32_bf16 v[148:151], v[40:43], v[52:55], v[148:151]
    ds_read_b128 v[28:31], v77 offset:256
    v_mfma_f32_16x16x32_bf16 v[176:179], v[40:43], v[56:59], v[176:179]
    ds_read_b128 v[32:35], v77 offset:4096
    v_mfma_f32_16x16x32_bf16 v[180:183], v[40:43], v[60:63], v[180:183]
    ds_read_b128 v[36:39], v77 offset:4352
    ds_read_b64_tr_b16 v[40:41], v14 offset:0
    ds_read_b64_tr_b16 v[42:43], v14 offset:1024
    v_mfma_f32_16x16x32_bf16 v[152:155], v[44:47], v[48:51], v[152:155]
    v_mfma_f32_16x16x32_bf16 v[156:159], v[44:47], v[52:55], v[156:159]
    v_mfma_f32_16x16x32_bf16 v[184:187], v[44:47], v[56:59], v[184:187]
    v_mfma_f32_16x16x32_bf16 v[188:191], v[44:47], v[60:63], v[188:191]
    ds_read_b64_tr_b16 v[44:45], v15 offset:0
    ds_read_b64_tr_b16 v[46:47], v15 offset:1024
    v_mfma_f32_16x16x32_bf16 v[160:163], v[64:67], v[48:51], v[160:163]
    s_add_u32 s84, s58, 0
    s_addc_u32 s85, s59, 0
    s_mov_b32 s86, 7340032
    s_mov_b32 s87, 0x00020000
    s_mov_b32 s92, 4194304
    buffer_load_dword v22, v21, s[84:87], s92 offen
    v_mfma_f32_16x16x32_bf16 v[164:167], v[64:67], v[52:55], v[164:167]
    v_mfma_f32_16x16x32_bf16 v[192:195], v[64:67], v[56:59], v[192:195]
    v_mfma_f32_16x16x32_bf16 v[196:199], v[64:67], v[60:63], v[196:199]
    ds_read_b64_tr_b16 v[64:65], v14 offset:16384
    ds_read_b64_tr_b16 v[66:67], v14 offset:17408
    v_mfma_f32_16x16x32_bf16 v[168:171], v[68:71], v[48:51], v[168:171]
    v_mfma_f32_16x16x32_bf16 v[172:175], v[68:71], v[52:55], v[172:175]
    v_mfma_f32_16x16x32_bf16 v[200:203], v[68:71], v[56:59], v[200:203]
    v_mfma_f32_16x16x32_bf16 v[204:207], v[68:71], v[60:63], v[204:207]
    ds_read_b64_tr_b16 v[68:69], v15 offset:16384
    ds_read_b64_tr_b16 v[70:71], v15 offset:17408
    s_waitcnt lgkmcnt(6)
    v_mfma_f32_16x16x32_bf16 v[80:83], v[40:43], v[24:27], v[80:83]
    ds_read_b128 v[48:51], v77 offset:8192
    v_mfma_f32_16x16x32_bf16 v[84:87], v[40:43], v[28:31], v[84:87]
    ds_read_b128 v[52:55], v77 offset:8448
    v_mfma_f32_16x16x32_bf16 v[112:115], v[40:43], v[32:35], v[112:115]
    ds_read_b128 v[56:59], v77 offset:12288
    v_mfma_f32_16x16x32_bf16 v[116:119], v[40:43], v[36:39], v[116:119]
    ds_read_b128 v[60:63], v77 offset:12544
    s_waitcnt lgkmcnt(8)
    v_mfma_f32_16x16x32_bf16 v[88:91], v[44:47], v[24:27], v[88:91]
    v_mfma_f32_16x16x32_bf16 v[92:95], v[44:47], v[28:31], v[92:95]
    v_mfma_f32_16x16x32_bf16 v[120:123], v[44:47], v[32:35], v[120:123]
    v_mfma_f32_16x16x32_bf16 v[124:127], v[44:47], v[36:39], v[124:127]
    s_waitcnt lgkmcnt(6)
    v_mfma_f32_16x16x32_bf16 v[96:99], v[64:67], v[24:27], v[96:99]
    v_mfma_f32_16x16x32_bf16 v[100:103], v[64:67], v[28:31], v[100:103]
    v_mfma_f32_16x16x32_bf16 v[128:131], v[64:67], v[32:35], v[128:131]
    v_mfma_f32_16x16x32_bf16 v[132:135], v[64:67], v[36:39], v[132:135]
    s_waitcnt lgkmcnt(4)
    v_mfma_f32_16x16x32_bf16 v[104:107], v[68:71], v[24:27], v[104:107]
    v_mfma_f32_16x16x32_bf16 v[108:111], v[68:71], v[28:31], v[108:111]
    v_mfma_f32_16x16x32_bf16 v[136:139], v[68:71], v[32:35], v[136:139]
    v_mfma_f32_16x16x32_bf16 v[140:143], v[68:71], v[36:39], v[140:143]
    s_waitcnt lgkmcnt(3)
    v_mfma_f32_16x16x32_bf16 v[144:147], v[40:43], v[48:51], v[144:147]
    ds_read_b128 v[24:27], v77 offset:2048
    s_waitcnt lgkmcnt(3)
    v_mfma_f32_16x16x32_bf16 v[148:151], v[40:43], v[52:55], v[148:151]
    ds_read_b128 v[28:31], v77 offset:2304
    s_waitcnt lgkmcnt(3)
    v_mfma_f32_16x16x32_bf16 v[176:179], v[40:43], v[56:59], v[176:179]
    ds_read_b128 v[32:35], v77 offset:6144
    s_waitcnt lgkmcnt(3)
    v_mfma_f32_16x16x32_bf16 v[180:183], v[40:43], v[60:63], v[180:183]
    ds_read_b128 v[36:39], v77 offset:6400
    ds_read_b64_tr_b16 v[40:41], v14 offset:8192
    ds_read_b64_tr_b16 v[42:43], v14 offset:9216
    v_mfma_f32_16x16x32_bf16 v[152:155], v[44:47], v[48:51], v[152:155]
    v_mfma_f32_16x16x32_bf16 v[156:159], v[44:47], v[52:55], v[156:159]
    v_mfma_f32_16x16x32_bf16 v[184:187], v[44:47], v[56:59], v[184:187]
    v_mfma_f32_16x16x32_bf16 v[188:191], v[44:47], v[60:63], v[188:191]
    ds_read_b64_tr_b16 v[44:45], v15 offset:8192
    ds_read_b64_tr_b16 v[46:47], v15 offset:9216
    v_mfma_f32_16x16x32_bf16 v[160:163], v[64:67], v[48:51], v[160:163]
    v_mfma_f32_16x16x32_bf16 v[164:167], v[64:67], v[52:55], v[164:167]
    v_mfma_f32_16x16x32_bf16 v[192:195], v[64:67], v[56:59], v[192:195]
    v_mfma_f32_16x16x32_bf16 v[196:199], v[64:67], v[60:63], v[196:199]
    ds_read_b64_tr_b16 v[64:65], v14 offset:24576
    ds_read_b64_tr_b16 v[66:67], v14 offset:25600
    v_mfma_f32_16x16x32_bf16 v[168:171], v[68:71], v[48:51], v[168:171]
    v_mfma_f32_16x16x32_bf16 v[172:175], v[68:71], v[52:55], v[172:175]
    v_mfma_f32_16x16x32_bf16 v[200:203], v[68:71], v[56:59], v[200:203]
    v_mfma_f32_16x16x32_bf16 v[204:207], v[68:71], v[60:63], v[204:207]
    ds_read_b64_tr_b16 v[68:69], v15 offset:24576
    ds_read_b64_tr_b16 v[70:71], v15 offset:25600
    s_waitcnt lgkmcnt(6)
    v_mfma_f32_16x16x32_bf16 v[80:83], v[40:43], v[24:27], v[80:83]
    ds_read_b128 v[48:51], v77 offset:10240
    s_and_b32 s35, s2, 7
    s_bfe_u32 s101, s2, 0x20003
    s_lshl2_add_u32 s35, s35, s101
    s_lshr_b32 s35, s35, 1
    s_lshl_b32 s35, s35, 5
    s_add_u32 s35, s35, 3072
    v_and_b32 v17, 7, v0
    v_lshlrev_b32 v17, 2, v17
    v_bfe_u32 v16, v0, 3, 1
    v_lshl_add_u32 v17, v16, 9, v17
    v_add_u32 v17, s35, v17
    buffer_load_dword v16, v17, s[88:91], 0 offen sc1
    v_mfma_f32_16x16x32_bf16 v[84:87], v[40:43], v[28:31], v[84:87]
    ds_read_b128 v[52:55], v77 offset:10496
    v_mfma_f32_16x16x32_bf16 v[112:115], v[40:43], v[32:35], v[112:115]
    ds_read_b128 v[56:59], v77 offset:14336
    v_mfma_f32_16x16x32_bf16 v[116:119], v[40:43], v[36:39], v[116:119]
    ds_read_b128 v[60:63], v77 offset:14592
    s_waitcnt lgkmcnt(8)
    v_mfma_f32_16x16x32_bf16 v[88:91], v[44:47], v[24:27], v[88:91]
    v_mfma_f32_16x16x32_bf16 v[92:95], v[44:47], v[28:31], v[92:95]
    v_mfma_f32_16x16x32_bf16 v[120:123], v[44:47], v[32:35], v[120:123]
    v_mfma_f32_16x16x32_bf16 v[124:127], v[44:47], v[36:39], v[124:127]
    s_waitcnt lgkmcnt(6)
    v_mfma_f32_16x16x32_bf16 v[96:99], v[64:67], v[24:27], v[96:99]
    v_mfma_f32_16x16x32_bf16 v[100:103], v[64:67], v[28:31], v[100:103]
    v_mfma_f32_16x16x32_bf16 v[128:131], v[64:67], v[32:35], v[128:131]
    v_mfma_f32_16x16x32_bf16 v[132:135], v[64:67], v[36:39], v[132:135]
    s_waitcnt lgkmcnt(4)
    v_mfma_f32_16x16x32_bf16 v[104:107], v[68:71], v[24:27], v[104:107]
    v_mfma_f32_16x16x32_bf16 v[108:111], v[68:71], v[28:31], v[108:111]
    v_mfma_f32_16x16x32_bf16 v[136:139], v[68:71], v[32:35], v[136:139]
    v_mfma_f32_16x16x32_bf16 v[140:143], v[68:71], v[36:39], v[140:143]
    s_waitcnt lgkmcnt(0)
    s_barrier
    v_mfma_f32_16x16x32_bf16 v[144:147], v[40:43], v[48:51], v[144:147]
    ds_read_b128 v[24:27], v77 offset:32768
    v_mfma_f32_16x16x32_bf16 v[148:151], v[40:43], v[52:55], v[148:151]
    ds_read_b128 v[28:31], v77 offset:33024
    v_mfma_f32_16x16x32_bf16 v[176:179], v[40:43], v[56:59], v[176:179]
    ds_read_b128 v[32:35], v77 offset:36864
    v_mfma_f32_16x16x32_bf16 v[180:183], v[40:43], v[60:63], v[180:183]
    ds_read_b128 v[36:39], v77 offset:37120
    ds_read_b64_tr_b16 v[40:41], v14 offset:32768
    ds_read_b64_tr_b16 v[42:43], v14 offset:33792
    v_mfma_f32_16x16x32_bf16 v[152:155], v[44:47], v[48:51], v[152:155]
    v_mfma_f32_16x16x32_bf16 v[156:159], v[44:47], v[52:55], v[156:159]
    v_mfma_f32_16x16x32_bf16 v[184:187], v[44:47], v[56:59], v[184:187]
    v_mfma_f32_16x16x32_bf16 v[188:191], v[44:47], v[60:63], v[188:191]
    ds_read_b64_tr_b16 v[44:45], v15 offset:32768
    ds_read_b64_tr_b16 v[46:47], v15 offset:33792
    v_mfma_f32_16x16x32_bf16 v[160:163], v[64:67], v[48:51], v[160:163]
    v_mfma_f32_16x16x32_bf16 v[164:167], v[64:67], v[52:55], v[164:167]
    v_mfma_f32_16x16x32_bf16 v[192:195], v[64:67], v[56:59], v[192:195]
    v_mfma_f32_16x16x32_bf16 v[196:199], v[64:67], v[60:63], v[196:199]
    ds_read_b64_tr_b16 v[64:65], v14 offset:49152
    ds_read_b64_tr_b16 v[66:67], v14 offset:50176
    v_mfma_f32_16x16x32_bf16 v[168:171], v[68:71], v[48:51], v[168:171]
    v_mfma_f32_16x16x32_bf16 v[172:175], v[68:71], v[52:55], v[172:175]
    v_mfma_f32_16x16x32_bf16 v[200:203], v[68:71], v[56:59], v[200:203]
    v_mfma_f32_16x16x32_bf16 v[204:207], v[68:71], v[60:63], v[204:207]
    ds_read_b64_tr_b16 v[68:69], v15 offset:49152
    ds_read_b64_tr_b16 v[70:71], v15 offset:50176
    s_waitcnt lgkmcnt(6)
    v_mfma_f32_16x16x32_bf16 v[80:83], v[40:43], v[24:27], v[80:83]
    ds_read_b128 v[48:51], v77 offset:40960
    v_mfma_f32_16x16x32_bf16 v[84:87], v[40:43], v[28:31], v[84:87]
    ds_read_b128 v[52:55], v77 offset:41216
    v_mfma_f32_16x16x32_bf16 v[112:115], v[40:43], v[32:35], v[112:115]
    ds_read_b128 v[56:59], v77 offset:45056
    v_mfma_f32_16x16x32_bf16 v[116:119], v[40:43], v[36:39], v[116:119]
    ds_read_b128 v[60:63], v77 offset:45312
    s_waitcnt lgkmcnt(8)
    v_mfma_f32_16x16x32_bf16 v[88:91], v[44:47], v[24:27], v[88:91]
    v_mfma_f32_16x16x32_bf16 v[92:95], v[44:47], v[28:31], v[92:95]
    v_mfma_f32_16x16x32_bf16 v[120:123], v[44:47], v[32:35], v[120:123]
    v_mfma_f32_16x16x32_bf16 v[124:127], v[44:47], v[36:39], v[124:127]
    s_waitcnt lgkmcnt(6)
    v_mfma_f32_16x16x32_bf16 v[96:99], v[64:67], v[24:27], v[96:99]
    v_mfma_f32_16x16x32_bf16 v[100:103], v[64:67], v[28:31], v[100:103]
    v_mfma_f32_16x16x32_bf16 v[128:131], v[64:67], v[32:35], v[128:131]
    v_mfma_f32_16x16x32_bf16 v[132:135], v[64:67], v[36:39], v[132:135]
    s_waitcnt lgkmcnt(4)
    v_mfma_f32_16x16x32_bf16 v[104:107], v[68:71], v[24:27], v[104:107]
    v_mfma_f32_16x16x32_bf16 v[108:111], v[68:71], v[28:31], v[108:111]
    v_mfma_f32_16x16x32_bf16 v[136:139], v[68:71], v[32:35], v[136:139]
    v_mfma_f32_16x16x32_bf16 v[140:143], v[68:71], v[36:39], v[140:143]
    s_waitcnt lgkmcnt(3)
    v_mfma_f32_16x16x32_bf16 v[144:147], v[40:43], v[48:51], v[144:147]
    ds_read_b128 v[24:27], v77 offset:34816
    s_waitcnt lgkmcnt(3)
    v_mfma_f32_16x16x32_bf16 v[148:151], v[40:43], v[52:55], v[148:151]
    ds_read_b128 v[28:31], v77 offset:35072
    s_waitcnt lgkmcnt(3)
    v_mfma_f32_16x16x32_bf16 v[176:179], v[40:43], v[56:59], v[176:179]
    ds_read_b128 v[32:35], v77 offset:38912
    s_waitcnt lgkmcnt(3)
    v_mfma_f32_16x16x32_bf16 v[180:183], v[40:43], v[60:63], v[180:183]
    ds_read_b128 v[36:39], v77 offset:39168
    ds_read_b64_tr_b16 v[40:41], v14 offset:40960
    ds_read_b64_tr_b16 v[42:43], v14 offset:41984
    v_mfma_f32_16x16x32_bf16 v[152:155], v[44:47], v[48:51], v[152:155]
    v_mfma_f32_16x16x32_bf16 v[156:159], v[44:47], v[52:55], v[156:159]
    v_mfma_f32_16x16x32_bf16 v[184:187], v[44:47], v[56:59], v[184:187]
    v_mfma_f32_16x16x32_bf16 v[188:191], v[44:47], v[60:63], v[188:191]
    ds_read_b64_tr_b16 v[44:45], v15 offset:40960
    ds_read_b64_tr_b16 v[46:47], v15 offset:41984
    v_mfma_f32_16x16x32_bf16 v[160:163], v[64:67], v[48:51], v[160:163]
    v_mfma_f32_16x16x32_bf16 v[164:167], v[64:67], v[52:55], v[164:167]
    v_mfma_f32_16x16x32_bf16 v[192:195], v[64:67], v[56:59], v[192:195]
    v_mfma_f32_16x16x32_bf16 v[196:199], v[64:67], v[60:63], v[196:199]
    ds_read_b64_tr_b16 v[64:65], v14 offset:57344
    ds_read_b64_tr_b16 v[66:67], v14 offset:58368
    v_mfma_f32_16x16x32_bf16 v[168:171], v[68:71], v[48:51], v[168:171]
    v_mfma_f32_16x16x32_bf16 v[172:175], v[68:71], v[52:55], v[172:175]
    v_mfma_f32_16x16x32_bf16 v[200:203], v[68:71], v[56:59], v[200:203]
    v_mfma_f32_16x16x32_bf16 v[204:207], v[68:71], v[60:63], v[204:207]
    ds_read_b64_tr_b16 v[68:69], v15 offset:57344
    ds_read_b64_tr_b16 v[70:71], v15 offset:58368
    s_waitcnt lgkmcnt(6)
    v_mfma_f32_16x16x32_bf16 v[80:83], v[40:43], v[24:27], v[80:83]
    ds_read_b128 v[48:51], v77 offset:43008
    v_mfma_f32_16x16x32_bf16 v[84:87], v[40:43], v[28:31], v[84:87]
    ds_read_b128 v[52:55], v77 offset:43264
    v_mfma_f32_16x16x32_bf16 v[112:115], v[40:43], v[32:35], v[112:115]
    ds_read_b128 v[56:59], v77 offset:47104
    v_mfma_f32_16x16x32_bf16 v[116:119], v[40:43], v[36:39], v[116:119]
    ds_read_b128 v[60:63], v77 offset:47360
    s_waitcnt lgkmcnt(8)
    v_mfma_f32_16x16x32_bf16 v[88:91], v[44:47], v[24:27], v[88:91]
    v_mfma_f32_16x16x32_bf16 v[92:95], v[44:47], v[28:31], v[92:95]
    v_mfma_f32_16x16x32_bf16 v[120:123], v[44:47], v[32:35], v[120:123]
    v_mfma_f32_16x16x32_bf16 v[124:127], v[44:47], v[36:39], v[124:127]
    s_waitcnt lgkmcnt(6)
    v_mfma_f32_16x16x32_bf16 v[96:99], v[64:67], v[24:27], v[96:99]
    v_mfma_f32_16x16x32_bf16 v[100:103], v[64:67], v[28:31], v[100:103]
    v_mfma_f32_16x16x32_bf16 v[128:131], v[64:67], v[32:35], v[128:131]
    v_mfma_f32_16x16x32_bf16 v[132:135], v[64:67], v[36:39], v[132:135]
    s_waitcnt lgkmcnt(4)
    v_mfma_f32_16x16x32_bf16 v[104:107], v[68:71], v[24:27], v[104:107]
    v_mfma_f32_16x16x32_bf16 v[108:111], v[68:71], v[28:31], v[108:111]
    v_mfma_f32_16x16x32_bf16 v[136:139], v[68:71], v[32:35], v[136:139]
    v_mfma_f32_16x16x32_bf16 v[140:143], v[68:71], v[36:39], v[140:143]
    s_waitcnt lgkmcnt(3)
    v_mfma_f32_16x16x32_bf16 v[144:147], v[40:43], v[48:51], v[144:147]
    s_waitcnt lgkmcnt(2)
    v_mfma_f32_16x16x32_bf16 v[148:151], v[40:43], v[52:55], v[148:151]
    s_waitcnt lgkmcnt(1)
    v_mfma_f32_16x16x32_bf16 v[176:179], v[40:43], v[56:59], v[176:179]
    s_waitcnt lgkmcnt(0)
    v_mfma_f32_16x16x32_bf16 v[180:183], v[40:43], v[60:63], v[180:183]
    v_mfma_f32_16x16x32_bf16 v[152:155], v[44:47], v[48:51], v[152:155]
    v_mfma_f32_16x16x32_bf16 v[156:159], v[44:47], v[52:55], v[156:159]
    v_mfma_f32_16x16x32_bf16 v[184:187], v[44:47], v[56:59], v[184:187]
    v_mfma_f32_16x16x32_bf16 v[188:191], v[44:47], v[60:63], v[188:191]
    v_mfma_f32_16x16x32_bf16 v[160:163], v[64:67], v[48:51], v[160:163]
    v_mfma_f32_16x16x32_bf16 v[164:167], v[64:67], v[52:55], v[164:167]
    v_mfma_f32_16x16x32_bf16 v[192:195], v[64:67], v[56:59], v[192:195]
    v_mfma_f32_16x16x32_bf16 v[196:199], v[64:67], v[60:63], v[196:199]
    v_mfma_f32_16x16x32_bf16 v[168:171], v[68:71], v[48:51], v[168:171]
    v_mfma_f32_16x16x32_bf16 v[172:175], v[68:71], v[52:55], v[172:175]
    v_mfma_f32_16x16x32_bf16 v[200:203], v[68:71], v[56:59], v[200:203]
    v_mfma_f32_16x16x32_bf16 v[204:207], v[68:71], v[60:63], v[204:207]
L_pj_epi:
    s_waitcnt lgkmcnt(0)
    s_barrier
    s_mov_b32 s69, s19
    s_mov_b32 s70, s27
    s_mov_b32 s71, s28
    s_lshl_b32 s68, s98, 5
    s_add_u32 s68, s68, s97
    s_lshl_b32 s68, s68, 2
    s_add_u32 s68, s68, 4096
    s_add_u32 s64, s48, 54525952
    s_addc_u32 s65, s49, 0
    s_mov_b32 s66, 31457280
    s_mov_b32 s67, 0x00020000
    s_sub_u32 s35, 15, s98
    s_cmp_eq_u32 s70, 0
    s_cselect_b32 s35, s35, s98
    s_mul_i32 s35, s35, 1920
    s_lshl3_add_u32 s100, s97, s35
    s_lshl1_add_u32 s100, s71, s100
    s_add_u32 s100, s100, 256
    s_lshl_b32 s100, s100, 10
    s_mov_b32 s38, s2
    s_and_b32 s35, s38, 7
    s_bfe_u32 s36, s38, 0x20003
    s_lshl2_add_u32 s33, s35, s36
    s_lshr_b32 s34, s38, 5
    v_lshrrev_b32 v7, 6, v0
    v_and_b32 v11, 63, v0
    v_readfirstlane_b32 s24, v7
    v_lshlrev_b32 v1, 4, v11
    s_nop 1
    s_lshr_b32 s25, s24, 2
    s_and_b32 s26, s24, 3
    s_lshl_b32 s35, s24, 12
    s_mov_b32 s27, s35
    s_add_u32 s28, s35, 32768
    s_add_u32 s29, s35, 65536
    s_add_u32 s30, s35, 98304
    v_add_u32 v10, s35, v1
    s_sub_u32 s21, 15, s34
    s_mov_b32 s22, 0
    s_mov_b32 s23, 0
    s_lshl_b32 s35, s33, 19
    s_add_u32 s36, s35, 20971520
    s_add_u32 s4, s48, s36
    s_addc_u32 s5, s49, 0
    s_mov_b32 s6, 524288
    s_mov_b32 s7, 0x00020000
    s_add_u32 s36, s35, 4194304
    s_add_u32 s16, s48, s36
    s_addc_u32 s17, s49, 0
    s_mov_b32 s18, 524288
    s_mov_b32 s19, 0x00020000
    s_add_u32 s36, s35, 37748736
    s_add_u32 s8, s48, s36
    s_addc_u32 s9, s49, 0
    s_mov_b32 s10, 524288
    s_mov_b32 s11, 0x00020000
    s_add_u32 s52, s48, 87031808
    s_addc_u32 s53, s49, 0
    s_mov_b32 s54, 65536
    s_mov_b32 s55, 0x00020000
    s_cmp_ge_i32 s61, 0
    s_cbranch_scc1 L_pj_noearly0
    s_waitcnt vmcnt(0)
    s_branch L_spnc_17
L_spn_15:
    buffer_load_dword v16, v17, s[52:55], 0 offen sc1
    s_waitcnt vmcnt(0)
L_spnc_17:
    v_cmp_ne_u32 vcc, s95, v16
    s_cbranch_vccz L_spnok_16
    s_sleep 8
    s_branch L_spn_15
L_spnok_16:
    s_mov_b32 m0, s27
    s_nop 0
    buffer_load_dwordx4 v10, s[4:7], s22 offen offset:0 lds
    buffer_load_dwordx4 v10, s[4:7], s22 offen offset:1024 lds
    buffer_load_dwordx4 v10, s[4:7], s22 offen offset:2048 lds
    buffer_load_dwordx4 v10, s[4:7], s22 offen offset:3072 lds
    s_add_u32 s22, s22, 32768
    s_mov_b32 m0, s29
    s_nop 0
    buffer_load_dwordx4 v10, s[8:11], s23 offen offset:0 lds
    buffer_load_dwordx4 v10, s[8:11], s23 offen offset:1024 lds
    buffer_load_dwordx4 v10, s[8:11], s23 offen offset:2048 lds
    buffer_load_dwordx4 v10, s[8:11], s23 offen offset:3072 lds
    s_add_u32 s23, s23, 32768
    s_mov_b32 m0, s28
    s_nop 0
    buffer_load_dwordx4 v10, s[4:7], s22 offen offset:0 lds
    buffer_load_dwordx4 v10, s[4:7], s22 offen offset:1024 lds
    buffer_load_dwordx4 v10, s[4:7], s22 offen offset:2048 lds
    buffer_load_dwordx4 v10, s[4:7], s22 offen offset:3072 lds
    s_add_u32 s22, s22, 32768
L_pj_noearly0:
    s_add_u32 s12, s48, 54525952
    s_addc_u32 s13, s49, 0
    s_mov_b32 s14, 31457280
    s_mov_b32 s15, 0x00020000
    s_mov_b32 s31, 0x4b800000
    v_mov_b32 v9, 0xf149f2ca
    v_and_b32 v11, 63, v0
    v_and_b32 v7, 0x33, v11
    v_bfe_u32 v12, v11, 2, 1
    v_lshl_or_b32 v7, v12, 3, v7
    v_bfe_u32 v12, v11, 3, 1
    v_lshl_or_b32 v7, v12, 2, v7
    s_lshl_b32 s35, s25, 14
    v_lshl_add_u32 v2, v7, 4, s35
    s_add_u32 s36, s35, 65536
    v_add_u32 v3, s36, v1
    v_and_b32 v7, 31, v11
    v_lshrrev_b32 v12, 5, v11
    v_lshlrev_b32 v12, 3, v12
    v_sub_u32 v7, v7, v12
    s_lshl_b32 s35, s26, 5
    s_lshl_b32 s36, s25, 6
    s_sub_u32 s35, s35, s36
    v_add_u32 v8, s35, v7
    s_mov_b32 s32, 0
    s_mov_b32 s37, 0
    s_mov_b32 s78, 0x3e0293ee
    s_mov_b32 s79, 0x3e0293ee
    s_lshl_b32 s70, s70, 15
    s_lshl_b32 s71, s71, 11
    s_add_u32 s70, s70, s71
    s_add_u32 s70, s70, 98304
    v_add_u32 v14, s70, v1
    v_pk_mul_f32 v[80:81], v[80:81], s[78:79]
    v_pk_mul_f32 v[82:83], v[82:83], s[78:79]
    v_pk_mul_f32 v[84:85], v[84:85], s[78:79]
    v_pk_mul_f32 v[86:87], v[86:87], s[78:79]
    v_cvt_pk_bf16_f32 v80, v80, v81
    v_cvt_pk_bf16_f32 v81, v82, v83
    v_cvt_pk_bf16_f32 v82, v84, v85
    v_cvt_pk_bf16_f32 v83, v86, v87
    s_nop 1
    v_permlane16_swap_b32 v80, v82
    v_permlane16_swap_b32 v81, v83
    ds_write_b128 v14, v[80:83] offset:0
    v_pk_mul_f32 v[88:89], v[88:89], s[78:79]
    v_pk_mul_f32 v[90:91], v[90:91], s[78:79]
    v_pk_mul_f32 v[92:93], v[92:93], s[78:79]
    v_pk_mul_f32 v[94:95], v[94:95], s[78:79]
    v_cvt_pk_bf16_f32 v88, v88, v89
    v_cvt_pk_bf16_f32 v89, v90, v91
    v_cvt_pk_bf16_f32 v90, v92, v93
    v_cvt_pk_bf16_f32 v91, v94, v95
    s_nop 1
    v_permlane16_swap_b32 v88, v90
    v_permlane16_swap_b32 v89, v91
    ds_write_b128 v14, v[88:91] offset:1024
    v_pk_mul_f32 v[112:113], v[112:113], s[78:79]
    v_pk_mul_f32 v[114:115], v[114:115], s[78:79]
    v_pk_mul_f32 v[116:117], v[116:117], s[78:79]
    v_pk_mul_f32 v[118:119], v[118:119], s[78:79]
    v_cvt_pk_bf16_f32 v112, v112, v113
    v_cvt_pk_bf16_f32 v113, v114, v115
    v_cvt_pk_bf16_f32 v114, v116, v117
    v_cvt_pk_bf16_f32 v115, v118, v119
    s_nop 1
    v_permlane16_swap_b32 v112, v114
    v_permlane16_swap_b32 v113, v115
    ds_write_b128 v14, v[112:115] offset:8192
    v_pk_mul_f32 v[120:121], v[120:121], s[78:79]
    v_pk_mul_f32 v[122:123], v[122:123], s[78:79]
    v_pk_mul_f32 v[124:125], v[124:125], s[78:79]
    v_pk_mul_f32 v[126:127], v[126:127], s[78:79]
    v_cvt_pk_bf16_f32 v120, v120, v121
    v_cvt_pk_bf16_f32 v121, v122, v123
    v_cvt_pk_bf16_f32 v122, v124, v125
    v_cvt_pk_bf16_f32 v123, v126, v127
    s_nop 1
    v_permlane16_swap_b32 v120, v122
    v_permlane16_swap_b32 v121, v123
    ds_write_b128 v14, v[120:123] offset:9216
    v_pk_mul_f32 v[144:145], v[144:145], s[78:79]
    v_pk_mul_f32 v[146:147], v[146:147], s[78:79]
    v_pk_mul_f32 v[148:149], v[148:149], s[78:79]
    v_pk_mul_f32 v[150:151], v[150:151], s[78:79]
    v_cvt_pk_bf16_f32 v144, v144, v145
    v_cvt_pk_bf16_f32 v145, v146, v147
    v_cvt_pk_bf16_f32 v146, v148, v149
    v_cvt_pk_bf16_f32 v147, v150, v151
    s_nop 1
    v_permlane16_swap_b32 v144, v146
    v_permlane16_swap_b32 v145, v147
    ds_write_b128 v14, v[144:147] offset:16384
    v_pk_mul_f32 v[152:153], v[152:153], s[78:79]
    v_pk_mul_f32 v[154:155], v[154:155], s[78:79]
    v_pk_mul_f32 v[156:157], v[156:157], s[78:79]
    v_pk_mul_f32 v[158:159], v[158:159], s[78:79]
    v_cvt_pk_bf16_f32 v152, v152, v153
    v_cvt_pk_bf16_f32 v153, v154, v155
    v_cvt_pk_bf16_f32 v154, v156, v157
    v_cvt_pk_bf16_f32 v155, v158, v159
    s_nop 1
    v_permlane16_swap_b32 v152, v154
    v_permlane16_swap_b32 v153, v155
    ds_write_b128 v14, v[152:155] offset:17408
    v_pk_mul_f32 v[176:177], v[176:177], s[78:79]
    v_pk_mul_f32 v[178:179], v[178:179], s[78:79]
    v_pk_mul_f32 v[180:181], v[180:181], s[78:79]
    v_pk_mul_f32 v[182:183], v[182:183], s[78:79]
    v_cvt_pk_bf16_f32 v176, v176, v177
    v_cvt_pk_bf16_f32 v177, v178, v179
    v_cvt_pk_bf16_f32 v178, v180, v181
    v_cvt_pk_bf16_f32 v179, v182, v183
    s_nop 1
    v_permlane16_swap_b32 v176, v178
    v_permlane16_swap_b32 v177, v179
    ds_write_b128 v14, v[176:179] offset:24576
    v_pk_mul_f32 v[184:185], v[184:185], s[78:79]
    v_pk_mul_f32 v[186:187], v[186:187], s[78:79]
    v_pk_mul_f32 v[188:189], v[188:189], s[78:79]
    v_pk_mul_f32 v[190:191], v[190:191], s[78:79]
    v_cvt_pk_bf16_f32 v184, v184, v185
    v_cvt_pk_bf16_f32 v185, v186, v187
    v_cvt_pk_bf16_f32 v186, v188, v189
    v_cvt_pk_bf16_f32 v187, v190, v191
    s_nop 1
    v_permlane16_swap_b32 v184, v186
    v_permlane16_swap_b32 v185, v187
    ds_write_b128 v14, v[184:187] offset:25600
    s_cmp_eq_u32 s99, 0
    s_cbranch_scc1 L_pj_H0
    s_mov_b32 s78, 0xbdd2d3e8
    s_mov_b32 s79, 0xbdd2d3e8
    v_mov_b32 v64, 0xc0135761
    v_mov_b32 v65, 0xc0135761
    v_mov_b32 v66, 1.0
    v_mov_b32 v67, 1.0
    v_pk_add_f32 v[96:97], v[96:97], v[224:225]
    v_pk_add_f32 v[98:99], v[98:99], v[226:227]
    v_pk_add_f32 v[100:101], v[100:101], v[228:229]
    v_pk_add_f32 v[102:103], v[102:103], v[230:231]
    v_pk_mul_f32 v[48:49], v[96:97], v[96:97]
    v_pk_mul_f32 v[50:51], v[98:99], v[98:99]
    v_pk_mul_f32 v[52:53], v[100:101], v[100:101]
    v_pk_mul_f32 v[54:55], v[102:103], v[102:103]
    v_pk_fma_f32 v[48:49], v[48:49], s[78:79], v[64:65]
    v_pk_fma_f32 v[50:51], v[50:51], s[78:79], v[64:65]
    v_pk_fma_f32 v[52:53], v[52:53], s[78:79], v[64:65]
    v_pk_fma_f32 v[54:55], v[54:55], s[78:79], v[64:65]
    v_pk_mul_f32 v[48:49], v[48:49], v[96:97]
    v_pk_mul_f32 v[50:51], v[50:51], v[98:99]
    v_pk_mul_f32 v[52:53], v[52:53], v[100:101]
    v_pk_mul_f32 v[54:55], v[54:55], v[102:103]
    v_exp_f32 v48, v48
    v_exp_f32 v49, v49
    v_exp_f32 v50, v50
    v_exp_f32 v51, v51
    v_exp_f32 v52, v52
    v_exp_f32 v53, v53
    v_exp_f32 v54, v54
    v_exp_f32 v55, v55
    v_pk_add_f32 v[48:49], v[48:49], v[66:67]
    v_pk_add_f32 v[50:51], v[50:51], v[66:67]
    v_pk_add_f32 v[52:53], v[52:53], v[66:67]
    v_pk_add_f32 v[54:55], v[54:55], v[66:67]
    v_rcp_f32 v48, v48
    v_rcp_f32 v49, v49
    v_rcp_f32 v50, v50
    v_rcp_f32 v51, v51
    v_rcp_f32 v52, v52
    v_rcp_f32 v53, v53
    v_rcp_f32 v54, v54
    v_rcp_f32 v55, v55
    v_pk_mul_f32 v[96:97], v[96:97], v[48:49]
    v_pk_mul_f32 v[98:99], v[98:99], v[50:51]
    v_pk_mul_f32 v[100:101], v[100:101], v[52:53]
    v_pk_mul_f32 v[102:103], v[102:103], v[54:55]
    v_cvt_pk_bf16_f32 v96, v96, v97
    v_cvt_pk_bf16_f32 v97, v98, v99
    v_cvt_pk_bf16_f32 v98, v100, v101
    v_cvt_pk_bf16_f32 v99, v102, v103
    s_nop 1
    v_permlane16_swap_b32 v96, v98
    v_permlane16_swap_b32 v97, v99
    v_pk_add_f32 v[104:105], v[104:105], v[232:233]
    v_pk_add_f32 v[106:107], v[106:107], v[234:235]
    v_pk_add_f32 v[108:109], v[108:109], v[236:237]
    v_pk_add_f32 v[110:111], v[110:111], v[238:239]
    v_pk_mul_f32 v[56:57], v[104:105], v[104:105]
    v_pk_mul_f32 v[58:59], v[106:107], v[106:107]
    v_pk_mul_f32 v[60:61], v[108:109], v[108:109]
    v_pk_mul_f32 v[62:63], v[110:111], v[110:111]
    v_pk_fma_f32 v[56:57], v[56:57], s[78:79], v[64:65]
    v_pk_fma_f32 v[58:59], v[58:59], s[78:79], v[64:65]
    v_pk_fma_f32 v[60:61], v[60:61], s[78:79], v[64:65]
    v_pk_fma_f32 v[62:63], v[62:63], s[78:79], v[64:65]
    v_pk_mul_f32 v[56:57], v[56:57], v[104:105]
    v_pk_mul_f32 v[58:59], v[58:59], v[106:107]
    v_pk_mul_f32 v[60:61], v[60:61], v[108:109]
    v_pk_mul_f32 v[62:63], v[62:63], v[110:111]
    v_exp_f32 v56, v56
    v_exp_f32 v57, v57
    v_exp_f32 v58, v58
    v_exp_f32 v59, v59
    v_exp_f32 v60, v60
    v_exp_f32 v61, v61
    v_exp_f32 v62, v62
    v_exp_f32 v63, v63
    v_pk_add_f32 v[56:57], v[56:57], v[66:67]
    v_pk_add_f32 v[58:59], v[58:59], v[66:67]
    v_pk_add_f32 v[60:61], v[60:61], v[66:67]
    v_pk_add_f32 v[62:63], v[62:63], v[66:67]
    v_rcp_f32 v56, v56
    v_rcp_f32 v57, v57
    v_rcp_f32 v58, v58
    v_rcp_f32 v59, v59
    v_rcp_f32 v60, v60
    v_rcp_f32 v61, v61
    v_rcp_f32 v62, v62
    v_rcp_f32 v63, v63
    v_pk_mul_f32 v[104:105], v[104:105], v[56:57]
    v_pk_mul_f32 v[106:107], v[106:107], v[58:59]
    v_pk_mul_f32 v[108:109], v[108:109], v[60:61]
    v_pk_mul_f32 v[110:111], v[110:111], v[62:63]
    v_cvt_pk_bf16_f32 v104, v104, v105
    v_cvt_pk_bf16_f32 v105, v106, v107
    v_cvt_pk_bf16_f32 v106, v108, v109
    v_cvt_pk_bf16_f32 v107, v110, v111
    s_nop 1
    v_permlane16_swap_b32 v104, v106
    v_permlane16_swap_b32 v105, v107
    v_pk_add_f32 v[128:129], v[128:129], v[224:225]
    v_pk_add_f32 v[130:131], v[130:131], v[226:227]
    v_pk_add_f32 v[132:133], v[132:133], v[228:229]
    v_pk_add_f32 v[134:135], v[134:135], v[230:231]
    v_pk_mul_f32 v[48:49], v[128:129], v[128:129]
    v_pk_mul_f32 v[50:51], v[130:131], v[130:131]
    v_pk_mul_f32 v[52:53], v[132:133], v[132:133]
    v_pk_mul_f32 v[54:55], v[134:135], v[134:135]
    v_pk_fma_f32 v[48:49], v[48:49], s[78:79], v[64:65]
    v_pk_fma_f32 v[50:51], v[50:51], s[78:79], v[64:65]
    v_pk_fma_f32 v[52:53], v[52:53], s[78:79], v[64:65]
    v_pk_fma_f32 v[54:55], v[54:55], s[78:79], v[64:65]
    v_pk_mul_f32 v[48:49], v[48:49], v[128:129]
    v_pk_mul_f32 v[50:51], v[50:51], v[130:131]
    v_pk_mul_f32 v[52:53], v[52:53], v[132:133]
    v_pk_mul_f32 v[54:55], v[54:55], v[134:135]
    v_exp_f32 v48, v48
    v_exp_f32 v49, v49
    v_exp_f32 v50, v50
    v_exp_f32 v51, v51
    v_exp_f32 v52, v52
    v_exp_f32 v53, v53
    v_exp_f32 v54, v54
    v_exp_f32 v55, v55
    v_pk_add_f32 v[48:49], v[48:49], v[66:67]
    v_pk_add_f32 v[50:51], v[50:51], v[66:67]
    v_pk_add_f32 v[52:53], v[52:53], v[66:67]
    v_pk_add_f32 v[54:55], v[54:55], v[66:67]
    v_rcp_f32 v48, v48
    v_rcp_f32 v49, v49
    v_rcp_f32 v50, v50
    v_rcp_f32 v51, v51
    v_rcp_f32 v52, v52
    v_rcp_f32 v53, v53
    v_rcp_f32 v54, v54
    v_rcp_f32 v55, v55
    v_pk_mul_f32 v[128:129], v[128:129], v[48:49]
    v_pk_mul_f32 v[130:131], v[130:131], v[50:51]
    v_pk_mul_f32 v[132:133], v[132:133], v[52:53]
    v_pk_mul_f32 v[134:135], v[134:135], v[54:55]
    v_cvt_pk_bf16_f32 v128, v128, v129
    v_cvt_pk_bf16_f32 v129, v130, v131
    v_cvt_pk_bf16_f32 v130, v132, v133
    v_cvt_pk_bf16_f32 v131, v134, v135
    s_nop 1
    v_permlane16_swap_b32 v128, v130
    v_permlane16_swap_b32 v129, v131
    v_pk_add_f32 v[136:137], v[136:137], v[232:233]
    v_pk_add_f32 v[138:139], v[138:139], v[234:235]
    v_pk_add_f32 v[140:141], v[140:141], v[236:237]
    v_pk_add_f32 v[142:143], v[142:143], v[238:239]
    v_pk_mul_f32 v[56:57], v[136:137], v[136:137]
    v_pk_mul_f32 v[58:59], v[138:139], v[138:139]
    v_pk_mul_f32 v[60:61], v[140:141], v[140:141]
    v_pk_mul_f32 v[62:63], v[142:143], v[142:143]
    v_pk_fma_f32 v[56:57], v[56:57], s[78:79], v[64:65]
    v_pk_fma_f32 v[58:59], v[58:59], s[78:79], v[64:65]
    v_pk_fma_f32 v[60:61], v[60:61], s[78:79], v[64:65]
    v_pk_fma_f32 v[62:63], v[62:63], s[78:79], v[64:65]
    v_pk_mul_f32 v[56:57], v[56:57], v[136:137]
    v_pk_mul_f32 v[58:59], v[58:59], v[138:139]
    v_pk_mul_f32 v[60:61], v[60:61], v[140:141]
    v_pk_mul_f32 v[62:63], v[62:63], v[142:143]
    v_exp_f32 v56, v56
    v_exp_f32 v57, v57
    v_exp_f32 v58, v58
    v_exp_f32 v59, v59
    v_exp_f32 v60, v60
    v_exp_f32 v61, v61
    v_exp_f32 v62, v62
    v_exp_f32 v63, v63
    v_pk_add_f32 v[56:57], v[56:57], v[66:67]
    v_pk_add_f32 v[58:59], v[58:59], v[66:67]
    v_pk_add_f32 v[60:61], v[60:61], v[66:67]
    v_pk_add_f32 v[62:63], v[62:63], v[66:67]
    v_rcp_f32 v56, v56
    v_rcp_f32 v57, v57
    v_rcp_f32 v58, v58
    v_rcp_f32 v59, v59
    v_rcp_f32 v60, v60
    v_rcp_f32 v61, v61
    v_rcp_f32 v62, v62
    v_rcp_f32 v63, v63
    v_pk_mul_f32 v[136:137], v[136:137], v[56:57]
    v_pk_mul_f32 v[138:139], v[138:139], v[58:59]
    v_pk_mul_f32 v[140:141], v[140:141], v[60:61]
    v_pk_mul_f32 v[142:143], v[142:143], v[62:63]
    v_cvt_pk_bf16_f32 v136, v136, v137
    v_cvt_pk_bf16_f32 v137, v138, v139
    v_cvt_pk_bf16_f32 v138, v140, v141
    v_cvt_pk_bf16_f32 v139, v142, v143
    s_nop 1
    v_permlane16_swap_b32 v136, v138
    v_permlane16_swap_b32 v137, v139
    v_pk_add_f32 v[160:161], v[160:161], v[224:225]
    v_pk_add_f32 v[162:163], v[162:163], v[226:227]
    v_pk_add_f32 v[164:165], v[164:165], v[228:229]
    v_pk_add_f32 v[166:167], v[166:167], v[230:231]
    v_pk_mul_f32 v[48:49], v[160:161], v[160:161]
    v_pk_mul_f32 v[50:51], v[162:163], v[162:163]
    v_pk_mul_f32 v[52:53], v[164:165], v[164:165]
    v_pk_mul_f32 v[54:55], v[166:167], v[166:167]
    v_pk_fma_f32 v[48:49], v[48:49], s[78:79], v[64:65]
    v_pk_fma_f32 v[50:51], v[50:51], s[78:79], v[64:65]
    v_pk_fma_f32 v[52:53], v[52:53], s[78:79], v[64:65]
    v_pk_fma_f32 v[54:55], v[54:55], s[78:79], v[64:65]
    v_pk_mul_f32 v[48:49], v[48:49], v[160:161]
    v_pk_mul_f32 v[50:51], v[50:51], v[162:163]
    v_pk_mul_f32 v[52:53], v[52:53], v[164:165]
    v_pk_mul_f32 v[54:55], v[54:55], v[166:167]
    v_exp_f32 v48, v48
    v_exp_f32 v49, v49
    v_exp_f32 v50, v50
    v_exp_f32 v51, v51
    v_exp_f32 v52, v52
    v_exp_f32 v53, v53
    v_exp_f32 v54, v54
    v_exp_f32 v55, v55
    v_pk_add_f32 v[48:49], v[48:49], v[66:67]
    v_pk_add_f32 v[50:51], v[50:51], v[66:67]
    v_pk_add_f32 v[52:53], v[52:53], v[66:67]
    v_pk_add_f32 v[54:55], v[54:55], v[66:67]
    v_rcp_f32 v48, v48
    v_rcp_f32 v49, v49
    v_rcp_f32 v50, v50
    v_rcp_f32 v51, v51
    v_rcp_f32 v52, v52
    v_rcp_f32 v53, v53
    v_rcp_f32 v54, v54
    v_rcp_f32 v55, v55
    v_pk_mul_f32 v[160:161], v[160:161], v[48:49]
    v_pk_mul_f32 v[162:163], v[162:163], v[50:51]
    v_pk_mul_f32 v[164:165], v[164:165], v[52:53]
    v_pk_mul_f32 v[166:167], v[166:167], v[54:55]
    v_cvt_pk_bf16_f32 v160, v160, v161
    v_cvt_pk_bf16_f32 v161, v162, v163
    v_cvt_pk_bf16_f32 v162, v164, v165
    v_cvt_pk_bf16_f32 v163, v166, v167
    s_nop 1
    v_permlane16_swap_b32 v160, v162
    v_permlane16_swap_b32 v161, v163
    v_pk_add_f32 v[168:169], v[168:169], v[232:233]
    v_pk_add_f32 v[170:171], v[170:171], v[234:235]
    v_pk_add_f32 v[172:173], v[172:173], v[236:237]
    v_pk_add_f32 v[174:175], v[174:175], v[238:239]
    v_pk_mul_f32 v[56:57], v[168:169], v[168:169]
    v_pk_mul_f32 v[58:59], v[170:171], v[170:171]
    v_pk_mul_f32 v[60:61], v[172:173], v[172:173]
    v_pk_mul_f32 v[62:63], v[174:175], v[174:175]
    v_pk_fma_f32 v[56:57], v[56:57], s[78:79], v[64:65]
    v_pk_fma_f32 v[58:59], v[58:59], s[78:79], v[64:65]
    v_pk_fma_f32 v[60:61], v[60:61], s[78:79], v[64:65]
    v_pk_fma_f32 v[62:63], v[62:63], s[78:79], v[64:65]
    v_pk_mul_f32 v[56:57], v[56:57], v[168:169]
    v_pk_mul_f32 v[58:59], v[58:59], v[170:171]
    v_pk_mul_f32 v[60:61], v[60:61], v[172:173]
    v_pk_mul_f32 v[62:63], v[62:63], v[174:175]
    v_exp_f32 v56, v56
    v_exp_f32 v57, v57
    v_exp_f32 v58, v58
    v_exp_f32 v59, v59
    v_exp_f32 v60, v60
    v_exp_f32 v61, v61
    v_exp_f32 v62, v62
    v_exp_f32 v63, v63
    v_pk_add_f32 v[56:57], v[56:57], v[66:67]
    v_pk_add_f32 v[58:59], v[58:59], v[66:67]
    v_pk_add_f32 v[60:61], v[60:61], v[66:67]
    v_pk_add_f32 v[62:63], v[62:63], v[66:67]
    v_rcp_f32 v56, v56
    v_rcp_f32 v57, v57
    v_rcp_f32 v58, v58
    v_rcp_f32 v59, v59
    v_rcp_f32 v60, v60
    v_rcp_f32 v61, v61
    v_rcp_f32 v62, v62
    v_rcp_f32 v63, v63
    v_pk_mul_f32 v[168:169], v[168:169], v[56:57]
    v_pk_mul_f32 v[170:171], v[170:171], v[58:59]
    v_pk_mul_f32 v[172:173], v[172:173], v[60:61]
    v_pk_mul_f32 v[174:175], v[174:175], v[62:63]
    v_cvt_pk_bf16_f32 v168, v168, v169
    v_cvt_pk_bf16_f32 v169, v170, v171
    v_cvt_pk_bf16_f32 v170, v172, v173
    v_cvt_pk_bf16_f32 v171, v174, v175
    s_nop 1
    v_permlane16_swap_b32 v168, v170
    v_permlane16_swap_b32 v169, v171
    v_pk_add_f32 v[192:193], v[192:193], v[224:225]
    v_pk_add_f32 v[194:195], v[194:195], v[226:227]
    v_pk_add_f32 v[196:197], v[196:197], v[228:229]
    v_pk_add_f32 v[198:199], v[198:199], v[230:231]
    v_pk_mul_f32 v[48:49], v[192:193], v[192:193]
    v_pk_mul_f32 v[50:51], v[194:195], v[194:195]
    v_pk_mul_f32 v[52:53], v[196:197], v[196:197]
    v_pk_mul_f32 v[54:55], v[198:199], v[198:199]
    v_pk_fma_f32 v[48:49], v[48:49], s[78:79], v[64:65]
    v_pk_fma_f32 v[50:51], v[50:51], s[78:79], v[64:65]
    v_pk_fma_f32 v[52:53], v[52:53], s[78:79], v[64:65]
    v_pk_fma_f32 v[54:55], v[54:55], s[78:79], v[64:65]
    v_pk_mul_f32 v[48:49], v[48:49], v[192:193]
    v_pk_mul_f32 v[50:51], v[50:51], v[194:195]
    v_pk_mul_f32 v[52:53], v[52:53], v[196:197]
    v_pk_mul_f32 v[54:55], v[54:55], v[198:199]
    v_exp_f32 v48, v48
    v_exp_f32 v49, v49
    v_exp_f32 v50, v50
    v_exp_f32 v51, v51
    v_exp_f32 v52, v52
    v_exp_f32 v53, v53
    v_exp_f32 v54, v54
    v_exp_f32 v55, v55
    v_pk_add_f32 v[48:49], v[48:49], v[66:67]
    v_pk_add_f32 v[50:51], v[50:51], v[66:67]
    v_pk_add_f32 v[52:53], v[52:53], v[66:67]
    v_pk_add_f32 v[54:55], v[54:55], v[66:67]
    v_rcp_f32 v48, v48
    v_rcp_f32 v49, v49
    v_rcp_f32 v50, v50
    v_rcp_f32 v51, v51
    v_rcp_f32 v52, v52
    v_rcp_f32 v53, v53
    v_rcp_f32 v54, v54
    v_rcp_f32 v55, v55
    v_pk_mul_f32 v[192:193], v[192:193], v[48:49]
    v_pk_mul_f32 v[194:195], v[194:195], v[50:51]
    v_pk_mul_f32 v[196:197], v[196:197], v[52:53]
    v_pk_mul_f32 v[198:199], v[198:199], v[54:55]
    v_cvt_pk_bf16_f32 v192, v192, v193
    v_cvt_pk_bf16_f32 v193, v194, v195
    v_cvt_pk_bf16_f32 v194, v196, v197
    v_cvt_pk_bf16_f32 v195, v198, v199
    s_nop 1
    v_permlane16_swap_b32 v192, v194
    v_permlane16_swap_b32 v193, v195
    v_pk_add_f32 v[200:201], v[200:201], v[232:233]
    v_pk_add_f32 v[202:203], v[202:203], v[234:235]
    v_pk_add_f32 v[204:205], v[204:205], v[236:237]
    v_pk_add_f32 v[206:207], v[206:207], v[238:239]
    v_pk_mul_f32 v[56:57], v[200:201], v[200:201]
    v_pk_mul_f32 v[58:59], v[202:203], v[202:203]
    v_pk_mul_f32 v[60:61], v[204:205], v[204:205]
    v_pk_mul_f32 v[62:63], v[206:207], v[206:207]
    v_pk_fma_f32 v[56:57], v[56:57], s[78:79], v[64:65]
    v_pk_fma_f32 v[58:59], v[58:59], s[78:79], v[64:65]
    v_pk_fma_f32 v[60:61], v[60:61], s[78:79], v[64:65]
    v_pk_fma_f32 v[62:63], v[62:63], s[78:79], v[64:65]
    v_pk_mul_f32 v[56:57], v[56:57], v[200:201]
    v_pk_mul_f32 v[58:59], v[58:59], v[202:203]
    v_pk_mul_f32 v[60:61], v[60:61], v[204:205]
    v_pk_mul_f32 v[62:63], v[62:63], v[206:207]
    v_exp_f32 v56, v56
    v_exp_f32 v57, v57
    v_exp_f32 v58, v58
    v_exp_f32 v59, v59
    v_exp_f32 v60, v60
    v_exp_f32 v61, v61
    v_exp_f32 v62, v62
    v_exp_f32 v63, v63
    v_pk_add_f32 v[56:57], v[56:57], v[66:67]
    v_pk_add_f32 v[58:59], v[58:59], v[66:67]
    v_pk_add_f32 v[60:61], v[60:61], v[66:67]
    v_pk_add_f32 v[62:63], v[62:63], v[66:67]
    v_rcp_f32 v56, v56
    v_rcp_f32 v57, v57
    v_rcp_f32 v58, v58
    v_rcp_f32 v59, v59
    v_rcp_f32 v60, v60
    v_rcp_f32 v61, v61
    v_rcp_f32 v62, v62
    v_rcp_f32 v63, v63
    v_pk_mul_f32 v[200:201], v[200:201], v[56:57]
    v_pk_mul_f32 v[202:203], v[202:203], v[58:59]
    v_pk_mul_f32 v[204:205], v[204:205], v[60:61]
    v_pk_mul_f32 v[206:207], v[206:207], v[62:63]
    v_cvt_pk_bf16_f32 v200, v200, v201
    v_cvt_pk_bf16_f32 v201, v202, v203
    v_cvt_pk_bf16_f32 v202, v204, v205
    v_cvt_pk_bf16_f32 v203, v206, v207
    s_nop 1
    v_permlane16_swap_b32 v200, v202
    v_permlane16_swap_b32 v201, v203
    s_waitcnt vmcnt(0)
    buffer_store_dwordx4 v[96:99], v1, s[64:67], s100 offen offset:0 sc1
    buffer_store_dwordx4 v[104:107], v1, s[64:67], s100 offen offset:1024 sc1
    s_add_u32 s100, s100, 491520
    buffer_store_dwordx4 v[128:131], v1, s[64:67], s100 offen offset:0 sc1
    buffer_store_dwordx4 v[136:139], v1, s[64:67], s100 offen offset:1024 sc1
    s_add_u32 s100, s100, 491520
    buffer_store_dwordx4 v[160:163], v1, s[64:67], s100 offen offset:0 sc1
    buffer_store_dwordx4 v[168:171], v1, s[64:67], s100 offen offset:1024 sc1
    s_add_u32 s100, s100, 491520
    buffer_store_dwordx4 v[192:195], v1, s[64:67], s100 offen offset:0 sc1
    buffer_store_dwordx4 v[200:203], v1, s[64:67], s100 offen offset:1024 sc1
    s_waitcnt lgkmcnt(0)
    s_branch L_pj_fin
L_pj_H0:
    s_waitcnt vmcnt(0) lgkmcnt(0)
L_pj_fin:
    s_cmp_ge_i32 s61, 0
    s_cbranch_scc1 L_pj_help
    s_barrier
    s_mul_i32 s39, s68, s99
    s_lshl_b32 s78, s26, 13
    s_add_u32 s78, s78, 98304
    v_add_u32 v14, s78, v1
    ds_read_b128 v[16:19], v14 offset:0
    ds_read_b128 v[20:23], v14 offset:1024
    ds_read_b128 v[24:27], v14 offset:2048
    ds_read_b128 v[28:31], v14 offset:3072
    ds_read_b128 v[32:35], v14 offset:4096
    ds_read_b128 v[36:39], v14 offset:5120
    ds_read_b128 v[40:43], v14 offset:6144
    ds_read_b128 v[44:47], v14 offset:7168
    s_branch L_at_fast
L_pj_help:
    s_waitcnt vmcnt(0)
    s_barrier
    s_cmp_lg_u32 s69, 4
    s_cbranch_scc1 L_noqh_18
    v_mov_b32 v244, 0
    v_mov_b32 v245, s95
    s_mov_b64 exec, 1
    buffer_store_dword v245, v244, s[88:91], s68 offen sc1
    s_mov_b64 exec, -1
L_noqh_18:
    s_mov_b32 s2, s61
    s_branch L_pj_task
L_at_qblock:
    s_mov_b32 s20, 0
    v_mov_b32 v176, 0
    v_mov_b32 v177, 0
    v_mov_b32 v178, 0
    v_mov_b32 v179, 0
    v_mov_b32 v180, 0
    v_mov_b32 v181, 0
    v_mov_b32 v182, 0
    v_mov_b32 v183, 0
    v_mov_b32 v184, 0
    v_mov_b32 v185, 0
    v_mov_b32 v186, 0
    v_mov_b32 v187, 0
    v_mov_b32 v188, 0
    v_mov_b32 v189, 0
    v_mov_b32 v190, 0
    v_mov_b32 v191, 0
    v_mov_b32 v192, 0
    v_mov_b32 v193, 0
    v_mov_b32 v194, 0
    v_mov_b32 v195, 0
    v_mov_b32 v196, 0
    v_mov_b32 v197, 0
    v_mov_b32 v198, 0
    v_mov_b32 v199, 0
    v_mov_b32 v200, 0
    v_mov_b32 v201, 0
    v_mov_b32 v202, 0
    v_mov_b32 v203, 0
    v_mov_b32 v204, 0
    v_mov_b32 v205, 0
    v_mov_b32 v206, 0
    v_mov_b32 v207, 0
    v_mov_b32 v208, 0
    v_mov_b32 v209, 0
    v_mov_b32 v210, 0
    v_mov_b32 v211, 0
    v_mov_b32 v212, 0
    v_mov_b32 v213, 0
    v_mov_b32 v214, 0
    v_mov_b32 v215, 0
    v_mov_b32 v216, 0
    v_mov_b32 v217, 0
    v_mov_b32 v218, 0
    v_mov_b32 v219, 0
    v_mov_b32 v220, 0
    v_mov_b32 v221, 0
    v_mov_b32 v222, 0
    v_mov_b32 v223, 0
    v_mov_b32 v224, 0
    v_mov_b32 v225, 0
    v_mov_b32 v226, 0
    v_mov_b32 v227, 0
    v_mov_b32 v228, 0
    v_mov_b32 v229, 0
    v_mov_b32 v230, 0
    v_mov_b32 v231, 0
    v_mov_b32 v232, 0
    v_mov_b32 v233, 0
    v_mov_b32 v234, 0
    v_mov_b32 v235, 0
    v_mov_b32 v236, 0
    v_mov_b32 v237, 0
    v_mov_b32 v238, 0
    v_mov_b32 v239, 0
    v_mov_b32 v4, 0
    s_waitcnt vmcnt(8)
    s_barrier
    s_cmp_lg_u32 s37, 0
    s_cbranch_scc1 L_at_first1
    ds_read_b128 v[48:51], v2 offset:0
    ds_read_b128 v[52:55], v2 offset:1024
    ds_read_b128 v[56:59], v2 offset:2048
    ds_read_b128 v[60:63], v2 offset:3072
    ds_read_b128 v[64:67], v2 offset:4096
    ds_read_b128 v[68:71], v2 offset:5120
    ds_read_b128 v[72:75], v2 offset:6144
    ds_read_b128 v[76:79], v2 offset:7168
    s_waitcnt lgkmcnt(7)
    v_mfma_f32_32x32x16_bf16 v[112:127], v[48:51], v[16:19], 0
    s_waitcnt lgkmcnt(6)
    v_mfma_f32_32x32x16_bf16 v[112:127], v[52:55], v[20:23], v[112:127]
    s_waitcnt lgkmcnt(5)
    v_mfma_f32_32x32x16_bf16 v[112:127], v[56:59], v[24:27], v[112:127]
    s_waitcnt lgkmcnt(4)
    v_mfma_f32_32x32x16_bf16 v[112:127], v[60:63], v[28:31], v[112:127]
    s_waitcnt lgkmcnt(3)
    v_mfma_f32_32x32x16_bf16 v[112:127], v[64:67], v[32:35], v[112:127]
    s_waitcnt lgkmcnt(2)
    v_mfma_f32_32x32x16_bf16 v[112:127], v[68:71], v[36:39], v[112:127]
    s_waitcnt lgkmcnt(1)
    v_mfma_f32_32x32x16_bf16 v[112:127], v[72:75], v[40:43], v[112:127]
    s_waitcnt lgkmcnt(0)
    v_mfma_f32_32x32x16_bf16 v[112:127], v[76:79], v[44:47], v[112:127]
    ds_read_b128 v[48:51], v2 offset:8192
    ds_read_b128 v[52:55], v2 offset:9216
    ds_read_b128 v[56:59], v2 offset:10240
    ds_read_b128 v[60:63], v2 offset:11264
    ds_read_b128 v[64:67], v2 offset:12288
    ds_read_b128 v[68:71], v2 offset:13312
    ds_read_b128 v[72:75], v2 offset:14336
    ds_read_b128 v[76:79], v2 offset:15360
    s_nop 7
    s_cmp_lg_u32 s21, 0
    s_cbranch_scc1 L_nomask0_19
    v_cmp_le_i32 s[40:41], 0, v8
    v_cmp_le_i32 s[42:43], 1, v8
    v_cmp_le_i32 s[44:45], 2, v8
    v_cmp_le_i32 s[46:47], 3, v8
    v_cndmask_b32 v112, v9, v112, s[40:41]
    v_cndmask_b32 v113, v9, v113, s[42:43]
    v_cndmask_b32 v114, v9, v114, s[44:45]
    v_cndmask_b32 v115, v9, v115, s[46:47]
    v_cmp_le_i32 s[40:41], 4, v8
    v_cmp_le_i32 s[42:43], 5, v8
    v_cmp_le_i32 s[44:45], 6, v8
    v_cmp_le_i32 s[46:47], 7, v8
    v_cndmask_b32 v116, v9, v116, s[40:41]
    v_cndmask_b32 v117, v9, v117, s[42:43]
    v_cndmask_b32 v118, v9, v118, s[44:45]
    v_cndmask_b32 v119, v9, v119, s[46:47]
    v_cmp_le_i32 s[40:41], 16, v8
    v_cmp_le_i32 s[42:43], 17, v8
    v_cmp_le_i32 s[44:45], 18, v8
    v_cmp_le_i32 s[46:47], 19, v8
    v_cndmask_b32 v120, v9, v120, s[40:41]
    v_cndmask_b32 v121, v9, v121, s[42:43]
    v_cndmask_b32 v122, v9, v122, s[44:45]
    v_cndmask_b32 v123, v9, v123, s[46:47]
    v_cmp_le_i32 s[40:41], 20, v8
    v_cmp_le_i32 s[42:43], 21, v8
    v_cmp_le_i32 s[44:45], 22, v8
    v_cmp_le_i32 s[46:47], 23, v8
    v_cndmask_b32 v124, v9, v124, s[40:41]
    v_cndmask_b32 v125, v9, v125, s[42:43]
    v_cndmask_b32 v126, v9, v126, s[44:45]
    v_cndmask_b32 v127, v9, v127, s[46:47]
L_nomask0_19:
    v_max3_f32 v6, v112, v113, v114
    v_max3_f32 v7, v115, v116, v117
    v_max3_f32 v6, v6, v118, v119
    v_max3_f32 v7, v7, v120, v121
    v_max3_f32 v6, v6, v122, v123
    v_max3_f32 v7, v7, v124, v125
    v_max3_f32 v6, v6, v126, v127
    v_max_f32 v6, v6, v7
    v_mov_b32 v7, v6
    s_nop 1
    v_permlane32_swap_b32 v7, v6
    v_max_f32 v6, v6, v7
    v_sub_f32 v112, v112, v6
    v_sub_f32 v113, v113, v6
    v_sub_f32 v114, v114, v6
    v_sub_f32 v115, v115, v6
    v_sub_f32 v116, v116, v6
    v_sub_f32 v117, v117, v6
    v_sub_f32 v118, v118, v6
    v_sub_f32 v119, v119, v6
    v_sub_f32 v120, v120, v6
    v_sub_f32 v121, v121, v6
    v_sub_f32 v122, v122, v6
    v_sub_f32 v123, v123, v6
    v_sub_f32 v124, v124, v6
    v_sub_f32 v125, v125, v6
    v_sub_f32 v126, v126, v6
    v_sub_f32 v127, v127, v6
    v_sub_f32 v144, 0, v6
    v_sub_f32 v145, 0, v6
    v_sub_f32 v146, 0, v6
    v_sub_f32 v147, 0, v6
    v_sub_f32 v148, 0, v6
    v_sub_f32 v149, 0, v6
    v_sub_f32 v150, 0, v6
    v_sub_f32 v151, 0, v6
    v_sub_f32 v152, 0, v6
    v_sub_f32 v153, 0, v6
    v_sub_f32 v154, 0, v6
    v_sub_f32 v155, 0, v6
    v_sub_f32 v156, 0, v6
    v_sub_f32 v157, 0, v6
    v_sub_f32 v158, 0, v6
    v_sub_f32 v159, 0, v6
    s_waitcnt lgkmcnt(0) vmcnt(0)
    s_barrier
    s_cmp_lg_u32 s32, 0
    s_cbranch_scc1 L_ph1_20
    s_cmp_lg_u32 s24, 0
    s_cbranch_scc1 L_nofl_22
    s_lshl_b32 s36, s38, 2
    v_mov_b32 v12, 5120
    v_mov_b32 v13, s95
    s_mov_b64 exec, 1
    buffer_store_dword v13, v12, s[52:55], s36 offen sc1
    s_mov_b64 exec, -1
L_nofl_22:
    s_branch L_ph2_21
L_ph1_20:
    s_sub_u32 s35, 15, s34
    s_lshl_b32 s35, s35, 5
    s_add_u32 s35, s35, s33
    s_cmp_lg_u32 s24, 0
    s_cbranch_scc1 L_nofl_23
    s_lshl_b32 s36, s35, 2
    v_mov_b32 v12, 6144
    v_mov_b32 v13, s95
    s_mov_b64 exec, 1
    buffer_store_dword v13, v12, s[52:55], s36 offen sc1
    s_mov_b64 exec, -1
    s_movk_i32 s36, 5120
    buffer_load_dwordx4 v[240:243], v1, s[52:55], s36 offen sc1
L_nofl_23:
    s_load_dwordx2 s[74:75], s[0:1], 40
    s_load_dwordx2 s[72:73], s[0:1], 72
    s_bfe_u32 s64, s93, 0x20001
    s_and_b32 s65, s93, 1
    s_lshr_b32 s66, s93, 6
    s_lshl2_add_u32 s65, s65, s66
    s_bfe_u32 s66, s93, 0x30003
    v_bfe_u32 v251, v0, 3, 1
    v_lshl_add_u32 v251, s65, 1, v251
    v_sub_u32 v246, 15, v251
    v_min_u32 v251, v251, v246
    v_and_b32 v246, 7, v0
    v_min_u32 v246, 6, v246
    v_lshl_add_u32 v246, v251, 5, v246
    s_mul_i32 s67, s64, 7
    v_add_u32 v246, s67, v246
    v_lshlrev_b32 v246, 2, v246
    v_add_u32 v246, 4096, v246
    buffer_load_dword v251, v246, s[52:55], 0 offen sc1
    s_waitcnt lgkmcnt(0)
L_ph2_21:
L_at_loop:
    s_cmp_eq_u32 s20, s21
    s_cbranch_scc1 L_at_last0
    v_mfma_f32_32x32x16_bf16 v[128:143], v[48:51], v[16:19], v[144:159]
    ds_read_b128 v[80:83], v3 offset:0
    ds_read_b128 v[84:87], v3 offset:2048
    v_exp_f32 v168, v112
    v_exp_f32 v169, v113
    v_exp_f32 v170, v114
    v_exp_f32 v171, v115
    v_mfma_f32_32x32x16_bf16 v[128:143], v[52:55], v[20:23], v[128:143]
    ds_read_b128 v[88:91], v3 offset:4096
    ds_read_b128 v[92:95], v3 offset:6144
    v_cvt_pk_bf16_f32 v160, v168, v169
    v_add_f32 v174, v168, v169
    v_exp_f32 v172, v116
    v_exp_f32 v173, v117
    s_mov_b32 m0, s30
    s_nop 0
    buffer_load_dwordx4 v10, s[8:11], s23 offen offset:0 lds
    v_mfma_f32_32x32x16_bf16 v[128:143], v[56:59], v[24:27], v[128:143]
    ds_read_b128 v[96:99], v3 offset:1024
    ds_read_b128 v[100:103], v3 offset:3072
    v_cvt_pk_bf16_f32 v161, v170, v171
    v_add_f32 v174, v174, v170
    v_add_f32 v174, v174, v171
    buffer_load_dwordx4 v10, s[8:11], s23 offen offset:1024 lds
    v_mfma_f32_32x32x16_bf16 v[128:143], v[60:63], v[28:31], v[128:143]
    ds_read_b128 v[104:107], v3 offset:5120
    ds_read_b128 v[108:111], v3 offset:7168
    v_exp_f32 v168, v118
    v_exp_f32 v169, v119
    v_cvt_pk_bf16_f32 v162, v172, v173
    v_add_f32 v174, v174, v172
    v_mfma_f32_32x32x16_bf16 v[128:143], v[64:67], v[32:35], v[128:143]
    v_add_f32 v174, v174, v173
    s_nop 0
    v_cvt_pk_bf16_f32 v163, v168, v169
    v_add_f32 v174, v174, v168
    buffer_load_dwordx4 v10, s[8:11], s23 offen offset:2048 lds
    v_mfma_f32_32x32x16_bf16 v[128:143], v[68:71], v[36:39], v[128:143]
    v_add_f32 v174, v174, v169
    v_cmp_nge_f32 vcc, s31, v174
    v_exp_f32 v168, v120
    buffer_load_dwordx4 v10, s[8:11], s23 offen offset:3072 lds
    s_add_u32 s23, s23, 32768
    v_mfma_f32_32x32x16_bf16 v[128:143], v[72:75], v[40:43], v[128:143]
    v_exp_f32 v169, v121
    v_exp_f32 v170, v122
    v_exp_f32 v171, v123
    v_cvt_pk_bf16_f32 v164, v168, v169
    v_mfma_f32_32x32x16_bf16 v[128:143], v[76:79], v[44:47], v[128:143]
    v_add_f32 v175, v168, v169
    v_exp_f32 v172, v124
    v_exp_f32 v173, v125
    s_cbranch_vccnz L_slow_25
L_back_26:
    v_add_f32 v4, v4, v174
    s_nop 0
    s_waitcnt lgkmcnt(7)
    v_mfma_f32_32x32x16_bf16 v[176:191], v[80:83], v[160:163], v[176:191]
    v_cvt_pk_bf16_f32 v165, v170, v171
    v_add_f32 v175, v175, v170
    v_add_f32 v175, v175, v171
    v_exp_f32 v168, v126
    v_exp_f32 v169, v127
    s_waitcnt lgkmcnt(6)
    v_mfma_f32_32x32x16_bf16 v[192:207], v[84:87], v[160:163], v[192:207]
    v_cvt_pk_bf16_f32 v166, v172, v173
    v_add_f32 v175, v175, v172
    v_add_f32 v175, v175, v173
    s_nop 0
    ds_read_b128 v[48:51], v2 offset:32768
    s_waitcnt lgkmcnt(6)
    v_mfma_f32_32x32x16_bf16 v[208:223], v[88:91], v[160:163], v[208:223]
    v_cvt_pk_bf16_f32 v167, v168, v169
    v_add_f32 v175, v175, v168
    v_add_f32 v175, v175, v169
    v_cmp_nge_f32 vcc, s31, v175
    ds_read_b128 v[52:55], v2 offset:33792
    s_waitcnt lgkmcnt(6)
    v_mfma_f32_32x32x16_bf16 v[224:239], v[92:95], v[160:163], v[224:239]
    ds_read_b128 v[56:59], v2 offset:34816
    ds_read_b128 v[60:63], v2 offset:35840
    s_cbranch_vccnz L_slow_27
L_back_28:
    v_add_f32 v4, v4, v175
    s_nop 0
    s_waitcnt lgkmcnt(7)
    v_mfma_f32_32x32x16_bf16 v[176:191], v[96:99], v[164:167], v[176:191]
    ds_read_b128 v[64:67], v2 offset:36864
    ds_read_b128 v[68:71], v2 offset:37888
    ds_read_b128 v[72:75], v2 offset:38912
    s_waitcnt lgkmcnt(9)
    v_mfma_f32_32x32x16_bf16 v[192:207], v[100:103], v[164:167], v[192:207]
    ds_read_b128 v[76:79], v2 offset:39936
    s_add_u32 s35, s20, 2
    s_cmp_gt_u32 s35, s21
    s_cbranch_scc1 L_skipk_24
    s_mov_b32 m0, s27
    s_nop 0
    buffer_load_dwordx4 v10, s[4:7], s22 offen offset:0 lds
    buffer_load_dwordx4 v10, s[4:7], s22 offen offset:1024 lds
    buffer_load_dwordx4 v10, s[4:7], s22 offen offset:2048 lds
    buffer_load_dwordx4 v10, s[4:7], s22 offen offset:3072 lds
    s_add_u32 s22, s22, 32768
L_skipk_24:
    s_waitcnt lgkmcnt(9)
    v_mfma_f32_32x32x16_bf16 v[208:223], v[104:107], v[164:167], v[208:223]
    s_waitcnt lgkmcnt(8)
    v_mfma_f32_32x32x16_bf16 v[224:239], v[108:111], v[164:167], v[224:239]
    s_waitcnt lgkmcnt(7)
    v_mfma_f32_32x32x16_bf16 v[112:127], v[48:51], v[16:19], v[144:159]
    ds_read_b128 v[80:83], v3 offset:8192
    ds_read_b128 v[84:87], v3 offset:10240
    v_exp_f32 v168, v128
    v_exp_f32 v169, v129
    v_exp_f32 v170, v130
    v_exp_f32 v171, v131
    s_waitcnt lgkmcnt(8)
    v_mfma_f32_32x32x16_bf16 v[112:127], v[52:55], v[20:23], v[112:127]
    ds_read_b128 v[88:91], v3 offset:12288
    ds_read_b128 v[92:95], v3 offset:14336
    v_cvt_pk_bf16_f32 v160, v168, v169
    v_add_f32 v174, v168, v169
    v_exp_f32 v172, v132
    v_exp_f32 v173, v133
    s_waitcnt lgkmcnt(9)
    v_mfma_f32_32x32x16_bf16 v[112:127], v[56:59], v[24:27], v[112:127]
    ds_read_b128 v[96:99], v3 offset:9216
    ds_read_b128 v[100:103], v3 offset:11264
    v_cvt_pk_bf16_f32 v161, v170, v171
    v_add_f32 v174, v174, v170
    v_add_f32 v174, v174, v171
    s_waitcnt lgkmcnt(10)
    v_mfma_f32_32x32x16_bf16 v[112:127], v[60:63], v[28:31], v[112:127]
    ds_read_b128 v[104:107], v3 offset:13312
    ds_read_b128 v[108:111], v3 offset:15360
    v_exp_f32 v168, v134
    v_exp_f32 v169, v135
    v_cvt_pk_bf16_f32 v162, v172, v173
    v_add_f32 v174, v174, v172
    s_waitcnt lgkmcnt(11)
    v_mfma_f32_32x32x16_bf16 v[112:127], v[64:67], v[32:35], v[112:127]
    v_add_f32 v174, v174, v173
    s_nop 0
    v_cvt_pk_bf16_f32 v163, v168, v169
    v_add_f32 v174, v174, v168
    s_waitcnt lgkmcnt(10)
    v_mfma_f32_32x32x16_bf16 v[112:127], v[68:71], v[36:39], v[112:127]
    v_add_f32 v174, v174, v169
    v_cmp_nge_f32 vcc, s31, v174
    v_exp_f32 v168, v136
    s_waitcnt lgkmcnt(9)
    v_mfma_f32_32x32x16_bf16 v[112:127], v[72:75], v[40:43], v[112:127]
    v_exp_f32 v169, v137
    v_exp_f32 v170, v138
    v_exp_f32 v171, v139
    v_cvt_pk_bf16_f32 v164, v168, v169
    s_waitcnt lgkmcnt(8)
    v_mfma_f32_32x32x16_bf16 v[112:127], v[76:79], v[44:47], v[112:127]
    v_add_f32 v175, v168, v169
    v_exp_f32 v172, v140
    v_exp_f32 v173, v141
    s_cbranch_vccnz L_slow_29
L_back_30:
    v_add_f32 v4, v4, v174
    s_nop 0
    s_waitcnt lgkmcnt(7)
    v_mfma_f32_32x32x16_bf16 v[176:191], v[80:83], v[160:163], v[176:191]
    v_cvt_pk_bf16_f32 v165, v170, v171
    v_add_f32 v175, v175, v170
    v_add_f32 v175, v175, v171
    v_exp_f32 v168, v142
    v_exp_f32 v169, v143
    s_waitcnt lgkmcnt(6)
    v_mfma_f32_32x32x16_bf16 v[192:207], v[84:87], v[160:163], v[192:207]
    v_cvt_pk_bf16_f32 v166, v172, v173
    v_add_f32 v175, v175, v172
    v_add_f32 v175, v175, v173
    s_nop 0
    ds_read_b128 v[48:51], v2 offset:40960
    s_waitcnt lgkmcnt(6)
    v_mfma_f32_32x32x16_bf16 v[208:223], v[88:91], v[160:163], v[208:223]
    v_cvt_pk_bf16_f32 v167, v168, v169
    v_add_f32 v175, v175, v168
    v_add_f32 v175, v175, v169
    v_cmp_nge_f32 vcc, s31, v175
    ds_read_b128 v[52:55], v2 offset:41984
    s_waitcnt lgkmcnt(6)
    v_mfma_f32_32x32x16_bf16 v[224:239], v[92:95], v[160:163], v[224:239]
    ds_read_b128 v[56:59], v2 offset:43008
    ds_read_b128 v[60:63], v2 offset:44032
    s_cbranch_vccnz L_slow_31
L_back_32:
    v_add_f32 v4, v4, v175
    s_nop 0
    s_waitcnt lgkmcnt(7)
    v_mfma_f32_32x32x16_bf16 v[176:191], v[96:99], v[164:167], v[176:191]
    ds_read_b128 v[64:67], v2 offset:45056
    ds_read_b128 v[68:71], v2 offset:46080
    s_waitcnt lgkmcnt(8)
    v_mfma_f32_32x32x16_bf16 v[192:207], v[100:103], v[164:167], v[192:207]
    ds_read_b128 v[72:75], v2 offset:47104
    ds_read_b128 v[76:79], v2 offset:48128
    s_waitcnt lgkmcnt(9)
    v_mfma_f32_32x32x16_bf16 v[208:223], v[104:107], v[164:167], v[208:223]
    s_add_u32 s35, s20, 1
    s_cmp_lg_u32 s35, s21
    s_cbranch_scc1 L_nomask_33
    v_cmp_le_i32 s[40:41], 0, v8
    v_cmp_le_i32 s[42:43], 1, v8
    v_cmp_le_i32 s[44:45], 2, v8
    v_cmp_le_i32 s[46:47], 3, v8
    v_cndmask_b32 v112, v9, v112, s[40:41]
    v_cndmask_b32 v113, v9, v113, s[42:43]
    v_cndmask_b32 v114, v9, v114, s[44:45]
    v_cndmask_b32 v115, v9, v115, s[46:47]
    v_cmp_le_i32 s[40:41], 4, v8
    v_cmp_le_i32 s[42:43], 5, v8
    v_cmp_le_i32 s[44:45], 6, v8
    v_cmp_le_i32 s[46:47], 7, v8
    v_cndmask_b32 v116, v9, v116, s[40:41]
    v_cndmask_b32 v117, v9, v117, s[42:43]
    v_cndmask_b32 v118, v9, v118, s[44:45]
    v_cndmask_b32 v119, v9, v119, s[46:47]
    v_cmp_le_i32 s[40:41], 16, v8
    v_cmp_le_i32 s[42:43], 17, v8
    v_cmp_le_i32 s[44:45], 18, v8
    v_cmp_le_i32 s[46:47], 19, v8
    v_cndmask_b32 v120, v9, v120, s[40:41]
    v_cndmask_b32 v121, v9, v121, s[42:43]
    v_cndmask_b32 v122, v9, v122, s[44:45]
    v_cndmask_b32 v123, v9, v123, s[46:47]
    v_cmp_le_i32 s[40:41], 20, v8
    v_cmp_le_i32 s[42:43], 21, v8
    v_cmp_le_i32 s[44:45], 22, v8
    v_cmp_le_i32 s[46:47], 23, v8
    v_cndmask_b32 v124, v9, v124, s[40:41]
    v_cndmask_b32 v125, v9, v125, s[42:43]
    v_cndmask_b32 v126, v9, v126, s[44:45]
    v_cndmask_b32 v127, v9, v127, s[46:47]
L_nomask_33:
    s_waitcnt lgkmcnt(8)
    v_mfma_f32_32x32x16_bf16 v[224:239], v[108:111], v[164:167], v[224:239]
    s_waitcnt lgkmcnt(0) vmcnt(0)
    s_barrier
    s_cmp_eq_u32 s39, 0
    s_cbranch_scc1 L_nopend_34
    s_lshr_b32 s35, s39, 2
    s_cmp_lg_u32 s24, 0
    s_cbranch_scc1 L_nofl_35
    s_lshl_b32 s36, s35, 2
    v_mov_b32 v12, 0
    v_mov_b32 v13, s95
    s_mov_b64 exec, 1
    buffer_store_dword v13, v12, s[52:55], s36 offen sc1
    s_mov_b64 exec, -1
L_nofl_35:
    s_mov_b32 s39, 0
L_nopend_34:
    s_add_u32 s20, s20, 1
L_at_loop1:
    s_cmp_eq_u32 s20, s21
    s_cbranch_scc1 L_at_last1
    v_mfma_f32_32x32x16_bf16 v[128:143], v[48:51], v[16:19], v[144:159]
    ds_read_b128 v[80:83], v3 offset:32768
    ds_read_b128 v[84:87], v3 offset:34816
    v_exp_f32 v168, v112
    v_exp_f32 v169, v113
    v_exp_f32 v170, v114
    v_exp_f32 v171, v115
    v_mfma_f32_32x32x16_bf16 v[128:143], v[52:55], v[20:23], v[128:143]
    ds_read_b128 v[88:91], v3 offset:36864
    ds_read_b128 v[92:95], v3 offset:38912
    v_cvt_pk_bf16_f32 v160, v168, v169
    v_add_f32 v174, v168, v169
    v_exp_f32 v172, v116
    v_exp_f32 v173, v117
    s_mov_b32 m0, s29
    s_nop 0
    buffer_load_dwordx4 v10, s[8:11], s23 offen offset:0 lds
    v_mfma_f32_32x32x16_bf16 v[128:143], v[56:59], v[24:27], v[128:143]
    ds_read_b128 v[96:99], v3 offset:33792
    ds_read_b128 v[100:103], v3 offset:35840
    v_cvt_pk_bf16_f32 v161, v170, v171
    v_add_f32 v174, v174, v170
    v_add_f32 v174, v174, v171
    buffer_load_dwordx4 v10, s[8:11], s23 offen offset:1024 lds
    v_mfma_f32_32x32x16_bf16 v[128:143], v[60:63], v[28:31], v[128:143]
    ds_read_b128 v[104:107], v3 offset:37888
    ds_read_b128 v[108:111], v3 offset:39936
    v_exp_f32 v168, v118
    v_exp_f32 v169, v119
    v_cvt_pk_bf16_f32 v162, v172, v173
    v_add_f32 v174, v174, v172
    v_mfma_f32_32x32x16_bf16 v[128:143], v[64:67], v[32:35], v[128:143]
    v_add_f32 v174, v174, v173
    s_nop 0
    v_cvt_pk_bf16_f32 v163, v168, v169
    v_add_f32 v174, v174, v168
    buffer_load_dwordx4 v10, s[8:11], s23 offen offset:2048 lds
    v_mfma_f32_32x32x16_bf16 v[128:143], v[68:71], v[36:39], v[128:143]
    v_add_f32 v174, v174, v169
    v_cmp_nge_f32 vcc, s31, v174
    v_exp_f32 v168, v120
    buffer_load_dwordx4 v10, s[8:11], s23 offen offset:3072 lds
    s_add_u32 s23, s23, 32768
    v_mfma_f32_32x32x16_bf16 v[128:143], v[72:75], v[40:43], v[128:143]
    v_exp_f32 v169, v121
    v_exp_f32 v170, v122
    v_exp_f32 v171, v123
    v_cvt_pk_bf16_f32 v164, v168, v169
    v_mfma_f32_32x32x16_bf16 v[128:143], v[76:79], v[44:47], v[128:143]
    v_add_f32 v175, v168, v169
    v_exp_f32 v172, v124
    v_exp_f32 v173, v125
    s_cbranch_vccnz L_slow_37
L_back_38:
    v_add_f32 v4, v4, v174
    s_nop 0
    s_waitcnt lgkmcnt(7)
    v_mfma_f32_32x32x16_bf16 v[176:191], v[80:83], v[160:163], v[176:191]
    v_cvt_pk_bf16_f32 v165, v170, v171
    v_add_f32 v175, v175, v170
    v_add_f32 v175, v175, v171
    v_exp_f32 v168, v126
    v_exp_f32 v169, v127
    s_waitcnt lgkmcnt(6)
    v_mfma_f32_32x32x16_bf16 v[192:207], v[84:87], v[160:163], v[192:207]
    v_cvt_pk_bf16_f32 v166, v172, v173
    v_add_f32 v175, v175, v172
    v_add_f32 v175, v175, v173
    s_nop 0
    ds_read_b128 v[48:51], v2 offset:0
    s_waitcnt lgkmcnt(6)
    v_mfma_f32_32x32x16_bf16 v[208:223], v[88:91], v[160:163], v[208:223]
    v_cvt_pk_bf16_f32 v167, v168, v169
    v_add_f32 v175, v175, v168
    v_add_f32 v175, v175, v169
    v_cmp_nge_f32 vcc, s31, v175
    ds_read_b128 v[52:55], v2 offset:1024
    s_waitcnt lgkmcnt(6)
    v_mfma_f32_32x32x16_bf16 v[224:239], v[92:95], v[160:163], v[224:239]
    ds_read_b128 v[56:59], v2 offset:2048
    ds_read_b128 v[60:63], v2 offset:3072
    s_cbranch_vccnz L_slow_39
L_back_40:
    v_add_f32 v4, v4, v175
    s_nop 0
    s_waitcnt lgkmcnt(7)
    v_mfma_f32_32x32x16_bf16 v[176:191], v[96:99], v[164:167], v[176:191]
    ds_read_b128 v[64:67], v2 offset:4096
    ds_read_b128 v[68:71], v2 offset:5120
    ds_read_b128 v[72:75], v2 offset:6144
    s_waitcnt lgkmcnt(9)
    v_mfma_f32_32x32x16_bf16 v[192:207], v[100:103], v[164:167], v[192:207]
    ds_read_b128 v[76:79], v2 offset:7168
    s_add_u32 s35, s20, 2
    s_cmp_gt_u32 s35, s21
    s_cbranch_scc1 L_skipk_36
    s_mov_b32 m0, s28
    s_nop 0
    buffer_load_dwordx4 v10, s[4:7], s22 offen offset:0 lds
    buffer_load_dwordx4 v10, s[4:7], s22 offen offset:1024 lds
    buffer_load_dwordx4 v10, s[4:7], s22 offen offset:2048 lds
    buffer_load_dwordx4 v10, s[4:7], s22 offen offset:3072 lds
    s_add_u32 s22, s22, 32768
L_skipk_36:
    s_waitcnt lgkmcnt(9)
    v_mfma_f32_32x32x16_bf16 v[208:223], v[104:107], v[164:167], v[208:223]
    s_waitcnt lgkmcnt(8)
    v_mfma_f32_32x32x16_bf16 v[224:239], v[108:111], v[164:167], v[224:239]
    s_waitcnt lgkmcnt(7)
    v_mfma_f32_32x32x16_bf16 v[112:127], v[48:51], v[16:19], v[144:159]
    ds_read_b128 v[80:83], v3 offset:40960
    ds_read_b128 v[84:87], v3 offset:43008
    v_exp_f32 v168, v128
    v_exp_f32 v169, v129
    v_exp_f32 v170, v130
    v_exp_f32 v171, v131
    s_waitcnt lgkmcnt(8)
    v_mfma_f32_32x32x16_bf16 v[112:127], v[52:55], v[20:23], v[112:127]
    ds_read_b128 v[88:91], v3 offset:45056
    ds_read_b128 v[92:95], v3 offset:47104
    v_cvt_pk_bf16_f32 v160, v168, v169
    v_add_f32 v174, v168, v169
    v_exp_f32 v172, v132
    v_exp_f32 v173, v133
    s_waitcnt lgkmcnt(9)
    v_mfma_f32_32x32x16_bf16 v[112:127], v[56:59], v[24:27], v[112:127]
    ds_read_b128 v[96:99], v3 offset:41984
    ds_read_b128 v[100:103], v3 offset:44032
    v_cvt_pk_bf16_f32 v161, v170, v171
    v_add_f32 v174, v174, v170
    v_add_f32 v174, v174, v171
    s_waitcnt lgkmcnt(10)
    v_mfma_f32_32x32x16_bf16 v[112:127], v[60:63], v[28:31], v[112:127]
    ds_read_b128 v[104:107], v3 offset:46080
    ds_read_b128 v[108:111], v3 offset:48128
    v_exp_f32 v168, v134
    v_exp_f32 v169, v135
    v_cvt_pk_bf16_f32 v162, v172, v173
    v_add_f32 v174, v174, v172
    s_waitcnt lgkmcnt(11)
    v_mfma_f32_32x32x16_bf16 v[112:127], v[64:67], v[32:35], v[112:127]
    v_add_f32 v174, v174, v173
    s_nop 0
    v_cvt_pk_bf16_f32 v163, v168, v169
    v_add_f32 v174, v174, v168
    s_waitcnt lgkmcnt(10)
    v_mfma_f32_32x32x16_bf16 v[112:127], v[68:71], v[36:39], v[112:127]
    v_add_f32 v174, v174, v169
    v_cmp_nge_f32 vcc, s31, v174
    v_exp_f32 v168, v136
    s_waitcnt lgkmcnt(9)
    v_mfma_f32_32x32x16_bf16 v[112:127], v[72:75], v[40:43], v[112:127]
    v_exp_f32 v169, v137
    v_exp_f32 v170, v138
    v_exp_f32 v171, v139
    v_cvt_pk_bf16_f32 v164, v168, v169
    s_waitcnt lgkmcnt(8)
    v_mfma_f32_32x32x16_bf16 v[112:127], v[76:79], v[44:47], v[112:127]
    v_add_f32 v175, v168, v169
    v_exp_f32 v172, v140
    v_exp_f32 v173, v141
    s_cbranch_vccnz L_slow_41
L_back_42:
    v_add_f32 v4, v4, v174
    s_nop 0
    s_waitcnt lgkmcnt(7)
    v_mfma_f32_32x32x16_bf16 v[176:191], v[80:83], v[160:163], v[176:191]
    v_cvt_pk_bf16_f32 v165, v170, v171
    v_add_f32 v175, v175, v170
    v_add_f32 v175, v175, v171
    v_exp_f32 v168, v142
    v_exp_f32 v169, v143
    s_waitcnt lgkmcnt(6)
    v_mfma_f32_32x32x16_bf16 v[192:207], v[84:87], v[160:163], v[192:207]
    v_cvt_pk_bf16_f32 v166, v172, v173
    v_add_f32 v175, v175, v172
    v_add_f32 v175, v175, v173
    s_nop 0
    ds_read_b128 v[48:51], v2 offset:8192
    s_waitcnt lgkmcnt(6)
    v_mfma_f32_32x32x16_bf16 v[208:223], v[88:91], v[160:163], v[208:223]
    v_cvt_pk_bf16_f32 v167, v168, v169
    v_add_f32 v175, v175, v168
    v_add_f32 v175, v175, v169
    v_cmp_nge_f32 vcc, s31, v175
    ds_read_b128 v[52:55], v2 offset:9216
    s_waitcnt lgkmcnt(6)
    v_mfma_f32_32x32x16_bf16 v[224:239], v[92:95], v[160:163], v[224:239]
    ds_read_b128 v[56:59], v2 offset:10240
    ds_read_b128 v[60:63], v2 offset:11264
    s_cbranch_vccnz L_slow_43
L_back_44:
    v_add_f32 v4, v4, v175
    s_nop 0
    s_waitcnt lgkmcnt(7)
    v_mfma_f32_32x32x16_bf16 v[176:191], v[96:99], v[164:167], v[176:191]
    ds_read_b128 v[64:67], v2 offset:12288
    ds_read_b128 v[68:71], v2 offset:13312
    s_waitcnt lgkmcnt(8)
    v_mfma_f32_32x32x16_bf16 v[192:207], v[100:103], v[164:167], v[192:207]
    ds_read_b128 v[72:75], v2 offset:14336
    ds_read_b128 v[76:79], v2 offset:15360
    s_waitcnt lgkmcnt(9)
    v_mfma_f32_32x32x16_bf16 v[208:223], v[104:107], v[164:167], v[208:223]
    s_add_u32 s35, s20, 1
    s_cmp_lg_u32 s35, s21
    s_cbranch_scc1 L_nomask_45
    v_cmp_le_i32 s[40:41], 0, v8
    v_cmp_le_i32 s[42:43], 1, v8
    v_cmp_le_i32 s[44:45], 2, v8
    v_cmp_le_i32 s[46:47], 3, v8
    v_cndmask_b32 v112, v9, v112, s[40:41]
    v_cndmask_b32 v113, v9, v113, s[42:43]
    v_cndmask_b32 v114, v9, v114, s[44:45]
    v_cndmask_b32 v115, v9, v115, s[46:47]
    v_cmp_le_i32 s[40:41], 4, v8
    v_cmp_le_i32 s[42:43], 5, v8
    v_cmp_le_i32 s[44:45], 6, v8
    v_cmp_le_i32 s[46:47], 7, v8
    v_cndmask_b32 v116, v9, v116, s[40:41]
    v_cndmask_b32 v117, v9, v117, s[42:43]
    v_cndmask_b32 v118, v9, v118, s[44:45]
    v_cndmask_b32 v119, v9, v119, s[46:47]
    v_cmp_le_i32 s[40:41], 16, v8
    v_cmp_le_i32 s[42:43], 17, v8
    v_cmp_le_i32 s[44:45], 18, v8
    v_cmp_le_i32 s[46:47], 19, v8
    v_cndmask_b32 v120, v9, v120, s[40:41]
    v_cndmask_b32 v121, v9, v121, s[42:43]
    v_cndmask_b32 v122, v9, v122, s[44:45]
    v_cndmask_b32 v123, v9, v123, s[46:47]
    v_cmp_le_i32 s[40:41], 20, v8
    v_cmp_le_i32 s[42:43], 21, v8
    v_cmp_le_i32 s[44:45], 22, v8
    v_cmp_le_i32 s[46:47], 23, v8
    v_cndmask_b32 v124, v9, v124, s[40:41]
    v_cndmask_b32 v125, v9, v125, s[42:43]
    v_cndmask_b32 v126, v9, v126, s[44:45]
    v_cndmask_b32 v127, v9, v127, s[46:47]
L_nomask_45:
    s_waitcnt lgkmcnt(8)
    v_mfma_f32_32x32x16_bf16 v[224:239], v[108:111], v[164:167], v[224:239]
    s_waitcnt lgkmcnt(0) vmcnt(0)
    s_barrier
    s_add_u32 s20, s20, 1
    s_branch L_at_loop
L_at_fast:
    s_mov_b32 s20, 0
    v_mov_b32 v176, 0
    v_mov_b32 v177, 0
    v_mov_b32 v178, 0
    v_mov_b32 v179, 0
    v_mov_b32 v180, 0
    v_mov_b32 v181, 0
    v_mov_b32 v182, 0
    v_mov_b32 v183, 0
    v_mov_b32 v184, 0
    v_mov_b32 v185, 0
    v_mov_b32 v186, 0
    v_mov_b32 v187, 0
    v_mov_b32 v188, 0
    v_mov_b32 v189, 0
    v_mov_b32 v190, 0
    v_mov_b32 v191, 0
    v_mov_b32 v192, 0
    v_mov_b32 v193, 0
    v_mov_b32 v194, 0
    v_mov_b32 v195, 0
    v_mov_b32 v196, 0
    v_mov_b32 v197, 0
    v_mov_b32 v198, 0
    v_mov_b32 v199, 0
    v_mov_b32 v200, 0
    v_mov_b32 v201, 0
    v_mov_b32 v202, 0
    v_mov_b32 v203, 0
    v_mov_b32 v204, 0
    v_mov_b32 v205, 0
    v_mov_b32 v206, 0
    v_mov_b32 v207, 0
    v_mov_b32 v208, 0
    v_mov_b32 v209, 0
    v_mov_b32 v210, 0
    v_mov_b32 v211, 0
    v_mov_b32 v212, 0
    v_mov_b32 v213, 0
    v_mov_b32 v214, 0
    v_mov_b32 v215, 0
    v_mov_b32 v216, 0
    v_mov_b32 v217, 0
    v_mov_b32 v218, 0
    v_mov_b32 v219, 0
    v_mov_b32 v220, 0
    v_mov_b32 v221, 0
    v_mov_b32 v222, 0
    v_mov_b32 v223, 0
    v_mov_b32 v224, 0
    v_mov_b32 v225, 0
    v_mov_b32 v226, 0
    v_mov_b32 v227, 0
    v_mov_b32 v228, 0
    v_mov_b32 v229, 0
    v_mov_b32 v230, 0
    v_mov_b32 v231, 0
    v_mov_b32 v232, 0
    v_mov_b32 v233, 0
    v_mov_b32 v234, 0
    v_mov_b32 v235, 0
    v_mov_b32 v236, 0
    v_mov_b32 v237, 0
    v_mov_b32 v238, 0
    v_mov_b32 v239, 0
    v_mov_b32 v4, 0
    s_waitcnt lgkmcnt(0)
    ds_read_b128 v[48:51], v2 offset:0
    ds_read_b128 v[52:55], v2 offset:1024
    ds_read_b128 v[56:59], v2 offset:2048
    ds_read_b128 v[60:63], v2 offset:3072
    ds_read_b128 v[64:67], v2 offset:4096
    ds_read_b128 v[68:71], v2 offset:5120
    ds_read_b128 v[72:75], v2 offset:6144
    ds_read_b128 v[76:79], v2 offset:7168
    s_waitcnt lgkmcnt(7)
    v_mfma_f32_32x32x16_bf16 v[112:127], v[48:51], v[16:19], 0
    s_waitcnt lgkmcnt(6)
    v_mfma_f32_32x32x16_bf16 v[112:127], v[52:55], v[20:23], v[112:127]
    s_waitcnt lgkmcnt(5)
    v_mfma_f32_32x32x16_bf16 v[112:127], v[56:59], v[24:27], v[112:127]
    s_waitcnt lgkmcnt(4)
    v_mfma_f32_32x32x16_bf16 v[112:127], v[60:63], v[28:31], v[112:127]
    s_waitcnt lgkmcnt(3)
    v_mfma_f32_32x32x16_bf16 v[112:127], v[64:67], v[32:35], v[112:127]
    s_waitcnt lgkmcnt(2)
    v_mfma_f32_32x32x16_bf16 v[112:127], v[68:71], v[36:39], v[112:127]
    s_waitcnt lgkmcnt(1)
    v_mfma_f32_32x32x16_bf16 v[112:127], v[72:75], v[40:43], v[112:127]
    s_waitcnt lgkmcnt(0)
    v_mfma_f32_32x32x16_bf16 v[112:127], v[76:79], v[44:47], v[112:127]
    ds_read_b128 v[48:51], v2 offset:8192
    ds_read_b128 v[52:55], v2 offset:9216
    ds_read_b128 v[56:59], v2 offset:10240
    ds_read_b128 v[60:63], v2 offset:11264
    ds_read_b128 v[64:67], v2 offset:12288
    ds_read_b128 v[68:71], v2 offset:13312
    ds_read_b128 v[72:75], v2 offset:14336
    ds_read_b128 v[76:79], v2 offset:15360
    s_nop 7
    s_cmp_lg_u32 s21, 0
    s_cbranch_scc1 L_nomask0_46
    v_cmp_le_i32 s[40:41], 0, v8
    v_cmp_le_i32 s[42:43], 1, v8
    v_cmp_le_i32 s[44:45], 2, v8
    v_cmp_le_i32 s[46:47], 3, v8
    v_cndmask_b32 v112, v9, v112, s[40:41]
    v_cndmask_b32 v113, v9, v113, s[42:43]
    v_cndmask_b32 v114, v9, v114, s[44:45]
    v_cndmask_b32 v115, v9, v115, s[46:47]
    v_cmp_le_i32 s[40:41], 4, v8
    v_cmp_le_i32 s[42:43], 5, v8
    v_cmp_le_i32 s[44:45], 6, v8
    v_cmp_le_i32 s[46:47], 7, v8
    v_cndmask_b32 v116, v9, v116, s[40:41]
    v_cndmask_b32 v117, v9, v117, s[42:43]
    v_cndmask_b32 v118, v9, v118, s[44:45]
    v_cndmask_b32 v119, v9, v119, s[46:47]
    v_cmp_le_i32 s[40:41], 16, v8
    v_cmp_le_i32 s[42:43], 17, v8
    v_cmp_le_i32 s[44:45], 18, v8
    v_cmp_le_i32 s[46:47], 19, v8
    v_cndmask_b32 v120, v9, v120, s[40:41]
    v_cndmask_b32 v121, v9, v121, s[42:43]
    v_cndmask_b32 v122, v9, v122, s[44:45]
    v_cndmask_b32 v123, v9, v123, s[46:47]
    v_cmp_le_i32 s[40:41], 20, v8
    v_cmp_le_i32 s[42:43], 21, v8
    v_cmp_le_i32 s[44:45], 22, v8
    v_cmp_le_i32 s[46:47], 23, v8
    v_cndmask_b32 v124, v9, v124, s[40:41]
    v_cndmask_b32 v125, v9, v125, s[42:43]
    v_cndmask_b32 v126, v9, v126, s[44:45]
    v_cndmask_b32 v127, v9, v127, s[46:47]
L_nomask0_46:
    v_max3_f32 v6, v112, v113, v114
    v_max3_f32 v7, v115, v116, v117
    v_max3_f32 v6, v6, v118, v119
    v_max3_f32 v7, v7, v120, v121
    v_max3_f32 v6, v6, v122, v123
    v_max3_f32 v7, v7, v124, v125
    v_max3_f32 v6, v6, v126, v127
    v_max_f32 v6, v6, v7
    v_mov_b32 v7, v6
    s_nop 1
    v_permlane32_swap_b32 v7, v6
    v_max_f32 v6, v6, v7
    v_sub_f32 v112, v112, v6
    v_sub_f32 v113, v113, v6
    v_sub_f32 v114, v114, v6
    v_sub_f32 v115, v115, v6
    v_sub_f32 v116, v116, v6
    v_sub_f32 v117, v117, v6
    v_sub_f32 v118, v118, v6
    v_sub_f32 v119, v119, v6
    v_sub_f32 v120, v120, v6
    v_sub_f32 v121, v121, v6
    v_sub_f32 v122, v122, v6
    v_sub_f32 v123, v123, v6
    v_sub_f32 v124, v124, v6
    v_sub_f32 v125, v125, v6
    v_sub_f32 v126, v126, v6
    v_sub_f32 v127, v127, v6
    v_sub_f32 v144, 0, v6
    v_sub_f32 v145, 0, v6
    v_sub_f32 v146, 0, v6
    v_sub_f32 v147, 0, v6
    v_sub_f32 v148, 0, v6
    v_sub_f32 v149, 0, v6
    v_sub_f32 v150, 0, v6
    v_sub_f32 v151, 0, v6
    v_sub_f32 v152, 0, v6
    v_sub_f32 v153, 0, v6
    v_sub_f32 v154, 0, v6
    v_sub_f32 v155, 0, v6
    v_sub_f32 v156, 0, v6
    v_sub_f32 v157, 0, v6
    v_sub_f32 v158, 0, v6
    v_sub_f32 v159, 0, v6
    s_waitcnt lgkmcnt(0) vmcnt(16)
    s_barrier
    s_cmp_lg_u32 s32, 0
    s_cbranch_scc1 L_ph1_47
    s_cmp_lg_u32 s24, 0
    s_cbranch_scc1 L_nofl_49
    s_lshl_b32 s36, s38, 2
    v_mov_b32 v12, 5120
    v_mov_b32 v13, s95
    s_mov_b64 exec, 1
    buffer_store_dword v13, v12, s[52:55], s36 offen sc1
    s_mov_b64 exec, -1
L_nofl_49:
    s_branch L_ph2_48
L_ph1_47:
    s_sub_u32 s35, 15, s34
    s_lshl_b32 s35, s35, 5
    s_add_u32 s35, s35, s33
    s_cmp_lg_u32 s24, 0
    s_cbranch_scc1 L_nofl_50
    s_lshl_b32 s36, s35, 2
    v_mov_b32 v12, 6144
    v_mov_b32 v13, s95
    s_mov_b64 exec, 1
    buffer_store_dword v13, v12, s[52:55], s36 offen sc1
    s_mov_b64 exec, -1
    s_movk_i32 s36, 5120
    buffer_load_dwordx4 v[240:243], v1, s[52:55], s36 offen sc1
L_nofl_50:
    s_load_dwordx2 s[74:75], s[0:1], 40
    s_load_dwordx2 s[72:73], s[0:1], 72
    s_bfe_u32 s64, s93, 0x20001
    s_and_b32 s65, s93, 1
    s_lshr_b32 s66, s93, 6
    s_lshl2_add_u32 s65, s65, s66
    s_bfe_u32 s66, s93, 0x30003
    v_bfe_u32 v251, v0, 3, 1
    v_lshl_add_u32 v251, s65, 1, v251
    v_sub_u32 v246, 15, v251
    v_min_u32 v251, v251, v246
    v_and_b32 v246, 7, v0
    v_min_u32 v246, 6, v246
    v_lshl_add_u32 v246, v251, 5, v246
    s_mul_i32 s67, s64, 7
    v_add_u32 v246, s67, v246
    v_lshlrev_b32 v246, 2, v246
    v_add_u32 v246, 4096, v246
    buffer_load_dword v251, v246, s[52:55], 0 offen sc1
    s_waitcnt lgkmcnt(0)
L_ph2_48:
    s_branch L_at_loop
L_at_first1:
    ds_read_b128 v[48:51], v2 offset:32768
    ds_read_b128 v[52:55], v2 offset:33792
    ds_read_b128 v[56:59], v2 offset:34816
    ds_read_b128 v[60:63], v2 offset:35840
    ds_read_b128 v[64:67], v2 offset:36864
    ds_read_b128 v[68:71], v2 offset:37888
    ds_read_b128 v[72:75], v2 offset:38912
    ds_read_b128 v[76:79], v2 offset:39936
    s_waitcnt lgkmcnt(7)
    v_mfma_f32_32x32x16_bf16 v[112:127], v[48:51], v[16:19], 0
    s_waitcnt lgkmcnt(6)
    v_mfma_f32_32x32x16_bf16 v[112:127], v[52:55], v[20:23], v[112:127]
    s_waitcnt lgkmcnt(5)
    v_mfma_f32_32x32x16_bf16 v[112:127], v[56:59], v[24:27], v[112:127]
    s_waitcnt lgkmcnt(4)
    v_mfma_f32_32x32x16_bf16 v[112:127], v[60:63], v[28:31], v[112:127]
    s_waitcnt lgkmcnt(3)
    v_mfma_f32_32x32x16_bf16 v[112:127], v[64:67], v[32:35], v[112:127]
    s_waitcnt lgkmcnt(2)
    v_mfma_f32_32x32x16_bf16 v[112:127], v[68:71], v[36:39], v[112:127]
    s_waitcnt lgkmcnt(1)
    v_mfma_f32_32x32x16_bf16 v[112:127], v[72:75], v[40:43], v[112:127]
    s_waitcnt lgkmcnt(0)
    v_mfma_f32_32x32x16_bf16 v[112:127], v[76:79], v[44:47], v[112:127]
    ds_read_b128 v[48:51], v2 offset:40960
    ds_read_b128 v[52:55], v2 offset:41984
    ds_read_b128 v[56:59], v2 offset:43008
    ds_read_b128 v[60:63], v2 offset:44032
    ds_read_b128 v[64:67], v2 offset:45056
    ds_read_b128 v[68:71], v2 offset:46080
    ds_read_b128 v[72:75], v2 offset:47104
    ds_read_b128 v[76:79], v2 offset:48128
    s_nop 7
    s_cmp_lg_u32 s21, 0
    s_cbranch_scc1 L_nomask0_51
    v_cmp_le_i32 s[40:41], 0, v8
    v_cmp_le_i32 s[42:43], 1, v8
    v_cmp_le_i32 s[44:45], 2, v8
    v_cmp_le_i32 s[46:47], 3, v8
    v_cndmask_b32 v112, v9, v112, s[40:41]
    v_cndmask_b32 v113, v9, v113, s[42:43]
    v_cndmask_b32 v114, v9, v114, s[44:45]
    v_cndmask_b32 v115, v9, v115, s[46:47]
    v_cmp_le_i32 s[40:41], 4, v8
    v_cmp_le_i32 s[42:43], 5, v8
    v_cmp_le_i32 s[44:45], 6, v8
    v_cmp_le_i32 s[46:47], 7, v8
    v_cndmask_b32 v116, v9, v116, s[40:41]
    v_cndmask_b32 v117, v9, v117, s[42:43]
    v_cndmask_b32 v118, v9, v118, s[44:45]
    v_cndmask_b32 v119, v9, v119, s[46:47]
    v_cmp_le_i32 s[40:41], 16, v8
    v_cmp_le_i32 s[42:43], 17, v8
    v_cmp_le_i32 s[44:45], 18, v8
    v_cmp_le_i32 s[46:47], 19, v8
    v_cndmask_b32 v120, v9, v120, s[40:41]
    v_cndmask_b32 v121, v9, v121, s[42:43]
    v_cndmask_b32 v122, v9, v122, s[44:45]
    v_cndmask_b32 v123, v9, v123, s[46:47]
    v_cmp_le_i32 s[40:41], 20, v8
    v_cmp_le_i32 s[42:43], 21, v8
    v_cmp_le_i32 s[44:45], 22, v8
    v_cmp_le_i32 s[46:47], 23, v8
    v_cndmask_b32 v124, v9, v124, s[40:41]
    v_cndmask_b32 v125, v9, v125, s[42:43]
    v_cndmask_b32 v126, v9, v126, s[44:45]
    v_cndmask_b32 v127, v9, v127, s[46:47]
L_nomask0_51:
    v_max3_f32 v6, v112, v113, v114
    v_max3_f32 v7, v115, v116, v117
    v_max3_f32 v6, v6, v118, v119
    v_max3_f32 v7, v7, v120, v121
    v_max3_f32 v6, v6, v122, v123
    v_max3_f32 v7, v7, v124, v125
    v_max3_f32 v6, v6, v126, v127
    v_max_f32 v6, v6, v7
    v_mov_b32 v7, v6
    s_nop 1
    v_permlane32_swap_b32 v7, v6
    v_max_f32 v6, v6, v7
    v_sub_f32 v112, v112, v6
    v_sub_f32 v113, v113, v6
    v_sub_f32 v114, v114, v6
    v_sub_f32 v115, v115, v6
    v_sub_f32 v116, v116, v6
    v_sub_f32 v117, v117, v6
    v_sub_f32 v118, v118, v6
    v_sub_f32 v119, v119, v6
    v_sub_f32 v120, v120, v6
    v_sub_f32 v121, v121, v6
    v_sub_f32 v122, v122, v6
    v_sub_f32 v123, v123, v6
    v_sub_f32 v124, v124, v6
    v_sub_f32 v125, v125, v6
    v_sub_f32 v126, v126, v6
    v_sub_f32 v127, v127, v6
    v_sub_f32 v144, 0, v6
    v_sub_f32 v145, 0, v6
    v_sub_f32 v146, 0, v6
    v_sub_f32 v147, 0, v6
    v_sub_f32 v148, 0, v6
    v_sub_f32 v149, 0, v6
    v_sub_f32 v150, 0, v6
    v_sub_f32 v151, 0, v6
    v_sub_f32 v152, 0, v6
    v_sub_f32 v153, 0, v6
    v_sub_f32 v154, 0, v6
    v_sub_f32 v155, 0, v6
    v_sub_f32 v156, 0, v6
    v_sub_f32 v157, 0, v6
    v_sub_f32 v158, 0, v6
    v_sub_f32 v159, 0, v6
    s_waitcnt lgkmcnt(0) vmcnt(0)
    s_barrier
    s_cmp_lg_u32 s32, 0
    s_cbranch_scc1 L_ph1_52
    s_cmp_lg_u32 s24, 0
    s_cbranch_scc1 L_nofl_54
    s_lshl_b32 s36, s38, 2
    v_mov_b32 v12, 5120
    v_mov_b32 v13, s95
    s_mov_b64 exec, 1
    buffer_store_dword v13, v12, s[52:55], s36 offen sc1
    s_mov_b64 exec, -1
L_nofl_54:
    s_branch L_ph2_53
L_ph1_52:
    s_sub_u32 s35, 15, s34
    s_lshl_b32 s35, s35, 5
    s_add_u32 s35, s35, s33
    s_cmp_lg_u32 s24, 0
    s_cbranch_scc1 L_nofl_55
    s_lshl_b32 s36, s35, 2
    v_mov_b32 v12, 6144
    v_mov_b32 v13, s95
    s_mov_b64 exec, 1
    buffer_store_dword v13, v12, s[52:55], s36 offen sc1
    s_mov_b64 exec, -1
    s_movk_i32 s36, 5120
    buffer_load_dwordx4 v[240:243], v1, s[52:55], s36 offen sc1
L_nofl_55:
    s_load_dwordx2 s[74:75], s[0:1], 40
    s_load_dwordx2 s[72:73], s[0:1], 72
    s_bfe_u32 s64, s93, 0x20001
    s_and_b32 s65, s93, 1
    s_lshr_b32 s66, s93, 6
    s_lshl2_add_u32 s65, s65, s66
    s_bfe_u32 s66, s93, 0x30003
    v_bfe_u32 v251, v0, 3, 1
    v_lshl_add_u32 v251, s65, 1, v251
    v_sub_u32 v246, 15, v251
    v_min_u32 v251, v251, v246
    v_and_b32 v246, 7, v0
    v_min_u32 v246, 6, v246
    v_lshl_add_u32 v246, v251, 5, v246
    s_mul_i32 s67, s64, 7
    v_add_u32 v246, s67, v246
    v_lshlrev_b32 v246, 2, v246
    v_add_u32 v246, 4096, v246
    buffer_load_dword v251, v246, s[52:55], 0 offen sc1
    s_waitcnt lgkmcnt(0)
L_ph2_53:
    s_branch L_at_loop1
L_at_last0:
    v_mfma_f32_32x32x16_bf16 v[128:143], v[48:51], v[16:19], v[144:159]
    ds_read_b128 v[80:83], v3 offset:0
    ds_read_b128 v[84:87], v3 offset:2048
    v_exp_f32 v168, v112
    v_exp_f32 v169, v113
    v_exp_f32 v170, v114
    v_exp_f32 v171, v115
    v_mfma_f32_32x32x16_bf16 v[128:143], v[52:55], v[20:23], v[128:143]
    ds_read_b128 v[88:91], v3 offset:4096
    ds_read_b128 v[92:95], v3 offset:6144
    v_cvt_pk_bf16_f32 v160, v168, v169
    v_add_f32 v174, v168, v169
    v_exp_f32 v172, v116
    v_exp_f32 v173, v117
    s_cmp_lg_u32 s32, 0
    s_cbranch_scc1 L_nonext_56
    s_mov_b32 s22, 0
    s_mov_b32 s23, 0
    s_mov_b32 m0, s28
    s_nop 0
    buffer_load_dwordx4 v10, s[4:7], s22 offen offset:0 lds
    buffer_load_dwordx4 v10, s[4:7], s22 offen offset:1024 lds
    buffer_load_dwordx4 v10, s[4:7], s22 offen offset:2048 lds
    buffer_load_dwordx4 v10, s[4:7], s22 offen offset:3072 lds
    s_add_u32 s22, s22, 32768
    s_mov_b32 m0, s30
    s_nop 0
    buffer_load_dwordx4 v10, s[8:11], s23 offen offset:0 lds
    buffer_load_dwordx4 v10, s[8:11], s23 offen offset:1024 lds
    buffer_load_dwordx4 v10, s[8:11], s23 offen offset:2048 lds
    buffer_load_dwordx4 v10, s[8:11], s23 offen offset:3072 lds
    s_add_u32 s23, s23, 32768
L_nonext_56:
    v_mfma_f32_32x32x16_bf16 v[128:143], v[56:59], v[24:27], v[128:143]
    ds_read_b128 v[96:99], v3 offset:1024
    ds_read_b128 v[100:103], v3 offset:3072
    v_cvt_pk_bf16_f32 v161, v170, v171
    v_add_f32 v174, v174, v170
    v_add_f32 v174, v174, v171
    v_mfma_f32_32x32x16_bf16 v[128:143], v[60:63], v[28:31], v[128:143]
    ds_read_b128 v[104:107], v3 offset:5120
    ds_read_b128 v[108:111], v3 offset:7168
    v_exp_f32 v168, v118
    v_exp_f32 v169, v119
    v_cvt_pk_bf16_f32 v162, v172, v173
    v_add_f32 v174, v174, v172
    v_mfma_f32_32x32x16_bf16 v[128:143], v[64:67], v[32:35], v[128:143]
    v_add_f32 v174, v174, v173
    s_nop 0
    v_cvt_pk_bf16_f32 v163, v168, v169
    v_add_f32 v174, v174, v168
    v_mfma_f32_32x32x16_bf16 v[128:143], v[68:71], v[36:39], v[128:143]
    v_add_f32 v174, v174, v169
    v_cmp_nge_f32 vcc, s31, v174
    v_exp_f32 v168, v120
    v_mfma_f32_32x32x16_bf16 v[128:143], v[72:75], v[40:43], v[128:143]
    v_exp_f32 v169, v121
    v_exp_f32 v170, v122
    v_exp_f32 v171, v123
    v_cvt_pk_bf16_f32 v164, v168, v169
    v_mfma_f32_32x32x16_bf16 v[128:143], v[76:79], v[44:47], v[128:143]
    v_add_f32 v175, v168, v169
    v_exp_f32 v172, v124
    v_exp_f32 v173, v125
    s_cmp_lg_u32 s32, 0
    s_cbranch_scc1 L_noq_57
    s_lshl_b32 s35, s26, 13
    s_add_u32 s35, s35, 131072
    v_add_u32 v240, s35, v1
    ds_read_b128 v[16:19], v240 offset:0
    ds_read_b128 v[20:23], v240 offset:1024
    ds_read_b128 v[24:27], v240 offset:2048
    ds_read_b128 v[28:31], v240 offset:3072
    ds_read_b128 v[32:35], v240 offset:4096
    ds_read_b128 v[36:39], v240 offset:5120
    ds_read_b128 v[40:43], v240 offset:6144
    ds_read_b128 v[44:47], v240 offset:7168
    s_branch L_noq2_58
L_noq_57:
    s_mov_b64 s[40:41], vcc
    s_mov_b32 s79, 32768
    s_mov_b32 s88, 491520
    s_movk_i32 s89, 2048
    s_movk_i32 s86, 4096
    s_mov_b32 s87, 131072
    s_mul_i32 s84, s64, 57344
    s_add_u32 s84, s84, 262144
    s_mul_i32 s85, s64, 1835008
    s_mul_i32 s96, s24, 4096
    s_add_u32 s96, s96, 0
    s_xor_b32 s96, s96, s79
    s_mul_i32 s99, s24, 2048
    s_add_u32 s99, s99, 65536
    s_xor_b32 s99, s99, s79
    s_mul_i32 s97, s24, 4096
    s_add_u32 s97, s97, 32768
    s_xor_b32 s97, s97, s79
    s_mul_i32 s100, s24, 2048
    s_add_u32 s100, s100, 81920
    s_xor_b32 s100, s100, s79
    s_mul_i32 s98, s24, 4096
    s_add_u32 s98, s98, 98304
    s_xor_b32 s98, s98, s79
    s_mul_i32 s101, s24, 2048
    s_add_u32 s101, s101, 131072
    s_mul_i32 s92, s24, s88
    v_add_u32 v248, s92, v1
    s_mul_i32 s92, s24, 8
    v_and_b32 v253, 63, v0
    v_lshrrev_b32 v252, 4, v253
    v_add_u32 v252, s92, v252
    v_and_b32 v253, 15, v253
    v_add_u32 v254, 0, v252
    v_and_b32 v255, 3, v254
    v_lshlrev_b32 v255, 2, v255
    v_bfe_u32 v249, v254, 3, 1
    v_lshl_or_b32 v255, v249, 1, v255
    v_xor_b32 v255, v255, v253
    v_mul_lo_u32 v254, v254, s89
    v_lshl_add_u32 v254, v255, 4, v254
    v_subrev_u32 v249, 0, v254
    v_add_u32 v254, 4, v252
    v_and_b32 v255, 3, v254
    v_lshlrev_b32 v255, 2, v255
    v_bfe_u32 v250, v254, 3, 1
    v_lshl_or_b32 v255, v250, 1, v255
    v_xor_b32 v255, v255, v253
    v_mul_lo_u32 v254, v254, s89
    v_lshl_add_u32 v254, v255, 4, v254
    v_subrev_u32 v250, 1024, v254
    s_mul_i32 s67, s65, 3932160
    s_sub_u32 s68, 31457280, s67
    s_add_u32 s67, s67, 54525952
    s_add_u32 s56, s48, s67
    s_addc_u32 s57, s49, 0
    s_mov_b32 s58, s68
    s_mov_b32 s59, 0x00020000
    s_lshl_b32 s67, s66, 8
    s_sub_u32 s68, 7340032, s67
    s_add_u32 s60, s72, s67
    s_addc_u32 s61, s73, 0
    s_mov_b32 s62, s68
    s_mov_b32 s63, 0x00020000
    s_mov_b32 s77, 0
    s_waitcnt vmcnt(0)
    v_cmp_ne_u32 vcc, s95, v251
    s_cbranch_vccnz L_noearly_59
    s_mov_b32 m0, s99
    s_nop 0
    buffer_load_dwordx4 v249, s[60:63], s85 offen offset:0 lds
    buffer_load_dwordx4 v250, s[60:63], s85 offen offset:1024 lds
    s_add_u32 s85, s85, s87
    s_mov_b32 m0, s96
    s_nop 0
    buffer_load_dwordx4 v248, s[56:59], s84 offen offset:0 lds
    buffer_load_dwordx4 v248, s[56:59], s84 offen offset:1024 lds
    buffer_load_dwordx4 v248, s[56:59], s84 offen offset:2048 lds
    buffer_load_dwordx4 v248, s[56:59], s84 offen offset:3072 lds
    s_add_u32 s84, s84, s86
    s_mov_b32 m0, s100
    s_nop 0
    buffer_load_dwordx4 v249, s[60:63], s85 offen offset:0 lds
    buffer_load_dwordx4 v250, s[60:63], s85 offen offset:1024 lds
    s_add_u32 s85, s85, s87
    s_mov_b32 s77, 1
L_noearly_59:
    s_mov_b64 vcc, s[40:41]
L_noq2_58:
    s_cbranch_vccnz L_slow_60
L_back_61:
    v_add_f32 v4, v4, v174
    s_nop 0
    s_waitcnt lgkmcnt(7)
    v_mfma_f32_32x32x16_bf16 v[176:191], v[80:83], v[160:163], v[176:191]
    v_cvt_pk_bf16_f32 v165, v170, v171
    v_add_f32 v175, v175, v170
    v_add_f32 v175, v175, v171
    v_exp_f32 v168, v126
    v_exp_f32 v169, v127
    s_waitcnt lgkmcnt(6)
    v_mfma_f32_32x32x16_bf16 v[192:207], v[84:87], v[160:163], v[192:207]
    v_cvt_pk_bf16_f32 v166, v172, v173
    v_add_f32 v175, v175, v172
    v_add_f32 v175, v175, v173
    s_nop 0
    s_waitcnt lgkmcnt(5)
    v_mfma_f32_32x32x16_bf16 v[208:223], v[88:91], v[160:163], v[208:223]
    v_cvt_pk_bf16_f32 v167, v168, v169
    v_add_f32 v175, v175, v168
    v_add_f32 v175, v175, v169
    v_cmp_nge_f32 vcc, s31, v175
    s_waitcnt lgkmcnt(4)
    v_mfma_f32_32x32x16_bf16 v[224:239], v[92:95], v[160:163], v[224:239]
    s_cbranch_vccnz L_slow_62
L_back_63:
    v_add_f32 v4, v4, v175
    s_nop 0
    s_waitcnt lgkmcnt(3)
    v_mfma_f32_32x32x16_bf16 v[176:191], v[96:99], v[164:167], v[176:191]
    v_cmp_le_i32 s[40:41], 32, v8
    v_cmp_le_i32 s[42:43], 33, v8
    v_cmp_le_i32 s[44:45], 34, v8
    v_cmp_le_i32 s[46:47], 35, v8
    v_cndmask_b32 v128, v9, v128, s[40:41]
    v_cndmask_b32 v129, v9, v129, s[42:43]
    v_cndmask_b32 v130, v9, v130, s[44:45]
    v_cndmask_b32 v131, v9, v131, s[46:47]
    v_cmp_le_i32 s[40:41], 36, v8
    v_cmp_le_i32 s[42:43], 37, v8
    v_cmp_le_i32 s[44:45], 38, v8
    v_cmp_le_i32 s[46:47], 39, v8
    v_cndmask_b32 v132, v9, v132, s[40:41]
    v_cndmask_b32 v133, v9, v133, s[42:43]
    v_cndmask_b32 v134, v9, v134, s[44:45]
    v_cndmask_b32 v135, v9, v135, s[46:47]
    v_cmp_le_i32 s[40:41], 48, v8
    v_cmp_le_i32 s[42:43], 49, v8
    v_cmp_le_i32 s[44:45], 50, v8
    v_cmp_le_i32 s[46:47], 51, v8
    v_cndmask_b32 v136, v9, v136, s[40:41]
    v_cndmask_b32 v137, v9, v137, s[42:43]
    v_cndmask_b32 v138, v9, v138, s[44:45]
    v_cndmask_b32 v139, v9, v139, s[46:47]
    v_cmp_le_i32 s[40:41], 52, v8
    v_cmp_le_i32 s[42:43], 53, v8
    v_cmp_le_i32 s[44:45], 54, v8
    v_cmp_le_i32 s[46:47], 55, v8
    v_cndmask_b32 v140, v9, v140, s[40:41]
    v_cndmask_b32 v141, v9, v141, s[42:43]
    v_cndmask_b32 v142, v9, v142, s[44:45]
    v_cndmask_b32 v143, v9, v143, s[46:47]
    s_waitcnt lgkmcnt(2)
    v_mfma_f32_32x32x16_bf16 v[192:207], v[100:103], v[164:167], v[192:207]
    s_waitcnt lgkmcnt(1)
    v_mfma_f32_32x32x16_bf16 v[208:223], v[104:107], v[164:167], v[208:223]
    s_waitcnt lgkmcnt(0)
    v_mfma_f32_32x32x16_bf16 v[224:239], v[108:111], v[164:167], v[224:239]
    s_waitcnt lgkmcnt(0)
    s_barrier
    ds_read_b128 v[80:83], v3 offset:8192
    ds_read_b128 v[84:87], v3 offset:10240
    v_exp_f32 v168, v128
    v_exp_f32 v169, v129
    v_exp_f32 v170, v130
    v_exp_f32 v171, v131
    ds_read_b128 v[88:91], v3 offset:12288
    ds_read_b128 v[92:95], v3 offset:14336
    v_cvt_pk_bf16_f32 v160, v168, v169
    v_add_f32 v174, v168, v169
    v_exp_f32 v172, v132
    v_exp_f32 v173, v133
    ds_read_b128 v[96:99], v3 offset:9216
    ds_read_b128 v[100:103], v3 offset:11264
    v_cvt_pk_bf16_f32 v161, v170, v171
    v_add_f32 v174, v174, v170
    v_add_f32 v174, v174, v171
    ds_read_b128 v[104:107], v3 offset:13312
    ds_read_b128 v[108:111], v3 offset:15360
    v_exp_f32 v168, v134
    v_exp_f32 v169, v135
    v_cvt_pk_bf16_f32 v162, v172, v173
    v_add_f32 v174, v174, v172
    v_add_f32 v174, v174, v173
    s_nop 0
    v_cvt_pk_bf16_f32 v163, v168, v169
    v_add_f32 v174, v174, v168
    v_add_f32 v174, v174, v169
    v_cmp_nge_f32 vcc, s31, v174
    v_exp_f32 v168, v136
    v_exp_f32 v169, v137
    v_exp_f32 v170, v138
    v_exp_f32 v171, v139
    v_cvt_pk_bf16_f32 v164, v168, v169
    v_add_f32 v175, v168, v169
    v_exp_f32 v172, v140
    v_exp_f32 v173, v141
    s_cbranch_vccnz L_slow_64
L_back_65:
    v_add_f32 v4, v4, v174
    s_nop 0
    s_waitcnt lgkmcnt(7)
    v_mfma_f32_32x32x16_bf16 v[176:191], v[80:83], v[160:163], v[176:191]
    v_cvt_pk_bf16_f32 v165, v170, v171
    v_add_f32 v175, v175, v170
    v_add_f32 v175, v175, v171
    v_exp_f32 v168, v142
    v_exp_f32 v169, v143
    s_waitcnt lgkmcnt(6)
    v_mfma_f32_32x32x16_bf16 v[192:207], v[84:87], v[160:163], v[192:207]
    v_cvt_pk_bf16_f32 v166, v172, v173
    v_add_f32 v175, v175, v172
    v_add_f32 v175, v175, v173
    s_nop 0
    s_waitcnt lgkmcnt(5)
    v_mfma_f32_32x32x16_bf16 v[208:223], v[88:91], v[160:163], v[208:223]
    v_cvt_pk_bf16_f32 v167, v168, v169
    v_add_f32 v175, v175, v168
    v_add_f32 v175, v175, v169
    v_cmp_nge_f32 vcc, s31, v175
    s_waitcnt lgkmcnt(4)
    v_mfma_f32_32x32x16_bf16 v[224:239], v[92:95], v[160:163], v[224:239]
    s_cbranch_vccnz L_slow_66
L_back_67:
    v_add_f32 v4, v4, v175
    s_nop 0
    s_waitcnt lgkmcnt(3)
    v_mfma_f32_32x32x16_bf16 v[176:191], v[96:99], v[164:167], v[176:191]
    s_waitcnt lgkmcnt(2)
    v_mfma_f32_32x32x16_bf16 v[192:207], v[100:103], v[164:167], v[192:207]
    s_waitcnt lgkmcnt(1)
    v_mfma_f32_32x32x16_bf16 v[208:223], v[104:107], v[164:167], v[208:223]
    s_waitcnt lgkmcnt(0)
    v_mfma_f32_32x32x16_bf16 v[224:239], v[108:111], v[164:167], v[224:239]
    s_mov_b32 s37, 1
    s_branch L_at_fin
L_at_last1:
    v_mfma_f32_32x32x16_bf16 v[128:143], v[48:51], v[16:19], v[144:159]
    ds_read_b128 v[80:83], v3 offset:32768
    ds_read_b128 v[84:87], v3 offset:34816
    v_exp_f32 v168, v112
    v_exp_f32 v169, v113
    v_exp_f32 v170, v114
    v_exp_f32 v171, v115
    v_mfma_f32_32x32x16_bf16 v[128:143], v[52:55], v[20:23], v[128:143]
    ds_read_b128 v[88:91], v3 offset:36864
    ds_read_b128 v[92:95], v3 offset:38912
    v_cvt_pk_bf16_f32 v160, v168, v169
    v_add_f32 v174, v168, v169
    v_exp_f32 v172, v116
    v_exp_f32 v173, v117
    s_cmp_lg_u32 s32, 0
    s_cbranch_scc1 L_nonext_68
    s_mov_b32 s22, 0
    s_mov_b32 s23, 0
    s_mov_b32 m0, s27
    s_nop 0
    buffer_load_dwordx4 v10, s[4:7], s22 offen offset:0 lds
    buffer_load_dwordx4 v10, s[4:7], s22 offen offset:1024 lds
    buffer_load_dwordx4 v10, s[4:7], s22 offen offset:2048 lds
    buffer_load_dwordx4 v10, s[4:7], s22 offen offset:3072 lds
    s_add_u32 s22, s22, 32768
    s_mov_b32 m0, s29
    s_nop 0
    buffer_load_dwordx4 v10, s[8:11], s23 offen offset:0 lds
    buffer_load_dwordx4 v10, s[8:11], s23 offen offset:1024 lds
    buffer_load_dwordx4 v10, s[8:11], s23 offen offset:2048 lds
    buffer_load_dwordx4 v10, s[8:11], s23 offen offset:3072 lds
    s_add_u32 s23, s23, 32768
L_nonext_68:
    v_mfma_f32_32x32x16_bf16 v[128:143], v[56:59], v[24:27], v[128:143]
    ds_read_b128 v[96:99], v3 offset:33792
    ds_read_b128 v[100:103], v3 offset:35840
    v_cvt_pk_bf16_f32 v161, v170, v171
    v_add_f32 v174, v174, v170
    v_add_f32 v174, v174, v171
    v_mfma_f32_32x32x16_bf16 v[128:143], v[60:63], v[28:31], v[128:143]
    ds_read_b128 v[104:107], v3 offset:37888
    ds_read_b128 v[108:111], v3 offset:39936
    v_exp_f32 v168, v118
    v_exp_f32 v169, v119
    v_cvt_pk_bf16_f32 v162, v172, v173
    v_add_f32 v174, v174, v172
    v_mfma_f32_32x32x16_bf16 v[128:143], v[64:67], v[32:35], v[128:143]
    v_add_f32 v174, v174, v173
    s_nop 0
    v_cvt_pk_bf16_f32 v163, v168, v169
    v_add_f32 v174, v174, v168
    v_mfma_f32_32x32x16_bf16 v[128:143], v[68:71], v[36:39], v[128:143]
    v_add_f32 v174, v174, v169
    v_cmp_nge_f32 vcc, s31, v174
    v_exp_f32 v168, v120
    v_mfma_f32_32x32x16_bf16 v[128:143], v[72:75], v[40:43], v[128:143]
    v_exp_f32 v169, v121
    v_exp_f32 v170, v122
    v_exp_f32 v171, v123
    v_cvt_pk_bf16_f32 v164, v168, v169
    v_mfma_f32_32x32x16_bf16 v[128:143], v[76:79], v[44:47], v[128:143]
    v_add_f32 v175, v168, v169
    v_exp_f32 v172, v124
    v_exp_f32 v173, v125
    s_cmp_lg_u32 s32, 0
    s_cbranch_scc1 L_noq_69
    s_lshl_b32 s35, s26, 13
    s_add_u32 s35, s35, 131072
    v_add_u32 v240, s35, v1
    ds_read_b128 v[16:19], v240 offset:0
    ds_read_b128 v[20:23], v240 offset:1024
    ds_read_b128 v[24:27], v240 offset:2048
    ds_read_b128 v[28:31], v240 offset:3072
    ds_read_b128 v[32:35], v240 offset:4096
    ds_read_b128 v[36:39], v240 offset:5120
    ds_read_b128 v[40:43], v240 offset:6144
    ds_read_b128 v[44:47], v240 offset:7168
    s_branch L_noq2_70
L_noq_69:
    s_mov_b64 s[40:41], vcc
    s_mov_b32 s79, 0
    s_mov_b32 s88, 491520
    s_movk_i32 s89, 2048
    s_movk_i32 s86, 4096
    s_mov_b32 s87, 131072
    s_mul_i32 s84, s64, 57344
    s_add_u32 s84, s84, 262144
    s_mul_i32 s85, s64, 1835008
    s_mul_i32 s96, s24, 4096
    s_add_u32 s96, s96, 0
    s_xor_b32 s96, s96, s79
    s_mul_i32 s99, s24, 2048
    s_add_u32 s99, s99, 65536
    s_xor_b32 s99, s99, s79
    s_mul_i32 s97, s24, 4096
    s_add_u32 s97, s97, 32768
    s_xor_b32 s97, s97, s79
    s_mul_i32 s100, s24, 2048
    s_add_u32 s100, s100, 81920
    s_xor_b32 s100, s100, s79
    s_mul_i32 s98, s24, 4096
    s_add_u32 s98, s98, 98304
    s_xor_b32 s98, s98, s79
    s_mul_i32 s101, s24, 2048
    s_add_u32 s101, s101, 131072
    s_mul_i32 s92, s24, s88
    v_add_u32 v248, s92, v1
    s_mul_i32 s92, s24, 8
    v_and_b32 v253, 63, v0
    v_lshrrev_b32 v252, 4, v253
    v_add_u32 v252, s92, v252
    v_and_b32 v253, 15, v253
    v_add_u32 v254, 0, v252
    v_and_b32 v255, 3, v254
    v_lshlrev_b32 v255, 2, v255
    v_bfe_u32 v249, v254, 3, 1
    v_lshl_or_b32 v255, v249, 1, v255
    v_xor_b32 v255, v255, v253
    v_mul_lo_u32 v254, v254, s89
    v_lshl_add_u32 v254, v255, 4, v254
    v_subrev_u32 v249, 0, v254
    v_add_u32 v254, 4, v252
    v_and_b32 v255, 3, v254
    v_lshlrev_b32 v255, 2, v255
    v_bfe_u32 v250, v254, 3, 1
    v_lshl_or_b32 v255, v250, 1, v255
    v_xor_b32 v255, v255, v253
    v_mul_lo_u32 v254, v254, s89
    v_lshl_add_u32 v254, v255, 4, v254
    v_subrev_u32 v250, 1024, v254
    s_mul_i32 s67, s65, 3932160
    s_sub_u32 s68, 31457280, s67
    s_add_u32 s67, s67, 54525952
    s_add_u32 s56, s48, s67
    s_addc_u32 s57, s49, 0
    s_mov_b32 s58, s68
    s_mov_b32 s59, 0x00020000
    s_lshl_b32 s67, s66, 8
    s_sub_u32 s68, 7340032, s67
    s_add_u32 s60, s72, s67
    s_addc_u32 s61, s73, 0
    s_mov_b32 s62, s68
    s_mov_b32 s63, 0x00020000
    s_mov_b32 s77, 0
    s_waitcnt vmcnt(0)
    v_cmp_ne_u32 vcc, s95, v251
    s_cbranch_vccnz L_noearly_71
    s_mov_b32 m0, s99
    s_nop 0
    buffer_load_dwordx4 v249, s[60:63], s85 offen offset:0 lds
    buffer_load_dwordx4 v250, s[60:63], s85 offen offset:1024 lds
    s_add_u32 s85, s85, s87
    s_mov_b32 m0, s96
    s_nop 0
    buffer_load_dwordx4 v248, s[56:59], s84 offen offset:0 lds
    buffer_load_dwordx4 v248, s[56:59], s84 offen offset:1024 lds
    buffer_load_dwordx4 v248, s[56:59], s84 offen offset:2048 lds
    buffer_load_dwordx4 v248, s[56:59], s84 offen offset:3072 lds
    s_add_u32 s84, s84, s86
    s_mov_b32 m0, s100
    s_nop 0
    buffer_load_dwordx4 v249, s[60:63], s85 offen offset:0 lds
    buffer_load_dwordx4 v250, s[60:63], s85 offen offset:1024 lds
    s_add_u32 s85, s85, s87
    s_mov_b32 s77, 1
L_noearly_71:
    s_mov_b64 vcc, s[40:41]
L_noq2_70:
    s_cbranch_vccnz L_slow_72
L_back_73:
    v_add_f32 v4, v4, v174
    s_nop 0
    s_waitcnt lgkmcnt(7)
    v_mfma_f32_32x32x16_bf16 v[176:191], v[80:83], v[160:163], v[176:191]
    v_cvt_pk_bf16_f32 v165, v170, v171
    v_add_f32 v175, v175, v170
    v_add_f32 v175, v175, v171
    v_exp_f32 v168, v126
    v_exp_f32 v169, v127
    s_waitcnt lgkmcnt(6)
    v_mfma_f32_32x32x16_bf16 v[192:207], v[84:87], v[160:163], v[192:207]
    v_cvt_pk_bf16_f32 v166, v172, v173
    v_add_f32 v175, v175, v172
    v_add_f32 v175, v175, v173
    s_nop 0
    s_waitcnt lgkmcnt(5)
    v_mfma_f32_32x32x16_bf16 v[208:223], v[88:91], v[160:163], v[208:223]
    v_cvt_pk_bf16_f32 v167, v168, v169
    v_add_f32 v175, v175, v168
    v_add_f32 v175, v175, v169
    v_cmp_nge_f32 vcc, s31, v175
    s_waitcnt lgkmcnt(4)
    v_mfma_f32_32x32x16_bf16 v[224:239], v[92:95], v[160:163], v[224:239]
    s_cbranch_vccnz L_slow_74
L_back_75:
    v_add_f32 v4, v4, v175
    s_nop 0
    s_waitcnt lgkmcnt(3)
    v_mfma_f32_32x32x16_bf16 v[176:191], v[96:99], v[164:167], v[176:191]
    v_cmp_le_i32 s[40:41], 32, v8
    v_cmp_le_i32 s[42:43], 33, v8
    v_cmp_le_i32 s[44:45], 34, v8
    v_cmp_le_i32 s[46:47], 35, v8
    v_cndmask_b32 v128, v9, v128, s[40:41]
    v_cndmask_b32 v129, v9, v129, s[42:43]
    v_cndmask_b32 v130, v9, v130, s[44:45]
    v_cndmask_b32 v131, v9, v131, s[46:47]
    v_cmp_le_i32 s[40:41], 36, v8
    v_cmp_le_i32 s[42:43], 37, v8
    v_cmp_le_i32 s[44:45], 38, v8
    v_cmp_le_i32 s[46:47], 39, v8
    v_cndmask_b32 v132, v9, v132, s[40:41]
    v_cndmask_b32 v133, v9, v133, s[42:43]
    v_cndmask_b32 v134, v9, v134, s[44:45]
    v_cndmask_b32 v135, v9, v135, s[46:47]
    v_cmp_le_i32 s[40:41], 48, v8
    v_cmp_le_i32 s[42:43], 49, v8
    v_cmp_le_i32 s[44:45], 50, v8
    v_cmp_le_i32 s[46:47], 51, v8
    v_cndmask_b32 v136, v9, v136, s[40:41]
    v_cndmask_b32 v137, v9, v137, s[42:43]
    v_cndmask_b32 v138, v9, v138, s[44:45]
    v_cndmask_b32 v139, v9, v139, s[46:47]
    v_cmp_le_i32 s[40:41], 52, v8
    v_cmp_le_i32 s[42:43], 53, v8
    v_cmp_le_i32 s[44:45], 54, v8
    v_cmp_le_i32 s[46:47], 55, v8
    v_cndmask_b32 v140, v9, v140, s[40:41]
    v_cndmask_b32 v141, v9, v141, s[42:43]
    v_cndmask_b32 v142, v9, v142, s[44:45]
    v_cndmask_b32 v143, v9, v143, s[46:47]
    s_waitcnt lgkmcnt(2)
    v_mfma_f32_32x32x16_bf16 v[192:207], v[100:103], v[164:167], v[192:207]
    s_waitcnt lgkmcnt(1)
    v_mfma_f32_32x32x16_bf16 v[208:223], v[104:107], v[164:167], v[208:223]
    s_waitcnt lgkmcnt(0)
    v_mfma_f32_32x32x16_bf16 v[224:239], v[108:111], v[164:167], v[224:239]
    s_waitcnt lgkmcnt(0)
    s_barrier
    ds_read_b128 v[80:83], v3 offset:40960
    ds_read_b128 v[84:87], v3 offset:43008
    v_exp_f32 v168, v128
    v_exp_f32 v169, v129
    v_exp_f32 v170, v130
    v_exp_f32 v171, v131
    ds_read_b128 v[88:91], v3 offset:45056
    ds_read_b128 v[92:95], v3 offset:47104
    v_cvt_pk_bf16_f32 v160, v168, v169
    v_add_f32 v174, v168, v169
    v_exp_f32 v172, v132
    v_exp_f32 v173, v133
    ds_read_b128 v[96:99], v3 offset:41984
    ds_read_b128 v[100:103], v3 offset:44032
    v_cvt_pk_bf16_f32 v161, v170, v171
    v_add_f32 v174, v174, v170
    v_add_f32 v174, v174, v171
    ds_read_b128 v[104:107], v3 offset:46080
    ds_read_b128 v[108:111], v3 offset:48128
    v_exp_f32 v168, v134
    v_exp_f32 v169, v135
    v_cvt_pk_bf16_f32 v162, v172, v173
    v_add_f32 v174, v174, v172
    v_add_f32 v174, v174, v173
    s_nop 0
    v_cvt_pk_bf16_f32 v163, v168, v169
    v_add_f32 v174, v174, v168
    v_add_f32 v174, v174, v169
    v_cmp_nge_f32 vcc, s31, v174
    v_exp_f32 v168, v136
    v_exp_f32 v169, v137
    v_exp_f32 v170, v138
    v_exp_f32 v171, v139
    v_cvt_pk_bf16_f32 v164, v168, v169
    v_add_f32 v175, v168, v169
    v_exp_f32 v172, v140
    v_exp_f32 v173, v141
    s_cbranch_vccnz L_slow_76
L_back_77:
    v_add_f32 v4, v4, v174
    s_nop 0
    s_waitcnt lgkmcnt(7)
    v_mfma_f32_32x32x16_bf16 v[176:191], v[80:83], v[160:163], v[176:191]
    v_cvt_pk_bf16_f32 v165, v170, v171
    v_add_f32 v175, v175, v170
    v_add_f32 v175, v175, v171
    v_exp_f32 v168, v142
    v_exp_f32 v169, v143
    s_waitcnt lgkmcnt(6)
    v_mfma_f32_32x32x16_bf16 v[192:207], v[84:87], v[160:163], v[192:207]
    v_cvt_pk_bf16_f32 v166, v172, v173
    v_add_f32 v175, v175, v172
    v_add_f32 v175, v175, v173
    s_nop 0
    s_waitcnt lgkmcnt(5)
    v_mfma_f32_32x32x16_bf16 v[208:223], v[88:91], v[160:163], v[208:223]
    v_cvt_pk_bf16_f32 v167, v168, v169
    v_add_f32 v175, v175, v168
    v_add_f32 v175, v175, v169
    v_cmp_nge_f32 vcc, s31, v175
    s_waitcnt lgkmcnt(4)
    v_mfma_f32_32x32x16_bf16 v[224:239], v[92:95], v[160:163], v[224:239]
    s_cbranch_vccnz L_slow_78
L_back_79:
    v_add_f32 v4, v4, v175
    s_nop 0
    s_waitcnt lgkmcnt(3)
    v_mfma_f32_32x32x16_bf16 v[176:191], v[96:99], v[164:167], v[176:191]
    s_waitcnt lgkmcnt(2)
    v_mfma_f32_32x32x16_bf16 v[192:207], v[100:103], v[164:167], v[192:207]
    s_waitcnt lgkmcnt(1)
    v_mfma_f32_32x32x16_bf16 v[208:223], v[104:107], v[164:167], v[208:223]
    s_waitcnt lgkmcnt(0)
    v_mfma_f32_32x32x16_bf16 v[224:239], v[108:111], v[164:167], v[224:239]
    s_mov_b32 s37, 0
L_at_fin:
    v_mov_b32 v7, v4
    s_nop 1
    v_permlane32_swap_b32 v7, v4
    v_add_f32 v5, v4, v7
    v_sub_f32 v4, 0, v144
    s_xor_b32 s35, s37, 1
    s_lshl_b32 s35, s35, 15
    s_add_u32 s36, s35, 65536
    s_cmp_eq_u32 s25, 0
    s_cselect_b32 s40, s35, 131072
    s_cselect_b32 s41, 131072, s35
    s_lshl_b32 s35, s26, 13
    s_add_u32 s40, s40, s35
    s_add_u32 s41, s41, s35
    v_add_u32 v11, s40, v1
    v_add_u32 v13, s41, v1
    s_lshl_b32 s35, s24, 9
    s_add_u32 s35, s35, s36
    v_lshrrev_b32 v12, 1, v1
    v_add_u32 v12, s35, v12
    s_cmp_eq_u32 s25, 0
    s_cbranch_scc1 L_at_send23
    ds_write_b128 v11, v[176:179] offset:0
    ds_write_b128 v11, v[180:183] offset:1024
    ds_write_b128 v11, v[184:187] offset:2048
    ds_write_b128 v11, v[188:191] offset:3072
    ds_write_b128 v11, v[192:195] offset:4096
    ds_write_b128 v11, v[196:199] offset:5120
    ds_write_b128 v11, v[200:203] offset:6144
    ds_write_b128 v11, v[204:207] offset:7168
    s_waitcnt lgkmcnt(0)
    v_mov_b32 v176, v208
    v_mov_b32 v177, v209
    v_mov_b32 v178, v210
    v_mov_b32 v179, v211
    v_mov_b32 v180, v212
    v_mov_b32 v181, v213
    v_mov_b32 v182, v214
    v_mov_b32 v183, v215
    v_mov_b32 v184, v216
    v_mov_b32 v185, v217
    v_mov_b32 v186, v218
    v_mov_b32 v187, v219
    v_mov_b32 v188, v220
    v_mov_b32 v189, v221
    v_mov_b32 v190, v222
    v_mov_b32 v191, v223
    v_mov_b32 v192, v224
    v_mov_b32 v193, v225
    v_mov_b32 v194, v226
    v_mov_b32 v195, v227
    v_mov_b32 v196, v228
    v_mov_b32 v197, v229
    v_mov_b32 v198, v230
    v_mov_b32 v199, v231
    v_mov_b32 v200, v232
    v_mov_b32 v201, v233
    v_mov_b32 v202, v234
    v_mov_b32 v203, v235
    v_mov_b32 v204, v236
    v_mov_b32 v205, v237
    v_mov_b32 v206, v238
    v_mov_b32 v207, v239
    s_branch L_at_sent
L_at_send23:
    ds_write_b128 v11, v[208:211] offset:0
    ds_write_b128 v11, v[212:215] offset:1024
    ds_write_b128 v11, v[216:219] offset:2048
    ds_write_b128 v11, v[220:223] offset:3072
    ds_write_b128 v11, v[224:227] offset:4096
    ds_write_b128 v11, v[228:231] offset:5120
    ds_write_b128 v11, v[232:235] offset:6144
    ds_write_b128 v11, v[236:239] offset:7168
L_at_sent:
    s_cmp_eq_u32 s32, 0
    s_cbranch_scc1 L_nochk_80
    s_cmp_lg_u32 s24, 0
    s_cbranch_scc1 L_nochk_80
    s_waitcnt vmcnt(0)
    v_xor_b32 v240, s95, v240
    v_xor_b32 v241, s95, v241
    v_xor_b32 v242, s95, v242
    v_xor_b32 v243, s95, v243
    v_or3_b32 v244, v240, v241, v242
    v_or_b32 v244, v244, v243
    v_cmp_ne_u32 vcc, 0, v244
    s_ff1_i32_b64 s40, vcc
    v_cmp_ne_u32 vcc, 0, v242
    s_nop 1
    v_cndmask_b32 v244, 3, 2, vcc
    v_cmp_ne_u32 vcc, 0, v241
    s_nop 1
    v_cndmask_b32 v244, v244, 1, vcc
    v_cmp_ne_u32 vcc, 0, v240
    s_nop 1
    v_cndmask_b32 v244, v244, 0, vcc
    s_nop 1
    v_readlane_b32 s41, v244, s40
    s_nop 3
    s_lshl2_add_u32 s41, s40, s41
    s_cmp_lt_i32 s40, 0
    s_cselect_b32 s41, -1, s41
    v_mov_b32 v240, s41
L_nochk_80:
    s_add_u32 s40, s36, 8192
    v_mov_b32 v241, s40
    s_waitcnt lgkmcnt(0)
    s_barrier
    s_cmp_lg_u32 s24, 0
    s_cbranch_scc1 L_nochk2_81
    ds_write_b32 v241, v240
L_nochk2_81:
    ds_write_b64 v12, v[4:5]
    ds_read_b128 v[208:211], v13 offset:0
    ds_read_b128 v[212:215], v13 offset:1024
    ds_read_b128 v[216:219], v13 offset:2048
    ds_read_b128 v[220:223], v13 offset:3072
    ds_read_b128 v[224:227], v13 offset:4096
    ds_read_b128 v[228:231], v13 offset:5120
    ds_read_b128 v[232:235], v13 offset:6144
    ds_read_b128 v[236:239], v13 offset:7168
    v_xor_b32 v12, 0x800, v12
    s_waitcnt lgkmcnt(0)
    s_barrier
    ds_read_b64 v[168:169], v12
    ds_read_b32 v240, v241
    s_waitcnt lgkmcnt(0)
    v_max_f32 v7, v4, v168
    v_sub_f32 v4, v4, v7
    v_sub_f32 v168, v168, v7
    v_exp_f32 v4, v4
    v_exp_f32 v168, v168
    s_nop 0
    v_mul_f32 v5, v5, v4
    v_fmac_f32 v5, v169, v168
    v_rcp_f32 v5, v5
    s_nop 0
    v_mul_f32 v4, v4, v5
    v_mul_f32 v168, v168, v5
    v_mul_f32 v176, v176, v4
    v_mul_f32 v177, v177, v4
    v_mul_f32 v178, v178, v4
    v_mul_f32 v179, v179, v4
    v_mul_f32 v180, v180, v4
    v_mul_f32 v181, v181, v4
    v_mul_f32 v182, v182, v4
    v_mul_f32 v183, v183, v4
    v_mul_f32 v184, v184, v4
    v_mul_f32 v185, v185, v4
    v_mul_f32 v186, v186, v4
    v_mul_f32 v187, v187, v4
    v_mul_f32 v188, v188, v4
    v_mul_f32 v189, v189, v4
    v_mul_f32 v190, v190, v4
    v_mul_f32 v191, v191, v4
    v_mul_f32 v192, v192, v4
    v_mul_f32 v193, v193, v4
    v_mul_f32 v194, v194, v4
    v_mul_f32 v195, v195, v4
    v_mul_f32 v196, v196, v4
    v_mul_f32 v197, v197, v4
    v_mul_f32 v198, v198, v4
    v_mul_f32 v199, v199, v4
    v_mul_f32 v200, v200, v4
    v_mul_f32 v201, v201, v4
    v_mul_f32 v202, v202, v4
    v_mul_f32 v203, v203, v4
    v_mul_f32 v204, v204, v4
    v_mul_f32 v205, v205, v4
    v_mul_f32 v206, v206, v4
    v_mul_f32 v207, v207, v4
    v_fmac_f32 v176, v208, v168
    v_fmac_f32 v177, v209, v168
    v_fmac_f32 v178, v210, v168
    v_fmac_f32 v179, v211, v168
    v_fmac_f32 v180, v212, v168
    v_fmac_f32 v181, v213, v168
    v_fmac_f32 v182, v214, v168
    v_fmac_f32 v183, v215, v168
    v_fmac_f32 v184, v216, v168
    v_fmac_f32 v185, v217, v168
    v_fmac_f32 v186, v218, v168
    v_fmac_f32 v187, v219, v168
    v_fmac_f32 v188, v220, v168
    v_fmac_f32 v189, v221, v168
    v_fmac_f32 v190, v222, v168
    v_fmac_f32 v191, v223, v168
    v_fmac_f32 v192, v224, v168
    v_fmac_f32 v193, v225, v168
    v_fmac_f32 v194, v226, v168
    v_fmac_f32 v195, v227, v168
    v_fmac_f32 v196, v228, v168
    v_fmac_f32 v197, v229, v168
    v_fmac_f32 v198, v230, v168
    v_fmac_f32 v199, v231, v168
    v_fmac_f32 v200, v232, v168
    v_fmac_f32 v201, v233, v168
    v_fmac_f32 v202, v234, v168
    v_fmac_f32 v203, v235, v168
    v_fmac_f32 v204, v236, v168
    v_fmac_f32 v205, v237, v168
    v_fmac_f32 v206, v238, v168
    v_fmac_f32 v207, v239, v168
    s_lshl2_add_u32 s35, s21, s26
    s_mul_i32 s35, s35, 480
    s_lshl3_add_u32 s35, s33, s35
    s_lshl2_add_u32 s35, s25, s35
    s_lshl_b32 s35, s35, 10
    v_cvt_pk_bf16_f32 v48, v176, v177
    v_cvt_pk_bf16_f32 v49, v178, v179
    v_cvt_pk_bf16_f32 v50, v180, v181
    v_cvt_pk_bf16_f32 v51, v182, v183
    s_nop 1
    v_permlane32_swap_b32 v48, v50
    v_permlane32_swap_b32 v49, v51
    buffer_store_dwordx4 v[48:51], v1, s[12:15], s35 offen offset:0 sc1
    v_cvt_pk_bf16_f32 v52, v184, v185
    v_cvt_pk_bf16_f32 v53, v186, v187
    v_cvt_pk_bf16_f32 v54, v188, v189
    v_cvt_pk_bf16_f32 v55, v190, v191
    s_nop 1
    v_permlane32_swap_b32 v52, v54
    v_permlane32_swap_b32 v53, v55
    buffer_store_dwordx4 v[52:55], v1, s[12:15], s35 offen offset:1024 sc1
    v_cvt_pk_bf16_f32 v56, v192, v193
    v_cvt_pk_bf16_f32 v57, v194, v195
    v_cvt_pk_bf16_f32 v58, v196, v197
    v_cvt_pk_bf16_f32 v59, v198, v199
    s_nop 1
    v_permlane32_swap_b32 v56, v58
    v_permlane32_swap_b32 v57, v59
    buffer_store_dwordx4 v[56:59], v1, s[12:15], s35 offen offset:2048 sc1
    v_cvt_pk_bf16_f32 v60, v200, v201
    v_cvt_pk_bf16_f32 v61, v202, v203
    v_cvt_pk_bf16_f32 v62, v204, v205
    v_cvt_pk_bf16_f32 v63, v206, v207
    s_nop 1
    v_permlane32_swap_b32 v60, v62
    v_permlane32_swap_b32 v61, v63
    buffer_store_dwordx4 v[60:63], v1, s[12:15], s35 offen offset:3072 sc1
    s_cmp_lg_u32 s32, 0
    s_cbranch_scc1 L_at_done
    s_mov_b32 s32, 1
    s_mov_b32 s21, s34
    s_xor_b32 s35, s37, 1
    s_lshl_b32 s35, s35, 15
    s_add_u32 m0, s27, s35
    s_nop 0
    buffer_load_dwordx4 v10, s[4:7], s22 offen offset:0 lds
    buffer_load_dwordx4 v10, s[4:7], s22 offen offset:1024 lds
    buffer_load_dwordx4 v10, s[4:7], s22 offen offset:2048 lds
    buffer_load_dwordx4 v10, s[4:7], s22 offen offset:3072 lds
    s_add_u32 s22, s22, 32768
    s_branch L_at_qblock
L_at_done:
    v_readfirstlane_b32 s3, v240
    s_lshl_b32 s94, s34, 5
    s_add_u32 s94, s94, s33
    s_cmp_lt_i32 s3, 0
    s_cbranch_scc1 L_ao_out
    s_waitcnt vmcnt(0)
    s_barrier
    s_cmp_lg_u32 s24, 0
    s_cbranch_scc1 L_nofl_82
    s_lshl_b32 s36, s94, 2
    v_mov_b32 v12, 6144
    v_mov_b32 v13, s95
    s_mov_b64 exec, 1
    buffer_store_dword v13, v12, s[52:55], s36 offen sc1
    s_mov_b64 exec, -1
L_nofl_82:
    s_mov_b32 s2, s3
    s_branch L_pj_task
L_ao_out:
    s_mov_b32 s2, s93
    s_mov_b32 s78, s24
    s_load_dwordx2 s[74:75], s[0:1], 40
    s_load_dwordx2 s[72:73], s[0:1], 72
    s_bfe_u32 s64, s93, 0x20001
    s_and_b32 s65, s93, 1
    s_lshr_b32 s66, s93, 6
    s_lshl2_add_u32 s65, s65, s66
    s_bfe_u32 s66, s93, 0x30003
    s_mul_i32 s67, s65, 3932160
    s_sub_u32 s68, 31457280, s67
    s_add_u32 s67, s67, 54525952
    s_add_u32 s56, s48, s67
    s_addc_u32 s57, s49, 0
    s_mov_b32 s58, s68
    s_mov_b32 s59, 0x00020000
    s_lshl_b32 s67, s66, 8
    s_sub_u32 s68, 7340032, s67
    s_waitcnt lgkmcnt(0)
    s_add_u32 s60, s72, s67
    s_addc_u32 s61, s73, 0
    s_mov_b32 s62, s68
    s_mov_b32 s63, 0x00020000
    s_cmp_lg_u32 s77, 0
    s_cbranch_scc1 L_ao_e1
L_spn_83:
    buffer_load_dword v251, v246, s[52:55], 0 offen sc1
    s_waitcnt vmcnt(0)
L_spnc_85:
    v_cmp_ne_u32 vcc, s95, v251
    s_cbranch_vccz L_spnok_84
    s_sleep 8
    s_branch L_spn_83
L_spnok_84:
    s_mov_b32 m0, s99
    s_nop 0
    buffer_load_dwordx4 v249, s[60:63], s85 offen offset:0 lds
    buffer_load_dwordx4 v250, s[60:63], s85 offen offset:1024 lds
    s_add_u32 s85, s85, s87
    s_mov_b32 m0, s96
    s_nop 0
    buffer_load_dwordx4 v248, s[56:59], s84 offen offset:0 lds
    buffer_load_dwordx4 v248, s[56:59], s84 offen offset:1024 lds
    buffer_load_dwordx4 v248, s[56:59], s84 offen offset:2048 lds
    buffer_load_dwordx4 v248, s[56:59], s84 offen offset:3072 lds
    s_add_u32 s84, s84, s86
    s_mov_b32 m0, s100
    s_nop 0
    buffer_load_dwordx4 v249, s[60:63], s85 offen offset:0 lds
    buffer_load_dwordx4 v250, s[60:63], s85 offen offset:1024 lds
    s_add_u32 s85, s85, s87
L_ao_e1:
    s_barrier
    s_mov_b32 m0, s97
    s_nop 0
    buffer_load_dwordx4 v248, s[56:59], s84 offen offset:0 lds
    buffer_load_dwordx4 v248, s[56:59], s84 offen offset:1024 lds
    buffer_load_dwordx4 v248, s[56:59], s84 offen offset:2048 lds
    buffer_load_dwordx4 v248, s[56:59], s84 offen offset:3072 lds
    s_add_u32 s84, s84, s86
    s_mov_b32 m0, s101
    s_nop 0
    buffer_load_dwordx4 v249, s[60:63], s85 offen offset:0 lds
    buffer_load_dwordx4 v250, s[60:63], s85 offen offset:1024 lds
    s_add_u32 s85, s85, s87
    s_mov_b32 m0, s98
    s_nop 0
    buffer_load_dwordx4 v248, s[56:59], s84 offen offset:0 lds
    buffer_load_dwordx4 v248, s[56:59], s84 offen offset:1024 lds
    buffer_load_dwordx4 v248, s[56:59], s84 offen offset:2048 lds
    buffer_load_dwordx4 v248, s[56:59], s84 offen offset:3072 lds
    s_add_u32 s84, s84, s86
    s_lshr_b32 s50, s78, 1
    s_and_b32 s51, s78, 1
    v_bfe_u32 v22, v1, 6, 2
    v_lshrrev_b32 v21, 8, v1
    v_lshl_add_u32 v21, v21, 3, v22
    v_and_b32 v20, 3, v21
    v_lshlrev_b32 v20, 2, v20
    v_bfe_u32 v23, v21, 3, 1
    v_lshl_or_b32 v20, v23, 1, v20
    v_lshlrev_b32 v21, 8, v21
    v_bfe_u32 v22, v1, 4, 1
    v_lshl_add_u32 v21, v22, 3, v21
    v_bfe_u32 v22, v1, 5, 1
    s_lshl_b32 s92, s51, 3
    s_add_u32 s92, s92, 0
    v_add_u32 v23, s92, v22
    v_xor_b32 v23, v23, v20
    v_lshl_add_u32 v23, v23, 4, v21
    v_add_u32 v160, 65536, v23
    v_xor_b32 v160, s79, v160
    v_add_u32 v164, 81920, v23
    v_xor_b32 v164, s79, v164
    v_add_u32 v168, 131072, v23
    s_lshl_b32 s92, s51, 3
    s_add_u32 s92, s92, 2
    v_add_u32 v23, s92, v22
    v_xor_b32 v23, v23, v20
    v_lshl_add_u32 v23, v23, 4, v21
    v_add_u32 v161, 65536, v23
    v_xor_b32 v161, s79, v161
    v_add_u32 v165, 81920, v23
    v_xor_b32 v165, s79, v165
    v_add_u32 v169, 131072, v23
    s_lshl_b32 s92, s51, 3
    s_add_u32 s92, s92, 4
    v_add_u32 v23, s92, v22
    v_xor_b32 v23, v23, v20
    v_lshl_add_u32 v23, v23, 4, v21
    v_add_u32 v162, 65536, v23
    v_xor_b32 v162, s79, v162
    v_add_u32 v166, 81920, v23
    v_xor_b32 v166, s79, v166
    v_add_u32 v170, 131072, v23
    s_lshl_b32 s92, s51, 3
    s_add_u32 s92, s92, 6
    v_add_u32 v23, s92, v22
    v_xor_b32 v23, v23, v20
    v_lshl_add_u32 v23, v23, 4, v21
    v_add_u32 v163, 65536, v23
    v_xor_b32 v163, s79, v163
    v_add_u32 v167, 81920, v23
    v_xor_b32 v167, s79, v167
    v_add_u32 v171, 131072, v23
    v_lshrrev_b32 v21, 8, v1
    v_and_b32 v20, 0xf0, v1
    v_lshl_add_u32 v20, v21, 9, v20
    s_mul_i32 s92, s50, 8192
    s_add_u32 s90, s92, 0
    s_xor_b32 s90, s90, s79
    v_add_u32 v10, s90, v20
    s_add_u32 s90, s92, 32768
    s_xor_b32 s90, s90, s79
    v_add_u32 v11, s90, v20
    s_add_u32 s90, s92, 98304
    s_xor_b32 s90, s90, s79
    v_add_u32 v12, s90, v20
    s_add_u32 s16, s48, 87040000
    s_addc_u32 s17, s49, 0
    s_mov_b32 s18, 32768
    s_mov_b32 s19, 0x00020000
    s_cmp_lg_u32 s77, 0
    s_cbranch_scc1 L_ao_e2
    s_waitcnt vmcnt(10)
L_ao_e2:
    s_waitcnt vmcnt(14)
    s_barrier
    ds_read_b64_tr_b16 v[36:37], v160 offset:0
    ds_read_b64_tr_b16 v[38:39], v160 offset:1024
    ds_read_b128 v[28:31], v10 offset:0
    ds_read_b128 v[32:35], v10 offset:256
    ds_read_b64_tr_b16 v[40:41], v161 offset:0
    ds_read_b64_tr_b16 v[42:43], v161 offset:1024
    ds_read_b64_tr_b16 v[52:53], v162 offset:0
    ds_read_b64_tr_b16 v[54:55], v162 offset:1024
    ds_read_b64_tr_b16 v[56:57], v163 offset:0
    ds_read_b64_tr_b16 v[58:59], v163 offset:1024
    s_waitcnt lgkmcnt(7)
    v_mfma_f32_16x16x32_bf16 v[64:67], v[36:39], v[28:31], 0
    ds_read_b128 v[44:47], v10 offset:4096
    s_waitcnt lgkmcnt(7)
    v_mfma_f32_16x16x32_bf16 v[68:71], v[36:39], v[32:35], 0
    ds_read_b128 v[48:51], v10 offset:4352
    s_waitcnt lgkmcnt(6)
    v_mfma_f32_16x16x32_bf16 v[72:75], v[40:43], v[28:31], 0
    v_mfma_f32_16x16x32_bf16 v[76:79], v[40:43], v[32:35], 0
    s_waitcnt lgkmcnt(4)
    v_mfma_f32_16x16x32_bf16 v[80:83], v[52:55], v[28:31], 0
    v_mfma_f32_16x16x32_bf16 v[84:87], v[52:55], v[32:35], 0
    s_waitcnt lgkmcnt(2)
    v_mfma_f32_16x16x32_bf16 v[88:91], v[56:59], v[28:31], 0
    v_mfma_f32_16x16x32_bf16 v[92:95], v[56:59], v[32:35], 0
    s_waitcnt lgkmcnt(1)
    v_mfma_f32_16x16x32_bf16 v[96:99], v[36:39], v[44:47], 0
    ds_read_b128 v[28:31], v10 offset:2048
    s_waitcnt lgkmcnt(1)
    v_mfma_f32_16x16x32_bf16 v[100:103], v[36:39], v[48:51], 0
    ds_read_b128 v[32:35], v10 offset:2304
    ds_read_b64_tr_b16 v[36:37], v160 offset:8192
    ds_read_b64_tr_b16 v[38:39], v160 offset:9216
    v_mfma_f32_16x16x32_bf16 v[104:107], v[40:43], v[44:47], 0
    v_mfma_f32_16x16x32_bf16 v[108:111], v[40:43], v[48:51], 0
    ds_read_b64_tr_b16 v[40:41], v161 offset:8192
    ds_read_b64_tr_b16 v[42:43], v161 offset:9216
    v_mfma_f32_16x16x32_bf16 v[112:115], v[52:55], v[44:47], 0
    v_mfma_f32_16x16x32_bf16 v[116:119], v[52:55], v[48:51], 0
    ds_read_b64_tr_b16 v[52:53], v162 offset:8192
    ds_read_b64_tr_b16 v[54:55], v162 offset:9216
    v_mfma_f32_16x16x32_bf16 v[120:123], v[56:59], v[44:47], 0
    v_mfma_f32_16x16x32_bf16 v[124:127], v[56:59], v[48:51], 0
    ds_read_b64_tr_b16 v[56:57], v163 offset:8192
    ds_read_b64_tr_b16 v[58:59], v163 offset:9216
    s_waitcnt lgkmcnt(6)
    v_mfma_f32_16x16x32_bf16 v[64:67], v[36:39], v[28:31], v[64:67]
    ds_read_b128 v[44:47], v10 offset:6144
    v_mfma_f32_16x16x32_bf16 v[68:71], v[36:39], v[32:35], v[68:71]
    ds_read_b128 v[48:51], v10 offset:6400
    s_waitcnt lgkmcnt(6)
    v_mfma_f32_16x16x32_bf16 v[72:75], v[40:43], v[28:31], v[72:75]
    v_mfma_f32_16x16x32_bf16 v[76:79], v[40:43], v[32:35], v[76:79]
    s_waitcnt lgkmcnt(4)
    v_mfma_f32_16x16x32_bf16 v[80:83], v[52:55], v[28:31], v[80:83]
    v_mfma_f32_16x16x32_bf16 v[84:87], v[52:55], v[32:35], v[84:87]
    s_waitcnt lgkmcnt(2)
    v_mfma_f32_16x16x32_bf16 v[88:91], v[56:59], v[28:31], v[88:91]
    v_mfma_f32_16x16x32_bf16 v[92:95], v[56:59], v[32:35], v[92:95]
    s_waitcnt lgkmcnt(0) vmcnt(6)
    s_barrier
    s_cmp_lg_u32 s78, 0
    s_cbranch_scc1 L_nofl_86
    s_lshl_b32 s94, s94, 2
    v_mov_b32 v20, 6144
    v_mov_b32 v21, s95
    s_mov_b64 exec, 1
    buffer_store_dword v21, v20, s[52:55], s94 offen sc1
    s_mov_b64 exec, -1
L_nofl_86:
    v_mfma_f32_16x16x32_bf16 v[96:99], v[36:39], v[44:47], v[96:99]
    ds_read_b128 v[28:31], v11 offset:0
    s_mov_b32 m0, s99
    s_nop 0
    buffer_load_dwordx4 v249, s[60:63], s85 offen offset:0 lds
    v_mfma_f32_16x16x32_bf16 v[100:103], v[36:39], v[48:51], v[100:103]
    ds_read_b128 v[32:35], v11 offset:256
    ds_read_b64_tr_b16 v[36:37], v164 offset:0
    ds_read_b64_tr_b16 v[38:39], v164 offset:1024
    buffer_load_dwordx4 v250, s[60:63], s85 offen offset:1024 lds
    s_add_u32 s85, s85, s87
    v_mfma_f32_16x16x32_bf16 v[104:107], v[40:43], v[44:47], v[104:107]
    s_mov_b32 m0, s96
    s_nop 0
    buffer_load_dwordx4 v248, s[56:59], s84 offen offset:0 lds
    v_mfma_f32_16x16x32_bf16 v[108:111], v[40:43], v[48:51], v[108:111]
    ds_read_b64_tr_b16 v[40:41], v165 offset:0
    ds_read_b64_tr_b16 v[42:43], v165 offset:1024
    v_mfma_f32_16x16x32_bf16 v[112:115], v[52:55], v[44:47], v[112:115]
    buffer_load_dwordx4 v248, s[56:59], s84 offen offset:1024 lds
    v_mfma_f32_16x16x32_bf16 v[116:119], v[52:55], v[48:51], v[116:119]
    ds_read_b64_tr_b16 v[52:53], v166 offset:0
    ds_read_b64_tr_b16 v[54:55], v166 offset:1024
    buffer_load_dwordx4 v248, s[56:59], s84 offen offset:2048 lds
    v_mfma_f32_16x16x32_bf16 v[120:123], v[56:59], v[44:47], v[120:123]
    buffer_load_dwordx4 v248, s[56:59], s84 offen offset:3072 lds
    s_add_u32 s84, s84, s86
    v_mfma_f32_16x16x32_bf16 v[124:127], v[56:59], v[48:51], v[124:127]
    ds_read_b64_tr_b16 v[56:57], v167 offset:0
    ds_read_b64_tr_b16 v[58:59], v167 offset:1024
    s_waitcnt lgkmcnt(6)
    v_mfma_f32_16x16x32_bf16 v[64:67], v[36:39], v[28:31], v[64:67]
    ds_read_b128 v[44:47], v11 offset:4096
    v_mfma_f32_16x16x32_bf16 v[68:71], v[36:39], v[32:35], v[68:71]
    ds_read_b128 v[48:51], v11 offset:4352
    s_waitcnt lgkmcnt(6)
    v_mfma_f32_16x16x32_bf16 v[72:75], v[40:43], v[28:31], v[72:75]
    v_mfma_f32_16x16x32_bf16 v[76:79], v[40:43], v[32:35], v[76:79]
    s_waitcnt lgkmcnt(4)
    v_mfma_f32_16x16x32_bf16 v[80:83], v[52:55], v[28:31], v[80:83]
    v_mfma_f32_16x16x32_bf16 v[84:87], v[52:55], v[32:35], v[84:87]
    s_waitcnt lgkmcnt(2)
    v_mfma_f32_16x16x32_bf16 v[88:91], v[56:59], v[28:31], v[88:91]
    v_mfma_f32_16x16x32_bf16 v[92:95], v[56:59], v[32:35], v[92:95]
    s_waitcnt lgkmcnt(1)
    v_mfma_f32_16x16x32_bf16 v[96:99], v[36:39], v[44:47], v[96:99]
    ds_read_b128 v[28:31], v11 offset:2048
    s_waitcnt lgkmcnt(1)
    v_mfma_f32_16x16x32_bf16 v[100:103], v[36:39], v[48:51], v[100:103]
    ds_read_b128 v[32:35], v11 offset:2304
    ds_read_b64_tr_b16 v[36:37], v164 offset:8192
    ds_read_b64_tr_b16 v[38:39], v164 offset:9216
    v_mfma_f32_16x16x32_bf16 v[104:107], v[40:43], v[44:47], v[104:107]
    v_mfma_f32_16x16x32_bf16 v[108:111], v[40:43], v[48:51], v[108:111]
    ds_read_b64_tr_b16 v[40:41], v165 offset:8192
    ds_read_b64_tr_b16 v[42:43], v165 offset:9216
    v_mfma_f32_16x16x32_bf16 v[112:115], v[52:55], v[44:47], v[112:115]
    v_mfma_f32_16x16x32_bf16 v[116:119], v[52:55], v[48:51], v[116:119]
    ds_read_b64_tr_b16 v[52:53], v166 offset:8192
    ds_read_b64_tr_b16 v[54:55], v166 offset:9216
    v_mfma_f32_16x16x32_bf16 v[120:123], v[56:59], v[44:47], v[120:123]
    v_mfma_f32_16x16x32_bf16 v[124:127], v[56:59], v[48:51], v[124:127]
    ds_read_b64_tr_b16 v[56:57], v167 offset:8192
    ds_read_b64_tr_b16 v[58:59], v167 offset:9216
    s_waitcnt lgkmcnt(6)
    v_mfma_f32_16x16x32_bf16 v[64:67], v[36:39], v[28:31], v[64:67]
    ds_read_b128 v[44:47], v11 offset:6144
    v_mfma_f32_16x16x32_bf16 v[68:71], v[36:39], v[32:35], v[68:71]
    ds_read_b128 v[48:51], v11 offset:6400
    s_waitcnt lgkmcnt(6)
    v_mfma_f32_16x16x32_bf16 v[72:75], v[40:43], v[28:31], v[72:75]
    v_mfma_f32_16x16x32_bf16 v[76:79], v[40:43], v[32:35], v[76:79]
    s_waitcnt lgkmcnt(4)
    v_mfma_f32_16x16x32_bf16 v[80:83], v[52:55], v[28:31], v[80:83]
    v_mfma_f32_16x16x32_bf16 v[84:87], v[52:55], v[32:35], v[84:87]
    s_waitcnt lgkmcnt(2)
    v_mfma_f32_16x16x32_bf16 v[88:91], v[56:59], v[28:31], v[88:91]
    v_mfma_f32_16x16x32_bf16 v[92:95], v[56:59], v[32:35], v[92:95]
    s_waitcnt lgkmcnt(0) vmcnt(6)
    s_barrier
    v_mfma_f32_16x16x32_bf16 v[96:99], v[36:39], v[44:47], v[96:99]
    ds_read_b128 v[28:31], v12 offset:0
    s_mov_b32 m0, s100
    s_nop 0
    buffer_load_dwordx4 v249, s[60:63], s85 offen offset:0 lds
    v_mfma_f32_16x16x32_bf16 v[100:103], v[36:39], v[48:51], v[100:103]
    ds_read_b128 v[32:35], v12 offset:256
    ds_read_b64_tr_b16 v[36:37], v168 offset:0
    ds_read_b64_tr_b16 v[38:39], v168 offset:1024
    buffer_load_dwordx4 v250, s[60:63], s85 offen offset:1024 lds
    s_add_u32 s85, s85, s87
    v_mfma_f32_16x16x32_bf16 v[104:107], v[40:43], v[44:47], v[104:107]
    s_mov_b32 m0, s97
    s_nop 0
    buffer_load_dwordx4 v248, s[56:59], s84 offen offset:0 lds
    v_mfma_f32_16x16x32_bf16 v[108:111], v[40:43], v[48:51], v[108:111]
    ds_read_b64_tr_b16 v[40:41], v169 offset:0
    ds_read_b64_tr_b16 v[42:43], v169 offset:1024
    v_mfma_f32_16x16x32_bf16 v[112:115], v[52:55], v[44:47], v[112:115]
    buffer_load_dwordx4 v248, s[56:59], s84 offen offset:1024 lds
    v_mfma_f32_16x16x32_bf16 v[116:119], v[52:55], v[48:51], v[116:119]
    ds_read_b64_tr_b16 v[52:53], v170 offset:0
    ds_read_b64_tr_b16 v[54:55], v170 offset:1024
    buffer_load_dwordx4 v248, s[56:59], s84 offen offset:2048 lds
    v_mfma_f32_16x16x32_bf16 v[120:123], v[56:59], v[44:47], v[120:123]
    buffer_load_dwordx4 v248, s[56:59], s84 offen offset:3072 lds
    s_add_u32 s84, s84, s86
    v_mfma_f32_16x16x32_bf16 v[124:127], v[56:59], v[48:51], v[124:127]
    ds_read_b64_tr_b16 v[56:57], v171 offset:0
    ds_read_b64_tr_b16 v[58:59], v171 offset:1024
    s_waitcnt lgkmcnt(6)
    v_mfma_f32_16x16x32_bf16 v[64:67], v[36:39], v[28:31], v[64:67]
    ds_read_b128 v[44:47], v12 offset:4096
    v_mfma_f32_16x16x32_bf16 v[68:71], v[36:39], v[32:35], v[68:71]
    ds_read_b128 v[48:51], v12 offset:4352
    s_waitcnt lgkmcnt(6)
    v_mfma_f32_16x16x32_bf16 v[72:75], v[40:43], v[28:31], v[72:75]
    v_mfma_f32_16x16x32_bf16 v[76:79], v[40:43], v[32:35], v[76:79]
    s_waitcnt lgkmcnt(4)
    v_mfma_f32_16x16x32_bf16 v[80:83], v[52:55], v[28:31], v[80:83]
    v_mfma_f32_16x16x32_bf16 v[84:87], v[52:55], v[32:35], v[84:87]
    s_waitcnt lgkmcnt(2)
    v_mfma_f32_16x16x32_bf16 v[88:91], v[56:59], v[28:31], v[88:91]
    v_mfma_f32_16x16x32_bf16 v[92:95], v[56:59], v[32:35], v[92:95]
    s_waitcnt lgkmcnt(1)
    v_mfma_f32_16x16x32_bf16 v[96:99], v[36:39], v[44:47], v[96:99]
    ds_read_b128 v[28:31], v12 offset:2048
    s_waitcnt lgkmcnt(1)
    v_mfma_f32_16x16x32_bf16 v[100:103], v[36:39], v[48:51], v[100:103]
    ds_read_b128 v[32:35], v12 offset:2304
    ds_read_b64_tr_b16 v[36:37], v168 offset:8192
    ds_read_b64_tr_b16 v[38:39], v168 offset:9216
    v_mfma_f32_16x16x32_bf16 v[104:107], v[40:43], v[44:47], v[104:107]
    v_mfma_f32_16x16x32_bf16 v[108:111], v[40:43], v[48:51], v[108:111]
    ds_read_b64_tr_b16 v[40:41], v169 offset:8192
    ds_read_b64_tr_b16 v[42:43], v169 offset:9216
    v_mfma_f32_16x16x32_bf16 v[112:115], v[52:55], v[44:47], v[112:115]
    v_mfma_f32_16x16x32_bf16 v[116:119], v[52:55], v[48:51], v[116:119]
    ds_read_b64_tr_b16 v[52:53], v170 offset:8192
    ds_read_b64_tr_b16 v[54:55], v170 offset:9216
    v_mfma_f32_16x16x32_bf16 v[120:123], v[56:59], v[44:47], v[120:123]
    v_mfma_f32_16x16x32_bf16 v[124:127], v[56:59], v[48:51], v[124:127]
    ds_read_b64_tr_b16 v[56:57], v171 offset:8192
    ds_read_b64_tr_b16 v[58:59], v171 offset:9216
    s_waitcnt lgkmcnt(6)
    v_mfma_f32_16x16x32_bf16 v[64:67], v[36:39], v[28:31], v[64:67]
    ds_read_b128 v[44:47], v12 offset:6144
    v_mfma_f32_16x16x32_bf16 v[68:71], v[36:39], v[32:35], v[68:71]
    ds_read_b128 v[48:51], v12 offset:6400
    s_waitcnt lgkmcnt(6)
    v_mfma_f32_16x16x32_bf16 v[72:75], v[40:43], v[28:31], v[72:75]
    v_mfma_f32_16x16x32_bf16 v[76:79], v[40:43], v[32:35], v[76:79]
    s_waitcnt lgkmcnt(4)
    v_mfma_f32_16x16x32_bf16 v[80:83], v[52:55], v[28:31], v[80:83]
    v_mfma_f32_16x16x32_bf16 v[84:87], v[52:55], v[32:35], v[84:87]
    s_waitcnt lgkmcnt(2)
    v_mfma_f32_16x16x32_bf16 v[88:91], v[56:59], v[28:31], v[88:91]
    v_mfma_f32_16x16x32_bf16 v[92:95], v[56:59], v[32:35], v[92:95]
    s_waitcnt lgkmcnt(0) vmcnt(6)
    s_barrier
    v_mfma_f32_16x16x32_bf16 v[96:99], v[36:39], v[44:47], v[96:99]
    ds_read_b128 v[28:31], v10 offset:0
    s_mov_b32 m0, s101
    s_nop 0
    buffer_load_dwordx4 v249, s[60:63], s85 offen offset:0 lds
    v_mfma_f32_16x16x32_bf16 v[100:103], v[36:39], v[48:51], v[100:103]
    ds_read_b128 v[32:35], v10 offset:256
    ds_read_b64_tr_b16 v[36:37], v160 offset:0
    ds_read_b64_tr_b16 v[38:39], v160 offset:1024
    buffer_load_dwordx4 v250, s[60:63], s85 offen offset:1024 lds
    s_add_u32 s85, s85, s87
    v_mfma_f32_16x16x32_bf16 v[104:107], v[40:43], v[44:47], v[104:107]
    s_mov_b32 m0, s98
    s_nop 0
    buffer_load_dwordx4 v248, s[56:59], s84 offen offset:0 lds
    v_mfma_f32_16x16x32_bf16 v[108:111], v[40:43], v[48:51], v[108:111]
    ds_read_b64_tr_b16 v[40:41], v161 offset:0
    ds_read_b64_tr_b16 v[42:43], v161 offset:1024
    v_mfma_f32_16x16x32_bf16 v[112:115], v[52:55], v[44:47], v[112:115]
    buffer_load_dwordx4 v248, s[56:59], s84 offen offset:1024 lds
    v_mfma_f32_16x16x32_bf16 v[116:119], v[52:55], v[48:51], v[116:119]
    ds_read_b64_tr_b16 v[52:53], v162 offset:0
    ds_read_b64_tr_b16 v[54:55], v162 offset:1024
    buffer_load_dwordx4 v248, s[56:59], s84 offen offset:2048 lds
    v_mfma_f32_16x16x32_bf16 v[120:123], v[56:59], v[44:47], v[120:123]
    buffer_load_dwordx4 v248, s[56:59], s84 offen offset:3072 lds
    s_add_u32 s84, s84, s86
    v_mfma_f32_16x16x32_bf16 v[124:127], v[56:59], v[48:51], v[124:127]
    ds_read_b64_tr_b16 v[56:57], v163 offset:0
    ds_read_b64_tr_b16 v[58:59], v163 offset:1024
    s_mov_b32 s91, 2
L_oa_loop_87:
    s_waitcnt lgkmcnt(6)
    v_mfma_f32_16x16x32_bf16 v[64:67], v[36:39], v[28:31], v[64:67]
    ds_read_b128 v[44:47], v10 offset:4096
    v_mfma_f32_16x16x32_bf16 v[68:71], v[36:39], v[32:35], v[68:71]
    ds_read_b128 v[48:51], v10 offset:4352
    s_waitcnt lgkmcnt(6)
    v_mfma_f32_16x16x32_bf16 v[72:75], v[40:43], v[28:31], v[72:75]
    v_mfma_f32_16x16x32_bf16 v[76:79], v[40:43], v[32:35], v[76:79]
    s_waitcnt lgkmcnt(4)
    v_mfma_f32_16x16x32_bf16 v[80:83], v[52:55], v[28:31], v[80:83]
    v_mfma_f32_16x16x32_bf16 v[84:87], v[52:55], v[32:35], v[84:87]
    s_waitcnt lgkmcnt(2)
    v_mfma_f32_16x16x32_bf16 v[88:91], v[56:59], v[28:31], v[88:91]
    v_mfma_f32_16x16x32_bf16 v[92:95], v[56:59], v[32:35], v[92:95]
    s_waitcnt lgkmcnt(1)
    v_mfma_f32_16x16x32_bf16 v[96:99], v[36:39], v[44:47], v[96:99]
    ds_read_b128 v[28:31], v10 offset:2048
    s_waitcnt lgkmcnt(1)
    v_mfma_f32_16x16x32_bf16 v[100:103], v[36:39], v[48:51], v[100:103]
    ds_read_b128 v[32:35], v10 offset:2304
    ds_read_b64_tr_b16 v[36:37], v160 offset:8192
    ds_read_b64_tr_b16 v[38:39], v160 offset:9216
    v_mfma_f32_16x16x32_bf16 v[104:107], v[40:43], v[44:47], v[104:107]
    v_mfma_f32_16x16x32_bf16 v[108:111], v[40:43], v[48:51], v[108:111]
    ds_read_b64_tr_b16 v[40:41], v161 offset:8192
    ds_read_b64_tr_b16 v[42:43], v161 offset:9216
    v_mfma_f32_16x16x32_bf16 v[112:115], v[52:55], v[44:47], v[112:115]
    v_mfma_f32_16x16x32_bf16 v[116:119], v[52:55], v[48:51], v[116:119]
    ds_read_b64_tr_b16 v[52:53], v162 offset:8192
    ds_read_b64_tr_b16 v[54:55], v162 offset:9216
    v_mfma_f32_16x16x32_bf16 v[120:123], v[56:59], v[44:47], v[120:123]
    v_mfma_f32_16x16x32_bf16 v[124:127], v[56:59], v[48:51], v[124:127]
    ds_read_b64_tr_b16 v[56:57], v163 offset:8192
    ds_read_b64_tr_b16 v[58:59], v163 offset:9216
    s_waitcnt lgkmcnt(6)
    v_mfma_f32_16x16x32_bf16 v[64:67], v[36:39], v[28:31], v[64:67]
    ds_read_b128 v[44:47], v10 offset:6144
    v_mfma_f32_16x16x32_bf16 v[68:71], v[36:39], v[32:35], v[68:71]
    ds_read_b128 v[48:51], v10 offset:6400
    s_waitcnt lgkmcnt(6)
    v_mfma_f32_16x16x32_bf16 v[72:75], v[40:43], v[28:31], v[72:75]
    v_mfma_f32_16x16x32_bf16 v[76:79], v[40:43], v[32:35], v[76:79]
    s_waitcnt lgkmcnt(4)
    v_mfma_f32_16x16x32_bf16 v[80:83], v[52:55], v[28:31], v[80:83]
    v_mfma_f32_16x16x32_bf16 v[84:87], v[52:55], v[32:35], v[84:87]
    s_waitcnt lgkmcnt(2)
    v_mfma_f32_16x16x32_bf16 v[88:91], v[56:59], v[28:31], v[88:91]
    v_mfma_f32_16x16x32_bf16 v[92:95], v[56:59], v[32:35], v[92:95]
    s_waitcnt lgkmcnt(0) vmcnt(6)
    s_barrier
    v_mfma_f32_16x16x32_bf16 v[96:99], v[36:39], v[44:47], v[96:99]
    ds_read_b128 v[28:31], v11 offset:0
    s_mov_b32 m0, s99
    s_nop 0
    buffer_load_dwordx4 v249, s[60:63], s85 offen offset:0 lds
    v_mfma_f32_16x16x32_bf16 v[100:103], v[36:39], v[48:51], v[100:103]
    ds_read_b128 v[32:35], v11 offset:256
    ds_read_b64_tr_b16 v[36:37], v164 offset:0
    ds_read_b64_tr_b16 v[38:39], v164 offset:1024
    buffer_load_dwordx4 v250, s[60:63], s85 offen offset:1024 lds
    s_add_u32 s85, s85, s87
    v_mfma_f32_16x16x32_bf16 v[104:107], v[40:43], v[44:47], v[104:107]
    s_mov_b32 m0, s96
    s_nop 0
    buffer_load_dwordx4 v248, s[56:59], s84 offen offset:0 lds
    v_mfma_f32_16x16x32_bf16 v[108:111], v[40:43], v[48:51], v[108:111]
    ds_read_b64_tr_b16 v[40:41], v165 offset:0
    ds_read_b64_tr_b16 v[42:43], v165 offset:1024
    v_mfma_f32_16x16x32_bf16 v[112:115], v[52:55], v[44:47], v[112:115]
    buffer_load_dwordx4 v248, s[56:59], s84 offen offset:1024 lds
    v_mfma_f32_16x16x32_bf16 v[116:119], v[52:55], v[48:51], v[116:119]
    ds_read_b64_tr_b16 v[52:53], v166 offset:0
    ds_read_b64_tr_b16 v[54:55], v166 offset:1024
    buffer_load_dwordx4 v248, s[56:59], s84 offen offset:2048 lds
    v_mfma_f32_16x16x32_bf16 v[120:123], v[56:59], v[44:47], v[120:123]
    buffer_load_dwordx4 v248, s[56:59], s84 offen offset:3072 lds
    s_add_u32 s84, s84, s86
    v_mfma_f32_16x16x32_bf16 v[124:127], v[56:59], v[48:51], v[124:127]
    ds_read_b64_tr_b16 v[56:57], v167 offset:0
    ds_read_b64_tr_b16 v[58:59], v167 offset:1024
    s_waitcnt lgkmcnt(6)
    v_mfma_f32_16x16x32_bf16 v[64:67], v[36:39], v[28:31], v[64:67]
    ds_read_b128 v[44:47], v11 offset:4096
    v_mfma_f32_16x16x32_bf16 v[68:71], v[36:39], v[32:35], v[68:71]
    ds_read_b128 v[48:51], v11 offset:4352
    s_waitcnt lgkmcnt(6)
    v_mfma_f32_16x16x32_bf16 v[72:75], v[40:43], v[28:31], v[72:75]
    v_mfma_f32_16x16x32_bf16 v[76:79], v[40:43], v[32:35], v[76:79]
    s_waitcnt lgkmcnt(4)
    v_mfma_f32_16x16x32_bf16 v[80:83], v[52:55], v[28:31], v[80:83]
    v_mfma_f32_16x16x32_bf16 v[84:87], v[52:55], v[32:35], v[84:87]
    s_waitcnt lgkmcnt(2)
    v_mfma_f32_16x16x32_bf16 v[88:91], v[56:59], v[28:31], v[88:91]
    v_mfma_f32_16x16x32_bf16 v[92:95], v[56:59], v[32:35], v[92:95]
    s_waitcnt lgkmcnt(1)
    v_mfma_f32_16x16x32_bf16 v[96:99], v[36:39], v[44:47], v[96:99]
    ds_read_b128 v[28:31], v11 offset:2048
    s_waitcnt lgkmcnt(1)
    v_mfma_f32_16x16x32_bf16 v[100:103], v[36:39], v[48:51], v[100:103]
    ds_read_b128 v[32:35], v11 offset:2304
    ds_read_b64_tr_b16 v[36:37], v164 offset:8192
    ds_read_b64_tr_b16 v[38:39], v164 offset:9216
    v_mfma_f32_16x16x32_bf16 v[104:107], v[40:43], v[44:47], v[104:107]
    v_mfma_f32_16x16x32_bf16 v[108:111], v[40:43], v[48:51], v[108:111]
    ds_read_b64_tr_b16 v[40:41], v165 offset:8192
    ds_read_b64_tr_b16 v[42:43], v165 offset:9216
    v_mfma_f32_16x16x32_bf16 v[112:115], v[52:55], v[44:47], v[112:115]
    v_mfma_f32_16x16x32_bf16 v[116:119], v[52:55], v[48:51], v[116:119]
    ds_read_b64_tr_b16 v[52:53], v166 offset:8192
    ds_read_b64_tr_b16 v[54:55], v166 offset:9216
    v_mfma_f32_16x16x32_bf16 v[120:123], v[56:59], v[44:47], v[120:123]
    v_mfma_f32_16x16x32_bf16 v[124:127], v[56:59], v[48:51], v[124:127]
    ds_read_b64_tr_b16 v[56:57], v167 offset:8192
    ds_read_b64_tr_b16 v[58:59], v167 offset:9216
    s_waitcnt lgkmcnt(6)
    v_mfma_f32_16x16x32_bf16 v[64:67], v[36:39], v[28:31], v[64:67]
    ds_read_b128 v[44:47], v11 offset:6144
    v_mfma_f32_16x16x32_bf16 v[68:71], v[36:39], v[32:35], v[68:71]
    ds_read_b128 v[48:51], v11 offset:6400
    s_waitcnt lgkmcnt(6)
    v_mfma_f32_16x16x32_bf16 v[72:75], v[40:43], v[28:31], v[72:75]
    v_mfma_f32_16x16x32_bf16 v[76:79], v[40:43], v[32:35], v[76:79]
    s_waitcnt lgkmcnt(4)
    v_mfma_f32_16x16x32_bf16 v[80:83], v[52:55], v[28:31], v[80:83]
    v_mfma_f32_16x16x32_bf16 v[84:87], v[52:55], v[32:35], v[84:87]
    s_waitcnt lgkmcnt(2)
    v_mfma_f32_16x16x32_bf16 v[88:91], v[56:59], v[28:31], v[88:91]
    v_mfma_f32_16x16x32_bf16 v[92:95], v[56:59], v[32:35], v[92:95]
    s_waitcnt lgkmcnt(0) vmcnt(6)
    s_barrier
    v_mfma_f32_16x16x32_bf16 v[96:99], v[36:39], v[44:47], v[96:99]
    ds_read_b128 v[28:31], v12 offset:0
    s_mov_b32 m0, s100
    s_nop 0
    buffer_load_dwordx4 v249, s[60:63], s85 offen offset:0 lds
    v_mfma_f32_16x16x32_bf16 v[100:103], v[36:39], v[48:51], v[100:103]
    ds_read_b128 v[32:35], v12 offset:256
    ds_read_b64_tr_b16 v[36:37], v168 offset:0
    ds_read_b64_tr_b16 v[38:39], v168 offset:1024
    buffer_load_dwordx4 v250, s[60:63], s85 offen offset:1024 lds
    s_add_u32 s85, s85, s87
    v_mfma_f32_16x16x32_bf16 v[104:107], v[40:43], v[44:47], v[104:107]
    s_mov_b32 m0, s97
    s_nop 0
    buffer_load_dwordx4 v248, s[56:59], s84 offen offset:0 lds
    v_mfma_f32_16x16x32_bf16 v[108:111], v[40:43], v[48:51], v[108:111]
    ds_read_b64_tr_b16 v[40:41], v169 offset:0
    ds_read_b64_tr_b16 v[42:43], v169 offset:1024
    v_mfma_f32_16x16x32_bf16 v[112:115], v[52:55], v[44:47], v[112:115]
    buffer_load_dwordx4 v248, s[56:59], s84 offen offset:1024 lds
    v_mfma_f32_16x16x32_bf16 v[116:119], v[52:55], v[48:51], v[116:119]
    ds_read_b64_tr_b16 v[52:53], v170 offset:0
    ds_read_b64_tr_b16 v[54:55], v170 offset:1024
    buffer_load_dwordx4 v248, s[56:59], s84 offen offset:2048 lds
    v_mfma_f32_16x16x32_bf16 v[120:123], v[56:59], v[44:47], v[120:123]
    buffer_load_dwordx4 v248, s[56:59], s84 offen offset:3072 lds
    s_add_u32 s84, s84, s86
    v_mfma_f32_16x16x32_bf16 v[124:127], v[56:59], v[48:51], v[124:127]
    ds_read_b64_tr_b16 v[56:57], v171 offset:0
    ds_read_b64_tr_b16 v[58:59], v171 offset:1024
    s_waitcnt lgkmcnt(6)
    v_mfma_f32_16x16x32_bf16 v[64:67], v[36:39], v[28:31], v[64:67]
    ds_read_b128 v[44:47], v12 offset:4096
    v_mfma_f32_16x16x32_bf16 v[68:71], v[36:39], v[32:35], v[68:71]
    ds_read_b128 v[48:51], v12 offset:4352
    s_waitcnt lgkmcnt(6)
    v_mfma_f32_16x16x32_bf16 v[72:75], v[40:43], v[28:31], v[72:75]
    v_mfma_f32_16x16x32_bf16 v[76:79], v[40:43], v[32:35], v[76:79]
    s_waitcnt lgkmcnt(4)
    v_mfma_f32_16x16x32_bf16 v[80:83], v[52:55], v[28:31], v[80:83]
    v_mfma_f32_16x16x32_bf16 v[84:87], v[52:55], v[32:35], v[84:87]
    s_waitcnt lgkmcnt(2)
    v_mfma_f32_16x16x32_bf16 v[88:91], v[56:59], v[28:31], v[88:91]
    v_mfma_f32_16x16x32_bf16 v[92:95], v[56:59], v[32:35], v[92:95]
    s_waitcnt lgkmcnt(1)
    v_mfma_f32_16x16x32_bf16 v[96:99], v[36:39], v[44:47], v[96:99]
    ds_read_b128 v[28:31], v12 offset:2048
    s_waitcnt lgkmcnt(1)
    v_mfma_f32_16x16x32_bf16 v[100:103], v[36:39], v[48:51], v[100:103]
    ds_read_b128 v[32:35], v12 offset:2304
    ds_read_b64_tr_b16 v[36:37], v168 offset:8192
    ds_read_b64_tr_b16 v[38:39], v168 offset:9216
    v_mfma_f32_16x16x32_bf16 v[104:107], v[40:43], v[44:47], v[104:107]
    v_mfma_f32_16x16x32_bf16 v[108:111], v[40:43], v[48:51], v[108:111]
    ds_read_b64_tr_b16 v[40:41], v169 offset:8192
    ds_read_b64_tr_b16 v[42:43], v169 offset:9216
    v_mfma_f32_16x16x32_bf16 v[112:115], v[52:55], v[44:47], v[112:115]
    v_mfma_f32_16x16x32_bf16 v[116:119], v[52:55], v[48:51], v[116:119]
    ds_read_b64_tr_b16 v[52:53], v170 offset:8192
    ds_read_b64_tr_b16 v[54:55], v170 offset:9216
    v_mfma_f32_16x16x32_bf16 v[120:123], v[56:59], v[44:47], v[120:123]
    v_mfma_f32_16x16x32_bf16 v[124:127], v[56:59], v[48:51], v[124:127]
    ds_read_b64_tr_b16 v[56:57], v171 offset:8192
    ds_read_b64_tr_b16 v[58:59], v171 offset:9216
    s_waitcnt lgkmcnt(6)
    v_mfma_f32_16x16x32_bf16 v[64:67], v[36:39], v[28:31], v[64:67]
    ds_read_b128 v[44:47], v12 offset:6144
    v_mfma_f32_16x16x32_bf16 v[68:71], v[36:39], v[32:35], v[68:71]
    ds_read_b128 v[48:51], v12 offset:6400
    s_waitcnt lgkmcnt(6)
    v_mfma_f32_16x16x32_bf16 v[72:75], v[40:43], v[28:31], v[72:75]
    v_mfma_f32_16x16x32_bf16 v[76:79], v[40:43], v[32:35], v[76:79]
    s_waitcnt lgkmcnt(4)
    v_mfma_f32_16x16x32_bf16 v[80:83], v[52:55], v[28:31], v[80:83]
    v_mfma_f32_16x16x32_bf16 v[84:87], v[52:55], v[32:35], v[84:87]
    s_waitcnt lgkmcnt(2)
    v_mfma_f32_16x16x32_bf16 v[88:91], v[56:59], v[28:31], v[88:91]
    v_mfma_f32_16x16x32_bf16 v[92:95], v[56:59], v[32:35], v[92:95]
    s_waitcnt lgkmcnt(0) vmcnt(6)
    s_barrier
    v_mfma_f32_16x16x32_bf16 v[96:99], v[36:39], v[44:47], v[96:99]
    ds_read_b128 v[28:31], v10 offset:0
    s_mov_b32 m0, s101
    s_nop 0
    buffer_load_dwordx4 v249, s[60:63], s85 offen offset:0 lds
    v_mfma_f32_16x16x32_bf16 v[100:103], v[36:39], v[48:51], v[100:103]
    ds_read_b128 v[32:35], v10 offset:256
    ds_read_b64_tr_b16 v[36:37], v160 offset:0
    ds_read_b64_tr_b16 v[38:39], v160 offset:1024
    buffer_load_dwordx4 v250, s[60:63], s85 offen offset:1024 lds
    s_add_u32 s85, s85, s87
    v_mfma_f32_16x16x32_bf16 v[104:107], v[40:43], v[44:47], v[104:107]
    s_mov_b32 m0, s98
    s_nop 0
    buffer_load_dwordx4 v248, s[56:59], s84 offen offset:0 lds
    v_mfma_f32_16x16x32_bf16 v[108:111], v[40:43], v[48:51], v[108:111]
    ds_read_b64_tr_b16 v[40:41], v161 offset:0
    ds_read_b64_tr_b16 v[42:43], v161 offset:1024
    v_mfma_f32_16x16x32_bf16 v[112:115], v[52:55], v[44:47], v[112:115]
    buffer_load_dwordx4 v248, s[56:59], s84 offen offset:1024 lds
    v_mfma_f32_16x16x32_bf16 v[116:119], v[52:55], v[48:51], v[116:119]
    ds_read_b64_tr_b16 v[52:53], v162 offset:0
    ds_read_b64_tr_b16 v[54:55], v162 offset:1024
    buffer_load_dwordx4 v248, s[56:59], s84 offen offset:2048 lds
    v_mfma_f32_16x16x32_bf16 v[120:123], v[56:59], v[44:47], v[120:123]
    buffer_load_dwordx4 v248, s[56:59], s84 offen offset:3072 lds
    s_add_u32 s84, s84, s86
    v_mfma_f32_16x16x32_bf16 v[124:127], v[56:59], v[48:51], v[124:127]
    ds_read_b64_tr_b16 v[56:57], v163 offset:0
    ds_read_b64_tr_b16 v[58:59], v163 offset:1024
    s_sub_u32 s91, s91, 1
    s_cmp_lg_u32 s91, 0
    s_cbranch_scc1 L_oa_loop_87
    s_waitcnt lgkmcnt(6)
    v_mfma_f32_16x16x32_bf16 v[64:67], v[36:39], v[28:31], v[64:67]
    ds_read_b128 v[44:47], v10 offset:4096
    v_mfma_f32_16x16x32_bf16 v[68:71], v[36:39], v[32:35], v[68:71]
    ds_read_b128 v[48:51], v10 offset:4352
    s_waitcnt lgkmcnt(6)
    v_mfma_f32_16x16x32_bf16 v[72:75], v[40:43], v[28:31], v[72:75]
    v_mfma_f32_16x16x32_bf16 v[76:79], v[40:43], v[32:35], v[76:79]
    s_waitcnt lgkmcnt(4)
    v_mfma_f32_16x16x32_bf16 v[80:83], v[52:55], v[28:31], v[80:83]
    v_mfma_f32_16x16x32_bf16 v[84:87], v[52:55], v[32:35], v[84:87]
    s_waitcnt lgkmcnt(2)
    v_mfma_f32_16x16x32_bf16 v[88:91], v[56:59], v[28:31], v[88:91]
    v_mfma_f32_16x16x32_bf16 v[92:95], v[56:59], v[32:35], v[92:95]
    s_waitcnt lgkmcnt(1)
    v_mfma_f32_16x16x32_bf16 v[96:99], v[36:39], v[44:47], v[96:99]
    ds_read_b128 v[28:31], v10 offset:2048
    s_waitcnt lgkmcnt(1)
    v_mfma_f32_16x16x32_bf16 v[100:103], v[36:39], v[48:51], v[100:103]
    ds_read_b128 v[32:35], v10 offset:2304
    ds_read_b64_tr_b16 v[36:37], v160 offset:8192
    ds_read_b64_tr_b16 v[38:39], v160 offset:9216
    v_mfma_f32_16x16x32_bf16 v[104:107], v[40:43], v[44:47], v[104:107]
    v_mfma_f32_16x16x32_bf16 v[108:111], v[40:43], v[48:51], v[108:111]
    ds_read_b64_tr_b16 v[40:41], v161 offset:8192
    ds_read_b64_tr_b16 v[42:43], v161 offset:9216
    v_mfma_f32_16x16x32_bf16 v[112:115], v[52:55], v[44:47], v[112:115]
    v_mfma_f32_16x16x32_bf16 v[116:119], v[52:55], v[48:51], v[116:119]
    ds_read_b64_tr_b16 v[52:53], v162 offset:8192
    ds_read_b64_tr_b16 v[54:55], v162 offset:9216
    v_mfma_f32_16x16x32_bf16 v[120:123], v[56:59], v[44:47], v[120:123]
    v_mfma_f32_16x16x32_bf16 v[124:127], v[56:59], v[48:51], v[124:127]
    ds_read_b64_tr_b16 v[56:57], v163 offset:8192
    ds_read_b64_tr_b16 v[58:59], v163 offset:9216
    s_waitcnt lgkmcnt(6)
    v_mfma_f32_16x16x32_bf16 v[64:67], v[36:39], v[28:31], v[64:67]
    ds_read_b128 v[44:47], v10 offset:6144
    v_mfma_f32_16x16x32_bf16 v[68:71], v[36:39], v[32:35], v[68:71]
    ds_read_b128 v[48:51], v10 offset:6400
    s_waitcnt lgkmcnt(6)
    v_mfma_f32_16x16x32_bf16 v[72:75], v[40:43], v[28:31], v[72:75]
    v_mfma_f32_16x16x32_bf16 v[76:79], v[40:43], v[32:35], v[76:79]
    s_waitcnt lgkmcnt(4)
    v_mfma_f32_16x16x32_bf16 v[80:83], v[52:55], v[28:31], v[80:83]
    v_mfma_f32_16x16x32_bf16 v[84:87], v[52:55], v[32:35], v[84:87]
    s_waitcnt lgkmcnt(2)
    v_mfma_f32_16x16x32_bf16 v[88:91], v[56:59], v[28:31], v[88:91]
    v_mfma_f32_16x16x32_bf16 v[92:95], v[56:59], v[32:35], v[92:95]
    s_waitcnt lgkmcnt(0) vmcnt(6)
    s_barrier
    v_mfma_f32_16x16x32_bf16 v[96:99], v[36:39], v[44:47], v[96:99]
    ds_read_b128 v[28:31], v11 offset:0
    s_mov_b32 m0, s99
    s_nop 0
    buffer_load_dwordx4 v249, s[60:63], s85 offen offset:0 lds
    v_mfma_f32_16x16x32_bf16 v[100:103], v[36:39], v[48:51], v[100:103]
    ds_read_b128 v[32:35], v11 offset:256
    ds_read_b64_tr_b16 v[36:37], v164 offset:0
    ds_read_b64_tr_b16 v[38:39], v164 offset:1024
    buffer_load_dwordx4 v250, s[60:63], s85 offen offset:1024 lds
    s_add_u32 s85, s85, s87
    v_mfma_f32_16x16x32_bf16 v[104:107], v[40:43], v[44:47], v[104:107]
    s_mov_b32 m0, s96
    s_nop 0
    buffer_load_dwordx4 v248, s[56:59], s84 offen offset:0 lds
    v_mfma_f32_16x16x32_bf16 v[108:111], v[40:43], v[48:51], v[108:111]
    ds_read_b64_tr_b16 v[40:41], v165 offset:0
    ds_read_b64_tr_b16 v[42:43], v165 offset:1024
    v_mfma_f32_16x16x32_bf16 v[112:115], v[52:55], v[44:47], v[112:115]
    buffer_load_dwordx4 v248, s[56:59], s84 offen offset:1024 lds
    v_mfma_f32_16x16x32_bf16 v[116:119], v[52:55], v[48:51], v[116:119]
    ds_read_b64_tr_b16 v[52:53], v166 offset:0
    ds_read_b64_tr_b16 v[54:55], v166 offset:1024
    buffer_load_dwordx4 v248, s[56:59], s84 offen offset:2048 lds
    v_mfma_f32_16x16x32_bf16 v[120:123], v[56:59], v[44:47], v[120:123]
    buffer_load_dwordx4 v248, s[56:59], s84 offen offset:3072 lds
    s_add_u32 s84, s84, s86
    v_mfma_f32_16x16x32_bf16 v[124:127], v[56:59], v[48:51], v[124:127]
    ds_read_b64_tr_b16 v[56:57], v167 offset:0
    ds_read_b64_tr_b16 v[58:59], v167 offset:1024
    s_waitcnt lgkmcnt(6)
    v_mfma_f32_16x16x32_bf16 v[64:67], v[36:39], v[28:31], v[64:67]
    ds_read_b128 v[44:47], v11 offset:4096
    v_bfe_u32 v26, v0, 3, 1
    v_and_b32 v27, 7, v0
    v_lshlrev_b32 v27, 2, v27
    v_lshl_add_u32 v27, v26, 7, v27
    s_lshl_b32 s67, s65, 8
    s_lshl_b32 s68, s64, 5
    s_add_u32 s67, s67, s68
    s_add_u32 s67, s67, 6144
    v_add_u32 v27, s67, v27
    buffer_load_dword v26, v27, s[52:55], 0 offen sc1
    v_mfma_f32_16x16x32_bf16 v[68:71], v[36:39], v[32:35], v[68:71]
    ds_read_b128 v[48:51], v11 offset:4352
    s_waitcnt lgkmcnt(6)
    v_mfma_f32_16x16x32_bf16 v[72:75], v[40:43], v[28:31], v[72:75]
    v_mfma_f32_16x16x32_bf16 v[76:79], v[40:43], v[32:35], v[76:79]
    s_waitcnt lgkmcnt(4)
    v_mfma_f32_16x16x32_bf16 v[80:83], v[52:55], v[28:31], v[80:83]
    v_mfma_f32_16x16x32_bf16 v[84:87], v[52:55], v[32:35], v[84:87]
    s_waitcnt lgkmcnt(2)
    v_mfma_f32_16x16x32_bf16 v[88:91], v[56:59], v[28:31], v[88:91]
    v_mfma_f32_16x16x32_bf16 v[92:95], v[56:59], v[32:35], v[92:95]
    s_waitcnt lgkmcnt(1)
    v_mfma_f32_16x16x32_bf16 v[96:99], v[36:39], v[44:47], v[96:99]
    ds_read_b128 v[28:31], v11 offset:2048
    s_waitcnt lgkmcnt(1)
    v_mfma_f32_16x16x32_bf16 v[100:103], v[36:39], v[48:51], v[100:103]
    ds_read_b128 v[32:35], v11 offset:2304
    ds_read_b64_tr_b16 v[36:37], v164 offset:8192
    ds_read_b64_tr_b16 v[38:39], v164 offset:9216
    v_mfma_f32_16x16x32_bf16 v[104:107], v[40:43], v[44:47], v[104:107]
    v_mfma_f32_16x16x32_bf16 v[108:111], v[40:43], v[48:51], v[108:111]
    ds_read_b64_tr_b16 v[40:41], v165 offset:8192
    ds_read_b64_tr_b16 v[42:43], v165 offset:9216
    v_mfma_f32_16x16x32_bf16 v[112:115], v[52:55], v[44:47], v[112:115]
    v_mfma_f32_16x16x32_bf16 v[116:119], v[52:55], v[48:51], v[116:119]
    ds_read_b64_tr_b16 v[52:53], v166 offset:8192
    ds_read_b64_tr_b16 v[54:55], v166 offset:9216
    v_mfma_f32_16x16x32_bf16 v[120:123], v[56:59], v[44:47], v[120:123]
    v_mfma_f32_16x16x32_bf16 v[124:127], v[56:59], v[48:51], v[124:127]
    ds_read_b64_tr_b16 v[56:57], v167 offset:8192
    ds_read_b64_tr_b16 v[58:59], v167 offset:9216
    s_waitcnt lgkmcnt(6)
    v_mfma_f32_16x16x32_bf16 v[64:67], v[36:39], v[28:31], v[64:67]
    ds_read_b128 v[44:47], v11 offset:6144
    v_mfma_f32_16x16x32_bf16 v[68:71], v[36:39], v[32:35], v[68:71]
    ds_read_b128 v[48:51], v11 offset:6400
    s_waitcnt lgkmcnt(6)
    v_mfma_f32_16x16x32_bf16 v[72:75], v[40:43], v[28:31], v[72:75]
    v_mfma_f32_16x16x32_bf16 v[76:79], v[40:43], v[32:35], v[76:79]
    s_waitcnt lgkmcnt(4)
    v_mfma_f32_16x16x32_bf16 v[80:83], v[52:55], v[28:31], v[80:83]
    v_mfma_f32_16x16x32_bf16 v[84:87], v[52:55], v[32:35], v[84:87]
    s_waitcnt lgkmcnt(2)
    v_mfma_f32_16x16x32_bf16 v[88:91], v[56:59], v[28:31], v[88:91]
    v_mfma_f32_16x16x32_bf16 v[92:95], v[56:59], v[32:35], v[92:95]
    s_waitcnt lgkmcnt(0) vmcnt(6)
    s_barrier
    v_mfma_f32_16x16x32_bf16 v[96:99], v[36:39], v[44:47], v[96:99]
    ds_read_b128 v[28:31], v12 offset:0
    s_mov_b32 m0, s100
    s_nop 0
    buffer_load_dwordx4 v249, s[60:63], s85 offen offset:0 lds
    v_mfma_f32_16x16x32_bf16 v[100:103], v[36:39], v[48:51], v[100:103]
    ds_read_b128 v[32:35], v12 offset:256
    ds_read_b64_tr_b16 v[36:37], v168 offset:0
    ds_read_b64_tr_b16 v[38:39], v168 offset:1024
    buffer_load_dwordx4 v250, s[60:63], s85 offen offset:1024 lds
    s_add_u32 s85, s85, s87
    v_mfma_f32_16x16x32_bf16 v[104:107], v[40:43], v[44:47], v[104:107]
    s_mov_b32 m0, s97
    s_nop 0
    buffer_load_dwordx4 v248, s[56:59], s84 offen offset:0 lds
    v_mfma_f32_16x16x32_bf16 v[108:111], v[40:43], v[48:51], v[108:111]
    ds_read_b64_tr_b16 v[40:41], v169 offset:0
    ds_read_b64_tr_b16 v[42:43], v169 offset:1024
    v_mfma_f32_16x16x32_bf16 v[112:115], v[52:55], v[44:47], v[112:115]
    buffer_load_dwordx4 v248, s[56:59], s84 offen offset:1024 lds
    v_mfma_f32_16x16x32_bf16 v[116:119], v[52:55], v[48:51], v[116:119]
    ds_read_b64_tr_b16 v[52:53], v170 offset:0
    ds_read_b64_tr_b16 v[54:55], v170 offset:1024
    buffer_load_dwordx4 v248, s[56:59], s84 offen offset:2048 lds
    v_mfma_f32_16x16x32_bf16 v[120:123], v[56:59], v[44:47], v[120:123]
    buffer_load_dwordx4 v248, s[56:59], s84 offen offset:3072 lds
    s_add_u32 s84, s84, s86
    v_mfma_f32_16x16x32_bf16 v[124:127], v[56:59], v[48:51], v[124:127]
    ds_read_b64_tr_b16 v[56:57], v171 offset:0
    ds_read_b64_tr_b16 v[58:59], v171 offset:1024
    s_waitcnt lgkmcnt(6)
    v_mfma_f32_16x16x32_bf16 v[64:67], v[36:39], v[28:31], v[64:67]
    ds_read_b128 v[44:47], v12 offset:4096
    v_mfma_f32_16x16x32_bf16 v[68:71], v[36:39], v[32:35], v[68:71]
    ds_read_b128 v[48:51], v12 offset:4352
    s_waitcnt lgkmcnt(6)
    v_mfma_f32_16x16x32_bf16 v[72:75], v[40:43], v[28:31], v[72:75]
    v_mfma_f32_16x16x32_bf16 v[76:79], v[40:43], v[32:35], v[76:79]
    s_waitcnt lgkmcnt(4)
    v_mfma_f32_16x16x32_bf16 v[80:83], v[52:55], v[28:31], v[80:83]
    v_mfma_f32_16x16x32_bf16 v[84:87], v[52:55], v[32:35], v[84:87]
    s_waitcnt lgkmcnt(2)
    v_mfma_f32_16x16x32_bf16 v[88:91], v[56:59], v[28:31], v[88:91]
    v_mfma_f32_16x16x32_bf16 v[92:95], v[56:59], v[32:35], v[92:95]
    s_waitcnt lgkmcnt(1)
    v_mfma_f32_16x16x32_bf16 v[96:99], v[36:39], v[44:47], v[96:99]
    ds_read_b128 v[28:31], v12 offset:2048
    s_waitcnt lgkmcnt(1)
    v_mfma_f32_16x16x32_bf16 v[100:103], v[36:39], v[48:51], v[100:103]
    ds_read_b128 v[32:35], v12 offset:2304
    ds_read_b64_tr_b16 v[36:37], v168 offset:8192
    ds_read_b64_tr_b16 v[38:39], v168 offset:9216
    v_mfma_f32_16x16x32_bf16 v[104:107], v[40:43], v[44:47], v[104:107]
    v_mfma_f32_16x16x32_bf16 v[108:111], v[40:43], v[48:51], v[108:111]
    ds_read_b64_tr_b16 v[40:41], v169 offset:8192
    ds_read_b64_tr_b16 v[42:43], v169 offset:9216
    v_mfma_f32_16x16x32_bf16 v[112:115], v[52:55], v[44:47], v[112:115]
    v_mfma_f32_16x16x32_bf16 v[116:119], v[52:55], v[48:51], v[116:119]
    ds_read_b64_tr_b16 v[52:53], v170 offset:8192
    ds_read_b64_tr_b16 v[54:55], v170 offset:9216
    v_mfma_f32_16x16x32_bf16 v[120:123], v[56:59], v[44:47], v[120:123]
    v_mfma_f32_16x16x32_bf16 v[124:127], v[56:59], v[48:51], v[124:127]
    ds_read_b64_tr_b16 v[56:57], v171 offset:8192
    ds_read_b64_tr_b16 v[58:59], v171 offset:9216
    s_waitcnt lgkmcnt(6)
    v_mfma_f32_16x16x32_bf16 v[64:67], v[36:39], v[28:31], v[64:67]
    ds_read_b128 v[44:47], v12 offset:6144
    v_mfma_f32_16x16x32_bf16 v[68:71], v[36:39], v[32:35], v[68:71]
    ds_read_b128 v[48:51], v12 offset:6400
    s_waitcnt lgkmcnt(6)
    v_mfma_f32_16x16x32_bf16 v[72:75], v[40:43], v[28:31], v[72:75]
    v_mfma_f32_16x16x32_bf16 v[76:79], v[40:43], v[32:35], v[76:79]
    s_waitcnt lgkmcnt(4)
    v_mfma_f32_16x16x32_bf16 v[80:83], v[52:55], v[28:31], v[80:83]
    v_mfma_f32_16x16x32_bf16 v[84:87], v[52:55], v[32:35], v[84:87]
    s_waitcnt lgkmcnt(2)
    v_mfma_f32_16x16x32_bf16 v[88:91], v[56:59], v[28:31], v[88:91]
    v_mfma_f32_16x16x32_bf16 v[92:95], v[56:59], v[32:35], v[92:95]
    s_waitcnt lgkmcnt(0) vmcnt(6)
    s_barrier
    v_cmp_ne_u32 vcc, s95, v26
    s_cbranch_vccnz L_pslow_88
L_pback_89:
    s_mul_i32 s84, s64, 65536
    s_mul_i32 s85, s64, 2097152
    s_lshl_b32 s67, s66, 8
    s_sub_u32 s68, 8388608, s67
    s_add_u32 s60, s74, s67
    s_addc_u32 s61, s75, 0
    s_mov_b32 s62, s68
    s_mov_b32 s63, 0x00020000
    v_mfma_f32_16x16x32_bf16 v[96:99], v[36:39], v[44:47], v[96:99]
    ds_read_b128 v[28:31], v10 offset:0
    s_mov_b32 m0, s101
    s_nop 0
    buffer_load_dwordx4 v249, s[60:63], s85 offen offset:0 lds
    v_mfma_f32_16x16x32_bf16 v[100:103], v[36:39], v[48:51], v[100:103]
    ds_read_b128 v[32:35], v10 offset:256
    ds_read_b64_tr_b16 v[36:37], v160 offset:0
    ds_read_b64_tr_b16 v[38:39], v160 offset:1024
    buffer_load_dwordx4 v250, s[60:63], s85 offen offset:1024 lds
    s_add_u32 s85, s85, s87
    v_mfma_f32_16x16x32_bf16 v[104:107], v[40:43], v[44:47], v[104:107]
    s_mov_b32 m0, s98
    s_nop 0
    buffer_load_dwordx4 v248, s[56:59], s84 offen offset:0 lds
    v_mfma_f32_16x16x32_bf16 v[108:111], v[40:43], v[48:51], v[108:111]
    ds_read_b64_tr_b16 v[40:41], v161 offset:0
    ds_read_b64_tr_b16 v[42:43], v161 offset:1024
    v_mfma_f32_16x16x32_bf16 v[112:115], v[52:55], v[44:47], v[112:115]
    buffer_load_dwordx4 v248, s[56:59], s84 offen offset:1024 lds
    v_mfma_f32_16x16x32_bf16 v[116:119], v[52:55], v[48:51], v[116:119]
    ds_read_b64_tr_b16 v[52:53], v162 offset:0
    ds_read_b64_tr_b16 v[54:55], v162 offset:1024
    buffer_load_dwordx4 v248, s[56:59], s84 offen offset:2048 lds
    v_mfma_f32_16x16x32_bf16 v[120:123], v[56:59], v[44:47], v[120:123]
    buffer_load_dwordx4 v248, s[56:59], s84 offen offset:3072 lds
    s_add_u32 s84, s84, s86
    v_mfma_f32_16x16x32_bf16 v[124:127], v[56:59], v[48:51], v[124:127]
    ds_read_b64_tr_b16 v[56:57], v163 offset:0
    ds_read_b64_tr_b16 v[58:59], v163 offset:1024
    s_mov_b32 s91, 5
L_ob_loop_90:
    s_waitcnt lgkmcnt(6)
    v_mfma_f32_16x16x32_bf16 v[64:67], v[36:39], v[28:31], v[64:67]
    ds_read_b128 v[44:47], v10 offset:4096
    v_mfma_f32_16x16x32_bf16 v[68:71], v[36:39], v[32:35], v[68:71]
    ds_read_b128 v[48:51], v10 offset:4352
    s_waitcnt lgkmcnt(6)
    v_mfma_f32_16x16x32_bf16 v[72:75], v[40:43], v[28:31], v[72:75]
    v_mfma_f32_16x16x32_bf16 v[76:79], v[40:43], v[32:35], v[76:79]
    s_waitcnt lgkmcnt(4)
    v_mfma_f32_16x16x32_bf16 v[80:83], v[52:55], v[28:31], v[80:83]
    v_mfma_f32_16x16x32_bf16 v[84:87], v[52:55], v[32:35], v[84:87]
    s_waitcnt lgkmcnt(2)
    v_mfma_f32_16x16x32_bf16 v[88:91], v[56:59], v[28:31], v[88:91]
    v_mfma_f32_16x16x32_bf16 v[92:95], v[56:59], v[32:35], v[92:95]
    s_waitcnt lgkmcnt(1)
    v_mfma_f32_16x16x32_bf16 v[96:99], v[36:39], v[44:47], v[96:99]
    ds_read_b128 v[28:31], v10 offset:2048
    s_waitcnt lgkmcnt(1)
    v_mfma_f32_16x16x32_bf16 v[100:103], v[36:39], v[48:51], v[100:103]
    ds_read_b128 v[32:35], v10 offset:2304
    ds_read_b64_tr_b16 v[36:37], v160 offset:8192
    ds_read_b64_tr_b16 v[38:39], v160 offset:9216
    v_mfma_f32_16x16x32_bf16 v[104:107], v[40:43], v[44:47], v[104:107]
    v_mfma_f32_16x16x32_bf16 v[108:111], v[40:43], v[48:51], v[108:111]
    ds_read_b64_tr_b16 v[40:41], v161 offset:8192
    ds_read_b64_tr_b16 v[42:43], v161 offset:9216
    v_mfma_f32_16x16x32_bf16 v[112:115], v[52:55], v[44:47], v[112:115]
    v_mfma_f32_16x16x32_bf16 v[116:119], v[52:55], v[48:51], v[116:119]
    ds_read_b64_tr_b16 v[52:53], v162 offset:8192
    ds_read_b64_tr_b16 v[54:55], v162 offset:9216
    v_mfma_f32_16x16x32_bf16 v[120:123], v[56:59], v[44:47], v[120:123]
    v_mfma_f32_16x16x32_bf16 v[124:127], v[56:59], v[48:51], v[124:127]
    ds_read_b64_tr_b16 v[56:57], v163 offset:8192
    ds_read_b64_tr_b16 v[58:59], v163 offset:9216
    s_waitcnt lgkmcnt(6)
    v_mfma_f32_16x16x32_bf16 v[64:67], v[36:39], v[28:31], v[64:67]
    ds_read_b128 v[44:47], v10 offset:6144
    v_mfma_f32_16x16x32_bf16 v[68:71], v[36:39], v[32:35], v[68:71]
    ds_read_b128 v[48:51], v10 offset:6400
    s_waitcnt lgkmcnt(6)
    v_mfma_f32_16x16x32_bf16 v[72:75], v[40:43], v[28:31], v[72:75]
    v_mfma_f32_16x16x32_bf16 v[76:79], v[40:43], v[32:35], v[76:79]
    s_waitcnt lgkmcnt(4)
    v_mfma_f32_16x16x32_bf16 v[80:83], v[52:55], v[28:31], v[80:83]
    v_mfma_f32_16x16x32_bf16 v[84:87], v[52:55], v[32:35], v[84:87]
    s_waitcnt lgkmcnt(2)
    v_mfma_f32_16x16x32_bf16 v[88:91], v[56:59], v[28:31], v[88:91]
    v_mfma_f32_16x16x32_bf16 v[92:95], v[56:59], v[32:35], v[92:95]
    s_waitcnt lgkmcnt(0) vmcnt(6)
    s_barrier
    v_mfma_f32_16x16x32_bf16 v[96:99], v[36:39], v[44:47], v[96:99]
    ds_read_b128 v[28:31], v11 offset:0
    s_mov_b32 m0, s99
    s_nop 0
    buffer_load_dwordx4 v249, s[60:63], s85 offen offset:0 lds
    v_mfma_f32_16x16x32_bf16 v[100:103], v[36:39], v[48:51], v[100:103]
    ds_read_b128 v[32:35], v11 offset:256
    ds_read_b64_tr_b16 v[36:37], v164 offset:0
    ds_read_b64_tr_b16 v[38:39], v164 offset:1024
    buffer_load_dwordx4 v250, s[60:63], s85 offen offset:1024 lds
    s_add_u32 s85, s85, s87
    v_mfma_f32_16x16x32_bf16 v[104:107], v[40:43], v[44:47], v[104:107]
    s_mov_b32 m0, s96
    s_nop 0
    buffer_load_dwordx4 v248, s[56:59], s84 offen offset:0 lds
    v_mfma_f32_16x16x32_bf16 v[108:111], v[40:43], v[48:51], v[108:111]
    ds_read_b64_tr_b16 v[40:41], v165 offset:0
    ds_read_b64_tr_b16 v[42:43], v165 offset:1024
    v_mfma_f32_16x16x32_bf16 v[112:115], v[52:55], v[44:47], v[112:115]
    buffer_load_dwordx4 v248, s[56:59], s84 offen offset:1024 lds
    v_mfma_f32_16x16x32_bf16 v[116:119], v[52:55], v[48:51], v[116:119]
    ds_read_b64_tr_b16 v[52:53], v166 offset:0
    ds_read_b64_tr_b16 v[54:55], v166 offset:1024
    buffer_load_dwordx4 v248, s[56:59], s84 offen offset:2048 lds
    v_mfma_f32_16x16x32_bf16 v[120:123], v[56:59], v[44:47], v[120:123]
    buffer_load_dwordx4 v248, s[56:59], s84 offen offset:3072 lds
    s_add_u32 s84, s84, s86
    v_mfma_f32_16x16x32_bf16 v[124:127], v[56:59], v[48:51], v[124:127]
    ds_read_b64_tr_b16 v[56:57], v167 offset:0
    ds_read_b64_tr_b16 v[58:59], v167 offset:1024
    s_waitcnt lgkmcnt(6)
    v_mfma_f32_16x16x32_bf16 v[64:67], v[36:39], v[28:31], v[64:67]
    ds_read_b128 v[44:47], v11 offset:4096
    v_mfma_f32_16x16x32_bf16 v[68:71], v[36:39], v[32:35], v[68:71]
    ds_read_b128 v[48:51], v11 offset:4352
    s_waitcnt lgkmcnt(6)
    v_mfma_f32_16x16x32_bf16 v[72:75], v[40:43], v[28:31], v[72:75]
    v_mfma_f32_16x16x32_bf16 v[76:79], v[40:43], v[32:35], v[76:79]
    s_waitcnt lgkmcnt(4)
    v_mfma_f32_16x16x32_bf16 v[80:83], v[52:55], v[28:31], v[80:83]
    v_mfma_f32_16x16x32_bf16 v[84:87], v[52:55], v[32:35], v[84:87]
    s_waitcnt lgkmcnt(2)
    v_mfma_f32_16x16x32_bf16 v[88:91], v[56:59], v[28:31], v[88:91]
    v_mfma_f32_16x16x32_bf16 v[92:95], v[56:59], v[32:35], v[92:95]
    s_waitcnt lgkmcnt(1)
    v_mfma_f32_16x16x32_bf16 v[96:99], v[36:39], v[44:47], v[96:99]
    ds_read_b128 v[28:31], v11 offset:2048
    s_waitcnt lgkmcnt(1)
    v_mfma_f32_16x16x32_bf16 v[100:103], v[36:39], v[48:51], v[100:103]
    ds_read_b128 v[32:35], v11 offset:2304
    ds_read_b64_tr_b16 v[36:37], v164 offset:8192
    ds_read_b64_tr_b16 v[38:39], v164 offset:9216
    v_mfma_f32_16x16x32_bf16 v[104:107], v[40:43], v[44:47], v[104:107]
    v_mfma_f32_16x16x32_bf16 v[108:111], v[40:43], v[48:51], v[108:111]
    ds_read_b64_tr_b16 v[40:41], v165 offset:8192
    ds_read_b64_tr_b16 v[42:43], v165 offset:9216
    v_mfma_f32_16x16x32_bf16 v[112:115], v[52:55], v[44:47], v[112:115]
    v_mfma_f32_16x16x32_bf16 v[116:119], v[52:55], v[48:51], v[116:119]
    ds_read_b64_tr_b16 v[52:53], v166 offset:8192
    ds_read_b64_tr_b16 v[54:55], v166 offset:9216
    v_mfma_f32_16x16x32_bf16 v[120:123], v[56:59], v[44:47], v[120:123]
    v_mfma_f32_16x16x32_bf16 v[124:127], v[56:59], v[48:51], v[124:127]
    ds_read_b64_tr_b16 v[56:57], v167 offset:8192
    ds_read_b64_tr_b16 v[58:59], v167 offset:9216
    s_waitcnt lgkmcnt(6)
    v_mfma_f32_16x16x32_bf16 v[64:67], v[36:39], v[28:31], v[64:67]
    ds_read_b128 v[44:47], v11 offset:6144
    v_mfma_f32_16x16x32_bf16 v[68:71], v[36:39], v[32:35], v[68:71]
    ds_read_b128 v[48:51], v11 offset:6400
    s_waitcnt lgkmcnt(6)
    v_mfma_f32_16x16x32_bf16 v[72:75], v[40:43], v[28:31], v[72:75]
    v_mfma_f32_16x16x32_bf16 v[76:79], v[40:43], v[32:35], v[76:79]
    s_waitcnt lgkmcnt(4)
    v_mfma_f32_16x16x32_bf16 v[80:83], v[52:55], v[28:31], v[80:83]
    v_mfma_f32_16x16x32_bf16 v[84:87], v[52:55], v[32:35], v[84:87]
    s_waitcnt lgkmcnt(2)
    v_mfma_f32_16x16x32_bf16 v[88:91], v[56:59], v[28:31], v[88:91]
    v_mfma_f32_16x16x32_bf16 v[92:95], v[56:59], v[32:35], v[92:95]
    s_waitcnt lgkmcnt(0) vmcnt(6)
    s_barrier
    v_mfma_f32_16x16x32_bf16 v[96:99], v[36:39], v[44:47], v[96:99]
    ds_read_b128 v[28:31], v12 offset:0
    s_mov_b32 m0, s100
    s_nop 0
    buffer_load_dwordx4 v249, s[60:63], s85 offen offset:0 lds
    v_mfma_f32_16x16x32_bf16 v[100:103], v[36:39], v[48:51], v[100:103]
    ds_read_b128 v[32:35], v12 offset:256
    ds_read_b64_tr_b16 v[36:37], v168 offset:0
    ds_read_b64_tr_b16 v[38:39], v168 offset:1024
    buffer_load_dwordx4 v250, s[60:63], s85 offen offset:1024 lds
    s_add_u32 s85, s85, s87
    v_mfma_f32_16x16x32_bf16 v[104:107], v[40:43], v[44:47], v[104:107]
    s_mov_b32 m0, s97
    s_nop 0
    buffer_load_dwordx4 v248, s[56:59], s84 offen offset:0 lds
    v_mfma_f32_16x16x32_bf16 v[108:111], v[40:43], v[48:51], v[108:111]
    ds_read_b64_tr_b16 v[40:41], v169 offset:0
    ds_read_b64_tr_b16 v[42:43], v169 offset:1024
    v_mfma_f32_16x16x32_bf16 v[112:115], v[52:55], v[44:47], v[112:115]
    buffer_load_dwordx4 v248, s[56:59], s84 offen offset:1024 lds
    v_mfma_f32_16x16x32_bf16 v[116:119], v[52:55], v[48:51], v[116:119]
    ds_read_b64_tr_b16 v[52:53], v170 offset:0
    ds_read_b64_tr_b16 v[54:55], v170 offset:1024
    buffer_load_dwordx4 v248, s[56:59], s84 offen offset:2048 lds
    v_mfma_f32_16x16x32_bf16 v[120:123], v[56:59], v[44:47], v[120:123]
    buffer_load_dwordx4 v248, s[56:59], s84 offen offset:3072 lds
    s_add_u32 s84, s84, s86
    v_mfma_f32_16x16x32_bf16 v[124:127], v[56:59], v[48:51], v[124:127]
    ds_read_b64_tr_b16 v[56:57], v171 offset:0
    ds_read_b64_tr_b16 v[58:59], v171 offset:1024
    s_waitcnt lgkmcnt(6)
    v_mfma_f32_16x16x32_bf16 v[64:67], v[36:39], v[28:31], v[64:67]
    ds_read_b128 v[44:47], v12 offset:4096
    v_mfma_f32_16x16x32_bf16 v[68:71], v[36:39], v[32:35], v[68:71]
    ds_read_b128 v[48:51], v12 offset:4352
    s_waitcnt lgkmcnt(6)
    v_mfma_f32_16x16x32_bf16 v[72:75], v[40:43], v[28:31], v[72:75]
    v_mfma_f32_16x16x32_bf16 v[76:79], v[40:43], v[32:35], v[76:79]
    s_waitcnt lgkmcnt(4)
    v_mfma_f32_16x16x32_bf16 v[80:83], v[52:55], v[28:31], v[80:83]
    v_mfma_f32_16x16x32_bf16 v[84:87], v[52:55], v[32:35], v[84:87]
    s_waitcnt lgkmcnt(2)
    v_mfma_f32_16x16x32_bf16 v[88:91], v[56:59], v[28:31], v[88:91]
    v_mfma_f32_16x16x32_bf16 v[92:95], v[56:59], v[32:35], v[92:95]
    s_waitcnt lgkmcnt(1)
    v_mfma_f32_16x16x32_bf16 v[96:99], v[36:39], v[44:47], v[96:99]
    ds_read_b128 v[28:31], v12 offset:2048
    s_waitcnt lgkmcnt(1)
    v_mfma_f32_16x16x32_bf16 v[100:103], v[36:39], v[48:51], v[100:103]
    ds_read_b128 v[32:35], v12 offset:2304
    ds_read_b64_tr_b16 v[36:37], v168 offset:8192
    ds_read_b64_tr_b16 v[38:39], v168 offset:9216
    v_mfma_f32_16x16x32_bf16 v[104:107], v[40:43], v[44:47], v[104:107]
    v_mfma_f32_16x16x32_bf16 v[108:111], v[40:43], v[48:51], v[108:111]
    ds_read_b64_tr_b16 v[40:41], v169 offset:8192
    ds_read_b64_tr_b16 v[42:43], v169 offset:9216
    v_mfma_f32_16x16x32_bf16 v[112:115], v[52:55], v[44:47], v[112:115]
    v_mfma_f32_16x16x32_bf16 v[116:119], v[52:55], v[48:51], v[116:119]
    ds_read_b64_tr_b16 v[52:53], v170 offset:8192
    ds_read_b64_tr_b16 v[54:55], v170 offset:9216
    v_mfma_f32_16x16x32_bf16 v[120:123], v[56:59], v[44:47], v[120:123]
    v_mfma_f32_16x16x32_bf16 v[124:127], v[56:59], v[48:51], v[124:127]
    ds_read_b64_tr_b16 v[56:57], v171 offset:8192
    ds_read_b64_tr_b16 v[58:59], v171 offset:9216
    s_waitcnt lgkmcnt(6)
    v_mfma_f32_16x16x32_bf16 v[64:67], v[36:39], v[28:31], v[64:67]
    ds_read_b128 v[44:47], v12 offset:6144
    v_mfma_f32_16x16x32_bf16 v[68:71], v[36:39], v[32:35], v[68:71]
    ds_read_b128 v[48:51], v12 offset:6400
    s_waitcnt lgkmcnt(6)
    v_mfma_f32_16x16x32_bf16 v[72:75], v[40:43], v[28:31], v[72:75]
    v_mfma_f32_16x16x32_bf16 v[76:79], v[40:43], v[32:35], v[76:79]
    s_waitcnt lgkmcnt(4)
    v_mfma_f32_16x16x32_bf16 v[80:83], v[52:55], v[28:31], v[80:83]
    v_mfma_f32_16x16x32_bf16 v[84:87], v[52:55], v[32:35], v[84:87]
    s_waitcnt lgkmcnt(2)
    v_mfma_f32_16x16x32_bf16 v[88:91], v[56:59], v[28:31], v[88:91]
    v_mfma_f32_16x16x32_bf16 v[92:95], v[56:59], v[32:35], v[92:95]
    s_waitcnt lgkmcnt(0) vmcnt(6)
    s_barrier
    v_mfma_f32_16x16x32_bf16 v[96:99], v[36:39], v[44:47], v[96:99]
    ds_read_b128 v[28:31], v10 offset:0
    s_mov_b32 m0, s101
    s_nop 0
    buffer_load_dwordx4 v249, s[60:63], s85 offen offset:0 lds
    v_mfma_f32_16x16x32_bf16 v[100:103], v[36:39], v[48:51], v[100:103]
    ds_read_b128 v[32:35], v10 offset:256
    ds_read_b64_tr_b16 v[36:37], v160 offset:0
    ds_read_b64_tr_b16 v[38:39], v160 offset:1024
    buffer_load_dwordx4 v250, s[60:63], s85 offen offset:1024 lds
    s_add_u32 s85, s85, s87
    v_mfma_f32_16x16x32_bf16 v[104:107], v[40:43], v[44:47], v[104:107]
    s_mov_b32 m0, s98
    s_nop 0
    buffer_load_dwordx4 v248, s[56:59], s84 offen offset:0 lds
    v_mfma_f32_16x16x32_bf16 v[108:111], v[40:43], v[48:51], v[108:111]
    ds_read_b64_tr_b16 v[40:41], v161 offset:0
    ds_read_b64_tr_b16 v[42:43], v161 offset:1024
    v_mfma_f32_16x16x32_bf16 v[112:115], v[52:55], v[44:47], v[112:115]
    buffer_load_dwordx4 v248, s[56:59], s84 offen offset:1024 lds
    v_mfma_f32_16x16x32_bf16 v[116:119], v[52:55], v[48:51], v[116:119]
    ds_read_b64_tr_b16 v[52:53], v162 offset:0
    ds_read_b64_tr_b16 v[54:55], v162 offset:1024
    buffer_load_dwordx4 v248, s[56:59], s84 offen offset:2048 lds
    v_mfma_f32_16x16x32_bf16 v[120:123], v[56:59], v[44:47], v[120:123]
    buffer_load_dwordx4 v248, s[56:59], s84 offen offset:3072 lds
    s_add_u32 s84, s84, s86
    v_mfma_f32_16x16x32_bf16 v[124:127], v[56:59], v[48:51], v[124:127]
    ds_read_b64_tr_b16 v[56:57], v163 offset:0
    ds_read_b64_tr_b16 v[58:59], v163 offset:1024
    s_sub_u32 s91, s91, 1
    s_cmp_lg_u32 s91, 0
    s_cbranch_scc1 L_ob_loop_90
    s_waitcnt lgkmcnt(6)
    v_mfma_f32_16x16x32_bf16 v[64:67], v[36:39], v[28:31], v[64:67]
    ds_read_b128 v[44:47], v10 offset:4096
    v_mfma_f32_16x16x32_bf16 v[68:71], v[36:39], v[32:35], v[68:71]
    ds_read_b128 v[48:51], v10 offset:4352
    s_waitcnt lgkmcnt(6)
    v_mfma_f32_16x16x32_bf16 v[72:75], v[40:43], v[28:31], v[72:75]
    v_mfma_f32_16x16x32_bf16 v[76:79], v[40:43], v[32:35], v[76:79]
    s_waitcnt lgkmcnt(4)
    v_mfma_f32_16x16x32_bf16 v[80:83], v[52:55], v[28:31], v[80:83]
    v_mfma_f32_16x16x32_bf16 v[84:87], v[52:55], v[32:35], v[84:87]
    s_waitcnt lgkmcnt(2)
    v_mfma_f32_16x16x32_bf16 v[88:91], v[56:59], v[28:31], v[88:91]
    v_mfma_f32_16x16x32_bf16 v[92:95], v[56:59], v[32:35], v[92:95]
    s_waitcnt lgkmcnt(1)
    v_mfma_f32_16x16x32_bf16 v[96:99], v[36:39], v[44:47], v[96:99]
    ds_read_b128 v[28:31], v10 offset:2048
    s_waitcnt lgkmcnt(1)
    v_mfma_f32_16x16x32_bf16 v[100:103], v[36:39], v[48:51], v[100:103]
    ds_read_b128 v[32:35], v10 offset:2304
    ds_read_b64_tr_b16 v[36:37], v160 offset:8192
    ds_read_b64_tr_b16 v[38:39], v160 offset:9216
    v_mfma_f32_16x16x32_bf16 v[104:107], v[40:43], v[44:47], v[104:107]
    v_mfma_f32_16x16x32_bf16 v[108:111], v[40:43], v[48:51], v[108:111]
    ds_read_b64_tr_b16 v[40:41], v161 offset:8192
    ds_read_b64_tr_b16 v[42:43], v161 offset:9216
    v_mfma_f32_16x16x32_bf16 v[112:115], v[52:55], v[44:47], v[112:115]
    v_mfma_f32_16x16x32_bf16 v[116:119], v[52:55], v[48:51], v[116:119]
    ds_read_b64_tr_b16 v[52:53], v162 offset:8192
    ds_read_b64_tr_b16 v[54:55], v162 offset:9216
    v_mfma_f32_16x16x32_bf16 v[120:123], v[56:59], v[44:47], v[120:123]
    v_mfma_f32_16x16x32_bf16 v[124:127], v[56:59], v[48:51], v[124:127]
    ds_read_b64_tr_b16 v[56:57], v163 offset:8192
    ds_read_b64_tr_b16 v[58:59], v163 offset:9216
    s_waitcnt lgkmcnt(6)
    v_mfma_f32_16x16x32_bf16 v[64:67], v[36:39], v[28:31], v[64:67]
    ds_read_b128 v[44:47], v10 offset:6144
    v_mfma_f32_16x16x32_bf16 v[68:71], v[36:39], v[32:35], v[68:71]
    ds_read_b128 v[48:51], v10 offset:6400
    s_waitcnt lgkmcnt(6)
    v_mfma_f32_16x16x32_bf16 v[72:75], v[40:43], v[28:31], v[72:75]
    v_mfma_f32_16x16x32_bf16 v[76:79], v[40:43], v[32:35], v[76:79]
    s_waitcnt lgkmcnt(4)
    v_mfma_f32_16x16x32_bf16 v[80:83], v[52:55], v[28:31], v[80:83]
    v_mfma_f32_16x16x32_bf16 v[84:87], v[52:55], v[32:35], v[84:87]
    s_waitcnt lgkmcnt(2)
    v_mfma_f32_16x16x32_bf16 v[88:91], v[56:59], v[28:31], v[88:91]
    v_mfma_f32_16x16x32_bf16 v[92:95], v[56:59], v[32:35], v[92:95]
    s_waitcnt lgkmcnt(0) vmcnt(6)
    s_barrier
    v_mfma_f32_16x16x32_bf16 v[96:99], v[36:39], v[44:47], v[96:99]
    ds_read_b128 v[28:31], v11 offset:0
    v_mfma_f32_16x16x32_bf16 v[100:103], v[36:39], v[48:51], v[100:103]
    ds_read_b128 v[32:35], v11 offset:256
    ds_read_b64_tr_b16 v[36:37], v164 offset:0
    ds_read_b64_tr_b16 v[38:39], v164 offset:1024
    v_mfma_f32_16x16x32_bf16 v[104:107], v[40:43], v[44:47], v[104:107]
    v_mfma_f32_16x16x32_bf16 v[108:111], v[40:43], v[48:51], v[108:111]
    ds_read_b64_tr_b16 v[40:41], v165 offset:0
    ds_read_b64_tr_b16 v[42:43], v165 offset:1024
    v_mfma_f32_16x16x32_bf16 v[112:115], v[52:55], v[44:47], v[112:115]
    v_mfma_f32_16x16x32_bf16 v[116:119], v[52:55], v[48:51], v[116:119]
    ds_read_b64_tr_b16 v[52:53], v166 offset:0
    ds_read_b64_tr_b16 v[54:55], v166 offset:1024
    v_mfma_f32_16x16x32_bf16 v[120:123], v[56:59], v[44:47], v[120:123]
    v_mfma_f32_16x16x32_bf16 v[124:127], v[56:59], v[48:51], v[124:127]
    ds_read_b64_tr_b16 v[56:57], v167 offset:0
    ds_read_b64_tr_b16 v[58:59], v167 offset:1024
    s_waitcnt lgkmcnt(6)
    v_mfma_f32_16x16x32_bf16 v[64:67], v[36:39], v[28:31], v[64:67]
    ds_read_b128 v[44:47], v11 offset:4096
    v_mfma_f32_16x16x32_bf16 v[68:71], v[36:39], v[32:35], v[68:71]
    ds_read_b128 v[48:51], v11 offset:4352
    s_waitcnt lgkmcnt(6)
    v_mfma_f32_16x16x32_bf16 v[72:75], v[40:43], v[28:31], v[72:75]
    v_mfma_f32_16x16x32_bf16 v[76:79], v[40:43], v[32:35], v[76:79]
    s_waitcnt lgkmcnt(4)
    v_mfma_f32_16x16x32_bf16 v[80:83], v[52:55], v[28:31], v[80:83]
    v_mfma_f32_16x16x32_bf16 v[84:87], v[52:55], v[32:35], v[84:87]
    s_waitcnt lgkmcnt(2)
    v_mfma_f32_16x16x32_bf16 v[88:91], v[56:59], v[28:31], v[88:91]
    v_mfma_f32_16x16x32_bf16 v[92:95], v[56:59], v[32:35], v[92:95]
    s_waitcnt lgkmcnt(1)
    v_mfma_f32_16x16x32_bf16 v[96:99], v[36:39], v[44:47], v[96:99]
    ds_read_b128 v[28:31], v11 offset:2048
    s_waitcnt lgkmcnt(1)
    v_mfma_f32_16x16x32_bf16 v[100:103], v[36:39], v[48:51], v[100:103]
    ds_read_b128 v[32:35], v11 offset:2304
    ds_read_b64_tr_b16 v[36:37], v164 offset:8192
    ds_read_b64_tr_b16 v[38:39], v164 offset:9216
    v_mfma_f32_16x16x32_bf16 v[104:107], v[40:43], v[44:47], v[104:107]
    v_mfma_f32_16x16x32_bf16 v[108:111], v[40:43], v[48:51], v[108:111]
    ds_read_b64_tr_b16 v[40:41], v165 offset:8192
    ds_read_b64_tr_b16 v[42:43], v165 offset:9216
    v_mfma_f32_16x16x32_bf16 v[112:115], v[52:55], v[44:47], v[112:115]
    v_mfma_f32_16x16x32_bf16 v[116:119], v[52:55], v[48:51], v[116:119]
    ds_read_b64_tr_b16 v[52:53], v166 offset:8192
    ds_read_b64_tr_b16 v[54:55], v166 offset:9216
    v_mfma_f32_16x16x32_bf16 v[120:123], v[56:59], v[44:47], v[120:123]
    v_mfma_f32_16x16x32_bf16 v[124:127], v[56:59], v[48:51], v[124:127]
    ds_read_b64_tr_b16 v[56:57], v167 offset:8192
    ds_read_b64_tr_b16 v[58:59], v167 offset:9216
    s_waitcnt lgkmcnt(6)
    v_mfma_f32_16x16x32_bf16 v[64:67], v[36:39], v[28:31], v[64:67]
    ds_read_b128 v[44:47], v11 offset:6144
    v_mfma_f32_16x16x32_bf16 v[68:71], v[36:39], v[32:35], v[68:71]
    ds_read_b128 v[48:51], v11 offset:6400
    s_waitcnt lgkmcnt(6)
    v_mfma_f32_16x16x32_bf16 v[72:75], v[40:43], v[28:31], v[72:75]
    v_mfma_f32_16x16x32_bf16 v[76:79], v[40:43], v[32:35], v[76:79]
    s_waitcnt lgkmcnt(4)
    v_mfma_f32_16x16x32_bf16 v[80:83], v[52:55], v[28:31], v[80:83]
    v_mfma_f32_16x16x32_bf16 v[84:87], v[52:55], v[32:35], v[84:87]
    s_waitcnt lgkmcnt(2)
    v_mfma_f32_16x16x32_bf16 v[88:91], v[56:59], v[28:31], v[88:91]
    v_mfma_f32_16x16x32_bf16 v[92:95], v[56:59], v[32:35], v[92:95]
    s_waitcnt lgkmcnt(0) vmcnt(0)
    s_barrier
    v_mfma_f32_16x16x32_bf16 v[96:99], v[36:39], v[44:47], v[96:99]
    ds_read_b128 v[28:31], v12 offset:0
    v_mfma_f32_16x16x32_bf16 v[100:103], v[36:39], v[48:51], v[100:103]
    ds_read_b128 v[32:35], v12 offset:256
    ds_read_b64_tr_b16 v[36:37], v168 offset:0
    ds_read_b64_tr_b16 v[38:39], v168 offset:1024
    v_mfma_f32_16x16x32_bf16 v[104:107], v[40:43], v[44:47], v[104:107]
    v_mfma_f32_16x16x32_bf16 v[108:111], v[40:43], v[48:51], v[108:111]
    ds_read_b64_tr_b16 v[40:41], v169 offset:0
    ds_read_b64_tr_b16 v[42:43], v169 offset:1024
    v_mfma_f32_16x16x32_bf16 v[112:115], v[52:55], v[44:47], v[112:115]
    v_mfma_f32_16x16x32_bf16 v[116:119], v[52:55], v[48:51], v[116:119]
    ds_read_b64_tr_b16 v[52:53], v170 offset:0
    ds_read_b64_tr_b16 v[54:55], v170 offset:1024
    v_mfma_f32_16x16x32_bf16 v[120:123], v[56:59], v[44:47], v[120:123]
    v_mfma_f32_16x16x32_bf16 v[124:127], v[56:59], v[48:51], v[124:127]
    ds_read_b64_tr_b16 v[56:57], v171 offset:0
    ds_read_b64_tr_b16 v[58:59], v171 offset:1024
    s_waitcnt lgkmcnt(6)
    v_mfma_f32_16x16x32_bf16 v[64:67], v[36:39], v[28:31], v[64:67]
    ds_read_b128 v[44:47], v12 offset:4096
    v_mfma_f32_16x16x32_bf16 v[68:71], v[36:39], v[32:35], v[68:71]
    ds_read_b128 v[48:51], v12 offset:4352
    s_waitcnt lgkmcnt(6)
    v_mfma_f32_16x16x32_bf16 v[72:75], v[40:43], v[28:31], v[72:75]
    v_mfma_f32_16x16x32_bf16 v[76:79], v[40:43], v[32:35], v[76:79]
    s_waitcnt lgkmcnt(4)
    v_mfma_f32_16x16x32_bf16 v[80:83], v[52:55], v[28:31], v[80:83]
    v_mfma_f32_16x16x32_bf16 v[84:87], v[52:55], v[32:35], v[84:87]
    s_waitcnt lgkmcnt(2)
    v_mfma_f32_16x16x32_bf16 v[88:91], v[56:59], v[28:31], v[88:91]
    v_mfma_f32_16x16x32_bf16 v[92:95], v[56:59], v[32:35], v[92:95]
    s_waitcnt lgkmcnt(1)
    v_mfma_f32_16x16x32_bf16 v[96:99], v[36:39], v[44:47], v[96:99]
    ds_read_b128 v[28:31], v12 offset:2048
    s_waitcnt lgkmcnt(1)
    v_mfma_f32_16x16x32_bf16 v[100:103], v[36:39], v[48:51], v[100:103]
    ds_read_b128 v[32:35], v12 offset:2304
    ds_read_b64_tr_b16 v[36:37], v168 offset:8192
    ds_read_b64_tr_b16 v[38:39], v168 offset:9216
    v_mfma_f32_16x16x32_bf16 v[104:107], v[40:43], v[44:47], v[104:107]
    v_mfma_f32_16x16x32_bf16 v[108:111], v[40:43], v[48:51], v[108:111]
    ds_read_b64_tr_b16 v[40:41], v169 offset:8192
    ds_read_b64_tr_b16 v[42:43], v169 offset:9216
    v_mfma_f32_16x16x32_bf16 v[112:115], v[52:55], v[44:47], v[112:115]
    v_mfma_f32_16x16x32_bf16 v[116:119], v[52:55], v[48:51], v[116:119]
    ds_read_b64_tr_b16 v[52:53], v170 offset:8192
    ds_read_b64_tr_b16 v[54:55], v170 offset:9216
    v_mfma_f32_16x16x32_bf16 v[120:123], v[56:59], v[44:47], v[120:123]
    v_mfma_f32_16x16x32_bf16 v[124:127], v[56:59], v[48:51], v[124:127]
    ds_read_b64_tr_b16 v[56:57], v171 offset:8192
    ds_read_b64_tr_b16 v[58:59], v171 offset:9216
    s_waitcnt lgkmcnt(6)
    v_mfma_f32_16x16x32_bf16 v[64:67], v[36:39], v[28:31], v[64:67]
    ds_read_b128 v[44:47], v12 offset:6144
    v_mfma_f32_16x16x32_bf16 v[68:71], v[36:39], v[32:35], v[68:71]
    ds_read_b128 v[48:51], v12 offset:6400
    s_waitcnt lgkmcnt(6)
    v_mfma_f32_16x16x32_bf16 v[72:75], v[40:43], v[28:31], v[72:75]
    v_mfma_f32_16x16x32_bf16 v[76:79], v[40:43], v[32:35], v[76:79]
    s_waitcnt lgkmcnt(4)
    v_mfma_f32_16x16x32_bf16 v[80:83], v[52:55], v[28:31], v[80:83]
    v_mfma_f32_16x16x32_bf16 v[84:87], v[52:55], v[32:35], v[84:87]
    s_waitcnt lgkmcnt(2)
    v_mfma_f32_16x16x32_bf16 v[88:91], v[56:59], v[28:31], v[88:91]
    v_mfma_f32_16x16x32_bf16 v[92:95], v[56:59], v[32:35], v[92:95]
    s_waitcnt lgkmcnt(1)
    v_mfma_f32_16x16x32_bf16 v[96:99], v[36:39], v[44:47], v[96:99]
    s_waitcnt lgkmcnt(0)
    v_mfma_f32_16x16x32_bf16 v[100:103], v[36:39], v[48:51], v[100:103]
    v_mfma_f32_16x16x32_bf16 v[104:107], v[40:43], v[44:47], v[104:107]
    v_mfma_f32_16x16x32_bf16 v[108:111], v[40:43], v[48:51], v[108:111]
    v_mfma_f32_16x16x32_bf16 v[112:115], v[52:55], v[44:47], v[112:115]
    v_mfma_f32_16x16x32_bf16 v[116:119], v[52:55], v[48:51], v[116:119]
    v_mfma_f32_16x16x32_bf16 v[120:123], v[56:59], v[44:47], v[120:123]
    v_mfma_f32_16x16x32_bf16 v[124:127], v[56:59], v[48:51], v[124:127]
    s_nop 15
    s_load_dwordx2 s[40:41], s[0:1], 0
    s_load_dwordx4 s[44:47], s[0:1], 80
    s_lshl3_add_u32 s67, s65, s66
    s_lshl_b32 s70, s67, 19
    s_lshl_b32 s71, s78, 14
    s_add_u32 s70, s70, s71
    s_add_u32 s12, s48, 88080384
    s_addc_u32 s13, s49, 0
    s_mov_b32 s14, 33554432
    s_mov_b32 s15, 0x00020000
    s_lshl3_add_u32 s67, s67, s78
    s_lshl_b32 s67, s67, 6
    s_lshl_b32 s71, s64, 17
    s_add_u32 s71, s71, s70
    s_cmp_lg_u32 s64, 0
    s_cbranch_scc1 L_ao_v1
    s_add_u32 s72, s71, 4096
    v_cvt_pk_bf16_f32 v80, v80, v81
    v_cvt_pk_bf16_f32 v81, v82, v83
    v_cvt_pk_bf16_f32 v82, v84, v85
    v_cvt_pk_bf16_f32 v83, v86, v87
    v_cvt_pk_bf16_f32 v84, v88, v89
    v_cvt_pk_bf16_f32 v85, v90, v91
    v_cvt_pk_bf16_f32 v86, v92, v93
    v_cvt_pk_bf16_f32 v87, v94, v95
    buffer_store_dwordx4 v[80:83], v1, s[12:15], s72 offen offset:0 sc1
    buffer_store_dwordx4 v[84:87], v1, s[12:15], s72 offen offset:1024 sc1
    s_add_u32 s72, s71, 8192
    v_cvt_pk_bf16_f32 v96, v96, v97
    v_cvt_pk_bf16_f32 v97, v98, v99
    v_cvt_pk_bf16_f32 v98, v100, v101
    v_cvt_pk_bf16_f32 v99, v102, v103
    v_cvt_pk_bf16_f32 v100, v104, v105
    v_cvt_pk_bf16_f32 v101, v106, v107
    v_cvt_pk_bf16_f32 v102, v108, v109
    v_cvt_pk_bf16_f32 v103, v110, v111
    buffer_store_dwordx4 v[96:99], v1, s[12:15], s72 offen offset:0 sc1
    buffer_store_dwordx4 v[100:103], v1, s[12:15], s72 offen offset:1024 sc1
    s_add_u32 s72, s71, 12288
    v_cvt_pk_bf16_f32 v112, v112, v113
    v_cvt_pk_bf16_f32 v113, v114, v115
    v_cvt_pk_bf16_f32 v114, v116, v117
    v_cvt_pk_bf16_f32 v115, v118, v119
    v_cvt_pk_bf16_f32 v116, v120, v121
    v_cvt_pk_bf16_f32 v117, v122, v123
    v_cvt_pk_bf16_f32 v118, v124, v125
    v_cvt_pk_bf16_f32 v119, v126, v127
    buffer_store_dwordx4 v[112:115], v1, s[12:15], s72 offen offset:0 sc1
    buffer_store_dwordx4 v[116:119], v1, s[12:15], s72 offen offset:1024 sc1
    v_mov_b32 v128, v64
    v_mov_b32 v129, v65
    v_mov_b32 v130, v66
    v_mov_b32 v131, v67
    v_mov_b32 v132, v68
    v_mov_b32 v133, v69
    v_mov_b32 v134, v70
    v_mov_b32 v135, v71
    v_mov_b32 v136, v72
    v_mov_b32 v137, v73
    v_mov_b32 v138, v74
    v_mov_b32 v139, v75
    v_mov_b32 v140, v76
    v_mov_b32 v141, v77
    v_mov_b32 v142, v78
    v_mov_b32 v143, v79
    s_branch L_ao_v4
L_ao_v1:
    s_cmp_lg_u32 s64, 1
    s_cbranch_scc1 L_ao_v2
    s_add_u32 s72, s71, 0
    v_cvt_pk_bf16_f32 v64, v64, v65
    v_cvt_pk_bf16_f32 v65, v66, v67
    v_cvt_pk_bf16_f32 v66, v68, v69
    v_cvt_pk_bf16_f32 v67, v70, v71
    v_cvt_pk_bf16_f32 v68, v72, v73
    v_cvt_pk_bf16_f32 v69, v74, v75
    v_cvt_pk_bf16_f32 v70, v76, v77
    v_cvt_pk_bf16_f32 v71, v78, v79
    buffer_store_dwordx4 v[64:67], v1, s[12:15], s72 offen offset:0 sc1
    buffer_store_dwordx4 v[68:71], v1, s[12:15], s72 offen offset:1024 sc1
    s_add_u32 s72, s71, 8192
    v_cvt_pk_bf16_f32 v96, v96, v97
    v_cvt_pk_bf16_f32 v97, v98, v99
    v_cvt_pk_bf16_f32 v98, v100, v101
    v_cvt_pk_bf16_f32 v99, v102, v103
    v_cvt_pk_bf16_f32 v100, v104, v105
    v_cvt_pk_bf16_f32 v101, v106, v107
    v_cvt_pk_bf16_f32 v102, v108, v109
    v_cvt_pk_bf16_f32 v103, v110, v111
    buffer_store_dwordx4 v[96:99], v1, s[12:15], s72 offen offset:0 sc1
    buffer_store_dwordx4 v[100:103], v1, s[12:15], s72 offen offset:1024 sc1
    s_add_u32 s72, s71, 12288
    v_cvt_pk_bf16_f32 v112, v112, v113
    v_cvt_pk_bf16_f32 v113, v114, v115
    v_cvt_pk_bf16_f32 v114, v116, v117
    v_cvt_pk_bf16_f32 v115, v118, v119
    v_cvt_pk_bf16_f32 v116, v120, v121
    v_cvt_pk_bf16_f32 v117, v122, v123
    v_cvt_pk_bf16_f32 v118, v124, v125
    v_cvt_pk_bf16_f32 v119, v126, v127
    buffer_store_dwordx4 v[112:115], v1, s[12:15], s72 offen offset:0 sc1
    buffer_store_dwordx4 v[116:119], v1, s[12:15], s72 offen offset:1024 sc1
    v_mov_b32 v128, v80
    v_mov_b32 v129, v81
    v_mov_b32 v130, v82
    v_mov_b32 v131, v83
    v_mov_b32 v132, v84
    v_mov_b32 v133, v85
    v_mov_b32 v134, v86
    v_mov_b32 v135, v87
    v_mov_b32 v136, v88
    v_mov_b32 v137, v89
    v_mov_b32 v138, v90
    v_mov_b32 v139, v91
    v_mov_b32 v140, v92
    v_mov_b32 v141, v93
    v_mov_b32 v142, v94
    v_mov_b32 v143, v95
    s_branch L_ao_v4
L_ao_v2:
    s_cmp_lg_u32 s64, 2
    s_cbranch_scc1 L_ao_v3
    s_add_u32 s72, s71, 0
    v_cvt_pk_bf16_f32 v64, v64, v65
    v_cvt_pk_bf16_f32 v65, v66, v67
    v_cvt_pk_bf16_f32 v66, v68, v69
    v_cvt_pk_bf16_f32 v67, v70, v71
    v_cvt_pk_bf16_f32 v68, v72, v73
    v_cvt_pk_bf16_f32 v69, v74, v75
    v_cvt_pk_bf16_f32 v70, v76, v77
    v_cvt_pk_bf16_f32 v71, v78, v79
    buffer_store_dwordx4 v[64:67], v1, s[12:15], s72 offen offset:0 sc1
    buffer_store_dwordx4 v[68:71], v1, s[12:15], s72 offen offset:1024 sc1
    s_add_u32 s72, s71, 4096
    v_cvt_pk_bf16_f32 v80, v80, v81
    v_cvt_pk_bf16_f32 v81, v82, v83
    v_cvt_pk_bf16_f32 v82, v84, v85
    v_cvt_pk_bf16_f32 v83, v86, v87
    v_cvt_pk_bf16_f32 v84, v88, v89
    v_cvt_pk_bf16_f32 v85, v90, v91
    v_cvt_pk_bf16_f32 v86, v92, v93
    v_cvt_pk_bf16_f32 v87, v94, v95
    buffer_store_dwordx4 v[80:83], v1, s[12:15], s72 offen offset:0 sc1
    buffer_store_dwordx4 v[84:87], v1, s[12:15], s72 offen offset:1024 sc1
    s_add_u32 s72, s71, 12288
    v_cvt_pk_bf16_f32 v112, v112, v113
    v_cvt_pk_bf16_f32 v113, v114, v115
    v_cvt_pk_bf16_f32 v114, v116, v117
    v_cvt_pk_bf16_f32 v115, v118, v119
    v_cvt_pk_bf16_f32 v116, v120, v121
    v_cvt_pk_bf16_f32 v117, v122, v123
    v_cvt_pk_bf16_f32 v118, v124, v125
    v_cvt_pk_bf16_f32 v119, v126, v127
    buffer_store_dwordx4 v[112:115], v1, s[12:15], s72 offen offset:0 sc1
    buffer_store_dwordx4 v[116:119], v1, s[12:15], s72 offen offset:1024 sc1
    v_mov_b32 v128, v96
    v_mov_b32 v129, v97
    v_mov_b32 v130, v98
    v_mov_b32 v131, v99
    v_mov_b32 v132, v100
    v_mov_b32 v133, v101
    v_mov_b32 v134, v102
    v_mov_b32 v135, v103
    v_mov_b32 v136, v104
    v_mov_b32 v137, v105
    v_mov_b32 v138, v106
    v_mov_b32 v139, v107
    v_mov_b32 v140, v108
    v_mov_b32 v141, v109
    v_mov_b32 v142, v110
    v_mov_b32 v143, v111
    s_branch L_ao_v4
L_ao_v3:
    s_add_u32 s72, s71, 0
    v_cvt_pk_bf16_f32 v64, v64, v65
    v_cvt_pk_bf16_f32 v65, v66, v67
    v_cvt_pk_bf16_f32 v66, v68, v69
    v_cvt_pk_bf16_f32 v67, v70, v71
    v_cvt_pk_bf16_f32 v68, v72, v73
    v_cvt_pk_bf16_f32 v69, v74, v75
    v_cvt_pk_bf16_f32 v70, v76, v77
    v_cvt_pk_bf16_f32 v71, v78, v79
    buffer_store_dwordx4 v[64:67], v1, s[12:15], s72 offen offset:0 sc1
    buffer_store_dwordx4 v[68:71], v1, s[12:15], s72 offen offset:1024 sc1
    s_add_u32 s72, s71, 4096
    v_cvt_pk_bf16_f32 v80, v80, v81
    v_cvt_pk_bf16_f32 v81, v82, v83
    v_cvt_pk_bf16_f32 v82, v84, v85
    v_cvt_pk_bf16_f32 v83, v86, v87
    v_cvt_pk_bf16_f32 v84, v88, v89
    v_cvt_pk_bf16_f32 v85, v90, v91
    v_cvt_pk_bf16_f32 v86, v92, v93
    v_cvt_pk_bf16_f32 v87, v94, v95
    buffer_store_dwordx4 v[80:83], v1, s[12:15], s72 offen offset:0 sc1
    buffer_store_dwordx4 v[84:87], v1, s[12:15], s72 offen offset:1024 sc1
    s_add_u32 s72, s71, 8192
    v_cvt_pk_bf16_f32 v96, v96, v97
    v_cvt_pk_bf16_f32 v97, v98, v99
    v_cvt_pk_bf16_f32 v98, v100, v101
    v_cvt_pk_bf16_f32 v99, v102, v103
    v_cvt_pk_bf16_f32 v100, v104, v105
    v_cvt_pk_bf16_f32 v101, v106, v107
    v_cvt_pk_bf16_f32 v102, v108, v109
    v_cvt_pk_bf16_f32 v103, v110, v111
    buffer_store_dwordx4 v[96:99], v1, s[12:15], s72 offen offset:0 sc1
    buffer_store_dwordx4 v[100:103], v1, s[12:15], s72 offen offset:1024 sc1
    v_mov_b32 v128, v112
    v_mov_b32 v129, v113
    v_mov_b32 v130, v114
    v_mov_b32 v131, v115
    v_mov_b32 v132, v116
    v_mov_b32 v133, v117
    v_mov_b32 v134, v118
    v_mov_b32 v135, v119
    v_mov_b32 v136, v120
    v_mov_b32 v137, v121
    v_mov_b32 v138, v122
    v_mov_b32 v139, v123
    v_mov_b32 v140, v124
    v_mov_b32 v141, v125
    v_mov_b32 v142, v126
    v_mov_b32 v143, v127
L_ao_v4:
    v_and_b32 v20, 31, v0
    v_lshlrev_b32 v20, 11, v20
    v_bfe_u32 v21, v0, 5, 1
    v_lshl_add_u32 v20, v21, 4, v20
    v_lshlrev_b32 v21, 4, v21
    s_lshl_b32 s72, s65, 2
    s_add_u32 s72, s72, s50
    s_lshl_b32 s72, s72, 17
    s_lshl1_add_u32 s73, s66, s51
    s_lshl_b32 s73, s73, 7
    v_mov_b32 v27, s67
    s_waitcnt lgkmcnt(0)
    s_add_u32 s4, s40, 0
    s_addc_u32 s5, s41, 0
    s_mov_b32 s6, 4194304
    s_mov_b32 s7, 0x00020000
    s_add_u32 s8, s44, 0
    s_addc_u32 s9, s45, 0
    s_mov_b32 s10, 2048
    s_mov_b32 s11, 0x00020000
    s_add_u32 s80, s46, 0
    s_addc_u32 s81, s47, 0
    s_mov_b32 s82, 4194304
    s_mov_b32 s83, 0x00020000
    s_waitcnt vmcnt(0)
    v_and_b32 v26, 7, v0
    v_lshl_add_u32 v26, v26, 2, v27
    v_mov_b32 v25, s95
    s_lshl_b32 s69, s64, 2
    s_mov_b64 exec, 1
    buffer_store_dword v25, v27, s[16:19], s69 offen sc1
    s_mov_b64 exec, -1
    s_and_b32 s76, s64, 1
    s_lshl_b32 s76, s76, 6
    s_add_u32 s76, s76, s73
    s_lshr_b32 s77, s64, 1
    s_lshl_b32 s77, s77, 16
    s_add_u32 s77, s77, s72
    s_add_u32 s77, s77, s76
    buffer_load_dwordx4 v[28:31], v20, s[4:7], s77 offen offset:0
    buffer_load_dwordx4 v[36:39], v21, s[8:11], s76 offen offset:0
    buffer_load_dwordx4 v[32:35], v20, s[4:7], s77 offen offset:32
    buffer_load_dwordx4 v[40:43], v21, s[8:11], s76 offen offset:32
    s_mov_b32 s75, 4000
    s_waitcnt vmcnt(4)
L_ao_spin:
    buffer_load_dword v25, v26, s[16:19], 0 offen sc1
    s_waitcnt vmcnt(0)
    v_cmp_eq_u32 vcc, s95, v25
    s_and_b32 s69, vcc_lo, 15
    s_bfe_u32 s74, vcc_lo, 0x40004
    s_cmp_eq_u32 s69, 15
    s_cbranch_scc1 L_ao_own
    s_cmp_eq_u32 s75, 0
    s_cbranch_scc1 L_ao_flush
    s_sleep 2
    s_sub_u32 s75, s75, 1
    s_cmp_lg_u32 s75, 0
    s_cbranch_scc1 L_ao_spin
    s_lshl_b32 s69, s64, 12
    s_add_u32 s69, s69, s71
    v_cvt_pk_bf16_f32 v144, v128, v129
    v_cvt_pk_bf16_f32 v145, v130, v131
    v_cvt_pk_bf16_f32 v146, v132, v133
    v_cvt_pk_bf16_f32 v147, v134, v135
    v_cvt_pk_bf16_f32 v148, v136, v137
    v_cvt_pk_bf16_f32 v149, v138, v139
    v_cvt_pk_bf16_f32 v150, v140, v141
    v_cvt_pk_bf16_f32 v151, v142, v143
    buffer_store_dwordx4 v[144:147], v1, s[12:15], s69 offen offset:0 sc1
    buffer_store_dwordx4 v[148:151], v1, s[12:15], s69 offen offset:1024 sc1
    s_waitcnt vmcnt(0)
    v_mov_b32 v25, s95
    s_lshl_b32 s69, s64, 2
    s_mov_b64 exec, 1
    buffer_store_dword v25, v27, s[16:19], s69 offen offset:16 sc1
    s_mov_b64 exec, -1
    s_waitcnt vmcnt(0)
    s_branch L_ao_spin
L_ao_own:
    s_bitset0_b32 s74, s64
    s_add_u32 s75, s64, 1
    s_and_b32 s75, s75, 3
    s_lshl_b32 s75, s75, 17
    s_add_u32 s75, s75, s70
    s_lshl_b32 s69, s64, 12
    s_add_u32 s75, s75, s69
    buffer_load_dwordx4 v[72:75], v1, s[12:15], s75 offen offset:0 sc1
    buffer_load_dwordx4 v[76:79], v1, s[12:15], s75 offen offset:1024 sc1
    s_add_u32 s75, s64, 2
    s_and_b32 s75, s75, 3
    s_lshl_b32 s75, s75, 17
    s_add_u32 s75, s75, s70
    s_lshl_b32 s69, s64, 12
    s_add_u32 s75, s75, s69
    buffer_load_dwordx4 v[80:83], v1, s[12:15], s75 offen offset:0 sc1
    buffer_load_dwordx4 v[84:87], v1, s[12:15], s75 offen offset:1024 sc1
    s_add_u32 s75, s64, 3
    s_and_b32 s75, s75, 3
    s_lshl_b32 s75, s75, 17
    s_add_u32 s75, s75, s70
    s_lshl_b32 s69, s64, 12
    s_add_u32 s75, s75, s69
    buffer_load_dwordx4 v[88:91], v1, s[12:15], s75 offen offset:0 sc1
    buffer_load_dwordx4 v[92:95], v1, s[12:15], s75 offen offset:1024 sc1
    s_waitcnt vmcnt(4)
    v_lshlrev_b32 v100, 16, v72
    v_and_b32 v101, 0xffff0000, v72
    v_pk_add_f32 v[128:129], v[128:129], v[100:101]
    v_lshlrev_b32 v100, 16, v73
    v_and_b32 v101, 0xffff0000, v73
    v_pk_add_f32 v[130:131], v[130:131], v[100:101]
    v_lshlrev_b32 v100, 16, v74
    v_and_b32 v101, 0xffff0000, v74
    v_pk_add_f32 v[132:133], v[132:133], v[100:101]
    v_lshlrev_b32 v100, 16, v75
    v_and_b32 v101, 0xffff0000, v75
    v_pk_add_f32 v[134:135], v[134:135], v[100:101]
    v_lshlrev_b32 v100, 16, v76
    v_and_b32 v101, 0xffff0000, v76
    v_pk_add_f32 v[136:137], v[136:137], v[100:101]
    v_lshlrev_b32 v100, 16, v77
    v_and_b32 v101, 0xffff0000, v77
    v_pk_add_f32 v[138:139], v[138:139], v[100:101]
    v_lshlrev_b32 v100, 16, v78
    v_and_b32 v101, 0xffff0000, v78
    v_pk_add_f32 v[140:141], v[140:141], v[100:101]
    v_lshlrev_b32 v100, 16, v79
    v_and_b32 v101, 0xffff0000, v79
    v_pk_add_f32 v[142:143], v[142:143], v[100:101]
    s_waitcnt vmcnt(2)
    v_lshlrev_b32 v100, 16, v80
    v_and_b32 v101, 0xffff0000, v80
    v_pk_add_f32 v[128:129], v[128:129], v[100:101]
    v_lshlrev_b32 v100, 16, v81
    v_and_b32 v101, 0xffff0000, v81
    v_pk_add_f32 v[130:131], v[130:131], v[100:101]
    v_lshlrev_b32 v100, 16, v82
    v_and_b32 v101, 0xffff0000, v82
    v_pk_add_f32 v[132:133], v[132:133], v[100:101]
    v_lshlrev_b32 v100, 16, v83
    v_and_b32 v101, 0xffff0000, v83
    v_pk_add_f32 v[134:135], v[134:135], v[100:101]
    v_lshlrev_b32 v100, 16, v84
    v_and_b32 v101, 0xffff0000, v84
    v_pk_add_f32 v[136:137], v[136:137], v[100:101]
    v_lshlrev_b32 v100, 16, v85
    v_and_b32 v101, 0xffff0000, v85
    v_pk_add_f32 v[138:139], v[138:139], v[100:101]
    v_lshlrev_b32 v100, 16, v86
    v_and_b32 v101, 0xffff0000, v86
    v_pk_add_f32 v[140:141], v[140:141], v[100:101]
    v_lshlrev_b32 v100, 16, v87
    v_and_b32 v101, 0xffff0000, v87
    v_pk_add_f32 v[142:143], v[142:143], v[100:101]
    s_waitcnt vmcnt(0)
    v_lshlrev_b32 v100, 16, v88
    v_and_b32 v101, 0xffff0000, v88
    v_pk_add_f32 v[128:129], v[128:129], v[100:101]
    v_lshlrev_b32 v100, 16, v89
    v_and_b32 v101, 0xffff0000, v89
    v_pk_add_f32 v[130:131], v[130:131], v[100:101]
    v_lshlrev_b32 v100, 16, v90
    v_and_b32 v101, 0xffff0000, v90
    v_pk_add_f32 v[132:133], v[132:133], v[100:101]
    v_lshlrev_b32 v100, 16, v91
    v_and_b32 v101, 0xffff0000, v91
    v_pk_add_f32 v[134:135], v[134:135], v[100:101]
    v_lshlrev_b32 v100, 16, v92
    v_and_b32 v101, 0xffff0000, v92
    v_pk_add_f32 v[136:137], v[136:137], v[100:101]
    v_lshlrev_b32 v100, 16, v93
    v_and_b32 v101, 0xffff0000, v93
    v_pk_add_f32 v[138:139], v[138:139], v[100:101]
    v_lshlrev_b32 v100, 16, v94
    v_and_b32 v101, 0xffff0000, v94
    v_pk_add_f32 v[140:141], v[140:141], v[100:101]
    v_lshlrev_b32 v100, 16, v95
    v_and_b32 v101, 0xffff0000, v95
    v_pk_add_f32 v[142:143], v[142:143], v[100:101]
    s_nop 1
    v_permlane16_swap_b32 v128, v132
    v_permlane16_swap_b32 v129, v133
    v_permlane16_swap_b32 v130, v134
    v_permlane16_swap_b32 v131, v135
    v_permlane16_swap_b32 v136, v140
    v_permlane16_swap_b32 v137, v141
    v_permlane16_swap_b32 v138, v142
    v_permlane16_swap_b32 v139, v143
    v_lshlrev_b32 v44, 16, v28
    v_and_b32 v45, 0xffff0000, v28
    v_lshlrev_b32 v46, 16, v36
    v_and_b32 v47, 0xffff0000, v36
    v_pk_add_f32 v[44:45], v[44:45], v[46:47]
    v_pk_add_f32 v[128:129], v[128:129], v[44:45]
    v_lshlrev_b32 v44, 16, v29
    v_and_b32 v45, 0xffff0000, v29
    v_lshlrev_b32 v46, 16, v37
    v_and_b32 v47, 0xffff0000, v37
    v_pk_add_f32 v[44:45], v[44:45], v[46:47]
    v_pk_add_f32 v[130:131], v[130:131], v[44:45]
    v_lshlrev_b32 v44, 16, v30
    v_and_b32 v45, 0xffff0000, v30
    v_lshlrev_b32 v46, 16, v38
    v_and_b32 v47, 0xffff0000, v38
    v_pk_add_f32 v[44:45], v[44:45], v[46:47]
    v_pk_add_f32 v[132:133], v[132:133], v[44:45]
    v_lshlrev_b32 v44, 16, v31
    v_and_b32 v45, 0xffff0000, v31
    v_lshlrev_b32 v46, 16, v39
    v_and_b32 v47, 0xffff0000, v39
    v_pk_add_f32 v[44:45], v[44:45], v[46:47]
    v_pk_add_f32 v[134:135], v[134:135], v[44:45]
    v_cvt_pk_bf16_f32 v48, v128, v129
    v_cvt_pk_bf16_f32 v49, v130, v131
    v_cvt_pk_bf16_f32 v50, v132, v133
    v_cvt_pk_bf16_f32 v51, v134, v135
    buffer_store_dwordx4 v[48:51], v20, s[80:83], s77 offen offset:0
    v_lshlrev_b32 v44, 16, v32
    v_and_b32 v45, 0xffff0000, v32
    v_lshlrev_b32 v46, 16, v40
    v_and_b32 v47, 0xffff0000, v40
    v_pk_add_f32 v[44:45], v[44:45], v[46:47]
    v_pk_add_f32 v[136:137], v[136:137], v[44:45]
    v_lshlrev_b32 v44, 16, v33
    v_and_b32 v45, 0xffff0000, v33
    v_lshlrev_b32 v46, 16, v41
    v_and_b32 v47, 0xffff0000, v41
    v_pk_add_f32 v[44:45], v[44:45], v[46:47]
    v_pk_add_f32 v[138:139], v[138:139], v[44:45]
    v_lshlrev_b32 v44, 16, v34
    v_and_b32 v45, 0xffff0000, v34
    v_lshlrev_b32 v46, 16, v42
    v_and_b32 v47, 0xffff0000, v42
    v_pk_add_f32 v[44:45], v[44:45], v[46:47]
    v_pk_add_f32 v[140:141], v[140:141], v[44:45]
    v_lshlrev_b32 v44, 16, v35
    v_and_b32 v45, 0xffff0000, v35
    v_lshlrev_b32 v46, 16, v43
    v_and_b32 v47, 0xffff0000, v43
    v_pk_add_f32 v[44:45], v[44:45], v[46:47]
    v_pk_add_f32 v[142:143], v[142:143], v[44:45]
    v_cvt_pk_bf16_f32 v52, v136, v137
    v_cvt_pk_bf16_f32 v53, v138, v139
    v_cvt_pk_bf16_f32 v54, v140, v141
    v_cvt_pk_bf16_f32 v55, v142, v143
    buffer_store_dwordx4 v[52:55], v20, s[80:83], s77 offen offset:32
L_ao_q:
    s_cmp_eq_u32 s74, 0
    s_cbranch_scc1 L_ao_flush
    s_ff1_i32_b32 s75, s74
    s_bitset0_b32 s74, s75
    s_lshl_b32 s71, s75, 12
    s_add_u32 s71, s71, s70
    buffer_load_dwordx4 v[64:67], v1, s[12:15], s71 offen offset:0 sc1
    buffer_load_dwordx4 v[68:71], v1, s[12:15], s71 offen offset:1024 sc1
    s_add_u32 s71, s71, 131072
    buffer_load_dwordx4 v[72:75], v1, s[12:15], s71 offen offset:0 sc1
    buffer_load_dwordx4 v[76:79], v1, s[12:15], s71 offen offset:1024 sc1
    s_add_u32 s71, s71, 131072
    buffer_load_dwordx4 v[80:83], v1, s[12:15], s71 offen offset:0 sc1
    buffer_load_dwordx4 v[84:87], v1, s[12:15], s71 offen offset:1024 sc1
    s_add_u32 s71, s71, 131072
    buffer_load_dwordx4 v[88:91], v1, s[12:15], s71 offen offset:0 sc1
    buffer_load_dwordx4 v[92:95], v1, s[12:15], s71 offen offset:1024 sc1
    s_and_b32 s76, s75, 1
    s_lshl_b32 s76, s76, 6
    s_add_u32 s76, s76, s73
    s_lshr_b32 s77, s75, 1
    s_lshl_b32 s77, s77, 16
    s_add_u32 s77, s77, s72
    s_add_u32 s77, s77, s76
    buffer_load_dwordx4 v[28:31], v20, s[4:7], s77 offen offset:0
    buffer_load_dwordx4 v[36:39], v21, s[8:11], s76 offen offset:0
    buffer_load_dwordx4 v[32:35], v20, s[4:7], s77 offen offset:32
    buffer_load_dwordx4 v[40:43], v21, s[8:11], s76 offen offset:32
    v_mov_b32 v128, 0
    v_mov_b32 v129, 0
    v_mov_b32 v130, 0
    v_mov_b32 v131, 0
    v_mov_b32 v132, 0
    v_mov_b32 v133, 0
    v_mov_b32 v134, 0
    v_mov_b32 v135, 0
    v_mov_b32 v136, 0
    v_mov_b32 v137, 0
    v_mov_b32 v138, 0
    v_mov_b32 v139, 0
    v_mov_b32 v140, 0
    v_mov_b32 v141, 0
    v_mov_b32 v142, 0
    v_mov_b32 v143, 0
    s_waitcnt vmcnt(0)
    v_lshlrev_b32 v100, 16, v64
    v_and_b32 v101, 0xffff0000, v64
    v_pk_add_f32 v[128:129], v[128:129], v[100:101]
    v_lshlrev_b32 v100, 16, v65
    v_and_b32 v101, 0xffff0000, v65
    v_pk_add_f32 v[130:131], v[130:131], v[100:101]
    v_lshlrev_b32 v100, 16, v66
    v_and_b32 v101, 0xffff0000, v66
    v_pk_add_f32 v[132:133], v[132:133], v[100:101]
    v_lshlrev_b32 v100, 16, v67
    v_and_b32 v101, 0xffff0000, v67
    v_pk_add_f32 v[134:135], v[134:135], v[100:101]
    v_lshlrev_b32 v100, 16, v68
    v_and_b32 v101, 0xffff0000, v68
    v_pk_add_f32 v[136:137], v[136:137], v[100:101]
    v_lshlrev_b32 v100, 16, v69
    v_and_b32 v101, 0xffff0000, v69
    v_pk_add_f32 v[138:139], v[138:139], v[100:101]
    v_lshlrev_b32 v100, 16, v70
    v_and_b32 v101, 0xffff0000, v70
    v_pk_add_f32 v[140:141], v[140:141], v[100:101]
    v_lshlrev_b32 v100, 16, v71
    v_and_b32 v101, 0xffff0000, v71
    v_pk_add_f32 v[142:143], v[142:143], v[100:101]
    v_lshlrev_b32 v100, 16, v72
    v_and_b32 v101, 0xffff0000, v72
    v_pk_add_f32 v[128:129], v[128:129], v[100:101]
    v_lshlrev_b32 v100, 16, v73
    v_and_b32 v101, 0xffff0000, v73
    v_pk_add_f32 v[130:131], v[130:131], v[100:101]
    v_lshlrev_b32 v100, 16, v74
    v_and_b32 v101, 0xffff0000, v74
    v_pk_add_f32 v[132:133], v[132:133], v[100:101]
    v_lshlrev_b32 v100, 16, v75
    v_and_b32 v101, 0xffff0000, v75
    v_pk_add_f32 v[134:135], v[134:135], v[100:101]
    v_lshlrev_b32 v100, 16, v76
    v_and_b32 v101, 0xffff0000, v76
    v_pk_add_f32 v[136:137], v[136:137], v[100:101]
    v_lshlrev_b32 v100, 16, v77
    v_and_b32 v101, 0xffff0000, v77
    v_pk_add_f32 v[138:139], v[138:139], v[100:101]
    v_lshlrev_b32 v100, 16, v78
    v_and_b32 v101, 0xffff0000, v78
    v_pk_add_f32 v[140:141], v[140:141], v[100:101]
    v_lshlrev_b32 v100, 16, v79
    v_and_b32 v101, 0xffff0000, v79
    v_pk_add_f32 v[142:143], v[142:143], v[100:101]
    v_lshlrev_b32 v100, 16, v80
    v_and_b32 v101, 0xffff0000, v80
    v_pk_add_f32 v[128:129], v[128:129], v[100:101]
    v_lshlrev_b32 v100, 16, v81
    v_and_b32 v101, 0xffff0000, v81
    v_pk_add_f32 v[130:131], v[130:131], v[100:101]
    v_lshlrev_b32 v100, 16, v82
    v_and_b32 v101, 0xffff0000, v82
    v_pk_add_f32 v[132:133], v[132:133], v[100:101]
    v_lshlrev_b32 v100, 16, v83
    v_and_b32 v101, 0xffff0000, v83
    v_pk_add_f32 v[134:135], v[134:135], v[100:101]
    v_lshlrev_b32 v100, 16, v84
    v_and_b32 v101, 0xffff0000, v84
    v_pk_add_f32 v[136:137], v[136:137], v[100:101]
    v_lshlrev_b32 v100, 16, v85
    v_and_b32 v101, 0xffff0000, v85
    v_pk_add_f32 v[138:139], v[138:139], v[100:101]
    v_lshlrev_b32 v100, 16, v86
    v_and_b32 v101, 0xffff0000, v86
    v_pk_add_f32 v[140:141], v[140:141], v[100:101]
    v_lshlrev_b32 v100, 16, v87
    v_and_b32 v101, 0xffff0000, v87
    v_pk_add_f32 v[142:143], v[142:143], v[100:101]
    v_lshlrev_b32 v100, 16, v88
    v_and_b32 v101, 0xffff0000, v88
    v_pk_add_f32 v[128:129], v[128:129], v[100:101]
    v_lshlrev_b32 v100, 16, v89
    v_and_b32 v101, 0xffff0000, v89
    v_pk_add_f32 v[130:131], v[130:131], v[100:101]
    v_lshlrev_b32 v100, 16, v90
    v_and_b32 v101, 0xffff0000, v90
    v_pk_add_f32 v[132:133], v[132:133], v[100:101]
    v_lshlrev_b32 v100, 16, v91
    v_and_b32 v101, 0xffff0000, v91
    v_pk_add_f32 v[134:135], v[134:135], v[100:101]
    v_lshlrev_b32 v100, 16, v92
    v_and_b32 v101, 0xffff0000, v92
    v_pk_add_f32 v[136:137], v[136:137], v[100:101]
    v_lshlrev_b32 v100, 16, v93
    v_and_b32 v101, 0xffff0000, v93
    v_pk_add_f32 v[138:139], v[138:139], v[100:101]
    v_lshlrev_b32 v100, 16, v94
    v_and_b32 v101, 0xffff0000, v94
    v_pk_add_f32 v[140:141], v[140:141], v[100:101]
    v_lshlrev_b32 v100, 16, v95
    v_and_b32 v101, 0xffff0000, v95
    v_pk_add_f32 v[142:143], v[142:143], v[100:101]
    s_nop 1
    v_permlane16_swap_b32 v128, v132
    v_permlane16_swap_b32 v129, v133
    v_permlane16_swap_b32 v130, v134
    v_permlane16_swap_b32 v131, v135
    v_permlane16_swap_b32 v136, v140
    v_permlane16_swap_b32 v137, v141
    v_permlane16_swap_b32 v138, v142
    v_permlane16_swap_b32 v139, v143
    v_lshlrev_b32 v44, 16, v28
    v_and_b32 v45, 0xffff0000, v28
    v_lshlrev_b32 v46, 16, v36
    v_and_b32 v47, 0xffff0000, v36
    v_pk_add_f32 v[44:45], v[44:45], v[46:47]
    v_pk_add_f32 v[128:129], v[128:129], v[44:45]
    v_lshlrev_b32 v44, 16, v29
    v_and_b32 v45, 0xffff0000, v29
    v_lshlrev_b32 v46, 16, v37
    v_and_b32 v47, 0xffff0000, v37
    v_pk_add_f32 v[44:45], v[44:45], v[46:47]
    v_pk_add_f32 v[130:131], v[130:131], v[44:45]
    v_lshlrev_b32 v44, 16, v30
    v_and_b32 v45, 0xffff0000, v30
    v_lshlrev_b32 v46, 16, v38
    v_and_b32 v47, 0xffff0000, v38
    v_pk_add_f32 v[44:45], v[44:45], v[46:47]
    v_pk_add_f32 v[132:133], v[132:133], v[44:45]
    v_lshlrev_b32 v44, 16, v31
    v_and_b32 v45, 0xffff0000, v31
    v_lshlrev_b32 v46, 16, v39
    v_and_b32 v47, 0xffff0000, v39
    v_pk_add_f32 v[44:45], v[44:45], v[46:47]
    v_pk_add_f32 v[134:135], v[134:135], v[44:45]
    v_cvt_pk_bf16_f32 v48, v128, v129
    v_cvt_pk_bf16_f32 v49, v130, v131
    v_cvt_pk_bf16_f32 v50, v132, v133
    v_cvt_pk_bf16_f32 v51, v134, v135
    buffer_store_dwordx4 v[48:51], v20, s[80:83], s77 offen offset:0
    v_lshlrev_b32 v44, 16, v32
    v_and_b32 v45, 0xffff0000, v32
    v_lshlrev_b32 v46, 16, v40
    v_and_b32 v47, 0xffff0000, v40
    v_pk_add_f32 v[44:45], v[44:45], v[46:47]
    v_pk_add_f32 v[136:137], v[136:137], v[44:45]
    v_lshlrev_b32 v44, 16, v33
    v_and_b32 v45, 0xffff0000, v33
    v_lshlrev_b32 v46, 16, v41
    v_and_b32 v47, 0xffff0000, v41
    v_pk_add_f32 v[44:45], v[44:45], v[46:47]
    v_pk_add_f32 v[138:139], v[138:139], v[44:45]
    v_lshlrev_b32 v44, 16, v34
    v_and_b32 v45, 0xffff0000, v34
    v_lshlrev_b32 v46, 16, v42
    v_and_b32 v47, 0xffff0000, v42
    v_pk_add_f32 v[44:45], v[44:45], v[46:47]
    v_pk_add_f32 v[140:141], v[140:141], v[44:45]
    v_lshlrev_b32 v44, 16, v35
    v_and_b32 v45, 0xffff0000, v35
    v_lshlrev_b32 v46, 16, v43
    v_and_b32 v47, 0xffff0000, v43
    v_pk_add_f32 v[44:45], v[44:45], v[46:47]
    v_pk_add_f32 v[142:143], v[142:143], v[44:45]
    v_cvt_pk_bf16_f32 v52, v136, v137
    v_cvt_pk_bf16_f32 v53, v138, v139
    v_cvt_pk_bf16_f32 v54, v140, v141
    v_cvt_pk_bf16_f32 v55, v142, v143
    buffer_store_dwordx4 v[52:55], v20, s[80:83], s77 offen offset:32
    s_branch L_ao_q
L_ao_flush:
L_ao_end:
    s_endpgm
L_slow_25:
    s_nop 15
    v_max3_f32 v6, v112, v113, v114
    v_max3_f32 v7, v115, v116, v117
    v_max3_f32 v6, v6, v118, v119
    v_max3_f32 v7, v7, v120, v121
    v_max3_f32 v6, v6, v122, v123
    v_max3_f32 v7, v7, v124, v125
    v_max3_f32 v6, v6, v126, v127
    v_max_f32 v6, v6, v7
    v_mov_b32 v7, v6
    s_nop 1
    v_permlane32_swap_b32 v7, v6
    v_max_f32 v6, v6, v7
    v_max_f32 v6, 0, v6
    v_sub_f32 v7, 0, v6
    v_exp_f32 v7, v7
    v_sub_f32 v112, v112, v6
    v_sub_f32 v113, v113, v6
    v_sub_f32 v114, v114, v6
    v_sub_f32 v115, v115, v6
    v_sub_f32 v116, v116, v6
    v_sub_f32 v117, v117, v6
    v_sub_f32 v118, v118, v6
    v_sub_f32 v119, v119, v6
    v_sub_f32 v120, v120, v6
    v_sub_f32 v121, v121, v6
    v_sub_f32 v122, v122, v6
    v_sub_f32 v123, v123, v6
    v_sub_f32 v124, v124, v6
    v_sub_f32 v125, v125, v6
    v_sub_f32 v126, v126, v6
    v_sub_f32 v127, v127, v6
    v_sub_f32 v128, v128, v6
    v_sub_f32 v129, v129, v6
    v_sub_f32 v130, v130, v6
    v_sub_f32 v131, v131, v6
    v_sub_f32 v132, v132, v6
    v_sub_f32 v133, v133, v6
    v_sub_f32 v134, v134, v6
    v_sub_f32 v135, v135, v6
    v_sub_f32 v136, v136, v6
    v_sub_f32 v137, v137, v6
    v_sub_f32 v138, v138, v6
    v_sub_f32 v139, v139, v6
    v_sub_f32 v140, v140, v6
    v_sub_f32 v141, v141, v6
    v_sub_f32 v142, v142, v6
    v_sub_f32 v143, v143, v6
    v_sub_f32 v144, v144, v6
    v_sub_f32 v145, v145, v6
    v_sub_f32 v146, v146, v6
    v_sub_f32 v147, v147, v6
    v_sub_f32 v148, v148, v6
    v_sub_f32 v149, v149, v6
    v_sub_f32 v150, v150, v6
    v_sub_f32 v151, v151, v6
    v_sub_f32 v152, v152, v6
    v_sub_f32 v153, v153, v6
    v_sub_f32 v154, v154, v6
    v_sub_f32 v155, v155, v6
    v_sub_f32 v156, v156, v6
    v_sub_f32 v157, v157, v6
    v_sub_f32 v158, v158, v6
    v_sub_f32 v159, v159, v6
    v_mul_f32 v4, v4, v7
    v_mul_f32 v176, v176, v7
    v_mul_f32 v177, v177, v7
    v_mul_f32 v178, v178, v7
    v_mul_f32 v179, v179, v7
    v_mul_f32 v180, v180, v7
    v_mul_f32 v181, v181, v7
    v_mul_f32 v182, v182, v7
    v_mul_f32 v183, v183, v7
    v_mul_f32 v184, v184, v7
    v_mul_f32 v185, v185, v7
    v_mul_f32 v186, v186, v7
    v_mul_f32 v187, v187, v7
    v_mul_f32 v188, v188, v7
    v_mul_f32 v189, v189, v7
    v_mul_f32 v190, v190, v7
    v_mul_f32 v191, v191, v7
    v_mul_f32 v192, v192, v7
    v_mul_f32 v193, v193, v7
    v_mul_f32 v194, v194, v7
    v_mul_f32 v195, v195, v7
    v_mul_f32 v196, v196, v7
    v_mul_f32 v197, v197, v7
    v_mul_f32 v198, v198, v7
    v_mul_f32 v199, v199, v7
    v_mul_f32 v200, v200, v7
    v_mul_f32 v201, v201, v7
    v_mul_f32 v202, v202, v7
    v_mul_f32 v203, v203, v7
    v_mul_f32 v204, v204, v7
    v_mul_f32 v205, v205, v7
    v_mul_f32 v206, v206, v7
    v_mul_f32 v207, v207, v7
    v_mul_f32 v208, v208, v7
    v_mul_f32 v209, v209, v7
    v_mul_f32 v210, v210, v7
    v_mul_f32 v211, v211, v7
    v_mul_f32 v212, v212, v7
    v_mul_f32 v213, v213, v7
    v_mul_f32 v214, v214, v7
    v_mul_f32 v215, v215, v7
    v_mul_f32 v216, v216, v7
    v_mul_f32 v217, v217, v7
    v_mul_f32 v218, v218, v7
    v_mul_f32 v219, v219, v7
    v_mul_f32 v220, v220, v7
    v_mul_f32 v221, v221, v7
    v_mul_f32 v222, v222, v7
    v_mul_f32 v223, v223, v7
    v_mul_f32 v224, v224, v7
    v_mul_f32 v225, v225, v7
    v_mul_f32 v226, v226, v7
    v_mul_f32 v227, v227, v7
    v_mul_f32 v228, v228, v7
    v_mul_f32 v229, v229, v7
    v_mul_f32 v230, v230, v7
    v_mul_f32 v231, v231, v7
    v_mul_f32 v232, v232, v7
    v_mul_f32 v233, v233, v7
    v_mul_f32 v234, v234, v7
    v_mul_f32 v235, v235, v7
    v_mul_f32 v236, v236, v7
    v_mul_f32 v237, v237, v7
    v_mul_f32 v238, v238, v7
    v_mul_f32 v239, v239, v7
    v_exp_f32 v168, v112
    v_exp_f32 v169, v113
    v_exp_f32 v170, v114
    v_exp_f32 v171, v115
    v_cvt_pk_bf16_f32 v160, v168, v169
    v_add_f32 v174, v168, v169
    v_exp_f32 v172, v116
    v_exp_f32 v173, v117
    v_cvt_pk_bf16_f32 v161, v170, v171
    v_add_f32 v174, v174, v170
    v_add_f32 v174, v174, v171
    v_exp_f32 v168, v118
    v_exp_f32 v169, v119
    v_cvt_pk_bf16_f32 v162, v172, v173
    v_add_f32 v174, v174, v172
    v_add_f32 v174, v174, v173
    s_nop 0
    v_cvt_pk_bf16_f32 v163, v168, v169
    v_add_f32 v174, v174, v168
    v_add_f32 v174, v174, v169
    v_exp_f32 v168, v120
    v_exp_f32 v169, v121
    v_exp_f32 v170, v122
    v_exp_f32 v171, v123
    v_cvt_pk_bf16_f32 v164, v168, v169
    v_add_f32 v175, v168, v169
    v_exp_f32 v172, v124
    v_exp_f32 v173, v125
    s_nop 1
    s_branch L_back_26
L_slow_27:
    s_nop 15
    v_max3_f32 v6, v112, v113, v114
    v_max3_f32 v7, v115, v116, v117
    v_max3_f32 v6, v6, v118, v119
    v_max3_f32 v7, v7, v120, v121
    v_max3_f32 v6, v6, v122, v123
    v_max3_f32 v7, v7, v124, v125
    v_max3_f32 v6, v6, v126, v127
    v_max_f32 v6, v6, v7
    v_mov_b32 v7, v6
    s_nop 1
    v_permlane32_swap_b32 v7, v6
    v_max_f32 v6, v6, v7
    v_max_f32 v6, 0, v6
    v_sub_f32 v7, 0, v6
    v_exp_f32 v7, v7
    v_sub_f32 v112, v112, v6
    v_sub_f32 v113, v113, v6
    v_sub_f32 v114, v114, v6
    v_sub_f32 v115, v115, v6
    v_sub_f32 v116, v116, v6
    v_sub_f32 v117, v117, v6
    v_sub_f32 v118, v118, v6
    v_sub_f32 v119, v119, v6
    v_sub_f32 v120, v120, v6
    v_sub_f32 v121, v121, v6
    v_sub_f32 v122, v122, v6
    v_sub_f32 v123, v123, v6
    v_sub_f32 v124, v124, v6
    v_sub_f32 v125, v125, v6
    v_sub_f32 v126, v126, v6
    v_sub_f32 v127, v127, v6
    v_sub_f32 v128, v128, v6
    v_sub_f32 v129, v129, v6
    v_sub_f32 v130, v130, v6
    v_sub_f32 v131, v131, v6
    v_sub_f32 v132, v132, v6
    v_sub_f32 v133, v133, v6
    v_sub_f32 v134, v134, v6
    v_sub_f32 v135, v135, v6
    v_sub_f32 v136, v136, v6
    v_sub_f32 v137, v137, v6
    v_sub_f32 v138, v138, v6
    v_sub_f32 v139, v139, v6
    v_sub_f32 v140, v140, v6
    v_sub_f32 v141, v141, v6
    v_sub_f32 v142, v142, v6
    v_sub_f32 v143, v143, v6
    v_sub_f32 v144, v144, v6
    v_sub_f32 v145, v145, v6
    v_sub_f32 v146, v146, v6
    v_sub_f32 v147, v147, v6
    v_sub_f32 v148, v148, v6
    v_sub_f32 v149, v149, v6
    v_sub_f32 v150, v150, v6
    v_sub_f32 v151, v151, v6
    v_sub_f32 v152, v152, v6
    v_sub_f32 v153, v153, v6
    v_sub_f32 v154, v154, v6
    v_sub_f32 v155, v155, v6
    v_sub_f32 v156, v156, v6
    v_sub_f32 v157, v157, v6
    v_sub_f32 v158, v158, v6
    v_sub_f32 v159, v159, v6
    v_mul_f32 v4, v4, v7
    v_mul_f32 v176, v176, v7
    v_mul_f32 v177, v177, v7
    v_mul_f32 v178, v178, v7
    v_mul_f32 v179, v179, v7
    v_mul_f32 v180, v180, v7
    v_mul_f32 v181, v181, v7
    v_mul_f32 v182, v182, v7
    v_mul_f32 v183, v183, v7
    v_mul_f32 v184, v184, v7
    v_mul_f32 v185, v185, v7
    v_mul_f32 v186, v186, v7
    v_mul_f32 v187, v187, v7
    v_mul_f32 v188, v188, v7
    v_mul_f32 v189, v189, v7
    v_mul_f32 v190, v190, v7
    v_mul_f32 v191, v191, v7
    v_mul_f32 v192, v192, v7
    v_mul_f32 v193, v193, v7
    v_mul_f32 v194, v194, v7
    v_mul_f32 v195, v195, v7
    v_mul_f32 v196, v196, v7
    v_mul_f32 v197, v197, v7
    v_mul_f32 v198, v198, v7
    v_mul_f32 v199, v199, v7
    v_mul_f32 v200, v200, v7
    v_mul_f32 v201, v201, v7
    v_mul_f32 v202, v202, v7
    v_mul_f32 v203, v203, v7
    v_mul_f32 v204, v204, v7
    v_mul_f32 v205, v205, v7
    v_mul_f32 v206, v206, v7
    v_mul_f32 v207, v207, v7
    v_mul_f32 v208, v208, v7
    v_mul_f32 v209, v209, v7
    v_mul_f32 v210, v210, v7
    v_mul_f32 v211, v211, v7
    v_mul_f32 v212, v212, v7
    v_mul_f32 v213, v213, v7
    v_mul_f32 v214, v214, v7
    v_mul_f32 v215, v215, v7
    v_mul_f32 v216, v216, v7
    v_mul_f32 v217, v217, v7
    v_mul_f32 v218, v218, v7
    v_mul_f32 v219, v219, v7
    v_mul_f32 v220, v220, v7
    v_mul_f32 v221, v221, v7
    v_mul_f32 v222, v222, v7
    v_mul_f32 v223, v223, v7
    v_mul_f32 v224, v224, v7
    v_mul_f32 v225, v225, v7
    v_mul_f32 v226, v226, v7
    v_mul_f32 v227, v227, v7
    v_mul_f32 v228, v228, v7
    v_mul_f32 v229, v229, v7
    v_mul_f32 v230, v230, v7
    v_mul_f32 v231, v231, v7
    v_mul_f32 v232, v232, v7
    v_mul_f32 v233, v233, v7
    v_mul_f32 v234, v234, v7
    v_mul_f32 v235, v235, v7
    v_mul_f32 v236, v236, v7
    v_mul_f32 v237, v237, v7
    v_mul_f32 v238, v238, v7
    v_mul_f32 v239, v239, v7
    v_exp_f32 v168, v120
    v_exp_f32 v169, v121
    v_exp_f32 v170, v122
    v_exp_f32 v171, v123
    v_cvt_pk_bf16_f32 v164, v168, v169
    v_add_f32 v175, v168, v169
    v_exp_f32 v172, v124
    v_exp_f32 v173, v125
    v_cvt_pk_bf16_f32 v165, v170, v171
    v_add_f32 v175, v175, v170
    v_add_f32 v175, v175, v171
    v_exp_f32 v168, v126
    v_exp_f32 v169, v127
    v_cvt_pk_bf16_f32 v166, v172, v173
    v_add_f32 v175, v175, v172
    v_add_f32 v175, v175, v173
    s_nop 0
    v_cvt_pk_bf16_f32 v167, v168, v169
    v_add_f32 v175, v175, v168
    v_add_f32 v175, v175, v169
    s_nop 1
    s_branch L_back_28
L_slow_29:
    s_nop 15
    v_max3_f32 v6, v128, v129, v130
    v_max3_f32 v7, v131, v132, v133
    v_max3_f32 v6, v6, v134, v135
    v_max3_f32 v7, v7, v136, v137
    v_max3_f32 v6, v6, v138, v139
    v_max3_f32 v7, v7, v140, v141
    v_max3_f32 v6, v6, v142, v143
    v_max_f32 v6, v6, v7
    v_mov_b32 v7, v6
    s_nop 1
    v_permlane32_swap_b32 v7, v6
    v_max_f32 v6, v6, v7
    v_max_f32 v6, 0, v6
    v_sub_f32 v7, 0, v6
    v_exp_f32 v7, v7
    v_sub_f32 v128, v128, v6
    v_sub_f32 v129, v129, v6
    v_sub_f32 v130, v130, v6
    v_sub_f32 v131, v131, v6
    v_sub_f32 v132, v132, v6
    v_sub_f32 v133, v133, v6
    v_sub_f32 v134, v134, v6
    v_sub_f32 v135, v135, v6
    v_sub_f32 v136, v136, v6
    v_sub_f32 v137, v137, v6
    v_sub_f32 v138, v138, v6
    v_sub_f32 v139, v139, v6
    v_sub_f32 v140, v140, v6
    v_sub_f32 v141, v141, v6
    v_sub_f32 v142, v142, v6
    v_sub_f32 v143, v143, v6
    v_sub_f32 v112, v112, v6
    v_sub_f32 v113, v113, v6
    v_sub_f32 v114, v114, v6
    v_sub_f32 v115, v115, v6
    v_sub_f32 v116, v116, v6
    v_sub_f32 v117, v117, v6
    v_sub_f32 v118, v118, v6
    v_sub_f32 v119, v119, v6
    v_sub_f32 v120, v120, v6
    v_sub_f32 v121, v121, v6
    v_sub_f32 v122, v122, v6
    v_sub_f32 v123, v123, v6
    v_sub_f32 v124, v124, v6
    v_sub_f32 v125, v125, v6
    v_sub_f32 v126, v126, v6
    v_sub_f32 v127, v127, v6
    v_sub_f32 v144, v144, v6
    v_sub_f32 v145, v145, v6
    v_sub_f32 v146, v146, v6
    v_sub_f32 v147, v147, v6
    v_sub_f32 v148, v148, v6
    v_sub_f32 v149, v149, v6
    v_sub_f32 v150, v150, v6
    v_sub_f32 v151, v151, v6
    v_sub_f32 v152, v152, v6
    v_sub_f32 v153, v153, v6
    v_sub_f32 v154, v154, v6
    v_sub_f32 v155, v155, v6
    v_sub_f32 v156, v156, v6
    v_sub_f32 v157, v157, v6
    v_sub_f32 v158, v158, v6
    v_sub_f32 v159, v159, v6
    v_mul_f32 v4, v4, v7
    v_mul_f32 v176, v176, v7
    v_mul_f32 v177, v177, v7
    v_mul_f32 v178, v178, v7
    v_mul_f32 v179, v179, v7
    v_mul_f32 v180, v180, v7
    v_mul_f32 v181, v181, v7
    v_mul_f32 v182, v182, v7
    v_mul_f32 v183, v183, v7
    v_mul_f32 v184, v184, v7
    v_mul_f32 v185, v185, v7
    v_mul_f32 v186, v186, v7
    v_mul_f32 v187, v187, v7
    v_mul_f32 v188, v188, v7
    v_mul_f32 v189, v189, v7
    v_mul_f32 v190, v190, v7
    v_mul_f32 v191, v191, v7
    v_mul_f32 v192, v192, v7
    v_mul_f32 v193, v193, v7
    v_mul_f32 v194, v194, v7
    v_mul_f32 v195, v195, v7
    v_mul_f32 v196, v196, v7
    v_mul_f32 v197, v197, v7
    v_mul_f32 v198, v198, v7
    v_mul_f32 v199, v199, v7
    v_mul_f32 v200, v200, v7
    v_mul_f32 v201, v201, v7
    v_mul_f32 v202, v202, v7
    v_mul_f32 v203, v203, v7
    v_mul_f32 v204, v204, v7
    v_mul_f32 v205, v205, v7
    v_mul_f32 v206, v206, v7
    v_mul_f32 v207, v207, v7
    v_mul_f32 v208, v208, v7
    v_mul_f32 v209, v209, v7
    v_mul_f32 v210, v210, v7
    v_mul_f32 v211, v211, v7
    v_mul_f32 v212, v212, v7
    v_mul_f32 v213, v213, v7
    v_mul_f32 v214, v214, v7
    v_mul_f32 v215, v215, v7
    v_mul_f32 v216, v216, v7
    v_mul_f32 v217, v217, v7
    v_mul_f32 v218, v218, v7
    v_mul_f32 v219, v219, v7
    v_mul_f32 v220, v220, v7
    v_mul_f32 v221, v221, v7
    v_mul_f32 v222, v222, v7
    v_mul_f32 v223, v223, v7
    v_mul_f32 v224, v224, v7
    v_mul_f32 v225, v225, v7
    v_mul_f32 v226, v226, v7
    v_mul_f32 v227, v227, v7
    v_mul_f32 v228, v228, v7
    v_mul_f32 v229, v229, v7
    v_mul_f32 v230, v230, v7
    v_mul_f32 v231, v231, v7
    v_mul_f32 v232, v232, v7
    v_mul_f32 v233, v233, v7
    v_mul_f32 v234, v234, v7
    v_mul_f32 v235, v235, v7
    v_mul_f32 v236, v236, v7
    v_mul_f32 v237, v237, v7
    v_mul_f32 v238, v238, v7
    v_mul_f32 v239, v239, v7
    v_exp_f32 v168, v128
    v_exp_f32 v169, v129
    v_exp_f32 v170, v130
    v_exp_f32 v171, v131
    v_cvt_pk_bf16_f32 v160, v168, v169
    v_add_f32 v174, v168, v169
    v_exp_f32 v172, v132
    v_exp_f32 v173, v133
    v_cvt_pk_bf16_f32 v161, v170, v171
    v_add_f32 v174, v174, v170
    v_add_f32 v174, v174, v171
    v_exp_f32 v168, v134
    v_exp_f32 v169, v135
    v_cvt_pk_bf16_f32 v162, v172, v173
    v_add_f32 v174, v174, v172
    v_add_f32 v174, v174, v173
    s_nop 0
    v_cvt_pk_bf16_f32 v163, v168, v169
    v_add_f32 v174, v174, v168
    v_add_f32 v174, v174, v169
    v_exp_f32 v168, v136
    v_exp_f32 v169, v137
    v_exp_f32 v170, v138
    v_exp_f32 v171, v139
    v_cvt_pk_bf16_f32 v164, v168, v169
    v_add_f32 v175, v168, v169
    v_exp_f32 v172, v140
    v_exp_f32 v173, v141
    s_nop 1
    s_branch L_back_30
L_slow_31:
    s_nop 15
    v_max3_f32 v6, v128, v129, v130
    v_max3_f32 v7, v131, v132, v133
    v_max3_f32 v6, v6, v134, v135
    v_max3_f32 v7, v7, v136, v137
    v_max3_f32 v6, v6, v138, v139
    v_max3_f32 v7, v7, v140, v141
    v_max3_f32 v6, v6, v142, v143
    v_max_f32 v6, v6, v7
    v_mov_b32 v7, v6
    s_nop 1
    v_permlane32_swap_b32 v7, v6
    v_max_f32 v6, v6, v7
    v_max_f32 v6, 0, v6
    v_sub_f32 v7, 0, v6
    v_exp_f32 v7, v7
    v_sub_f32 v128, v128, v6
    v_sub_f32 v129, v129, v6
    v_sub_f32 v130, v130, v6
    v_sub_f32 v131, v131, v6
    v_sub_f32 v132, v132, v6
    v_sub_f32 v133, v133, v6
    v_sub_f32 v134, v134, v6
    v_sub_f32 v135, v135, v6
    v_sub_f32 v136, v136, v6
    v_sub_f32 v137, v137, v6
    v_sub_f32 v138, v138, v6
    v_sub_f32 v139, v139, v6
    v_sub_f32 v140, v140, v6
    v_sub_f32 v141, v141, v6
    v_sub_f32 v142, v142, v6
    v_sub_f32 v143, v143, v6
    v_sub_f32 v112, v112, v6
    v_sub_f32 v113, v113, v6
    v_sub_f32 v114, v114, v6
    v_sub_f32 v115, v115, v6
    v_sub_f32 v116, v116, v6
    v_sub_f32 v117, v117, v6
    v_sub_f32 v118, v118, v6
    v_sub_f32 v119, v119, v6
    v_sub_f32 v120, v120, v6
    v_sub_f32 v121, v121, v6
    v_sub_f32 v122, v122, v6
    v_sub_f32 v123, v123, v6
    v_sub_f32 v124, v124, v6
    v_sub_f32 v125, v125, v6
    v_sub_f32 v126, v126, v6
    v_sub_f32 v127, v127, v6
    v_sub_f32 v144, v144, v6
    v_sub_f32 v145, v145, v6
    v_sub_f32 v146, v146, v6
    v_sub_f32 v147, v147, v6
    v_sub_f32 v148, v148, v6
    v_sub_f32 v149, v149, v6
    v_sub_f32 v150, v150, v6
    v_sub_f32 v151, v151, v6
    v_sub_f32 v152, v152, v6
    v_sub_f32 v153, v153, v6
    v_sub_f32 v154, v154, v6
    v_sub_f32 v155, v155, v6
    v_sub_f32 v156, v156, v6
    v_sub_f32 v157, v157, v6
    v_sub_f32 v158, v158, v6
    v_sub_f32 v159, v159, v6
    v_mul_f32 v4, v4, v7
    v_mul_f32 v176, v176, v7
    v_mul_f32 v177, v177, v7
    v_mul_f32 v178, v178, v7
    v_mul_f32 v179, v179, v7
    v_mul_f32 v180, v180, v7
    v_mul_f32 v181, v181, v7
    v_mul_f32 v182, v182, v7
    v_mul_f32 v183, v183, v7
    v_mul_f32 v184, v184, v7
    v_mul_f32 v185, v185, v7
    v_mul_f32 v186, v186, v7
    v_mul_f32 v187, v187, v7
    v_mul_f32 v188, v188, v7
    v_mul_f32 v189, v189, v7
    v_mul_f32 v190, v190, v7
    v_mul_f32 v191, v191, v7
    v_mul_f32 v192, v192, v7
    v_mul_f32 v193, v193, v7
    v_mul_f32 v194, v194, v7
    v_mul_f32 v195, v195, v7
    v_mul_f32 v196, v196, v7
    v_mul_f32 v197, v197, v7
    v_mul_f32 v198, v198, v7
    v_mul_f32 v199, v199, v7
    v_mul_f32 v200, v200, v7
    v_mul_f32 v201, v201, v7
    v_mul_f32 v202, v202, v7
    v_mul_f32 v203, v203, v7
    v_mul_f32 v204, v204, v7
    v_mul_f32 v205, v205, v7
    v_mul_f32 v206, v206, v7
    v_mul_f32 v207, v207, v7
    v_mul_f32 v208, v208, v7
    v_mul_f32 v209, v209, v7
    v_mul_f32 v210, v210, v7
    v_mul_f32 v211, v211, v7
    v_mul_f32 v212, v212, v7
    v_mul_f32 v213, v213, v7
    v_mul_f32 v214, v214, v7
    v_mul_f32 v215, v215, v7
    v_mul_f32 v216, v216, v7
    v_mul_f32 v217, v217, v7
    v_mul_f32 v218, v218, v7
    v_mul_f32 v219, v219, v7
    v_mul_f32 v220, v220, v7
    v_mul_f32 v221, v221, v7
    v_mul_f32 v222, v222, v7
    v_mul_f32 v223, v223, v7
    v_mul_f32 v224, v224, v7
    v_mul_f32 v225, v225, v7
    v_mul_f32 v226, v226, v7
    v_mul_f32 v227, v227, v7
    v_mul_f32 v228, v228, v7
    v_mul_f32 v229, v229, v7
    v_mul_f32 v230, v230, v7
    v_mul_f32 v231, v231, v7
    v_mul_f32 v232, v232, v7
    v_mul_f32 v233, v233, v7
    v_mul_f32 v234, v234, v7
    v_mul_f32 v235, v235, v7
    v_mul_f32 v236, v236, v7
    v_mul_f32 v237, v237, v7
    v_mul_f32 v238, v238, v7
    v_mul_f32 v239, v239, v7
    v_exp_f32 v168, v136
    v_exp_f32 v169, v137
    v_exp_f32 v170, v138
    v_exp_f32 v171, v139
    v_cvt_pk_bf16_f32 v164, v168, v169
    v_add_f32 v175, v168, v169
    v_exp_f32 v172, v140
    v_exp_f32 v173, v141
    v_cvt_pk_bf16_f32 v165, v170, v171
    v_add_f32 v175, v175, v170
    v_add_f32 v175, v175, v171
    v_exp_f32 v168, v142
    v_exp_f32 v169, v143
    v_cvt_pk_bf16_f32 v166, v172, v173
    v_add_f32 v175, v175, v172
    v_add_f32 v175, v175, v173
    s_nop 0
    v_cvt_pk_bf16_f32 v167, v168, v169
    v_add_f32 v175, v175, v168
    v_add_f32 v175, v175, v169
    s_nop 1
    s_branch L_back_32
L_slow_37:
    s_nop 15
    v_max3_f32 v6, v112, v113, v114
    v_max3_f32 v7, v115, v116, v117
    v_max3_f32 v6, v6, v118, v119
    v_max3_f32 v7, v7, v120, v121
    v_max3_f32 v6, v6, v122, v123
    v_max3_f32 v7, v7, v124, v125
    v_max3_f32 v6, v6, v126, v127
    v_max_f32 v6, v6, v7
    v_mov_b32 v7, v6
    s_nop 1
    v_permlane32_swap_b32 v7, v6
    v_max_f32 v6, v6, v7
    v_max_f32 v6, 0, v6
    v_sub_f32 v7, 0, v6
    v_exp_f32 v7, v7
    v_sub_f32 v112, v112, v6
    v_sub_f32 v113, v113, v6
    v_sub_f32 v114, v114, v6
    v_sub_f32 v115, v115, v6
    v_sub_f32 v116, v116, v6
    v_sub_f32 v117, v117, v6
    v_sub_f32 v118, v118, v6
    v_sub_f32 v119, v119, v6
    v_sub_f32 v120, v120, v6
    v_sub_f32 v121, v121, v6
    v_sub_f32 v122, v122, v6
    v_sub_f32 v123, v123, v6
    v_sub_f32 v124, v124, v6
    v_sub_f32 v125, v125, v6
    v_sub_f32 v126, v126, v6
    v_sub_f32 v127, v127, v6
    v_sub_f32 v128, v128, v6
    v_sub_f32 v129, v129, v6
    v_sub_f32 v130, v130, v6
    v_sub_f32 v131, v131, v6
    v_sub_f32 v132, v132, v6
    v_sub_f32 v133, v133, v6
    v_sub_f32 v134, v134, v6
    v_sub_f32 v135, v135, v6
    v_sub_f32 v136, v136, v6
    v_sub_f32 v137, v137, v6
    v_sub_f32 v138, v138, v6
    v_sub_f32 v139, v139, v6
    v_sub_f32 v140, v140, v6
    v_sub_f32 v141, v141, v6
    v_sub_f32 v142, v142, v6
    v_sub_f32 v143, v143, v6
    v_sub_f32 v144, v144, v6
    v_sub_f32 v145, v145, v6
    v_sub_f32 v146, v146, v6
    v_sub_f32 v147, v147, v6
    v_sub_f32 v148, v148, v6
    v_sub_f32 v149, v149, v6
    v_sub_f32 v150, v150, v6
    v_sub_f32 v151, v151, v6
    v_sub_f32 v152, v152, v6
    v_sub_f32 v153, v153, v6
    v_sub_f32 v154, v154, v6
    v_sub_f32 v155, v155, v6
    v_sub_f32 v156, v156, v6
    v_sub_f32 v157, v157, v6
    v_sub_f32 v158, v158, v6
    v_sub_f32 v159, v159, v6
    v_mul_f32 v4, v4, v7
    v_mul_f32 v176, v176, v7
    v_mul_f32 v177, v177, v7
    v_mul_f32 v178, v178, v7
    v_mul_f32 v179, v179, v7
    v_mul_f32 v180, v180, v7
    v_mul_f32 v181, v181, v7
    v_mul_f32 v182, v182, v7
    v_mul_f32 v183, v183, v7
    v_mul_f32 v184, v184, v7
    v_mul_f32 v185, v185, v7
    v_mul_f32 v186, v186, v7
    v_mul_f32 v187, v187, v7
    v_mul_f32 v188, v188, v7
    v_mul_f32 v189, v189, v7
    v_mul_f32 v190, v190, v7
    v_mul_f32 v191, v191, v7
    v_mul_f32 v192, v192, v7
    v_mul_f32 v193, v193, v7
    v_mul_f32 v194, v194, v7
    v_mul_f32 v195, v195, v7
    v_mul_f32 v196, v196, v7
    v_mul_f32 v197, v197, v7
    v_mul_f32 v198, v198, v7
    v_mul_f32 v199, v199, v7
    v_mul_f32 v200, v200, v7
    v_mul_f32 v201, v201, v7
    v_mul_f32 v202, v202, v7
    v_mul_f32 v203, v203, v7
    v_mul_f32 v204, v204, v7
    v_mul_f32 v205, v205, v7
    v_mul_f32 v206, v206, v7
    v_mul_f32 v207, v207, v7
    v_mul_f32 v208, v208, v7
    v_mul_f32 v209, v209, v7
    v_mul_f32 v210, v210, v7
    v_mul_f32 v211, v211, v7
    v_mul_f32 v212, v212, v7
    v_mul_f32 v213, v213, v7
    v_mul_f32 v214, v214, v7
    v_mul_f32 v215, v215, v7
    v_mul_f32 v216, v216, v7
    v_mul_f32 v217, v217, v7
    v_mul_f32 v218, v218, v7
    v_mul_f32 v219, v219, v7
    v_mul_f32 v220, v220, v7
    v_mul_f32 v221, v221, v7
    v_mul_f32 v222, v222, v7
    v_mul_f32 v223, v223, v7
    v_mul_f32 v224, v224, v7
    v_mul_f32 v225, v225, v7
    v_mul_f32 v226, v226, v7
    v_mul_f32 v227, v227, v7
    v_mul_f32 v228, v228, v7
    v_mul_f32 v229, v229, v7
    v_mul_f32 v230, v230, v7
    v_mul_f32 v231, v231, v7
    v_mul_f32 v232, v232, v7
    v_mul_f32 v233, v233, v7
    v_mul_f32 v234, v234, v7
    v_mul_f32 v235, v235, v7
    v_mul_f32 v236, v236, v7
    v_mul_f32 v237, v237, v7
    v_mul_f32 v238, v238, v7
    v_mul_f32 v239, v239, v7
    v_exp_f32 v168, v112
    v_exp_f32 v169, v113
    v_exp_f32 v170, v114
    v_exp_f32 v171, v115
    v_cvt_pk_bf16_f32 v160, v168, v169
    v_add_f32 v174, v168, v169
    v_exp_f32 v172, v116
    v_exp_f32 v173, v117
    v_cvt_pk_bf16_f32 v161, v170, v171
    v_add_f32 v174, v174, v170
    v_add_f32 v174, v174, v171
    v_exp_f32 v168, v118
    v_exp_f32 v169, v119
    v_cvt_pk_bf16_f32 v162, v172, v173
    v_add_f32 v174, v174, v172
    v_add_f32 v174, v174, v173
    s_nop 0
    v_cvt_pk_bf16_f32 v163, v168, v169
    v_add_f32 v174, v174, v168
    v_add_f32 v174, v174, v169
    v_exp_f32 v168, v120
    v_exp_f32 v169, v121
    v_exp_f32 v170, v122
    v_exp_f32 v171, v123
    v_cvt_pk_bf16_f32 v164, v168, v169
    v_add_f32 v175, v168, v169
    v_exp_f32 v172, v124
    v_exp_f32 v173, v125
    s_nop 1
    s_branch L_back_38
L_slow_39:
    s_nop 15
    v_max3_f32 v6, v112, v113, v114
    v_max3_f32 v7, v115, v116, v117
    v_max3_f32 v6, v6, v118, v119
    v_max3_f32 v7, v7, v120, v121
    v_max3_f32 v6, v6, v122, v123
    v_max3_f32 v7, v7, v124, v125
    v_max3_f32 v6, v6, v126, v127
    v_max_f32 v6, v6, v7
    v_mov_b32 v7, v6
    s_nop 1
    v_permlane32_swap_b32 v7, v6
    v_max_f32 v6, v6, v7
    v_max_f32 v6, 0, v6
    v_sub_f32 v7, 0, v6
    v_exp_f32 v7, v7
    v_sub_f32 v112, v112, v6
    v_sub_f32 v113, v113, v6
    v_sub_f32 v114, v114, v6
    v_sub_f32 v115, v115, v6
    v_sub_f32 v116, v116, v6
    v_sub_f32 v117, v117, v6
    v_sub_f32 v118, v118, v6
    v_sub_f32 v119, v119, v6
    v_sub_f32 v120, v120, v6
    v_sub_f32 v121, v121, v6
    v_sub_f32 v122, v122, v6
    v_sub_f32 v123, v123, v6
    v_sub_f32 v124, v124, v6
    v_sub_f32 v125, v125, v6
    v_sub_f32 v126, v126, v6
    v_sub_f32 v127, v127, v6
    v_sub_f32 v128, v128, v6
    v_sub_f32 v129, v129, v6
    v_sub_f32 v130, v130, v6
    v_sub_f32 v131, v131, v6
    v_sub_f32 v132, v132, v6
    v_sub_f32 v133, v133, v6
    v_sub_f32 v134, v134, v6
    v_sub_f32 v135, v135, v6
    v_sub_f32 v136, v136, v6
    v_sub_f32 v137, v137, v6
    v_sub_f32 v138, v138, v6
    v_sub_f32 v139, v139, v6
    v_sub_f32 v140, v140, v6
    v_sub_f32 v141, v141, v6
    v_sub_f32 v142, v142, v6
    v_sub_f32 v143, v143, v6
    v_sub_f32 v144, v144, v6
    v_sub_f32 v145, v145, v6
    v_sub_f32 v146, v146, v6
    v_sub_f32 v147, v147, v6
    v_sub_f32 v148, v148, v6
    v_sub_f32 v149, v149, v6
    v_sub_f32 v150, v150, v6
    v_sub_f32 v151, v151, v6
    v_sub_f32 v152, v152, v6
    v_sub_f32 v153, v153, v6
    v_sub_f32 v154, v154, v6
    v_sub_f32 v155, v155, v6
    v_sub_f32 v156, v156, v6
    v_sub_f32 v157, v157, v6
    v_sub_f32 v158, v158, v6
    v_sub_f32 v159, v159, v6
    v_mul_f32 v4, v4, v7
    v_mul_f32 v176, v176, v7
    v_mul_f32 v177, v177, v7
    v_mul_f32 v178, v178, v7
    v_mul_f32 v179, v179, v7
    v_mul_f32 v180, v180, v7
    v_mul_f32 v181, v181, v7
    v_mul_f32 v182, v182, v7
    v_mul_f32 v183, v183, v7
    v_mul_f32 v184, v184, v7
    v_mul_f32 v185, v185, v7
    v_mul_f32 v186, v186, v7
    v_mul_f32 v187, v187, v7
    v_mul_f32 v188, v188, v7
    v_mul_f32 v189, v189, v7
    v_mul_f32 v190, v190, v7
    v_mul_f32 v191, v191, v7
    v_mul_f32 v192, v192, v7
    v_mul_f32 v193, v193, v7
    v_mul_f32 v194, v194, v7
    v_mul_f32 v195, v195, v7
    v_mul_f32 v196, v196, v7
    v_mul_f32 v197, v197, v7
    v_mul_f32 v198, v198, v7
    v_mul_f32 v199, v199, v7
    v_mul_f32 v200, v200, v7
    v_mul_f32 v201, v201, v7
    v_mul_f32 v202, v202, v7
    v_mul_f32 v203, v203, v7
    v_mul_f32 v204, v204, v7
    v_mul_f32 v205, v205, v7
    v_mul_f32 v206, v206, v7
    v_mul_f32 v207, v207, v7
    v_mul_f32 v208, v208, v7
    v_mul_f32 v209, v209, v7
    v_mul_f32 v210, v210, v7
    v_mul_f32 v211, v211, v7
    v_mul_f32 v212, v212, v7
    v_mul_f32 v213, v213, v7
    v_mul_f32 v214, v214, v7
    v_mul_f32 v215, v215, v7
    v_mul_f32 v216, v216, v7
    v_mul_f32 v217, v217, v7
    v_mul_f32 v218, v218, v7
    v_mul_f32 v219, v219, v7
    v_mul_f32 v220, v220, v7
    v_mul_f32 v221, v221, v7
    v_mul_f32 v222, v222, v7
    v_mul_f32 v223, v223, v7
    v_mul_f32 v224, v224, v7
    v_mul_f32 v225, v225, v7
    v_mul_f32 v226, v226, v7
    v_mul_f32 v227, v227, v7
    v_mul_f32 v228, v228, v7
    v_mul_f32 v229, v229, v7
    v_mul_f32 v230, v230, v7
    v_mul_f32 v231, v231, v7
    v_mul_f32 v232, v232, v7
    v_mul_f32 v233, v233, v7
    v_mul_f32 v234, v234, v7
    v_mul_f32 v235, v235, v7
    v_mul_f32 v236, v236, v7
    v_mul_f32 v237, v237, v7
    v_mul_f32 v238, v238, v7
    v_mul_f32 v239, v239, v7
    v_exp_f32 v168, v120
    v_exp_f32 v169, v121
    v_exp_f32 v170, v122
    v_exp_f32 v171, v123
    v_cvt_pk_bf16_f32 v164, v168, v169
    v_add_f32 v175, v168, v169
    v_exp_f32 v172, v124
    v_exp_f32 v173, v125
    v_cvt_pk_bf16_f32 v165, v170, v171
    v_add_f32 v175, v175, v170
    v_add_f32 v175, v175, v171
    v_exp_f32 v168, v126
    v_exp_f32 v169, v127
    v_cvt_pk_bf16_f32 v166, v172, v173
    v_add_f32 v175, v175, v172
    v_add_f32 v175, v175, v173
    s_nop 0
    v_cvt_pk_bf16_f32 v167, v168, v169
    v_add_f32 v175, v175, v168
    v_add_f32 v175, v175, v169
    s_nop 1
    s_branch L_back_40
L_slow_41:
    s_nop 15
    v_max3_f32 v6, v128, v129, v130
    v_max3_f32 v7, v131, v132, v133
    v_max3_f32 v6, v6, v134, v135
    v_max3_f32 v7, v7, v136, v137
    v_max3_f32 v6, v6, v138, v139
    v_max3_f32 v7, v7, v140, v141
    v_max3_f32 v6, v6, v142, v143
    v_max_f32 v6, v6, v7
    v_mov_b32 v7, v6
    s_nop 1
    v_permlane32_swap_b32 v7, v6
    v_max_f32 v6, v6, v7
    v_max_f32 v6, 0, v6
    v_sub_f32 v7, 0, v6
    v_exp_f32 v7, v7
    v_sub_f32 v128, v128, v6
    v_sub_f32 v129, v129, v6
    v_sub_f32 v130, v130, v6
    v_sub_f32 v131, v131, v6
    v_sub_f32 v132, v132, v6
    v_sub_f32 v133, v133, v6
    v_sub_f32 v134, v134, v6
    v_sub_f32 v135, v135, v6
    v_sub_f32 v136, v136, v6
    v_sub_f32 v137, v137, v6
    v_sub_f32 v138, v138, v6
    v_sub_f32 v139, v139, v6
    v_sub_f32 v140, v140, v6
    v_sub_f32 v141, v141, v6
    v_sub_f32 v142, v142, v6
    v_sub_f32 v143, v143, v6
    v_sub_f32 v112, v112, v6
    v_sub_f32 v113, v113, v6
    v_sub_f32 v114, v114, v6
    v_sub_f32 v115, v115, v6
    v_sub_f32 v116, v116, v6
    v_sub_f32 v117, v117, v6
    v_sub_f32 v118, v118, v6
    v_sub_f32 v119, v119, v6
    v_sub_f32 v120, v120, v6
    v_sub_f32 v121, v121, v6
    v_sub_f32 v122, v122, v6
    v_sub_f32 v123, v123, v6
    v_sub_f32 v124, v124, v6
    v_sub_f32 v125, v125, v6
    v_sub_f32 v126, v126, v6
    v_sub_f32 v127, v127, v6
    v_sub_f32 v144, v144, v6
    v_sub_f32 v145, v145, v6
    v_sub_f32 v146, v146, v6
    v_sub_f32 v147, v147, v6
    v_sub_f32 v148, v148, v6
    v_sub_f32 v149, v149, v6
    v_sub_f32 v150, v150, v6
    v_sub_f32 v151, v151, v6
    v_sub_f32 v152, v152, v6
    v_sub_f32 v153, v153, v6
    v_sub_f32 v154, v154, v6
    v_sub_f32 v155, v155, v6
    v_sub_f32 v156, v156, v6
    v_sub_f32 v157, v157, v6
    v_sub_f32 v158, v158, v6
    v_sub_f32 v159, v159, v6
    v_mul_f32 v4, v4, v7
    v_mul_f32 v176, v176, v7
    v_mul_f32 v177, v177, v7
    v_mul_f32 v178, v178, v7
    v_mul_f32 v179, v179, v7
    v_mul_f32 v180, v180, v7
    v_mul_f32 v181, v181, v7
    v_mul_f32 v182, v182, v7
    v_mul_f32 v183, v183, v7
    v_mul_f32 v184, v184, v7
    v_mul_f32 v185, v185, v7
    v_mul_f32 v186, v186, v7
    v_mul_f32 v187, v187, v7
    v_mul_f32 v188, v188, v7
    v_mul_f32 v189, v189, v7
    v_mul_f32 v190, v190, v7
    v_mul_f32 v191, v191, v7
    v_mul_f32 v192, v192, v7
    v_mul_f32 v193, v193, v7
    v_mul_f32 v194, v194, v7
    v_mul_f32 v195, v195, v7
    v_mul_f32 v196, v196, v7
    v_mul_f32 v197, v197, v7
    v_mul_f32 v198, v198, v7
    v_mul_f32 v199, v199, v7
    v_mul_f32 v200, v200, v7
    v_mul_f32 v201, v201, v7
    v_mul_f32 v202, v202, v7
    v_mul_f32 v203, v203, v7
    v_mul_f32 v204, v204, v7
    v_mul_f32 v205, v205, v7
    v_mul_f32 v206, v206, v7
    v_mul_f32 v207, v207, v7
    v_mul_f32 v208, v208, v7
    v_mul_f32 v209, v209, v7
    v_mul_f32 v210, v210, v7
    v_mul_f32 v211, v211, v7
    v_mul_f32 v212, v212, v7
    v_mul_f32 v213, v213, v7
    v_mul_f32 v214, v214, v7
    v_mul_f32 v215, v215, v7
    v_mul_f32 v216, v216, v7
    v_mul_f32 v217, v217, v7
    v_mul_f32 v218, v218, v7
    v_mul_f32 v219, v219, v7
    v_mul_f32 v220, v220, v7
    v_mul_f32 v221, v221, v7
    v_mul_f32 v222, v222, v7
    v_mul_f32 v223, v223, v7
    v_mul_f32 v224, v224, v7
    v_mul_f32 v225, v225, v7
    v_mul_f32 v226, v226, v7
    v_mul_f32 v227, v227, v7
    v_mul_f32 v228, v228, v7
    v_mul_f32 v229, v229, v7
    v_mul_f32 v230, v230, v7
    v_mul_f32 v231, v231, v7
    v_mul_f32 v232, v232, v7
    v_mul_f32 v233, v233, v7
    v_mul_f32 v234, v234, v7
    v_mul_f32 v235, v235, v7
    v_mul_f32 v236, v236, v7
    v_mul_f32 v237, v237, v7
    v_mul_f32 v238, v238, v7
    v_mul_f32 v239, v239, v7
    v_exp_f32 v168, v128
    v_exp_f32 v169, v129
    v_exp_f32 v170, v130
    v_exp_f32 v171, v131
    v_cvt_pk_bf16_f32 v160, v168, v169
    v_add_f32 v174, v168, v169
    v_exp_f32 v172, v132
    v_exp_f32 v173, v133
    v_cvt_pk_bf16_f32 v161, v170, v171
    v_add_f32 v174, v174, v170
    v_add_f32 v174, v174, v171
    v_exp_f32 v168, v134
    v_exp_f32 v169, v135
    v_cvt_pk_bf16_f32 v162, v172, v173
    v_add_f32 v174, v174, v172
    v_add_f32 v174, v174, v173
    s_nop 0
    v_cvt_pk_bf16_f32 v163, v168, v169
    v_add_f32 v174, v174, v168
    v_add_f32 v174, v174, v169
    v_exp_f32 v168, v136
    v_exp_f32 v169, v137
    v_exp_f32 v170, v138
    v_exp_f32 v171, v139
    v_cvt_pk_bf16_f32 v164, v168, v169
    v_add_f32 v175, v168, v169
    v_exp_f32 v172, v140
    v_exp_f32 v173, v141
    s_nop 1
    s_branch L_back_42
L_slow_43:
    s_nop 15
    v_max3_f32 v6, v128, v129, v130
    v_max3_f32 v7, v131, v132, v133
    v_max3_f32 v6, v6, v134, v135
    v_max3_f32 v7, v7, v136, v137
    v_max3_f32 v6, v6, v138, v139
    v_max3_f32 v7, v7, v140, v141
    v_max3_f32 v6, v6, v142, v143
    v_max_f32 v6, v6, v7
    v_mov_b32 v7, v6
    s_nop 1
    v_permlane32_swap_b32 v7, v6
    v_max_f32 v6, v6, v7
    v_max_f32 v6, 0, v6
    v_sub_f32 v7, 0, v6
    v_exp_f32 v7, v7
    v_sub_f32 v128, v128, v6
    v_sub_f32 v129, v129, v6
    v_sub_f32 v130, v130, v6
    v_sub_f32 v131, v131, v6
    v_sub_f32 v132, v132, v6
    v_sub_f32 v133, v133, v6
    v_sub_f32 v134, v134, v6
    v_sub_f32 v135, v135, v6
    v_sub_f32 v136, v136, v6
    v_sub_f32 v137, v137, v6
    v_sub_f32 v138, v138, v6
    v_sub_f32 v139, v139, v6
    v_sub_f32 v140, v140, v6
    v_sub_f32 v141, v141, v6
    v_sub_f32 v142, v142, v6
    v_sub_f32 v143, v143, v6
    v_sub_f32 v112, v112, v6
    v_sub_f32 v113, v113, v6
    v_sub_f32 v114, v114, v6
    v_sub_f32 v115, v115, v6
    v_sub_f32 v116, v116, v6
    v_sub_f32 v117, v117, v6
    v_sub_f32 v118, v118, v6
    v_sub_f32 v119, v119, v6
    v_sub_f32 v120, v120, v6
    v_sub_f32 v121, v121, v6
    v_sub_f32 v122, v122, v6
    v_sub_f32 v123, v123, v6
    v_sub_f32 v124, v124, v6
    v_sub_f32 v125, v125, v6
    v_sub_f32 v126, v126, v6
    v_sub_f32 v127, v127, v6
    v_sub_f32 v144, v144, v6
    v_sub_f32 v145, v145, v6
    v_sub_f32 v146, v146, v6
    v_sub_f32 v147, v147, v6
    v_sub_f32 v148, v148, v6
    v_sub_f32 v149, v149, v6
    v_sub_f32 v150, v150, v6
    v_sub_f32 v151, v151, v6
    v_sub_f32 v152, v152, v6
    v_sub_f32 v153, v153, v6
    v_sub_f32 v154, v154, v6
    v_sub_f32 v155, v155, v6
    v_sub_f32 v156, v156, v6
    v_sub_f32 v157, v157, v6
    v_sub_f32 v158, v158, v6
    v_sub_f32 v159, v159, v6
    v_mul_f32 v4, v4, v7
    v_mul_f32 v176, v176, v7
    v_mul_f32 v177, v177, v7
    v_mul_f32 v178, v178, v7
    v_mul_f32 v179, v179, v7
    v_mul_f32 v180, v180, v7
    v_mul_f32 v181, v181, v7
    v_mul_f32 v182, v182, v7
    v_mul_f32 v183, v183, v7
    v_mul_f32 v184, v184, v7
    v_mul_f32 v185, v185, v7
    v_mul_f32 v186, v186, v7
    v_mul_f32 v187, v187, v7
    v_mul_f32 v188, v188, v7
    v_mul_f32 v189, v189, v7
    v_mul_f32 v190, v190, v7
    v_mul_f32 v191, v191, v7
    v_mul_f32 v192, v192, v7
    v_mul_f32 v193, v193, v7
    v_mul_f32 v194, v194, v7
    v_mul_f32 v195, v195, v7
    v_mul_f32 v196, v196, v7
    v_mul_f32 v197, v197, v7
    v_mul_f32 v198, v198, v7
    v_mul_f32 v199, v199, v7
    v_mul_f32 v200, v200, v7
    v_mul_f32 v201, v201, v7
    v_mul_f32 v202, v202, v7
    v_mul_f32 v203, v203, v7
    v_mul_f32 v204, v204, v7
    v_mul_f32 v205, v205, v7
    v_mul_f32 v206, v206, v7
    v_mul_f32 v207, v207, v7
    v_mul_f32 v208, v208, v7
    v_mul_f32 v209, v209, v7
    v_mul_f32 v210, v210, v7
    v_mul_f32 v211, v211, v7
    v_mul_f32 v212, v212, v7
    v_mul_f32 v213, v213, v7
    v_mul_f32 v214, v214, v7
    v_mul_f32 v215, v215, v7
    v_mul_f32 v216, v216, v7
    v_mul_f32 v217, v217, v7
    v_mul_f32 v218, v218, v7
    v_mul_f32 v219, v219, v7
    v_mul_f32 v220, v220, v7
    v_mul_f32 v221, v221, v7
    v_mul_f32 v222, v222, v7
    v_mul_f32 v223, v223, v7
    v_mul_f32 v224, v224, v7
    v_mul_f32 v225, v225, v7
    v_mul_f32 v226, v226, v7
    v_mul_f32 v227, v227, v7
    v_mul_f32 v228, v228, v7
    v_mul_f32 v229, v229, v7
    v_mul_f32 v230, v230, v7
    v_mul_f32 v231, v231, v7
    v_mul_f32 v232, v232, v7
    v_mul_f32 v233, v233, v7
    v_mul_f32 v234, v234, v7
    v_mul_f32 v235, v235, v7
    v_mul_f32 v236, v236, v7
    v_mul_f32 v237, v237, v7
    v_mul_f32 v238, v238, v7
    v_mul_f32 v239, v239, v7
    v_exp_f32 v168, v136
    v_exp_f32 v169, v137
    v_exp_f32 v170, v138
    v_exp_f32 v171, v139
    v_cvt_pk_bf16_f32 v164, v168, v169
    v_add_f32 v175, v168, v169
    v_exp_f32 v172, v140
    v_exp_f32 v173, v141
    v_cvt_pk_bf16_f32 v165, v170, v171
    v_add_f32 v175, v175, v170
    v_add_f32 v175, v175, v171
    v_exp_f32 v168, v142
    v_exp_f32 v169, v143
    v_cvt_pk_bf16_f32 v166, v172, v173
    v_add_f32 v175, v175, v172
    v_add_f32 v175, v175, v173
    s_nop 0
    v_cvt_pk_bf16_f32 v167, v168, v169
    v_add_f32 v175, v175, v168
    v_add_f32 v175, v175, v169
    s_nop 1
    s_branch L_back_44
L_slow_60:
    s_nop 15
    v_max3_f32 v6, v112, v113, v114
    v_max3_f32 v7, v115, v116, v117
    v_max3_f32 v6, v6, v118, v119
    v_max3_f32 v7, v7, v120, v121
    v_max3_f32 v6, v6, v122, v123
    v_max3_f32 v7, v7, v124, v125
    v_max3_f32 v6, v6, v126, v127
    v_max_f32 v6, v6, v7
    v_mov_b32 v7, v6
    s_nop 1
    v_permlane32_swap_b32 v7, v6
    v_max_f32 v6, v6, v7
    v_max_f32 v6, 0, v6
    v_sub_f32 v7, 0, v6
    v_exp_f32 v7, v7
    v_sub_f32 v112, v112, v6
    v_sub_f32 v113, v113, v6
    v_sub_f32 v114, v114, v6
    v_sub_f32 v115, v115, v6
    v_sub_f32 v116, v116, v6
    v_sub_f32 v117, v117, v6
    v_sub_f32 v118, v118, v6
    v_sub_f32 v119, v119, v6
    v_sub_f32 v120, v120, v6
    v_sub_f32 v121, v121, v6
    v_sub_f32 v122, v122, v6
    v_sub_f32 v123, v123, v6
    v_sub_f32 v124, v124, v6
    v_sub_f32 v125, v125, v6
    v_sub_f32 v126, v126, v6
    v_sub_f32 v127, v127, v6
    v_sub_f32 v128, v128, v6
    v_sub_f32 v129, v129, v6
    v_sub_f32 v130, v130, v6
    v_sub_f32 v131, v131, v6
    v_sub_f32 v132, v132, v6
    v_sub_f32 v133, v133, v6
    v_sub_f32 v134, v134, v6
    v_sub_f32 v135, v135, v6
    v_sub_f32 v136, v136, v6
    v_sub_f32 v137, v137, v6
    v_sub_f32 v138, v138, v6
    v_sub_f32 v139, v139, v6
    v_sub_f32 v140, v140, v6
    v_sub_f32 v141, v141, v6
    v_sub_f32 v142, v142, v6
    v_sub_f32 v143, v143, v6
    v_sub_f32 v144, v144, v6
    v_sub_f32 v145, v145, v6
    v_sub_f32 v146, v146, v6
    v_sub_f32 v147, v147, v6
    v_sub_f32 v148, v148, v6
    v_sub_f32 v149, v149, v6
    v_sub_f32 v150, v150, v6
    v_sub_f32 v151, v151, v6
    v_sub_f32 v152, v152, v6
    v_sub_f32 v153, v153, v6
    v_sub_f32 v154, v154, v6
    v_sub_f32 v155, v155, v6
    v_sub_f32 v156, v156, v6
    v_sub_f32 v157, v157, v6
    v_sub_f32 v158, v158, v6
    v_sub_f32 v159, v159, v6
    v_mul_f32 v4, v4, v7
    v_mul_f32 v176, v176, v7
    v_mul_f32 v177, v177, v7
    v_mul_f32 v178, v178, v7
    v_mul_f32 v179, v179, v7
    v_mul_f32 v180, v180, v7
    v_mul_f32 v181, v181, v7
    v_mul_f32 v182, v182, v7
    v_mul_f32 v183, v183, v7
    v_mul_f32 v184, v184, v7
    v_mul_f32 v185, v185, v7
    v_mul_f32 v186, v186, v7
    v_mul_f32 v187, v187, v7
    v_mul_f32 v188, v188, v7
    v_mul_f32 v189, v189, v7
    v_mul_f32 v190, v190, v7
    v_mul_f32 v191, v191, v7
    v_mul_f32 v192, v192, v7
    v_mul_f32 v193, v193, v7
    v_mul_f32 v194, v194, v7
    v_mul_f32 v195, v195, v7
    v_mul_f32 v196, v196, v7
    v_mul_f32 v197, v197, v7
    v_mul_f32 v198, v198, v7
    v_mul_f32 v199, v199, v7
    v_mul_f32 v200, v200, v7
    v_mul_f32 v201, v201, v7
    v_mul_f32 v202, v202, v7
    v_mul_f32 v203, v203, v7
    v_mul_f32 v204, v204, v7
    v_mul_f32 v205, v205, v7
    v_mul_f32 v206, v206, v7
    v_mul_f32 v207, v207, v7
    v_mul_f32 v208, v208, v7
    v_mul_f32 v209, v209, v7
    v_mul_f32 v210, v210, v7
    v_mul_f32 v211, v211, v7
    v_mul_f32 v212, v212, v7
    v_mul_f32 v213, v213, v7
    v_mul_f32 v214, v214, v7
    v_mul_f32 v215, v215, v7
    v_mul_f32 v216, v216, v7
    v_mul_f32 v217, v217, v7
    v_mul_f32 v218, v218, v7
    v_mul_f32 v219, v219, v7
    v_mul_f32 v220, v220, v7
    v_mul_f32 v221, v221, v7
    v_mul_f32 v222, v222, v7
    v_mul_f32 v223, v223, v7
    v_mul_f32 v224, v224, v7
    v_mul_f32 v225, v225, v7
    v_mul_f32 v226, v226, v7
    v_mul_f32 v227, v227, v7
    v_mul_f32 v228, v228, v7
    v_mul_f32 v229, v229, v7
    v_mul_f32 v230, v230, v7
    v_mul_f32 v231, v231, v7
    v_mul_f32 v232, v232, v7
    v_mul_f32 v233, v233, v7
    v_mul_f32 v234, v234, v7
    v_mul_f32 v235, v235, v7
    v_mul_f32 v236, v236, v7
    v_mul_f32 v237, v237, v7
    v_mul_f32 v238, v238, v7
    v_mul_f32 v239, v239, v7
    v_exp_f32 v168, v112
    v_exp_f32 v169, v113
    v_exp_f32 v170, v114
    v_exp_f32 v171, v115
    v_cvt_pk_bf16_f32 v160, v168, v169
    v_add_f32 v174, v168, v169
    v_exp_f32 v172, v116
    v_exp_f32 v173, v117
    v_cvt_pk_bf16_f32 v161, v170, v171
    v_add_f32 v174, v174, v170
    v_add_f32 v174, v174, v171
    v_exp_f32 v168, v118
    v_exp_f32 v169, v119
    v_cvt_pk_bf16_f32 v162, v172, v173
    v_add_f32 v174, v174, v172
    v_add_f32 v174, v174, v173
    s_nop 0
    v_cvt_pk_bf16_f32 v163, v168, v169
    v_add_f32 v174, v174, v168
    v_add_f32 v174, v174, v169
    v_exp_f32 v168, v120
    v_exp_f32 v169, v121
    v_exp_f32 v170, v122
    v_exp_f32 v171, v123
    v_cvt_pk_bf16_f32 v164, v168, v169
    v_add_f32 v175, v168, v169
    v_exp_f32 v172, v124
    v_exp_f32 v173, v125
    s_nop 1
    s_branch L_back_61
L_slow_62:
    s_nop 15
    v_max3_f32 v6, v112, v113, v114
    v_max3_f32 v7, v115, v116, v117
    v_max3_f32 v6, v6, v118, v119
    v_max3_f32 v7, v7, v120, v121
    v_max3_f32 v6, v6, v122, v123
    v_max3_f32 v7, v7, v124, v125
    v_max3_f32 v6, v6, v126, v127
    v_max_f32 v6, v6, v7
    v_mov_b32 v7, v6
    s_nop 1
    v_permlane32_swap_b32 v7, v6
    v_max_f32 v6, v6, v7
    v_max_f32 v6, 0, v6
    v_sub_f32 v7, 0, v6
    v_exp_f32 v7, v7
    v_sub_f32 v112, v112, v6
    v_sub_f32 v113, v113, v6
    v_sub_f32 v114, v114, v6
    v_sub_f32 v115, v115, v6
    v_sub_f32 v116, v116, v6
    v_sub_f32 v117, v117, v6
    v_sub_f32 v118, v118, v6
    v_sub_f32 v119, v119, v6
    v_sub_f32 v120, v120, v6
    v_sub_f32 v121, v121, v6
    v_sub_f32 v122, v122, v6
    v_sub_f32 v123, v123, v6
    v_sub_f32 v124, v124, v6
    v_sub_f32 v125, v125, v6
    v_sub_f32 v126, v126, v6
    v_sub_f32 v127, v127, v6
    v_sub_f32 v128, v128, v6
    v_sub_f32 v129, v129, v6
    v_sub_f32 v130, v130, v6
    v_sub_f32 v131, v131, v6
    v_sub_f32 v132, v132, v6
    v_sub_f32 v133, v133, v6
    v_sub_f32 v134, v134, v6
    v_sub_f32 v135, v135, v6
    v_sub_f32 v136, v136, v6
    v_sub_f32 v137, v137, v6
    v_sub_f32 v138, v138, v6
    v_sub_f32 v139, v139, v6
    v_sub_f32 v140, v140, v6
    v_sub_f32 v141, v141, v6
    v_sub_f32 v142, v142, v6
    v_sub_f32 v143, v143, v6
    v_sub_f32 v144, v144, v6
    v_sub_f32 v145, v145, v6
    v_sub_f32 v146, v146, v6
    v_sub_f32 v147, v147, v6
    v_sub_f32 v148, v148, v6
    v_sub_f32 v149, v149, v6
    v_sub_f32 v150, v150, v6
    v_sub_f32 v151, v151, v6
    v_sub_f32 v152, v152, v6
    v_sub_f32 v153, v153, v6
    v_sub_f32 v154, v154, v6
    v_sub_f32 v155, v155, v6
    v_sub_f32 v156, v156, v6
    v_sub_f32 v157, v157, v6
    v_sub_f32 v158, v158, v6
    v_sub_f32 v159, v159, v6
    v_mul_f32 v4, v4, v7
    v_mul_f32 v176, v176, v7
    v_mul_f32 v177, v177, v7
    v_mul_f32 v178, v178, v7
    v_mul_f32 v179, v179, v7
    v_mul_f32 v180, v180, v7
    v_mul_f32 v181, v181, v7
    v_mul_f32 v182, v182, v7
    v_mul_f32 v183, v183, v7
    v_mul_f32 v184, v184, v7
    v_mul_f32 v185, v185, v7
    v_mul_f32 v186, v186, v7
    v_mul_f32 v187, v187, v7
    v_mul_f32 v188, v188, v7
    v_mul_f32 v189, v189, v7
    v_mul_f32 v190, v190, v7
    v_mul_f32 v191, v191, v7
    v_mul_f32 v192, v192, v7
    v_mul_f32 v193, v193, v7
    v_mul_f32 v194, v194, v7
    v_mul_f32 v195, v195, v7
    v_mul_f32 v196, v196, v7
    v_mul_f32 v197, v197, v7
    v_mul_f32 v198, v198, v7
    v_mul_f32 v199, v199, v7
    v_mul_f32 v200, v200, v7
    v_mul_f32 v201, v201, v7
    v_mul_f32 v202, v202, v7
    v_mul_f32 v203, v203, v7
    v_mul_f32 v204, v204, v7
    v_mul_f32 v205, v205, v7
    v_mul_f32 v206, v206, v7
    v_mul_f32 v207, v207, v7
    v_mul_f32 v208, v208, v7
    v_mul_f32 v209, v209, v7
    v_mul_f32 v210, v210, v7
    v_mul_f32 v211, v211, v7
    v_mul_f32 v212, v212, v7
    v_mul_f32 v213, v213, v7
    v_mul_f32 v214, v214, v7
    v_mul_f32 v215, v215, v7
    v_mul_f32 v216, v216, v7
    v_mul_f32 v217, v217, v7
    v_mul_f32 v218, v218, v7
    v_mul_f32 v219, v219, v7
    v_mul_f32 v220, v220, v7
    v_mul_f32 v221, v221, v7
    v_mul_f32 v222, v222, v7
    v_mul_f32 v223, v223, v7
    v_mul_f32 v224, v224, v7
    v_mul_f32 v225, v225, v7
    v_mul_f32 v226, v226, v7
    v_mul_f32 v227, v227, v7
    v_mul_f32 v228, v228, v7
    v_mul_f32 v229, v229, v7
    v_mul_f32 v230, v230, v7
    v_mul_f32 v231, v231, v7
    v_mul_f32 v232, v232, v7
    v_mul_f32 v233, v233, v7
    v_mul_f32 v234, v234, v7
    v_mul_f32 v235, v235, v7
    v_mul_f32 v236, v236, v7
    v_mul_f32 v237, v237, v7
    v_mul_f32 v238, v238, v7
    v_mul_f32 v239, v239, v7
    v_exp_f32 v168, v120
    v_exp_f32 v169, v121
    v_exp_f32 v170, v122
    v_exp_f32 v171, v123
    v_cvt_pk_bf16_f32 v164, v168, v169
    v_add_f32 v175, v168, v169
    v_exp_f32 v172, v124
    v_exp_f32 v173, v125
    v_cvt_pk_bf16_f32 v165, v170, v171
    v_add_f32 v175, v175, v170
    v_add_f32 v175, v175, v171
    v_exp_f32 v168, v126
    v_exp_f32 v169, v127
    v_cvt_pk_bf16_f32 v166, v172, v173
    v_add_f32 v175, v175, v172
    v_add_f32 v175, v175, v173
    s_nop 0
    v_cvt_pk_bf16_f32 v167, v168, v169
    v_add_f32 v175, v175, v168
    v_add_f32 v175, v175, v169
    s_nop 1
    s_branch L_back_63
L_slow_64:
    s_nop 15
    v_max3_f32 v6, v128, v129, v130
    v_max3_f32 v7, v131, v132, v133
    v_max3_f32 v6, v6, v134, v135
    v_max3_f32 v7, v7, v136, v137
    v_max3_f32 v6, v6, v138, v139
    v_max3_f32 v7, v7, v140, v141
    v_max3_f32 v6, v6, v142, v143
    v_max_f32 v6, v6, v7
    v_mov_b32 v7, v6
    s_nop 1
    v_permlane32_swap_b32 v7, v6
    v_max_f32 v6, v6, v7
    v_max_f32 v6, 0, v6
    v_sub_f32 v7, 0, v6
    v_exp_f32 v7, v7
    v_sub_f32 v128, v128, v6
    v_sub_f32 v129, v129, v6
    v_sub_f32 v130, v130, v6
    v_sub_f32 v131, v131, v6
    v_sub_f32 v132, v132, v6
    v_sub_f32 v133, v133, v6
    v_sub_f32 v134, v134, v6
    v_sub_f32 v135, v135, v6
    v_sub_f32 v136, v136, v6
    v_sub_f32 v137, v137, v6
    v_sub_f32 v138, v138, v6
    v_sub_f32 v139, v139, v6
    v_sub_f32 v140, v140, v6
    v_sub_f32 v141, v141, v6
    v_sub_f32 v142, v142, v6
    v_sub_f32 v143, v143, v6
    v_sub_f32 v144, v144, v6
    v_sub_f32 v145, v145, v6
    v_sub_f32 v146, v146, v6
    v_sub_f32 v147, v147, v6
    v_sub_f32 v148, v148, v6
    v_sub_f32 v149, v149, v6
    v_sub_f32 v150, v150, v6
    v_sub_f32 v151, v151, v6
    v_sub_f32 v152, v152, v6
    v_sub_f32 v153, v153, v6
    v_sub_f32 v154, v154, v6
    v_sub_f32 v155, v155, v6
    v_sub_f32 v156, v156, v6
    v_sub_f32 v157, v157, v6
    v_sub_f32 v158, v158, v6
    v_sub_f32 v159, v159, v6
    v_mul_f32 v4, v4, v7
    v_mul_f32 v176, v176, v7
    v_mul_f32 v177, v177, v7
    v_mul_f32 v178, v178, v7
    v_mul_f32 v179, v179, v7
    v_mul_f32 v180, v180, v7
    v_mul_f32 v181, v181, v7
    v_mul_f32 v182, v182, v7
    v_mul_f32 v183, v183, v7
    v_mul_f32 v184, v184, v7
    v_mul_f32 v185, v185, v7
    v_mul_f32 v186, v186, v7
    v_mul_f32 v187, v187, v7
    v_mul_f32 v188, v188, v7
    v_mul_f32 v189, v189, v7
    v_mul_f32 v190, v190, v7
    v_mul_f32 v191, v191, v7
    v_mul_f32 v192, v192, v7
    v_mul_f32 v193, v193, v7
    v_mul_f32 v194, v194, v7
    v_mul_f32 v195, v195, v7
    v_mul_f32 v196, v196, v7
    v_mul_f32 v197, v197, v7
    v_mul_f32 v198, v198, v7
    v_mul_f32 v199, v199, v7
    v_mul_f32 v200, v200, v7
    v_mul_f32 v201, v201, v7
    v_mul_f32 v202, v202, v7
    v_mul_f32 v203, v203, v7
    v_mul_f32 v204, v204, v7
    v_mul_f32 v205, v205, v7
    v_mul_f32 v206, v206, v7
    v_mul_f32 v207, v207, v7
    v_mul_f32 v208, v208, v7
    v_mul_f32 v209, v209, v7
    v_mul_f32 v210, v210, v7
    v_mul_f32 v211, v211, v7
    v_mul_f32 v212, v212, v7
    v_mul_f32 v213, v213, v7
    v_mul_f32 v214, v214, v7
    v_mul_f32 v215, v215, v7
    v_mul_f32 v216, v216, v7
    v_mul_f32 v217, v217, v7
    v_mul_f32 v218, v218, v7
    v_mul_f32 v219, v219, v7
    v_mul_f32 v220, v220, v7
    v_mul_f32 v221, v221, v7
    v_mul_f32 v222, v222, v7
    v_mul_f32 v223, v223, v7
    v_mul_f32 v224, v224, v7
    v_mul_f32 v225, v225, v7
    v_mul_f32 v226, v226, v7
    v_mul_f32 v227, v227, v7
    v_mul_f32 v228, v228, v7
    v_mul_f32 v229, v229, v7
    v_mul_f32 v230, v230, v7
    v_mul_f32 v231, v231, v7
    v_mul_f32 v232, v232, v7
    v_mul_f32 v233, v233, v7
    v_mul_f32 v234, v234, v7
    v_mul_f32 v235, v235, v7
    v_mul_f32 v236, v236, v7
    v_mul_f32 v237, v237, v7
    v_mul_f32 v238, v238, v7
    v_mul_f32 v239, v239, v7
    v_exp_f32 v168, v128
    v_exp_f32 v169, v129
    v_exp_f32 v170, v130
    v_exp_f32 v171, v131
    v_cvt_pk_bf16_f32 v160, v168, v169
    v_add_f32 v174, v168, v169
    v_exp_f32 v172, v132
    v_exp_f32 v173, v133
    v_cvt_pk_bf16_f32 v161, v170, v171
    v_add_f32 v174, v174, v170
    v_add_f32 v174, v174, v171
    v_exp_f32 v168, v134
    v_exp_f32 v169, v135
    v_cvt_pk_bf16_f32 v162, v172, v173
    v_add_f32 v174, v174, v172
    v_add_f32 v174, v174, v173
    s_nop 0
    v_cvt_pk_bf16_f32 v163, v168, v169
    v_add_f32 v174, v174, v168
    v_add_f32 v174, v174, v169
    v_exp_f32 v168, v136
    v_exp_f32 v169, v137
    v_exp_f32 v170, v138
    v_exp_f32 v171, v139
    v_cvt_pk_bf16_f32 v164, v168, v169
    v_add_f32 v175, v168, v169
    v_exp_f32 v172, v140
    v_exp_f32 v173, v141
    s_nop 1
    s_branch L_back_65
L_slow_66:
    s_nop 15
    v_max3_f32 v6, v128, v129, v130
    v_max3_f32 v7, v131, v132, v133
    v_max3_f32 v6, v6, v134, v135
    v_max3_f32 v7, v7, v136, v137
    v_max3_f32 v6, v6, v138, v139
    v_max3_f32 v7, v7, v140, v141
    v_max3_f32 v6, v6, v142, v143
    v_max_f32 v6, v6, v7
    v_mov_b32 v7, v6
    s_nop 1
    v_permlane32_swap_b32 v7, v6
    v_max_f32 v6, v6, v7
    v_max_f32 v6, 0, v6
    v_sub_f32 v7, 0, v6
    v_exp_f32 v7, v7
    v_sub_f32 v128, v128, v6
    v_sub_f32 v129, v129, v6
    v_sub_f32 v130, v130, v6
    v_sub_f32 v131, v131, v6
    v_sub_f32 v132, v132, v6
    v_sub_f32 v133, v133, v6
    v_sub_f32 v134, v134, v6
    v_sub_f32 v135, v135, v6
    v_sub_f32 v136, v136, v6
    v_sub_f32 v137, v137, v6
    v_sub_f32 v138, v138, v6
    v_sub_f32 v139, v139, v6
    v_sub_f32 v140, v140, v6
    v_sub_f32 v141, v141, v6
    v_sub_f32 v142, v142, v6
    v_sub_f32 v143, v143, v6
    v_sub_f32 v144, v144, v6
    v_sub_f32 v145, v145, v6
    v_sub_f32 v146, v146, v6
    v_sub_f32 v147, v147, v6
    v_sub_f32 v148, v148, v6
    v_sub_f32 v149, v149, v6
    v_sub_f32 v150, v150, v6
    v_sub_f32 v151, v151, v6
    v_sub_f32 v152, v152, v6
    v_sub_f32 v153, v153, v6
    v_sub_f32 v154, v154, v6
    v_sub_f32 v155, v155, v6
    v_sub_f32 v156, v156, v6
    v_sub_f32 v157, v157, v6
    v_sub_f32 v158, v158, v6
    v_sub_f32 v159, v159, v6
    v_mul_f32 v4, v4, v7
    v_mul_f32 v176, v176, v7
    v_mul_f32 v177, v177, v7
    v_mul_f32 v178, v178, v7
    v_mul_f32 v179, v179, v7
    v_mul_f32 v180, v180, v7
    v_mul_f32 v181, v181, v7
    v_mul_f32 v182, v182, v7
    v_mul_f32 v183, v183, v7
    v_mul_f32 v184, v184, v7
    v_mul_f32 v185, v185, v7
    v_mul_f32 v186, v186, v7
    v_mul_f32 v187, v187, v7
    v_mul_f32 v188, v188, v7
    v_mul_f32 v189, v189, v7
    v_mul_f32 v190, v190, v7
    v_mul_f32 v191, v191, v7
    v_mul_f32 v192, v192, v7
    v_mul_f32 v193, v193, v7
    v_mul_f32 v194, v194, v7
    v_mul_f32 v195, v195, v7
    v_mul_f32 v196, v196, v7
    v_mul_f32 v197, v197, v7
    v_mul_f32 v198, v198, v7
    v_mul_f32 v199, v199, v7
    v_mul_f32 v200, v200, v7
    v_mul_f32 v201, v201, v7
    v_mul_f32 v202, v202, v7
    v_mul_f32 v203, v203, v7
    v_mul_f32 v204, v204, v7
    v_mul_f32 v205, v205, v7
    v_mul_f32 v206, v206, v7
    v_mul_f32 v207, v207, v7
    v_mul_f32 v208, v208, v7
    v_mul_f32 v209, v209, v7
    v_mul_f32 v210, v210, v7
    v_mul_f32 v211, v211, v7
    v_mul_f32 v212, v212, v7
    v_mul_f32 v213, v213, v7
    v_mul_f32 v214, v214, v7
    v_mul_f32 v215, v215, v7
    v_mul_f32 v216, v216, v7
    v_mul_f32 v217, v217, v7
    v_mul_f32 v218, v218, v7
    v_mul_f32 v219, v219, v7
    v_mul_f32 v220, v220, v7
    v_mul_f32 v221, v221, v7
    v_mul_f32 v222, v222, v7
    v_mul_f32 v223, v223, v7
    v_mul_f32 v224, v224, v7
    v_mul_f32 v225, v225, v7
    v_mul_f32 v226, v226, v7
    v_mul_f32 v227, v227, v7
    v_mul_f32 v228, v228, v7
    v_mul_f32 v229, v229, v7
    v_mul_f32 v230, v230, v7
    v_mul_f32 v231, v231, v7
    v_mul_f32 v232, v232, v7
    v_mul_f32 v233, v233, v7
    v_mul_f32 v234, v234, v7
    v_mul_f32 v235, v235, v7
    v_mul_f32 v236, v236, v7
    v_mul_f32 v237, v237, v7
    v_mul_f32 v238, v238, v7
    v_mul_f32 v239, v239, v7
    v_exp_f32 v168, v136
    v_exp_f32 v169, v137
    v_exp_f32 v170, v138
    v_exp_f32 v171, v139
    v_cvt_pk_bf16_f32 v164, v168, v169
    v_add_f32 v175, v168, v169
    v_exp_f32 v172, v140
    v_exp_f32 v173, v141
    v_cvt_pk_bf16_f32 v165, v170, v171
    v_add_f32 v175, v175, v170
    v_add_f32 v175, v175, v171
    v_exp_f32 v168, v142
    v_exp_f32 v169, v143
    v_cvt_pk_bf16_f32 v166, v172, v173
    v_add_f32 v175, v175, v172
    v_add_f32 v175, v175, v173
    s_nop 0
    v_cvt_pk_bf16_f32 v167, v168, v169
    v_add_f32 v175, v175, v168
    v_add_f32 v175, v175, v169
    s_nop 1
    s_branch L_back_67
L_slow_72:
    s_nop 15
    v_max3_f32 v6, v112, v113, v114
    v_max3_f32 v7, v115, v116, v117
    v_max3_f32 v6, v6, v118, v119
    v_max3_f32 v7, v7, v120, v121
    v_max3_f32 v6, v6, v122, v123
    v_max3_f32 v7, v7, v124, v125
    v_max3_f32 v6, v6, v126, v127
    v_max_f32 v6, v6, v7
    v_mov_b32 v7, v6
    s_nop 1
    v_permlane32_swap_b32 v7, v6
    v_max_f32 v6, v6, v7
    v_max_f32 v6, 0, v6
    v_sub_f32 v7, 0, v6
    v_exp_f32 v7, v7
    v_sub_f32 v112, v112, v6
    v_sub_f32 v113, v113, v6
    v_sub_f32 v114, v114, v6
    v_sub_f32 v115, v115, v6
    v_sub_f32 v116, v116, v6
    v_sub_f32 v117, v117, v6
    v_sub_f32 v118, v118, v6
    v_sub_f32 v119, v119, v6
    v_sub_f32 v120, v120, v6
    v_sub_f32 v121, v121, v6
    v_sub_f32 v122, v122, v6
    v_sub_f32 v123, v123, v6
    v_sub_f32 v124, v124, v6
    v_sub_f32 v125, v125, v6
    v_sub_f32 v126, v126, v6
    v_sub_f32 v127, v127, v6
    v_sub_f32 v128, v128, v6
    v_sub_f32 v129, v129, v6
    v_sub_f32 v130, v130, v6
    v_sub_f32 v131, v131, v6
    v_sub_f32 v132, v132, v6
    v_sub_f32 v133, v133, v6
    v_sub_f32 v134, v134, v6
    v_sub_f32 v135, v135, v6
    v_sub_f32 v136, v136, v6
    v_sub_f32 v137, v137, v6
    v_sub_f32 v138, v138, v6
    v_sub_f32 v139, v139, v6
    v_sub_f32 v140, v140, v6
    v_sub_f32 v141, v141, v6
    v_sub_f32 v142, v142, v6
    v_sub_f32 v143, v143, v6
    v_sub_f32 v144, v144, v6
    v_sub_f32 v145, v145, v6
    v_sub_f32 v146, v146, v6
    v_sub_f32 v147, v147, v6
    v_sub_f32 v148, v148, v6
    v_sub_f32 v149, v149, v6
    v_sub_f32 v150, v150, v6
    v_sub_f32 v151, v151, v6
    v_sub_f32 v152, v152, v6
    v_sub_f32 v153, v153, v6
    v_sub_f32 v154, v154, v6
    v_sub_f32 v155, v155, v6
    v_sub_f32 v156, v156, v6
    v_sub_f32 v157, v157, v6
    v_sub_f32 v158, v158, v6
    v_sub_f32 v159, v159, v6
    v_mul_f32 v4, v4, v7
    v_mul_f32 v176, v176, v7
    v_mul_f32 v177, v177, v7
    v_mul_f32 v178, v178, v7
    v_mul_f32 v179, v179, v7
    v_mul_f32 v180, v180, v7
    v_mul_f32 v181, v181, v7
    v_mul_f32 v182, v182, v7
    v_mul_f32 v183, v183, v7
    v_mul_f32 v184, v184, v7
    v_mul_f32 v185, v185, v7
    v_mul_f32 v186, v186, v7
    v_mul_f32 v187, v187, v7
    v_mul_f32 v188, v188, v7
    v_mul_f32 v189, v189, v7
    v_mul_f32 v190, v190, v7
    v_mul_f32 v191, v191, v7
    v_mul_f32 v192, v192, v7
    v_mul_f32 v193, v193, v7
    v_mul_f32 v194, v194, v7
    v_mul_f32 v195, v195, v7
    v_mul_f32 v196, v196, v7
    v_mul_f32 v197, v197, v7
    v_mul_f32 v198, v198, v7
    v_mul_f32 v199, v199, v7
    v_mul_f32 v200, v200, v7
    v_mul_f32 v201, v201, v7
    v_mul_f32 v202, v202, v7
    v_mul_f32 v203, v203, v7
    v_mul_f32 v204, v204, v7
    v_mul_f32 v205, v205, v7
    v_mul_f32 v206, v206, v7
    v_mul_f32 v207, v207, v7
    v_mul_f32 v208, v208, v7
    v_mul_f32 v209, v209, v7
    v_mul_f32 v210, v210, v7
    v_mul_f32 v211, v211, v7
    v_mul_f32 v212, v212, v7
    v_mul_f32 v213, v213, v7
    v_mul_f32 v214, v214, v7
    v_mul_f32 v215, v215, v7
    v_mul_f32 v216, v216, v7
    v_mul_f32 v217, v217, v7
    v_mul_f32 v218, v218, v7
    v_mul_f32 v219, v219, v7
    v_mul_f32 v220, v220, v7
    v_mul_f32 v221, v221, v7
    v_mul_f32 v222, v222, v7
    v_mul_f32 v223, v223, v7
    v_mul_f32 v224, v224, v7
    v_mul_f32 v225, v225, v7
    v_mul_f32 v226, v226, v7
    v_mul_f32 v227, v227, v7
    v_mul_f32 v228, v228, v7
    v_mul_f32 v229, v229, v7
    v_mul_f32 v230, v230, v7
    v_mul_f32 v231, v231, v7
    v_mul_f32 v232, v232, v7
    v_mul_f32 v233, v233, v7
    v_mul_f32 v234, v234, v7
    v_mul_f32 v235, v235, v7
    v_mul_f32 v236, v236, v7
    v_mul_f32 v237, v237, v7
    v_mul_f32 v238, v238, v7
    v_mul_f32 v239, v239, v7
    v_exp_f32 v168, v112
    v_exp_f32 v169, v113
    v_exp_f32 v170, v114
    v_exp_f32 v171, v115
    v_cvt_pk_bf16_f32 v160, v168, v169
    v_add_f32 v174, v168, v169
    v_exp_f32 v172, v116
    v_exp_f32 v173, v117
    v_cvt_pk_bf16_f32 v161, v170, v171
    v_add_f32 v174, v174, v170
    v_add_f32 v174, v174, v171
    v_exp_f32 v168, v118
    v_exp_f32 v169, v119
    v_cvt_pk_bf16_f32 v162, v172, v173
    v_add_f32 v174, v174, v172
    v_add_f32 v174, v174, v173
    s_nop 0
    v_cvt_pk_bf16_f32 v163, v168, v169
    v_add_f32 v174, v174, v168
    v_add_f32 v174, v174, v169
    v_exp_f32 v168, v120
    v_exp_f32 v169, v121
    v_exp_f32 v170, v122
    v_exp_f32 v171, v123
    v_cvt_pk_bf16_f32 v164, v168, v169
    v_add_f32 v175, v168, v169
    v_exp_f32 v172, v124
    v_exp_f32 v173, v125
    s_nop 1
    s_branch L_back_73
L_slow_74:
    s_nop 15
    v_max3_f32 v6, v112, v113, v114
    v_max3_f32 v7, v115, v116, v117
    v_max3_f32 v6, v6, v118, v119
    v_max3_f32 v7, v7, v120, v121
    v_max3_f32 v6, v6, v122, v123
    v_max3_f32 v7, v7, v124, v125
    v_max3_f32 v6, v6, v126, v127
    v_max_f32 v6, v6, v7
    v_mov_b32 v7, v6
    s_nop 1
    v_permlane32_swap_b32 v7, v6
    v_max_f32 v6, v6, v7
    v_max_f32 v6, 0, v6
    v_sub_f32 v7, 0, v6
    v_exp_f32 v7, v7
    v_sub_f32 v112, v112, v6
    v_sub_f32 v113, v113, v6
    v_sub_f32 v114, v114, v6
    v_sub_f32 v115, v115, v6
    v_sub_f32 v116, v116, v6
    v_sub_f32 v117, v117, v6
    v_sub_f32 v118, v118, v6
    v_sub_f32 v119, v119, v6
    v_sub_f32 v120, v120, v6
    v_sub_f32 v121, v121, v6
    v_sub_f32 v122, v122, v6
    v_sub_f32 v123, v123, v6
    v_sub_f32 v124, v124, v6
    v_sub_f32 v125, v125, v6
    v_sub_f32 v126, v126, v6
    v_sub_f32 v127, v127, v6
    v_sub_f32 v128, v128, v6
    v_sub_f32 v129, v129, v6
    v_sub_f32 v130, v130, v6
    v_sub_f32 v131, v131, v6
    v_sub_f32 v132, v132, v6
    v_sub_f32 v133, v133, v6
    v_sub_f32 v134, v134, v6
    v_sub_f32 v135, v135, v6
    v_sub_f32 v136, v136, v6
    v_sub_f32 v137, v137, v6
    v_sub_f32 v138, v138, v6
    v_sub_f32 v139, v139, v6
    v_sub_f32 v140, v140, v6
    v_sub_f32 v141, v141, v6
    v_sub_f32 v142, v142, v6
    v_sub_f32 v143, v143, v6
    v_sub_f32 v144, v144, v6
    v_sub_f32 v145, v145, v6
    v_sub_f32 v146, v146, v6
    v_sub_f32 v147, v147, v6
    v_sub_f32 v148, v148, v6
    v_sub_f32 v149, v149, v6
    v_sub_f32 v150, v150, v6
    v_sub_f32 v151, v151, v6
    v_sub_f32 v152, v152, v6
    v_sub_f32 v153, v153, v6
    v_sub_f32 v154, v154, v6
    v_sub_f32 v155, v155, v6
    v_sub_f32 v156, v156, v6
    v_sub_f32 v157, v157, v6
    v_sub_f32 v158, v158, v6
    v_sub_f32 v159, v159, v6
    v_mul_f32 v4, v4, v7
    v_mul_f32 v176, v176, v7
    v_mul_f32 v177, v177, v7
    v_mul_f32 v178, v178, v7
    v_mul_f32 v179, v179, v7
    v_mul_f32 v180, v180, v7
    v_mul_f32 v181, v181, v7
    v_mul_f32 v182, v182, v7
    v_mul_f32 v183, v183, v7
    v_mul_f32 v184, v184, v7
    v_mul_f32 v185, v185, v7
    v_mul_f32 v186, v186, v7
    v_mul_f32 v187, v187, v7
    v_mul_f32 v188, v188, v7
    v_mul_f32 v189, v189, v7
    v_mul_f32 v190, v190, v7
    v_mul_f32 v191, v191, v7
    v_mul_f32 v192, v192, v7
    v_mul_f32 v193, v193, v7
    v_mul_f32 v194, v194, v7
    v_mul_f32 v195, v195, v7
    v_mul_f32 v196, v196, v7
    v_mul_f32 v197, v197, v7
    v_mul_f32 v198, v198, v7
    v_mul_f32 v199, v199, v7
    v_mul_f32 v200, v200, v7
    v_mul_f32 v201, v201, v7
    v_mul_f32 v202, v202, v7
    v_mul_f32 v203, v203, v7
    v_mul_f32 v204, v204, v7
    v_mul_f32 v205, v205, v7
    v_mul_f32 v206, v206, v7
    v_mul_f32 v207, v207, v7
    v_mul_f32 v208, v208, v7
    v_mul_f32 v209, v209, v7
    v_mul_f32 v210, v210, v7
    v_mul_f32 v211, v211, v7
    v_mul_f32 v212, v212, v7
    v_mul_f32 v213, v213, v7
    v_mul_f32 v214, v214, v7
    v_mul_f32 v215, v215, v7
    v_mul_f32 v216, v216, v7
    v_mul_f32 v217, v217, v7
    v_mul_f32 v218, v218, v7
    v_mul_f32 v219, v219, v7
    v_mul_f32 v220, v220, v7
    v_mul_f32 v221, v221, v7
    v_mul_f32 v222, v222, v7
    v_mul_f32 v223, v223, v7
    v_mul_f32 v224, v224, v7
    v_mul_f32 v225, v225, v7
    v_mul_f32 v226, v226, v7
    v_mul_f32 v227, v227, v7
    v_mul_f32 v228, v228, v7
    v_mul_f32 v229, v229, v7
    v_mul_f32 v230, v230, v7
    v_mul_f32 v231, v231, v7
    v_mul_f32 v232, v232, v7
    v_mul_f32 v233, v233, v7
    v_mul_f32 v234, v234, v7
    v_mul_f32 v235, v235, v7
    v_mul_f32 v236, v236, v7
    v_mul_f32 v237, v237, v7
    v_mul_f32 v238, v238, v7
    v_mul_f32 v239, v239, v7
    v_exp_f32 v168, v120
    v_exp_f32 v169, v121
    v_exp_f32 v170, v122
    v_exp_f32 v171, v123
    v_cvt_pk_bf16_f32 v164, v168, v169
    v_add_f32 v175, v168, v169
    v_exp_f32 v172, v124
    v_exp_f32 v173, v125
    v_cvt_pk_bf16_f32 v165, v170, v171
    v_add_f32 v175, v175, v170
    v_add_f32 v175, v175, v171
    v_exp_f32 v168, v126
    v_exp_f32 v169, v127
    v_cvt_pk_bf16_f32 v166, v172, v173
    v_add_f32 v175, v175, v172
    v_add_f32 v175, v175, v173
    s_nop 0
    v_cvt_pk_bf16_f32 v167, v168, v169
    v_add_f32 v175, v175, v168
    v_add_f32 v175, v175, v169
    s_nop 1
    s_branch L_back_75
L_slow_76:
    s_nop 15
    v_max3_f32 v6, v128, v129, v130
    v_max3_f32 v7, v131, v132, v133
    v_max3_f32 v6, v6, v134, v135
    v_max3_f32 v7, v7, v136, v137
    v_max3_f32 v6, v6, v138, v139
    v_max3_f32 v7, v7, v140, v141
    v_max3_f32 v6, v6, v142, v143
    v_max_f32 v6, v6, v7
    v_mov_b32 v7, v6
    s_nop 1
    v_permlane32_swap_b32 v7, v6
    v_max_f32 v6, v6, v7
    v_max_f32 v6, 0, v6
    v_sub_f32 v7, 0, v6
    v_exp_f32 v7, v7
    v_sub_f32 v128, v128, v6
    v_sub_f32 v129, v129, v6
    v_sub_f32 v130, v130, v6
    v_sub_f32 v131, v131, v6
    v_sub_f32 v132, v132, v6
    v_sub_f32 v133, v133, v6
    v_sub_f32 v134, v134, v6
    v_sub_f32 v135, v135, v6
    v_sub_f32 v136, v136, v6
    v_sub_f32 v137, v137, v6
    v_sub_f32 v138, v138, v6
    v_sub_f32 v139, v139, v6
    v_sub_f32 v140, v140, v6
    v_sub_f32 v141, v141, v6
    v_sub_f32 v142, v142, v6
    v_sub_f32 v143, v143, v6
    v_sub_f32 v144, v144, v6
    v_sub_f32 v145, v145, v6
    v_sub_f32 v146, v146, v6
    v_sub_f32 v147, v147, v6
    v_sub_f32 v148, v148, v6
    v_sub_f32 v149, v149, v6
    v_sub_f32 v150, v150, v6
    v_sub_f32 v151, v151, v6
    v_sub_f32 v152, v152, v6
    v_sub_f32 v153, v153, v6
    v_sub_f32 v154, v154, v6
    v_sub_f32 v155, v155, v6
    v_sub_f32 v156, v156, v6
    v_sub_f32 v157, v157, v6
    v_sub_f32 v158, v158, v6
    v_sub_f32 v159, v159, v6
    v_mul_f32 v4, v4, v7
    v_mul_f32 v176, v176, v7
    v_mul_f32 v177, v177, v7
    v_mul_f32 v178, v178, v7
    v_mul_f32 v179, v179, v7
    v_mul_f32 v180, v180, v7
    v_mul_f32 v181, v181, v7
    v_mul_f32 v182, v182, v7
    v_mul_f32 v183, v183, v7
    v_mul_f32 v184, v184, v7
    v_mul_f32 v185, v185, v7
    v_mul_f32 v186, v186, v7
    v_mul_f32 v187, v187, v7
    v_mul_f32 v188, v188, v7
    v_mul_f32 v189, v189, v7
    v_mul_f32 v190, v190, v7
    v_mul_f32 v191, v191, v7
    v_mul_f32 v192, v192, v7
    v_mul_f32 v193, v193, v7
    v_mul_f32 v194, v194, v7
    v_mul_f32 v195, v195, v7
    v_mul_f32 v196, v196, v7
    v_mul_f32 v197, v197, v7
    v_mul_f32 v198, v198, v7
    v_mul_f32 v199, v199, v7
    v_mul_f32 v200, v200, v7
    v_mul_f32 v201, v201, v7
    v_mul_f32 v202, v202, v7
    v_mul_f32 v203, v203, v7
    v_mul_f32 v204, v204, v7
    v_mul_f32 v205, v205, v7
    v_mul_f32 v206, v206, v7
    v_mul_f32 v207, v207, v7
    v_mul_f32 v208, v208, v7
    v_mul_f32 v209, v209, v7
    v_mul_f32 v210, v210, v7
    v_mul_f32 v211, v211, v7
    v_mul_f32 v212, v212, v7
    v_mul_f32 v213, v213, v7
    v_mul_f32 v214, v214, v7
    v_mul_f32 v215, v215, v7
    v_mul_f32 v216, v216, v7
    v_mul_f32 v217, v217, v7
    v_mul_f32 v218, v218, v7
    v_mul_f32 v219, v219, v7
    v_mul_f32 v220, v220, v7
    v_mul_f32 v221, v221, v7
    v_mul_f32 v222, v222, v7
    v_mul_f32 v223, v223, v7
    v_mul_f32 v224, v224, v7
    v_mul_f32 v225, v225, v7
    v_mul_f32 v226, v226, v7
    v_mul_f32 v227, v227, v7
    v_mul_f32 v228, v228, v7
    v_mul_f32 v229, v229, v7
    v_mul_f32 v230, v230, v7
    v_mul_f32 v231, v231, v7
    v_mul_f32 v232, v232, v7
    v_mul_f32 v233, v233, v7
    v_mul_f32 v234, v234, v7
    v_mul_f32 v235, v235, v7
    v_mul_f32 v236, v236, v7
    v_mul_f32 v237, v237, v7
    v_mul_f32 v238, v238, v7
    v_mul_f32 v239, v239, v7
    v_exp_f32 v168, v128
    v_exp_f32 v169, v129
    v_exp_f32 v170, v130
    v_exp_f32 v171, v131
    v_cvt_pk_bf16_f32 v160, v168, v169
    v_add_f32 v174, v168, v169
    v_exp_f32 v172, v132
    v_exp_f32 v173, v133
    v_cvt_pk_bf16_f32 v161, v170, v171
    v_add_f32 v174, v174, v170
    v_add_f32 v174, v174, v171
    v_exp_f32 v168, v134
    v_exp_f32 v169, v135
    v_cvt_pk_bf16_f32 v162, v172, v173
    v_add_f32 v174, v174, v172
    v_add_f32 v174, v174, v173
    s_nop 0
    v_cvt_pk_bf16_f32 v163, v168, v169
    v_add_f32 v174, v174, v168
    v_add_f32 v174, v174, v169
    v_exp_f32 v168, v136
    v_exp_f32 v169, v137
    v_exp_f32 v170, v138
    v_exp_f32 v171, v139
    v_cvt_pk_bf16_f32 v164, v168, v169
    v_add_f32 v175, v168, v169
    v_exp_f32 v172, v140
    v_exp_f32 v173, v141
    s_nop 1
    s_branch L_back_77
L_slow_78:
    s_nop 15
    v_max3_f32 v6, v128, v129, v130
    v_max3_f32 v7, v131, v132, v133
    v_max3_f32 v6, v6, v134, v135
    v_max3_f32 v7, v7, v136, v137
    v_max3_f32 v6, v6, v138, v139
    v_max3_f32 v7, v7, v140, v141
    v_max3_f32 v6, v6, v142, v143
    v_max_f32 v6, v6, v7
    v_mov_b32 v7, v6
    s_nop 1
    v_permlane32_swap_b32 v7, v6
    v_max_f32 v6, v6, v7
    v_max_f32 v6, 0, v6
    v_sub_f32 v7, 0, v6
    v_exp_f32 v7, v7
    v_sub_f32 v128, v128, v6
    v_sub_f32 v129, v129, v6
    v_sub_f32 v130, v130, v6
    v_sub_f32 v131, v131, v6
    v_sub_f32 v132, v132, v6
    v_sub_f32 v133, v133, v6
    v_sub_f32 v134, v134, v6
    v_sub_f32 v135, v135, v6
    v_sub_f32 v136, v136, v6
    v_sub_f32 v137, v137, v6
    v_sub_f32 v138, v138, v6
    v_sub_f32 v139, v139, v6
    v_sub_f32 v140, v140, v6
    v_sub_f32 v141, v141, v6
    v_sub_f32 v142, v142, v6
    v_sub_f32 v143, v143, v6
    v_sub_f32 v144, v144, v6
    v_sub_f32 v145, v145, v6
    v_sub_f32 v146, v146, v6
    v_sub_f32 v147, v147, v6
    v_sub_f32 v148, v148, v6
    v_sub_f32 v149, v149, v6
    v_sub_f32 v150, v150, v6
    v_sub_f32 v151, v151, v6
    v_sub_f32 v152, v152, v6
    v_sub_f32 v153, v153, v6
    v_sub_f32 v154, v154, v6
    v_sub_f32 v155, v155, v6
    v_sub_f32 v156, v156, v6
    v_sub_f32 v157, v157, v6
    v_sub_f32 v158, v158, v6
    v_sub_f32 v159, v159, v6
    v_mul_f32 v4, v4, v7
    v_mul_f32 v176, v176, v7
    v_mul_f32 v177, v177, v7
    v_mul_f32 v178, v178, v7
    v_mul_f32 v179, v179, v7
    v_mul_f32 v180, v180, v7
    v_mul_f32 v181, v181, v7
    v_mul_f32 v182, v182, v7
    v_mul_f32 v183, v183, v7
    v_mul_f32 v184, v184, v7
    v_mul_f32 v185, v185, v7
    v_mul_f32 v186, v186, v7
    v_mul_f32 v187, v187, v7
    v_mul_f32 v188, v188, v7
    v_mul_f32 v189, v189, v7
    v_mul_f32 v190, v190, v7
    v_mul_f32 v191, v191, v7
    v_mul_f32 v192, v192, v7
    v_mul_f32 v193, v193, v7
    v_mul_f32 v194, v194, v7
    v_mul_f32 v195, v195, v7
    v_mul_f32 v196, v196, v7
    v_mul_f32 v197, v197, v7
    v_mul_f32 v198, v198, v7
    v_mul_f32 v199, v199, v7
    v_mul_f32 v200, v200, v7
    v_mul_f32 v201, v201, v7
    v_mul_f32 v202, v202, v7
    v_mul_f32 v203, v203, v7
    v_mul_f32 v204, v204, v7
    v_mul_f32 v205, v205, v7
    v_mul_f32 v206, v206, v7
    v_mul_f32 v207, v207, v7
    v_mul_f32 v208, v208, v7
    v_mul_f32 v209, v209, v7
    v_mul_f32 v210, v210, v7
    v_mul_f32 v211, v211, v7
    v_mul_f32 v212, v212, v7
    v_mul_f32 v213, v213, v7
    v_mul_f32 v214, v214, v7
    v_mul_f32 v215, v215, v7
    v_mul_f32 v216, v216, v7
    v_mul_f32 v217, v217, v7
    v_mul_f32 v218, v218, v7
    v_mul_f32 v219, v219, v7
    v_mul_f32 v220, v220, v7
    v_mul_f32 v221, v221, v7
    v_mul_f32 v222, v222, v7
    v_mul_f32 v223, v223, v7
    v_mul_f32 v224, v224, v7
    v_mul_f32 v225, v225, v7
    v_mul_f32 v226, v226, v7
    v_mul_f32 v227, v227, v7
    v_mul_f32 v228, v228, v7
    v_mul_f32 v229, v229, v7
    v_mul_f32 v230, v230, v7
    v_mul_f32 v231, v231, v7
    v_mul_f32 v232, v232, v7
    v_mul_f32 v233, v233, v7
    v_mul_f32 v234, v234, v7
    v_mul_f32 v235, v235, v7
    v_mul_f32 v236, v236, v7
    v_mul_f32 v237, v237, v7
    v_mul_f32 v238, v238, v7
    v_mul_f32 v239, v239, v7
    v_exp_f32 v168, v136
    v_exp_f32 v169, v137
    v_exp_f32 v170, v138
    v_exp_f32 v171, v139
    v_cvt_pk_bf16_f32 v164, v168, v169
    v_add_f32 v175, v168, v169
    v_exp_f32 v172, v140
    v_exp_f32 v173, v141
    v_cvt_pk_bf16_f32 v165, v170, v171
    v_add_f32 v175, v175, v170
    v_add_f32 v175, v175, v171
    v_exp_f32 v168, v142
    v_exp_f32 v169, v143
    v_cvt_pk_bf16_f32 v166, v172, v173
    v_add_f32 v175, v175, v172
    v_add_f32 v175, v175, v173
    s_nop 0
    v_cvt_pk_bf16_f32 v167, v168, v169
    v_add_f32 v175, v175, v168
    v_add_f32 v175, v175, v169
    s_nop 1
    s_branch L_back_79
L_pollslow_2:
    s_mov_b32 s78, 0
L_spin_91:
    buffer_load_dwordx4 v[248:251], v1, s[88:91], 0 offen offset:1024 sc1
    s_waitcnt vmcnt(0)
    v_xor_b32 v248, s95, v248
    v_xor_b32 v249, s95, v249
    v_xor_b32 v250, s95, v250
    v_xor_b32 v251, s95, v251
    v_or3_b32 v252, v248, v249, v250
    v_or_b32 v252, v252, v251
    v_cmp_ne_u32 vcc, 0, v252
    s_cbranch_vccz L_pollback_3
    s_add_u32 s78, s78, 1
    s_cmp_ge_u32 s78, 32
    s_cbranch_scc1 L_help_92
    s_sleep 8
    s_branch L_spin_91
L_help_92:
    s_ff1_i32_b64 s35, vcc
    v_cmp_ne_u32 vcc, 0, v250
    s_nop 1
    v_cndmask_b32 v252, 3, 2, vcc
    v_cmp_ne_u32 vcc, 0, v249
    s_nop 1
    v_cndmask_b32 v252, v252, 1, vcc
    v_cmp_ne_u32 vcc, 0, v248
    s_nop 1
    v_cndmask_b32 v252, v252, 0, vcc
    s_nop 1
    v_readlane_b32 s79, v252, s35
    s_nop 3
    s_lshl2_add_u32 s79, s35, s79
    s_cmp_lt_i32 s35, 0
    s_cselect_b32 s79, -1, s79
    s_lshl_b32 s34, s79, 3
    s_mov_b32 s78, 8
L_rowl_93:
    s_lshl_b32 s35, s34, 11
    v_lshlrev_b32 v16, 1, v1
    buffer_load_dwordx4 v[248:251], v16, s[36:39], s35 offen
    buffer_load_dwordx4 v[252:255], v16, s[36:39], s35 offen offset:16
    s_waitcnt vmcnt(0)
    v_lshlrev_b32 v208, 16, v248
    v_and_b32 v209, 0xffff0000, v248
    v_lshlrev_b32 v210, 16, v249
    v_and_b32 v211, 0xffff0000, v249
    v_lshlrev_b32 v212, 16, v250
    v_and_b32 v213, 0xffff0000, v250
    v_lshlrev_b32 v214, 16, v251
    v_and_b32 v215, 0xffff0000, v251
    v_lshlrev_b32 v216, 16, v252
    v_and_b32 v217, 0xffff0000, v252
    v_lshlrev_b32 v218, 16, v253
    v_and_b32 v219, 0xffff0000, v253
    v_lshlrev_b32 v220, 16, v254
    v_and_b32 v221, 0xffff0000, v254
    v_lshlrev_b32 v222, 16, v255
    v_and_b32 v223, 0xffff0000, v255
    v_add_f32 v224, v208, v209
    v_add_f32 v226, v210, v211
    v_add_f32 v224, v224, v212
    v_add_f32 v226, v226, v213
    v_add_f32 v224, v224, v214
    v_add_f32 v226, v226, v215
    v_add_f32 v224, v224, v216
    v_add_f32 v226, v226, v217
    v_add_f32 v224, v224, v218
    v_add_f32 v226, v226, v219
    v_add_f32 v224, v224, v220
    v_add_f32 v226, v226, v221
    v_add_f32 v224, v224, v222
    v_add_f32 v226, v226, v223
    v_add_f32 v224, v224, v226
    s_nop 1
    v_add_f32_dpp v224, v224, v224 quad_perm:[1,0,3,2] row_mask:0xf bank_mask:0xf
    s_nop 1
    v_add_f32_dpp v224, v224, v224 quad_perm:[2,3,0,1] row_mask:0xf bank_mask:0xf
    s_nop 1
    v_add_f32_dpp v224, v224, v224 row_half_mirror row_mask:0xf bank_mask:0xf
    s_nop 1
    v_add_f32_dpp v224, v224, v224 row_mirror row_mask:0xf bank_mask:0xf
    v_mov_b32 v226, v224
    s_nop 1
    v_permlane16_swap_b32 v226, v224
    v_add_f32 v224, v224, v226
    v_mov_b32 v226, v224
    s_nop 1
    v_permlane32_swap_b32 v226, v224
    v_add_f32 v224, v224, v226
    v_mul_f32 v224, 0x3a800000, v224
    v_sub_f32 v227, v208, v224
    v_mul_f32 v225, v227, v227
    v_sub_f32 v227, v209, v224
    v_fmac_f32 v225, v227, v227
    v_sub_f32 v227, v210, v224
    v_fmac_f32 v225, v227, v227
    v_sub_f32 v227, v211, v224
    v_fmac_f32 v225, v227, v227
    v_sub_f32 v227, v212, v224
    v_fmac_f32 v225, v227, v227
    v_sub_f32 v227, v213, v224
    v_fmac_f32 v225, v227, v227
    v_sub_f32 v227, v214, v224
    v_fmac_f32 v225, v227, v227
    v_sub_f32 v227, v215, v224
    v_fmac_f32 v225, v227, v227
    v_sub_f32 v227, v216, v224
    v_fmac_f32 v225, v227, v227
    v_sub_f32 v227, v217, v224
    v_fmac_f32 v225, v227, v227
    v_sub_f32 v227, v218, v224
    v_fmac_f32 v225, v227, v227
    v_sub_f32 v227, v219, v224
    v_fmac_f32 v225, v227, v227
    v_sub_f32 v227, v220, v224
    v_fmac_f32 v225, v227, v227
    v_sub_f32 v227, v221, v224
    v_fmac_f32 v225, v227, v227
    v_sub_f32 v227, v222, v224
    v_fmac_f32 v225, v227, v227
    v_sub_f32 v227, v223, v224
    v_fmac_f32 v225, v227, v227
    s_nop 1
    v_add_f32_dpp v225, v225, v225 quad_perm:[1,0,3,2] row_mask:0xf bank_mask:0xf
    s_nop 1
    v_add_f32_dpp v225, v225, v225 quad_perm:[2,3,0,1] row_mask:0xf bank_mask:0xf
    s_nop 1
    v_add_f32_dpp v225, v225, v225 row_half_mirror row_mask:0xf bank_mask:0xf
    s_nop 1
    v_add_f32_dpp v225, v225, v225 row_mirror row_mask:0xf bank_mask:0xf
    v_mov_b32 v226, v225
    s_nop 1
    v_permlane16_swap_b32 v226, v225
    v_add_f32 v225, v225, v226
    v_mov_b32 v226, v225
    s_nop 1
    v_permlane32_swap_b32 v226, v225
    v_add_f32 v225, v225, v226
    v_mul_f32 v225, 0x3a800000, v225
    v_cvt_pk_bf16_f32 v224, v224, v224
    v_lshlrev_b32 v224, 16, v224
    v_cvt_pk_bf16_f32 v225, v225, v225
    v_lshlrev_b32 v225, 16, v225
    v_add_f32 v225, 0x3727c5ac, v225
    v_cvt_pk_bf16_f32 v225, v225, v225
    v_lshlrev_b32 v225, 16, v225
    v_sqrt_f32 v225, v225
    s_nop 0
    v_cvt_pk_bf16_f32 v225, v225, v225
    v_lshlrev_b32 v225, 16, v225
    v_rcp_f32 v225, v225
    v_sub_f32 v208, v208, v224
    v_sub_f32 v209, v209, v224
    v_sub_f32 v210, v210, v224
    v_sub_f32 v211, v211, v224
    v_sub_f32 v212, v212, v224
    v_sub_f32 v213, v213, v224
    v_sub_f32 v214, v214, v224
    v_sub_f32 v215, v215, v224
    v_sub_f32 v216, v216, v224
    v_sub_f32 v217, v217, v224
    v_sub_f32 v218, v218, v224
    v_sub_f32 v219, v219, v224
    v_sub_f32 v220, v220, v224
    v_sub_f32 v221, v221, v224
    v_sub_f32 v222, v222, v224
    v_sub_f32 v223, v223, v224
    v_cvt_pk_bf16_f32 v248, v208, v209
    v_cvt_pk_bf16_f32 v249, v210, v211
    v_cvt_pk_bf16_f32 v250, v212, v213
    v_cvt_pk_bf16_f32 v251, v214, v215
    v_cvt_pk_bf16_f32 v252, v216, v217
    v_cvt_pk_bf16_f32 v253, v218, v219
    v_cvt_pk_bf16_f32 v254, v220, v221
    v_cvt_pk_bf16_f32 v255, v222, v223
    v_lshlrev_b32 v208, 16, v248
    v_and_b32 v209, 0xffff0000, v248
    v_lshlrev_b32 v210, 16, v249
    v_and_b32 v211, 0xffff0000, v249
    v_lshlrev_b32 v212, 16, v250
    v_and_b32 v213, 0xffff0000, v250
    v_lshlrev_b32 v214, 16, v251
    v_and_b32 v215, 0xffff0000, v251
    v_lshlrev_b32 v216, 16, v252
    v_and_b32 v217, 0xffff0000, v252
    v_lshlrev_b32 v218, 16, v253
    v_and_b32 v219, 0xffff0000, v253
    v_lshlrev_b32 v220, 16, v254
    v_and_b32 v221, 0xffff0000, v254
    v_lshlrev_b32 v222, 16, v255
    v_and_b32 v223, 0xffff0000, v255
    v_mul_f32 v208, v208, v225
    v_mul_f32 v209, v209, v225
    v_mul_f32 v210, v210, v225
    v_mul_f32 v211, v211, v225
    v_mul_f32 v212, v212, v225
    v_mul_f32 v213, v213, v225
    v_mul_f32 v214, v214, v225
    v_mul_f32 v215, v215, v225
    v_mul_f32 v216, v216, v225
    v_mul_f32 v217, v217, v225
    v_mul_f32 v218, v218, v225
    v_mul_f32 v219, v219, v225
    v_mul_f32 v220, v220, v225
    v_mul_f32 v221, v221, v225
    v_mul_f32 v222, v222, v225
    v_mul_f32 v223, v223, v225
    v_cvt_pk_bf16_f32 v248, v208, v209
    v_cvt_pk_bf16_f32 v249, v210, v211
    v_cvt_pk_bf16_f32 v250, v212, v213
    v_cvt_pk_bf16_f32 v251, v214, v215
    v_cvt_pk_bf16_f32 v252, v216, v217
    v_cvt_pk_bf16_f32 v253, v218, v219
    v_cvt_pk_bf16_f32 v254, v220, v221
    v_cvt_pk_bf16_f32 v255, v222, v223
    v_lshlrev_b32 v228, 6, v1
    s_lshr_b32 s35, s34, 5
    s_lshl_b32 s35, s35, 16
    s_and_b32 s101, s34, 31
    s_lshl4_add_u32 s35, s101, s35
    buffer_store_dwordx4 v[248:251], v228, s[80:83], s35 offen sc1
    buffer_store_dwordx4 v[252:255], v228, s[80:83], s35 offen offset:512 sc1
    s_nop 1
    s_add_u32 s34, s34, 1
    s_sub_u32 s78, s78, 1
    s_cmp_lg_u32 s78, 0
    s_cbranch_scc1 L_rowl_93
    s_waitcnt vmcnt(0)
    s_lshl_b32 s79, s79, 2
    v_mov_b32 v16, s79
    v_mov_b32 v17, s95
    s_mov_b64 exec, 1
    buffer_store_dword v17, v16, s[88:91], 0 offen offset:1024 sc1
    s_mov_b64 exec, -1
    s_mov_b32 s78, 31
    s_branch L_spin_91
L_pollslow_4:
    s_mov_b32 s78, 0
L_spin_94:
    buffer_load_dwordx4 v[248:251], v1, s[88:91], 0 offen offset:1024 sc1
    s_waitcnt vmcnt(0)
    v_xor_b32 v248, s95, v248
    v_xor_b32 v249, s95, v249
    v_xor_b32 v250, s95, v250
    v_xor_b32 v251, s95, v251
    v_or3_b32 v252, v248, v249, v250
    v_or_b32 v252, v252, v251
    v_cmp_ne_u32 vcc, 0, v252
    s_cbranch_vccz L_pollback_5
    s_add_u32 s78, s78, 1
    s_cmp_ge_u32 s78, 32
    s_cbranch_scc1 L_help_95
    s_sleep 8
    s_branch L_spin_94
L_help_95:
    s_ff1_i32_b64 s35, vcc
    v_cmp_ne_u32 vcc, 0, v250
    s_nop 1
    v_cndmask_b32 v252, 3, 2, vcc
    v_cmp_ne_u32 vcc, 0, v249
    s_nop 1
    v_cndmask_b32 v252, v252, 1, vcc
    v_cmp_ne_u32 vcc, 0, v248
    s_nop 1
    v_cndmask_b32 v252, v252, 0, vcc
    s_nop 1
    v_readlane_b32 s79, v252, s35
    s_nop 3
    s_lshl2_add_u32 s79, s35, s79
    s_cmp_lt_i32 s35, 0
    s_cselect_b32 s79, -1, s79
    s_lshl_b32 s34, s79, 3
    s_mov_b32 s78, 8
L_rowl_96:
    s_lshl_b32 s35, s34, 11
    v_lshlrev_b32 v16, 1, v1
    buffer_load_dwordx4 v[248:251], v16, s[36:39], s35 offen
    buffer_load_dwordx4 v[252:255], v16, s[36:39], s35 offen offset:16
    s_waitcnt vmcnt(0)
    v_lshlrev_b32 v208, 16, v248
    v_and_b32 v209, 0xffff0000, v248
    v_lshlrev_b32 v210, 16, v249
    v_and_b32 v211, 0xffff0000, v249
    v_lshlrev_b32 v212, 16, v250
    v_and_b32 v213, 0xffff0000, v250
    v_lshlrev_b32 v214, 16, v251
    v_and_b32 v215, 0xffff0000, v251
    v_lshlrev_b32 v216, 16, v252
    v_and_b32 v217, 0xffff0000, v252
    v_lshlrev_b32 v218, 16, v253
    v_and_b32 v219, 0xffff0000, v253
    v_lshlrev_b32 v220, 16, v254
    v_and_b32 v221, 0xffff0000, v254
    v_lshlrev_b32 v222, 16, v255
    v_and_b32 v223, 0xffff0000, v255
    v_add_f32 v224, v208, v209
    v_add_f32 v226, v210, v211
    v_add_f32 v224, v224, v212
    v_add_f32 v226, v226, v213
    v_add_f32 v224, v224, v214
    v_add_f32 v226, v226, v215
    v_add_f32 v224, v224, v216
    v_add_f32 v226, v226, v217
    v_add_f32 v224, v224, v218
    v_add_f32 v226, v226, v219
    v_add_f32 v224, v224, v220
    v_add_f32 v226, v226, v221
    v_add_f32 v224, v224, v222
    v_add_f32 v226, v226, v223
    v_add_f32 v224, v224, v226
    s_nop 1
    v_add_f32_dpp v224, v224, v224 quad_perm:[1,0,3,2] row_mask:0xf bank_mask:0xf
    s_nop 1
    v_add_f32_dpp v224, v224, v224 quad_perm:[2,3,0,1] row_mask:0xf bank_mask:0xf
    s_nop 1
    v_add_f32_dpp v224, v224, v224 row_half_mirror row_mask:0xf bank_mask:0xf
    s_nop 1
    v_add_f32_dpp v224, v224, v224 row_mirror row_mask:0xf bank_mask:0xf
    v_mov_b32 v226, v224
    s_nop 1
    v_permlane16_swap_b32 v226, v224
    v_add_f32 v224, v224, v226
    v_mov_b32 v226, v224
    s_nop 1
    v_permlane32_swap_b32 v226, v224
    v_add_f32 v224, v224, v226
    v_mul_f32 v224, 0x3a800000, v224
    v_sub_f32 v227, v208, v224
    v_mul_f32 v225, v227, v227
    v_sub_f32 v227, v209, v224
    v_fmac_f32 v225, v227, v227
    v_sub_f32 v227, v210, v224
    v_fmac_f32 v225, v227, v227
    v_sub_f32 v227, v211, v224
    v_fmac_f32 v225, v227, v227
    v_sub_f32 v227, v212, v224
    v_fmac_f32 v225, v227, v227
    v_sub_f32 v227, v213, v224
    v_fmac_f32 v225, v227, v227
    v_sub_f32 v227, v214, v224
    v_fmac_f32 v225, v227, v227
    v_sub_f32 v227, v215, v224
    v_fmac_f32 v225, v227, v227
    v_sub_f32 v227, v216, v224
    v_fmac_f32 v225, v227, v227
    v_sub_f32 v227, v217, v224
    v_fmac_f32 v225, v227, v227
    v_sub_f32 v227, v218, v224
    v_fmac_f32 v225, v227, v227
    v_sub_f32 v227, v219, v224
    v_fmac_f32 v225, v227, v227
    v_sub_f32 v227, v220, v224
    v_fmac_f32 v225, v227, v227
    v_sub_f32 v227, v221, v224
    v_fmac_f32 v225, v227, v227
    v_sub_f32 v227, v222, v224
    v_fmac_f32 v225, v227, v227
    v_sub_f32 v227, v223, v224
    v_fmac_f32 v225, v227, v227
    s_nop 1
    v_add_f32_dpp v225, v225, v225 quad_perm:[1,0,3,2] row_mask:0xf bank_mask:0xf
    s_nop 1
    v_add_f32_dpp v225, v225, v225 quad_perm:[2,3,0,1] row_mask:0xf bank_mask:0xf
    s_nop 1
    v_add_f32_dpp v225, v225, v225 row_half_mirror row_mask:0xf bank_mask:0xf
    s_nop 1
    v_add_f32_dpp v225, v225, v225 row_mirror row_mask:0xf bank_mask:0xf
    v_mov_b32 v226, v225
    s_nop 1
    v_permlane16_swap_b32 v226, v225
    v_add_f32 v225, v225, v226
    v_mov_b32 v226, v225
    s_nop 1
    v_permlane32_swap_b32 v226, v225
    v_add_f32 v225, v225, v226
    v_mul_f32 v225, 0x3a800000, v225
    v_cvt_pk_bf16_f32 v224, v224, v224
    v_lshlrev_b32 v224, 16, v224
    v_cvt_pk_bf16_f32 v225, v225, v225
    v_lshlrev_b32 v225, 16, v225
    v_add_f32 v225, 0x3727c5ac, v225
    v_cvt_pk_bf16_f32 v225, v225, v225
    v_lshlrev_b32 v225, 16, v225
    v_sqrt_f32 v225, v225
    s_nop 0
    v_cvt_pk_bf16_f32 v225, v225, v225
    v_lshlrev_b32 v225, 16, v225
    v_rcp_f32 v225, v225
    v_sub_f32 v208, v208, v224
    v_sub_f32 v209, v209, v224
    v_sub_f32 v210, v210, v224
    v_sub_f32 v211, v211, v224
    v_sub_f32 v212, v212, v224
    v_sub_f32 v213, v213, v224
    v_sub_f32 v214, v214, v224
    v_sub_f32 v215, v215, v224
    v_sub_f32 v216, v216, v224
    v_sub_f32 v217, v217, v224
    v_sub_f32 v218, v218, v224
    v_sub_f32 v219, v219, v224
    v_sub_f32 v220, v220, v224
    v_sub_f32 v221, v221, v224
    v_sub_f32 v222, v222, v224
    v_sub_f32 v223, v223, v224
    v_cvt_pk_bf16_f32 v248, v208, v209
    v_cvt_pk_bf16_f32 v249, v210, v211
    v_cvt_pk_bf16_f32 v250, v212, v213
    v_cvt_pk_bf16_f32 v251, v214, v215
    v_cvt_pk_bf16_f32 v252, v216, v217
    v_cvt_pk_bf16_f32 v253, v218, v219
    v_cvt_pk_bf16_f32 v254, v220, v221
    v_cvt_pk_bf16_f32 v255, v222, v223
    v_lshlrev_b32 v208, 16, v248
    v_and_b32 v209, 0xffff0000, v248
    v_lshlrev_b32 v210, 16, v249
    v_and_b32 v211, 0xffff0000, v249
    v_lshlrev_b32 v212, 16, v250
    v_and_b32 v213, 0xffff0000, v250
    v_lshlrev_b32 v214, 16, v251
    v_and_b32 v215, 0xffff0000, v251
    v_lshlrev_b32 v216, 16, v252
    v_and_b32 v217, 0xffff0000, v252
    v_lshlrev_b32 v218, 16, v253
    v_and_b32 v219, 0xffff0000, v253
    v_lshlrev_b32 v220, 16, v254
    v_and_b32 v221, 0xffff0000, v254
    v_lshlrev_b32 v222, 16, v255
    v_and_b32 v223, 0xffff0000, v255
    v_mul_f32 v208, v208, v225
    v_mul_f32 v209, v209, v225
    v_mul_f32 v210, v210, v225
    v_mul_f32 v211, v211, v225
    v_mul_f32 v212, v212, v225
    v_mul_f32 v213, v213, v225
    v_mul_f32 v214, v214, v225
    v_mul_f32 v215, v215, v225
    v_mul_f32 v216, v216, v225
    v_mul_f32 v217, v217, v225
    v_mul_f32 v218, v218, v225
    v_mul_f32 v219, v219, v225
    v_mul_f32 v220, v220, v225
    v_mul_f32 v221, v221, v225
    v_mul_f32 v222, v222, v225
    v_mul_f32 v223, v223, v225
    v_cvt_pk_bf16_f32 v248, v208, v209
    v_cvt_pk_bf16_f32 v249, v210, v211
    v_cvt_pk_bf16_f32 v250, v212, v213
    v_cvt_pk_bf16_f32 v251, v214, v215
    v_cvt_pk_bf16_f32 v252, v216, v217
    v_cvt_pk_bf16_f32 v253, v218, v219
    v_cvt_pk_bf16_f32 v254, v220, v221
    v_cvt_pk_bf16_f32 v255, v222, v223
    v_lshlrev_b32 v228, 6, v1
    s_lshr_b32 s35, s34, 5
    s_lshl_b32 s35, s35, 16
    s_and_b32 s101, s34, 31
    s_lshl4_add_u32 s35, s101, s35
    buffer_store_dwordx4 v[248:251], v228, s[80:83], s35 offen sc1
    buffer_store_dwordx4 v[252:255], v228, s[80:83], s35 offen offset:512 sc1
    s_nop 1
    s_add_u32 s34, s34, 1
    s_sub_u32 s78, s78, 1
    s_cmp_lg_u32 s78, 0
    s_cbranch_scc1 L_rowl_96
    s_waitcnt vmcnt(0)
    s_lshl_b32 s79, s79, 2
    v_mov_b32 v16, s79
    v_mov_b32 v17, s95
    s_mov_b64 exec, 1
    buffer_store_dword v17, v16, s[88:91], 0 offen offset:1024 sc1
    s_mov_b64 exec, -1
    s_mov_b32 s78, 31
    s_branch L_spin_94
L_pslow_88:
    s_sleep 2
    buffer_load_dword v26, v27, s[52:55], 0 offen sc1
    s_waitcnt vmcnt(0)
    v_cmp_ne_u32 vcc, s95, v26
    s_cbranch_vccnz L_pslow_88
    s_branch L_pback_89
L_code_end:
    s_endpgm
.section .rodata,"a"
.p2align 6
.amdhsa_kernel mega_kernel
  .amdhsa_next_free_vgpr 256
  .amdhsa_next_free_sgpr 102
  .amdhsa_accum_offset 256
  .amdhsa_group_segment_fixed_size 0
  .amdhsa_kernarg_size 112
  .amdhsa_user_sgpr_count 2
  .amdhsa_user_sgpr_kernarg_segment_ptr 1
  .amdhsa_system_sgpr_workgroup_id_x 1
.end_amdhsa_kernel
```
